```python
import torch

def _softmax(x, axis=-1):
    return torch.softmax(x, dim=axis)

def _gelu(x):
    return torch.nn.functional.gelu(x, approximate='tanh')

def _silu(x):
    return torch.nn.functional.silu(x)

def _sigmoid(x):
    return torch.sigmoid(x)

def _layernorm(x, axis=-1, eps=1e-05):
    m = x.mean(dim=axis, keepdim=True)
    v = x.var(dim=axis, keepdim=True, unbiased=False)
    return (x - m) / torch.sqrt(v + eps)

def _scatter_add(tgt, idx, src, axis=0):
    return tgt.clone().index_add_(axis, idx, src)

def _segment_sum(src, seg, n):
    out = torch.zeros((n,) + src.shape[1:], dtype=src.dtype)
    return out.index_add_(0, seg, src)

def _pad(x, pw):
    flat = tuple((v for pair in reversed(pw) for v in pair))
    return torch.nn.functional.pad(x, flat)
kernel_name = 'adaLN_cond__spectral_gfnet__glu_gated_reglu__prompt'

def setup_inputs():

    _w = lambda a: (lambda t: t.to(torch.bfloat16) if t.is_floating_point() else t)(torch.as_tensor(a))

    def _A_setup():
        B, S, D = (1, 2048, 576)
        Df = D // 2 + 1
        return {'x': _w((lambda *s: torch.randn(*s, dtype=torch.bfloat16) * 0.05)(B, S, D)), 'w_r': _w((lambda *s: torch.randn(*s, dtype=torch.bfloat16) * 3.2)(S, Df) * 0.02), 'w_i': _w((lambda *s: torch.randn(*s, dtype=torch.bfloat16) * 3.2)(S, Df) * 0.02)}
    _A_in = _A_setup()

    def _B_setup():
        B, S, D, F = (1, 2048, 576, 4608)
        return {'x': _w((lambda *s: torch.randn(*s, dtype=torch.bfloat16) * 0.05)(B, S, D)), 'W_gate': _w((lambda *s: torch.randn(*s, dtype=torch.bfloat16) * 0.4)(D, F) * (2.0 / D) ** 0.5), 'W_up': _w((lambda *s: torch.randn(*s, dtype=torch.bfloat16) * 0.4)(D, F) * (2.0 / D) ** 0.5), 'W_down': _w((lambda *s: torch.randn(*s, dtype=torch.bfloat16) * 0.4)(F, D) * (1.0 / F) ** 0.5)}
    _B_in = _B_setup()
    return {'A_x': _A_in['x'], 'A_w_r': _A_in['w_r'], 'A_w_i': _A_in['w_i'], 'B_x': _B_in['x'], 'B_W_gate': _B_in['W_gate'], 'B_W_up': _B_in['W_up'], 'B_W_down': _B_in['W_down'], 'c': _w((lambda *s: torch.randn(*s, dtype=torch.bfloat16) * 0.1)(1, 576) * 8.0), 'w_mod': _w((lambda *s: torch.randn(*s, dtype=torch.bfloat16) * 0.1)(576, 6 * 576) * 576 ** (-0.5) * 8.0)}

def reference(A_x, A_w_r, A_w_i, B_x, B_W_gate, B_W_up, B_W_down, c, w_mod):

    def _A_ref(x, w_r, w_i):
        B, S, D = x.shape
        X = (lambda x, axes=(-2, -1): torch.fft.rfft2(x.float(), dim=axes))(x, axes=(-2, -1))
        W = w_r + 1j * w_i
        X = X * W
        y = (lambda x, s, axes=(-2, -1): torch.fft.irfft2(x, s=s, dim=axes).to(torch.bfloat16))(X, (S, D), axes=(-2, -1))
        return y

    def _B_ref(x, W_gate, W_up, W_down):
        gate = torch.einsum('bsd,df->bsf', x, W_gate)
        up = torch.einsum('bsd,df->bsf', x, W_up)
        gate = gate * (lambda x, dt: x.to(dt))(gate > 0, gate.dtype)
        h = gate * up
        return torch.einsum('bsf,fd->bsd', h, W_down)
    x = A_x
    mod = (_silu(c) @ w_mod).reshape(c.shape[0], 6, 1, -1)
    sa, ca, ga, sb, cb, gb = (mod[:, 0].clone(), mod[:, 1].clone(), mod[:, 2].clone(), mod[:, 3].clone(), mod[:, 4].clone(), mod[:, 5].clone())
    h = _layernorm(x, axis=-1) * (1 + ca) + sa
    x = x + ga * _A_ref(h, A_w_r, A_w_i)
    h = _layernorm(x, axis=-1) * (1 + cb) + sb
    x = x + gb * _B_ref(h, B_W_gate, B_W_up, B_W_down)
    return x
```

```asm
; @launch kernel=k0_kernel grid=(288,1,1) block=(256,1,1) lds=75136
; @launch kernel=k2_kernel grid=(256,1,1) block=(256,1,1) lds=45072
; @launch kernel=k4_kernel grid=(256,1,1) block=(256,1,1) lds=163840
.amdgcn_target "amdgcn-amd-amdhsa--gfx950"
.text
.p2align 12
.fill 832, 4, 0xbf800000
.globl k0_kernel
.p2align 8
.type k0_kernel,@function
k0_kernel:
    s_cmp_ge_u32 s2, 288
    s_cbranch_scc1 k0_kernel_end
    s_load_dwordx2 s[4:5], s[0:1], 0
    s_load_dwordx2 s[6:7], s[0:1], 88
    s_load_dwordx2 s[8:9], s[0:1], 8
    s_load_dwordx2 s[10:11], s[0:1], 16
    s_load_dwordx2 s[12:13], s[0:1], 56
    s_load_dwordx2 s[14:15], s[0:1], 64
    s_load_dwordx2 s[16:17], s[0:1], 80
    s_load_dwordx2 s[18:19], s[0:1], 32
    s_load_dwordx2 s[20:21], s[0:1], 40
    s_load_dwordx2 s[22:23], s[0:1], 48
    v_and_b32 v1, 63, v0
    v_lshlrev_b32 v2, 4, v1
    v_mov_b32 v3, 0
    v_lshrrev_b32 v4, 6, v0
    s_nop 0
    v_readfirstlane_b32 s24, v4
    s_cmp_lt_u32 s2, 32
    s_cbranch_scc1 k0_kernel_extra
    s_sub_u32 s2, s2, 32
    s_cmp_ge_u32 s2, 36
    s_cbranch_scc1 k0_kernel_nogemv
    s_mul_i32 s37, s2, 3641
    s_lshr_b32 s37, s37, 16
    s_mul_i32 s25, s37, 18
    s_sub_u32 s36, s2, s25
    s_waitcnt lgkmcnt(0)
    s_mov_b32 s40, s12
    s_mov_b32 s41, s13
    s_mov_b32 s42, 1152
    s_mov_b32 s43, 0x20000
    s_mov_b32 s44, s14
    s_mov_b32 s45, s15
    s_mov_b32 s46, 3981312
    s_mov_b32 s47, 0x20000
    v_lshrrev_b32 v12, 3, v1
    s_mul_i32 s48, s24, 72
    s_mul_i32 s49, s37, 288
    s_add_u32 s48, s48, s49
    v_add_u32 v12, s48, v12
    v_mul_u32_u24 v13, 6912, v12
    v_and_b32 v4, 7, v1
    v_lshl_add_u32 v13, v4, 4, v13
    v_lshlrev_b32 v12, 1, v12
    s_lshl_b32 s49, s36, 7
    buffer_load_ushort v14, v12, s[40:43], 0 offen offset:0
    buffer_load_ushort v15, v12, s[40:43], 0 offen offset:16
    buffer_load_ushort v16, v12, s[40:43], 0 offen offset:32
    buffer_load_ushort v17, v12, s[40:43], 0 offen offset:48
    buffer_load_ushort v18, v12, s[40:43], 0 offen offset:64
    buffer_load_ushort v19, v12, s[40:43], 0 offen offset:80
    buffer_load_ushort v20, v12, s[40:43], 0 offen offset:96
    buffer_load_ushort v21, v12, s[40:43], 0 offen offset:112
    buffer_load_ushort v22, v12, s[40:43], 0 offen offset:128
    buffer_load_dwordx4 v[24:27], v13, s[44:47], s49 offen
    s_add_u32 s49, s49, 55296
    buffer_load_dwordx4 v[28:31], v13, s[44:47], s49 offen
    s_add_u32 s49, s49, 55296
    buffer_load_dwordx4 v[32:35], v13, s[44:47], s49 offen
    s_add_u32 s49, s49, 55296
    buffer_load_dwordx4 v[36:39], v13, s[44:47], s49 offen
    s_add_u32 s49, s49, 55296
    buffer_load_dwordx4 v[40:43], v13, s[44:47], s49 offen
    s_add_u32 s49, s49, 55296
    buffer_load_dwordx4 v[44:47], v13, s[44:47], s49 offen
    s_add_u32 s49, s49, 55296
    buffer_load_dwordx4 v[48:51], v13, s[44:47], s49 offen
    s_add_u32 s49, s49, 55296
    buffer_load_dwordx4 v[52:55], v13, s[44:47], s49 offen
    s_add_u32 s49, s49, 55296
    buffer_load_dwordx4 v[56:59], v13, s[44:47], s49 offen
    s_mov_b32 s50, 0xffff0000
    s_mov_b32 s51, 0xbfb8aa3b
    v_mov_b32 v60, 0
    v_mov_b32 v61, 0
    v_mov_b32 v62, 0
    v_mov_b32 v63, 0
    v_mov_b32 v64, 0
    v_mov_b32 v65, 0
    v_mov_b32 v66, 0
    v_mov_b32 v67, 0
    v_and_b32 v4, 7, v1
    v_lshrrev_b32 v5, 3, v1
    v_lshl_add_u32 v4, v4, 3, v5
    s_mul_i32 s48, s24, 256
    v_lshl_add_u32 v72, v4, 2, s48
    v_and_b32 v4, 8, v1
    v_cmp_ne_u32 vcc, 0, v4
    s_waitcnt vmcnt(17)
    v_lshlrev_b32 v14, 16, v14
    s_waitcnt vmcnt(16)
    v_lshlrev_b32 v15, 16, v15
    s_waitcnt vmcnt(15)
    v_lshlrev_b32 v16, 16, v16
    s_waitcnt vmcnt(14)
    v_lshlrev_b32 v17, 16, v17
    s_waitcnt vmcnt(13)
    v_lshlrev_b32 v18, 16, v18
    s_waitcnt vmcnt(12)
    v_lshlrev_b32 v19, 16, v19
    s_waitcnt vmcnt(11)
    v_lshlrev_b32 v20, 16, v20
    s_waitcnt vmcnt(10)
    v_lshlrev_b32 v21, 16, v21
    s_waitcnt vmcnt(9)
    v_lshlrev_b32 v22, 16, v22
    v_mul_f32 v74, s51, v14
    v_mul_f32 v75, s51, v15
    v_mul_f32 v76, s51, v16
    v_mul_f32 v77, s51, v17
    v_mul_f32 v78, s51, v18
    v_mul_f32 v79, s51, v19
    v_mul_f32 v80, s51, v20
    v_mul_f32 v81, s51, v21
    v_mul_f32 v82, s51, v22
    v_exp_f32 v74, v74
    v_exp_f32 v75, v75
    v_exp_f32 v76, v76
    v_exp_f32 v77, v77
    v_exp_f32 v78, v78
    v_exp_f32 v79, v79
    v_exp_f32 v80, v80
    v_exp_f32 v81, v81
    v_exp_f32 v82, v82
    v_add_f32 v74, 1.0, v74
    v_add_f32 v75, 1.0, v75
    v_add_f32 v76, 1.0, v76
    v_add_f32 v77, 1.0, v77
    v_add_f32 v78, 1.0, v78
    v_add_f32 v79, 1.0, v79
    v_add_f32 v80, 1.0, v80
    v_add_f32 v81, 1.0, v81
    v_add_f32 v82, 1.0, v82
    v_rcp_f32 v74, v74
    v_rcp_f32 v75, v75
    v_rcp_f32 v76, v76
    v_rcp_f32 v77, v77
    v_rcp_f32 v78, v78
    v_rcp_f32 v79, v79
    v_rcp_f32 v80, v80
    v_rcp_f32 v81, v81
    v_rcp_f32 v82, v82
    v_mul_f32 v74, v74, v14
    v_mul_f32 v75, v75, v15
    v_mul_f32 v76, v76, v16
    v_mul_f32 v77, v77, v17
    v_mul_f32 v78, v78, v18
    v_mul_f32 v79, v79, v19
    v_mul_f32 v80, v80, v20
    v_mul_f32 v81, v81, v21
    v_mul_f32 v82, v82, v22
    v_cvt_pk_bf16_f32 v74, v74, v74
    v_cvt_pk_bf16_f32 v75, v75, v75
    v_cvt_pk_bf16_f32 v76, v76, v76
    v_cvt_pk_bf16_f32 v77, v77, v77
    v_cvt_pk_bf16_f32 v78, v78, v78
    v_cvt_pk_bf16_f32 v79, v79, v79
    v_cvt_pk_bf16_f32 v80, v80, v80
    v_cvt_pk_bf16_f32 v81, v81, v81
    v_cvt_pk_bf16_f32 v82, v82, v82
    v_and_b32 v84, s50, v74
    s_waitcnt vmcnt(8)
    v_lshlrev_b32 v68, 16, v24
    v_and_b32 v69, s50, v24
    v_pk_fma_f32 v[60:61], v[68:69], v[84:85], v[60:61] op_sel_hi:[1,0,1]
    v_lshlrev_b32 v70, 16, v25
    v_and_b32 v71, s50, v25
    v_pk_fma_f32 v[62:63], v[70:71], v[84:85], v[62:63] op_sel_hi:[1,0,1]
    v_lshlrev_b32 v68, 16, v26
    v_and_b32 v69, s50, v26
    v_pk_fma_f32 v[64:65], v[68:69], v[84:85], v[64:65] op_sel_hi:[1,0,1]
    v_lshlrev_b32 v70, 16, v27
    v_and_b32 v71, s50, v27
    v_pk_fma_f32 v[66:67], v[70:71], v[84:85], v[66:67] op_sel_hi:[1,0,1]
    v_and_b32 v84, s50, v75
    s_waitcnt vmcnt(7)
    v_lshlrev_b32 v68, 16, v28
    v_and_b32 v69, s50, v28
    v_pk_fma_f32 v[60:61], v[68:69], v[84:85], v[60:61] op_sel_hi:[1,0,1]
    v_lshlrev_b32 v70, 16, v29
    v_and_b32 v71, s50, v29
    v_pk_fma_f32 v[62:63], v[70:71], v[84:85], v[62:63] op_sel_hi:[1,0,1]
    v_lshlrev_b32 v68, 16, v30
    v_and_b32 v69, s50, v30
    v_pk_fma_f32 v[64:65], v[68:69], v[84:85], v[64:65] op_sel_hi:[1,0,1]
    v_lshlrev_b32 v70, 16, v31
    v_and_b32 v71, s50, v31
    v_pk_fma_f32 v[66:67], v[70:71], v[84:85], v[66:67] op_sel_hi:[1,0,1]
    v_and_b32 v84, s50, v76
    s_waitcnt vmcnt(6)
    v_lshlrev_b32 v68, 16, v32
    v_and_b32 v69, s50, v32
    v_pk_fma_f32 v[60:61], v[68:69], v[84:85], v[60:61] op_sel_hi:[1,0,1]
    v_lshlrev_b32 v70, 16, v33
    v_and_b32 v71, s50, v33
    v_pk_fma_f32 v[62:63], v[70:71], v[84:85], v[62:63] op_sel_hi:[1,0,1]
    v_lshlrev_b32 v68, 16, v34
    v_and_b32 v69, s50, v34
    v_pk_fma_f32 v[64:65], v[68:69], v[84:85], v[64:65] op_sel_hi:[1,0,1]
    v_lshlrev_b32 v70, 16, v35
    v_and_b32 v71, s50, v35
    v_pk_fma_f32 v[66:67], v[70:71], v[84:85], v[66:67] op_sel_hi:[1,0,1]
    v_and_b32 v84, s50, v77
    s_waitcnt vmcnt(5)
    v_lshlrev_b32 v68, 16, v36
    v_and_b32 v69, s50, v36
    v_pk_fma_f32 v[60:61], v[68:69], v[84:85], v[60:61] op_sel_hi:[1,0,1]
    v_lshlrev_b32 v70, 16, v37
    v_and_b32 v71, s50, v37
    v_pk_fma_f32 v[62:63], v[70:71], v[84:85], v[62:63] op_sel_hi:[1,0,1]
    v_lshlrev_b32 v68, 16, v38
    v_and_b32 v69, s50, v38
    v_pk_fma_f32 v[64:65], v[68:69], v[84:85], v[64:65] op_sel_hi:[1,0,1]
    v_lshlrev_b32 v70, 16, v39
    v_and_b32 v71, s50, v39
    v_pk_fma_f32 v[66:67], v[70:71], v[84:85], v[66:67] op_sel_hi:[1,0,1]
    v_and_b32 v84, s50, v78
    s_waitcnt vmcnt(4)
    v_lshlrev_b32 v68, 16, v40
    v_and_b32 v69, s50, v40
    v_pk_fma_f32 v[60:61], v[68:69], v[84:85], v[60:61] op_sel_hi:[1,0,1]
    v_lshlrev_b32 v70, 16, v41
    v_and_b32 v71, s50, v41
    v_pk_fma_f32 v[62:63], v[70:71], v[84:85], v[62:63] op_sel_hi:[1,0,1]
    v_lshlrev_b32 v68, 16, v42
    v_and_b32 v69, s50, v42
    v_pk_fma_f32 v[64:65], v[68:69], v[84:85], v[64:65] op_sel_hi:[1,0,1]
    v_lshlrev_b32 v70, 16, v43
    v_and_b32 v71, s50, v43
    v_pk_fma_f32 v[66:67], v[70:71], v[84:85], v[66:67] op_sel_hi:[1,0,1]
    v_and_b32 v84, s50, v79
    s_waitcnt vmcnt(3)
    v_lshlrev_b32 v68, 16, v44
    v_and_b32 v69, s50, v44
    v_pk_fma_f32 v[60:61], v[68:69], v[84:85], v[60:61] op_sel_hi:[1,0,1]
    v_lshlrev_b32 v70, 16, v45
    v_and_b32 v71, s50, v45
    v_pk_fma_f32 v[62:63], v[70:71], v[84:85], v[62:63] op_sel_hi:[1,0,1]
    v_lshlrev_b32 v68, 16, v46
    v_and_b32 v69, s50, v46
    v_pk_fma_f32 v[64:65], v[68:69], v[84:85], v[64:65] op_sel_hi:[1,0,1]
    v_lshlrev_b32 v70, 16, v47
    v_and_b32 v71, s50, v47
    v_pk_fma_f32 v[66:67], v[70:71], v[84:85], v[66:67] op_sel_hi:[1,0,1]
    v_and_b32 v84, s50, v80
    s_waitcnt vmcnt(2)
    v_lshlrev_b32 v68, 16, v48
    v_and_b32 v69, s50, v48
    v_pk_fma_f32 v[60:61], v[68:69], v[84:85], v[60:61] op_sel_hi:[1,0,1]
    v_lshlrev_b32 v70, 16, v49
    v_and_b32 v71, s50, v49
    v_pk_fma_f32 v[62:63], v[70:71], v[84:85], v[62:63] op_sel_hi:[1,0,1]
    v_lshlrev_b32 v68, 16, v50
    v_and_b32 v69, s50, v50
    v_pk_fma_f32 v[64:65], v[68:69], v[84:85], v[64:65] op_sel_hi:[1,0,1]
    v_lshlrev_b32 v70, 16, v51
    v_and_b32 v71, s50, v51
    v_pk_fma_f32 v[66:67], v[70:71], v[84:85], v[66:67] op_sel_hi:[1,0,1]
    v_and_b32 v84, s50, v81
    s_waitcnt vmcnt(1)
    v_lshlrev_b32 v68, 16, v52
    v_and_b32 v69, s50, v52
    v_pk_fma_f32 v[60:61], v[68:69], v[84:85], v[60:61] op_sel_hi:[1,0,1]
    v_lshlrev_b32 v70, 16, v53
    v_and_b32 v71, s50, v53
    v_pk_fma_f32 v[62:63], v[70:71], v[84:85], v[62:63] op_sel_hi:[1,0,1]
    v_lshlrev_b32 v68, 16, v54
    v_and_b32 v69, s50, v54
    v_pk_fma_f32 v[64:65], v[68:69], v[84:85], v[64:65] op_sel_hi:[1,0,1]
    v_lshlrev_b32 v70, 16, v55
    v_and_b32 v71, s50, v55
    v_pk_fma_f32 v[66:67], v[70:71], v[84:85], v[66:67] op_sel_hi:[1,0,1]
    v_and_b32 v84, s50, v82
    s_waitcnt vmcnt(0)
    v_lshlrev_b32 v68, 16, v56
    v_and_b32 v69, s50, v56
    v_pk_fma_f32 v[60:61], v[68:69], v[84:85], v[60:61] op_sel_hi:[1,0,1]
    v_lshlrev_b32 v70, 16, v57
    v_and_b32 v71, s50, v57
    v_pk_fma_f32 v[62:63], v[70:71], v[84:85], v[62:63] op_sel_hi:[1,0,1]
    v_lshlrev_b32 v68, 16, v58
    v_and_b32 v69, s50, v58
    v_pk_fma_f32 v[64:65], v[68:69], v[84:85], v[64:65] op_sel_hi:[1,0,1]
    v_lshlrev_b32 v70, 16, v59
    v_and_b32 v71, s50, v59
    v_pk_fma_f32 v[66:67], v[70:71], v[84:85], v[66:67] op_sel_hi:[1,0,1]
    v_permlane32_swap_b32 v60, v64
    v_permlane32_swap_b32 v61, v65
    v_permlane32_swap_b32 v62, v66
    v_permlane32_swap_b32 v63, v67
    v_add_f32 v60, v60, v64
    v_add_f32 v61, v61, v65
    v_add_f32 v62, v62, v66
    v_add_f32 v63, v63, v67
    s_nop 0
    v_permlane16_swap_b32 v60, v62
    v_permlane16_swap_b32 v61, v63
    v_add_f32 v60, v60, v62
    v_add_f32 v61, v61, v63
    s_nop 0
    v_add_f32_dpp v60, v60, v60 row_ror:8 row_mask:0xf bank_mask:0xf
    v_add_f32_dpp v61, v61, v61 row_ror:8 row_mask:0xf bank_mask:0xf
    v_cndmask_b32 v60, v60, v61, vcc
    ds_write_b32 v72, v60 offset:21504
    s_waitcnt lgkmcnt(0)
    s_barrier
    s_cmp_lg_u32 s24, 0
    s_cbranch_scc1 k0_kernel_gv_done
    v_lshlrev_b32 v4, 2, v1
    ds_read_b32 v24, v4 offset:21504
    ds_read_b32 v25, v4 offset:21760
    ds_read_b32 v26, v4 offset:22016
    ds_read_b32 v27, v4 offset:22272
    s_waitcnt lgkmcnt(2)
    v_add_f32 v24, v24, v25
    s_waitcnt lgkmcnt(0)
    v_add_f32 v26, v26, v27
    v_add_f32 v24, v24, v26
    s_add_u32 s28, s6, 327680
    s_addc_u32 s29, s7, 0
    s_mov_b32 s30, 9216
    s_mov_b32 s31, 0x20000
    s_mov_b32 s32, s16
    s_mov_b32 s33, s17
    s_mov_b32 s34, 256
    s_mov_b32 s35, 0x20000
    s_cmp_ge_u32 s36, 9
    s_cselect_b32 s25, 9, 0
    s_cselect_b32 s26, 8, 0
    s_sub_u32 s25, s36, s25
    s_lshl_b32 s25, s25, 9
    s_add_u32 s25, s25, s26
    s_mul_i32 s26, s37, 4608
    s_add_u32 s25, s25, s26
    v_lshrrev_b32 v5, 1, v1
    v_lshlrev_b32 v5, 4, v5
    v_and_b32 v6, 1, v1
    v_lshl_add_u32 v5, v6, 2, v5
    buffer_store_dword v24, v5, s[28:31], s25 offen sc1
    v_mov_b32 v5, 0
    v_mov_b32 v6, 1
    s_waitcnt vmcnt(0)
    s_mov_b64 exec, 1
    buffer_atomic_add v6, v5, s[32:35], 0 offen sc0 sc1
    s_waitcnt vmcnt(0)
    v_readfirstlane_b32 s25, v6
    s_nop 1
    s_cmp_eq_u32 s25, 35
    s_cselect_b32 s25, 128, 0x40000000
    v_mov_b32 v6, 1
    buffer_store_dword v6, v5, s[32:35], s25 offen sc1
    s_mov_b64 exec, -1
k0_kernel_gv_done:
k0_kernel_nogemv:
    s_getpc_b64 s[36:37]
k0_kernel_pc1:
    s_add_u32 s36, s36, tabs+0-k0_kernel_pc1
    s_addc_u32 s37, s37, 0
    s_mul_i32 s38, s24, 4096
    s_add_u32 s36, s36, s38
    s_addc_u32 s37, s37, 0
    s_add_u32 m0, s38, 0
    v_lshl_add_u64 v[12:13], v[2:3], 0, s[36:37]
    global_load_lds_dwordx4 v[12:13], off offset:0
    global_load_lds_dwordx4 v[12:13], off offset:1024
    global_load_lds_dwordx4 v[12:13], off offset:2048
    global_load_lds_dwordx4 v[12:13], off offset:3072
    s_and_b32 s39, s2, 3
    s_lshl_b32 s39, s39, 3
    s_bfe_u32 s25, s2, 0x30003
    s_add_u32 s39, s39, s25
    s_bfe_u32 s25, s2, 0x10002
    s_lshl_b32 s41, s25, 5
    s_lshl_b32 s40, s25, 12
    s_bfe_u32 s25, s2, 0x10007
    s_lshl_b32 s26, s25, 4
    s_add_u32 s41, s41, s26
    s_lshl_b32 s26, s25, 11
    s_add_u32 s40, s40, s26
    s_bfe_u32 s25, s2, 0x10006
    s_lshl_b32 s26, s25, 2
    s_add_u32 s41, s41, s26
    s_lshl_b32 s26, s25, 10
    s_add_u32 s40, s40, s26
    s_lshr_b32 s25, s24, 1
    s_lshl_b32 s25, s25, 3
    s_add_u32 s41, s41, s25
    s_and_b32 s25, s24, 1
    s_lshl_b32 s25, s25, 1
    s_add_u32 s41, s41, s25
    s_lshl_b32 s41, s41, 5
    s_add_u32 s41, s41, s39
    s_mul_i32 s41, s41, 1152
    v_and_b32 v4, 31, v1
    v_lshrrev_b32 v5, 5, v1
    v_mul_u32_u24 v14, 36864, v5
    v_lshl_add_u32 v14, v4, 2, v14
    v_lshlrev_b32 v16, 4, v0
    s_lshl_b32 s25, s24, 7
    s_add_u32 s25, s25, 4096
    v_add_u32 v17, s25, v2
    s_waitcnt lgkmcnt(0)
    s_mov_b32 s44, s4
    s_mov_b32 s45, s5
    s_mov_b32 s46, 2359296
    s_mov_b32 s47, 0x20000
    buffer_load_dword v18, v14, s[44:47], s41 offen offset:0
    buffer_load_dword v19, v14, s[44:47], s41 offen offset:128
    buffer_load_dword v20, v14, s[44:47], s41 offen offset:256
    buffer_load_dword v21, v14, s[44:47], s41 offen offset:384
    buffer_load_dword v22, v14, s[44:47], s41 offen offset:512
    buffer_load_dword v23, v14, s[44:47], s41 offen offset:640
    buffer_load_dword v24, v14, s[44:47], s41 offen offset:768
    buffer_load_dword v25, v14, s[44:47], s41 offen offset:896
    buffer_load_dword v26, v14, s[44:47], s41 offen offset:1024
    s_add_u32 s52, s6, 4194304
    s_addc_u32 s53, s7, 0
    s_mov_b32 s54, 2367488
    s_mov_b32 s55, 0x20000
    s_add_u32 s28, s6, 327680
    s_addc_u32 s29, s7, 0
    s_mov_b32 s30, 9216
    s_mov_b32 s31, 0x20000
    s_mov_b32 s32, s16
    s_mov_b32 s33, s17
    s_mov_b32 s34, 256
    s_mov_b32 s35, 0x20000
    s_lshl_b32 s26, s39, 5
    s_add_u32 s40, s40, s26
    s_mul_i32 s27, s24, 2336
    s_add_u32 s27, s27, 21504
    v_mul_u32_u24 v15, 1152, v5
    v_lshl_add_u32 v15, v4, 2, v15
    v_add_u32 v15, s27, v15
    v_lshlrev_b32 v89, 4, v4
    v_lshrrev_b32 v4, 4, v1
    v_bfe_u32 v5, v1, 2, 2
    v_lshl_add_u32 v4, v4, 3, v5
    v_add_u32 v4, 0, v4
    v_min_u32 v4, 17, v4
    v_lshlrev_b32 v4, 6, v4
    v_and_b32 v5, 3, v1
    v_lshl_add_u32 v4, v5, 3, v4
    v_add_u32 v78, s27, v4
    v_lshrrev_b32 v4, 4, v1
    v_bfe_u32 v5, v1, 2, 2
    v_lshl_add_u32 v4, v4, 3, v5
    v_add_u32 v4, 4, v4
    v_min_u32 v4, 17, v4
    v_lshlrev_b32 v4, 6, v4
    v_and_b32 v5, 3, v1
    v_lshl_add_u32 v4, v5, 3, v4
    v_add_u32 v79, s27, v4
    v_lshrrev_b32 v4, 4, v1
    v_mul_u32_u24 v4, 36, v4
    v_and_b32 v5, 15, v1
    v_add_u32 v4, v4, v5
    v_sub_u32 v5, 126, v4
    s_lshl_b32 s25, s24, 2
    s_add_u32 s25, s25, 30848
    v_mad_u32_u24 v80, v4, 48, s25
    v_mad_u32_u24 v81, v5, 48, s25
    v_lshrrev_b32 v4, 1, v0
    v_add_u32 v4, 0, v4
    v_and_b32 v5, 1, v0
    v_lshlrev_b32 v5, 4, v5
    v_lshl_add_u32 v86, v4, 13, v5
    v_min_u32 v4, 288, v4
    v_mad_u32_u24 v82, v4, 48, v5
    v_lshrrev_b32 v4, 1, v0
    v_add_u32 v4, 128, v4
    v_and_b32 v5, 1, v0
    v_lshlrev_b32 v5, 4, v5
    v_lshl_add_u32 v87, v4, 13, v5
    v_min_u32 v4, 288, v4
    v_mad_u32_u24 v83, v4, 48, v5
    v_lshrrev_b32 v4, 1, v0
    v_add_u32 v4, 256, v4
    v_and_b32 v5, 1, v0
    v_lshlrev_b32 v5, 4, v5
    v_lshl_add_u32 v88, v4, 13, v5
    v_min_u32 v4, 288, v4
    v_mad_u32_u24 v84, v4, 48, v5
    s_mov_b32 s56, 0xffff0000
    s_waitcnt vmcnt(8)
    v_lshlrev_b32 v90, 16, v18
    v_and_b32 v91, s56, v18
    s_waitcnt vmcnt(7)
    v_lshlrev_b32 v92, 16, v19
    v_and_b32 v93, s56, v19
    s_waitcnt vmcnt(6)
    v_lshlrev_b32 v94, 16, v20
    v_and_b32 v95, s56, v20
    s_waitcnt vmcnt(5)
    v_lshlrev_b32 v96, 16, v21
    v_and_b32 v97, s56, v21
    s_waitcnt vmcnt(4)
    v_lshlrev_b32 v98, 16, v22
    v_and_b32 v99, s56, v22
    s_waitcnt vmcnt(3)
    v_lshlrev_b32 v100, 16, v23
    v_and_b32 v101, s56, v23
    s_waitcnt vmcnt(2)
    v_lshlrev_b32 v102, 16, v24
    v_and_b32 v103, s56, v24
    s_waitcnt vmcnt(1)
    v_lshlrev_b32 v104, 16, v25
    v_and_b32 v105, s56, v25
    s_waitcnt vmcnt(0)
    v_lshlrev_b32 v106, 16, v26
    v_and_b32 v107, s56, v26
    v_mov_b32_dpp v108, v90 row_newbcast:0 row_mask:0xf bank_mask:0xf
    v_mov_b32 v109, v108
    s_nop 1
    v_permlane16_swap_b32 v108, v109
    v_pk_add_f32 v[90:91], v[90:91], v[108:109] op_sel_hi:[1,0] neg_lo:[0,1] neg_hi:[0,1]
    v_pk_add_f32 v[92:93], v[92:93], v[108:109] op_sel_hi:[1,0] neg_lo:[0,1] neg_hi:[0,1]
    v_pk_add_f32 v[94:95], v[94:95], v[108:109] op_sel_hi:[1,0] neg_lo:[0,1] neg_hi:[0,1]
    v_pk_add_f32 v[96:97], v[96:97], v[108:109] op_sel_hi:[1,0] neg_lo:[0,1] neg_hi:[0,1]
    v_pk_add_f32 v[98:99], v[98:99], v[108:109] op_sel_hi:[1,0] neg_lo:[0,1] neg_hi:[0,1]
    v_pk_add_f32 v[100:101], v[100:101], v[108:109] op_sel_hi:[1,0] neg_lo:[0,1] neg_hi:[0,1]
    v_pk_add_f32 v[102:103], v[102:103], v[108:109] op_sel_hi:[1,0] neg_lo:[0,1] neg_hi:[0,1]
    v_pk_add_f32 v[104:105], v[104:105], v[108:109] op_sel_hi:[1,0] neg_lo:[0,1] neg_hi:[0,1]
    v_pk_add_f32 v[106:107], v[106:107], v[108:109] op_sel_hi:[1,0] neg_lo:[0,1] neg_hi:[0,1]
    v_pk_add_f32 v[110:111], v[90:91], v[92:93]
    v_pk_mul_f32 v[112:113], v[90:91], v[90:91]
    v_pk_fma_f32 v[112:113], v[92:93], v[92:93], v[112:113]
    v_pk_add_f32 v[110:111], v[110:111], v[94:95]
    v_pk_fma_f32 v[112:113], v[94:95], v[94:95], v[112:113]
    v_pk_add_f32 v[110:111], v[110:111], v[96:97]
    v_pk_fma_f32 v[112:113], v[96:97], v[96:97], v[112:113]
    v_pk_add_f32 v[110:111], v[110:111], v[98:99]
    v_pk_fma_f32 v[112:113], v[98:99], v[98:99], v[112:113]
    v_pk_add_f32 v[110:111], v[110:111], v[100:101]
    v_pk_fma_f32 v[112:113], v[100:101], v[100:101], v[112:113]
    v_pk_add_f32 v[110:111], v[110:111], v[102:103]
    v_pk_fma_f32 v[112:113], v[102:103], v[102:103], v[112:113]
    v_pk_add_f32 v[110:111], v[110:111], v[104:105]
    v_pk_fma_f32 v[112:113], v[104:105], v[104:105], v[112:113]
    v_pk_add_f32 v[110:111], v[110:111], v[106:107]
    v_pk_fma_f32 v[112:113], v[106:107], v[106:107], v[112:113]
    v_add_f32 v110, v110, v111
    v_add_f32 v112, v112, v113
    s_nop 0
    v_add_f32_dpp v110, v110, v110 quad_perm:[1,0,3,2] row_mask:0xf bank_mask:0xf
    v_add_f32_dpp v112, v112, v112 quad_perm:[1,0,3,2] row_mask:0xf bank_mask:0xf
    s_nop 0
    v_add_f32_dpp v110, v110, v110 quad_perm:[2,3,0,1] row_mask:0xf bank_mask:0xf
    v_add_f32_dpp v112, v112, v112 quad_perm:[2,3,0,1] row_mask:0xf bank_mask:0xf
    s_nop 0
    v_add_f32_dpp v110, v110, v110 row_half_mirror row_mask:0xf bank_mask:0xf
    v_add_f32_dpp v112, v112, v112 row_half_mirror row_mask:0xf bank_mask:0xf
    s_nop 0
    v_add_f32_dpp v110, v110, v110 row_mirror row_mask:0xf bank_mask:0xf
    v_add_f32_dpp v112, v112, v112 row_mirror row_mask:0xf bank_mask:0xf
    v_mov_b32 v114, v110
    v_mov_b32 v115, v112
    s_nop 0
    v_permlane16_swap_b32 v110, v114
    v_permlane16_swap_b32 v112, v115
    v_add_f32 v110, v110, v114
    v_add_f32 v112, v112, v115
    v_mul_f32 v110, 0x3ae38e39, v110
    v_mul_f32 v112, 0x3ae38e39, v112
    v_fma_f32 v112, -v110, v110, v112
    v_max_f32 v112, 0, v112
    v_add_f32 v112, 0x3727c5ac, v112
    v_rsq_f32 v112, v112
    s_nop 0
    v_mul_f32 v110, v110, v112
    v_pk_fma_f32 v[90:91], v[90:91], v[112:113], v[110:111] op_sel_hi:[1,0,0] neg_lo:[0,0,1] neg_hi:[0,0,1]
    v_pk_fma_f32 v[92:93], v[92:93], v[112:113], v[110:111] op_sel_hi:[1,0,0] neg_lo:[0,0,1] neg_hi:[0,0,1]
    v_pk_fma_f32 v[94:95], v[94:95], v[112:113], v[110:111] op_sel_hi:[1,0,0] neg_lo:[0,0,1] neg_hi:[0,0,1]
    v_pk_fma_f32 v[96:97], v[96:97], v[112:113], v[110:111] op_sel_hi:[1,0,0] neg_lo:[0,0,1] neg_hi:[0,0,1]
    v_pk_fma_f32 v[98:99], v[98:99], v[112:113], v[110:111] op_sel_hi:[1,0,0] neg_lo:[0,0,1] neg_hi:[0,0,1]
    v_pk_fma_f32 v[100:101], v[100:101], v[112:113], v[110:111] op_sel_hi:[1,0,0] neg_lo:[0,0,1] neg_hi:[0,0,1]
    v_pk_fma_f32 v[102:103], v[102:103], v[112:113], v[110:111] op_sel_hi:[1,0,0] neg_lo:[0,0,1] neg_hi:[0,0,1]
    v_pk_fma_f32 v[104:105], v[104:105], v[112:113], v[110:111] op_sel_hi:[1,0,0] neg_lo:[0,0,1] neg_hi:[0,0,1]
    v_pk_fma_f32 v[106:107], v[106:107], v[112:113], v[110:111] op_sel_hi:[1,0,0] neg_lo:[0,0,1] neg_hi:[0,0,1]
    s_cmp_lg_u32 s24, 0
    s_cbranch_scc1 k0_kernel_go
    s_cmp_eq_u32 s2, 999
    s_cselect_b32 s26, 0, 128
    s_cselect_b32 s27, 36, 1
    s_mov_b32 s25, 0
k0_kernel_spin:
    buffer_load_dword v77, v3, s[32:35], s26 offen sc1
    s_add_u32 s25, s25, 1
    s_cmp_ge_u32 s25, 200000
    s_waitcnt vmcnt(0)
    s_cbranch_scc1 k0_kernel_seen
    v_cmp_gt_u32 vcc, s27, v77
    s_nop 1
    s_cbranch_vccz k0_kernel_seen
    s_sleep 2
    s_branch k0_kernel_spin
k0_kernel_seen:
    s_branch k0_kernel_go2
k0_kernel_go:
    s_waitcnt vmcnt(0)
k0_kernel_go2:
    s_barrier
    s_mov_b32 s25, 0
    buffer_load_dwordx4 v[28:31], v16, s[28:31], s25 offen sc1
    s_mov_b64 exec, 0xff
    buffer_load_dwordx4 v[52:55], v17, s[28:31], s25 offen sc1
    s_mov_b64 exec, -1
    s_add_u32 s25, s25, 4608
    buffer_load_dwordx4 v[32:35], v16, s[28:31], s25 offen sc1
    s_mov_b64 exec, 0xff
    buffer_load_dwordx4 v[56:59], v17, s[28:31], s25 offen sc1
    s_mov_b64 exec, -1
    s_getpc_b64 s[58:59]
k0_kernel_pc2:
    s_sub_u32 s58, s58, k0_kernel_pc2-k0_kernel
    s_subb_u32 s59, s59, 0
    s_lshr_b32 s60, s2, 3
    s_add_u32 s60, s60, 1
    s_cmp_eq_u32 s24, 3
    s_cselect_b32 s60, s60, 99
    s_lshl_b32 s60, s60, 13
    v_lshl_add_u32 v118, v1, 7, s60
    s_mov_b32 s61, tabs_end-k0_kernel-128
    v_min_u32 v118, s61, v118
    v_mov_b32 v119, 0
    v_lshl_add_u64 v[120:121], v[118:119], 0, s[58:59]
    global_load_dword v118, v[120:121], off
    ds_read_b128 v[124:127], v2 offset:0
    ds_read_b128 v[128:131], v2 offset:1024
    ds_read_b128 v[132:135], v2 offset:2048
    ds_read_b128 v[136:139], v2 offset:3072
    ds_read_b128 v[140:143], v2 offset:4096
    ds_read_b128 v[144:147], v2 offset:5120
    ds_read_b128 v[148:151], v2 offset:6144
    ds_read_b128 v[152:155], v2 offset:7168
    ds_read_b128 v[156:159], v2 offset:8192
    ds_read_b128 v[160:163], v2 offset:9216
    ds_read_b128 v[164:167], v2 offset:10240
    ds_read_b128 v[168:171], v2 offset:11264
    ds_read_b128 v[172:175], v2 offset:12288
    ds_read_b128 v[176:179], v2 offset:13312
    s_waitcnt vmcnt(2)
    v_pk_add_f32 v[28:29], v[28:29], v[32:33]
    v_pk_add_f32 v[30:31], v[30:31], v[34:35]
    v_cvt_pk_bf16_f32 v32, v28, v29
    v_cvt_pk_bf16_f32 v33, v30, v31
    v_lshlrev_b32 v28, 16, v32
    v_and_b32 v29, s56, v32
    v_lshlrev_b32 v30, 16, v33
    v_and_b32 v31, s56, v33
    v_add_f32 v30, 1.0, v30
    v_add_f32 v31, 1.0, v31
    v_cvt_pk_bf16_f32 v33, v30, v31
    v_lshlrev_b32 v30, 16, v33
    v_and_b32 v31, s56, v33
    ds_write_b128 v16, v[28:31] offset:16384
    s_waitcnt vmcnt(1)
    v_pk_add_f32 v[52:53], v[52:53], v[56:57]
    v_pk_add_f32 v[54:55], v[54:55], v[58:59]
    v_cvt_pk_bf16_f32 v56, v52, v53
    v_cvt_pk_bf16_f32 v57, v54, v55
    v_lshlrev_b32 v52, 16, v56
    v_and_b32 v53, s56, v56
    v_lshlrev_b32 v54, 16, v57
    v_and_b32 v55, s56, v57
    v_add_f32 v54, 1.0, v54
    v_add_f32 v55, 1.0, v55
    v_cvt_pk_bf16_f32 v57, v54, v55
    v_lshlrev_b32 v54, 16, v57
    v_and_b32 v55, s56, v57
    s_mov_b64 exec, 0xff
    ds_write_b128 v17, v[52:55] offset:16384
    s_mov_b64 exec, -1
    s_waitcnt lgkmcnt(0)
    s_barrier
    ds_read_b128 v[28:31], v89 offset:16384
    ds_read_b128 v[32:35], v89 offset:16896
    ds_read_b128 v[36:39], v89 offset:17408
    ds_read_b128 v[40:43], v89 offset:17920
    ds_read_b128 v[44:47], v89 offset:18432
    ds_read_b128 v[48:51], v89 offset:18944
    ds_read_b128 v[52:55], v89 offset:19456
    ds_read_b128 v[56:59], v89 offset:19968
    ds_read_b128 v[60:63], v89 offset:20480
    s_waitcnt lgkmcnt(8)
    v_pk_fma_f32 v[90:91], v[90:91], v[30:31], v[28:29]
    v_cvt_pk_bf16_f32 v18, v90, v91
    s_waitcnt lgkmcnt(7)
    v_pk_fma_f32 v[92:93], v[92:93], v[34:35], v[32:33]
    v_cvt_pk_bf16_f32 v19, v92, v93
    s_waitcnt lgkmcnt(6)
    v_pk_fma_f32 v[94:95], v[94:95], v[38:39], v[36:37]
    v_cvt_pk_bf16_f32 v20, v94, v95
    s_waitcnt lgkmcnt(5)
    v_pk_fma_f32 v[96:97], v[96:97], v[42:43], v[40:41]
    v_cvt_pk_bf16_f32 v21, v96, v97
    s_waitcnt lgkmcnt(4)
    v_pk_fma_f32 v[98:99], v[98:99], v[46:47], v[44:45]
    v_cvt_pk_bf16_f32 v22, v98, v99
    s_waitcnt lgkmcnt(3)
    v_pk_fma_f32 v[100:101], v[100:101], v[50:51], v[48:49]
    v_cvt_pk_bf16_f32 v23, v100, v101
    s_waitcnt lgkmcnt(2)
    v_pk_fma_f32 v[102:103], v[102:103], v[54:55], v[52:53]
    v_cvt_pk_bf16_f32 v24, v102, v103
    s_waitcnt lgkmcnt(1)
    v_pk_fma_f32 v[104:105], v[104:105], v[58:59], v[56:57]
    v_cvt_pk_bf16_f32 v25, v104, v105
    s_waitcnt lgkmcnt(0)
    v_pk_fma_f32 v[106:107], v[106:107], v[62:63], v[60:61]
    v_cvt_pk_bf16_f32 v26, v106, v107
    ds_write_b32 v15, v18 offset:0
    ds_write_b32 v15, v19 offset:128
    ds_write_b32 v15, v20 offset:256
    ds_write_b32 v15, v21 offset:384
    ds_write_b32 v15, v22 offset:512
    ds_write_b32 v15, v23 offset:640
    ds_write_b32 v15, v24 offset:768
    ds_write_b32 v15, v25 offset:896
    ds_write_b32 v15, v26 offset:1024
    ds_read_b64_tr_b16 v[28:29], v78 offset:0
    ds_read_b64_tr_b16 v[30:31], v79 offset:0
    ds_read_b64_tr_b16 v[32:33], v78 offset:32
    ds_read_b64_tr_b16 v[34:35], v79 offset:32
    ds_read_b64_tr_b16 v[36:37], v78 offset:1152
    ds_read_b64_tr_b16 v[38:39], v79 offset:1152
    ds_read_b64_tr_b16 v[40:41], v78 offset:1184
    ds_read_b64_tr_b16 v[42:43], v79 offset:1184
    s_waitcnt lgkmcnt(6)
    v_mfma_f32_16x16x32_bf16 v[180:183], v[28:31], v[124:127], 0
    v_mfma_f32_16x16x32_bf16 v[184:187], v[28:31], v[128:131], 0
    s_waitcnt lgkmcnt(4)
    v_mfma_f32_16x16x32_bf16 v[188:191], v[32:35], v[124:127], 0
    v_mfma_f32_16x16x32_bf16 v[192:195], v[32:35], v[128:131], 0
    s_waitcnt lgkmcnt(2)
    v_mfma_f32_16x16x32_bf16 v[196:199], v[36:39], v[124:127], 0
    v_mfma_f32_16x16x32_bf16 v[200:203], v[36:39], v[128:131], 0
    s_waitcnt lgkmcnt(0)
    v_mfma_f32_16x16x32_bf16 v[204:207], v[40:43], v[124:127], 0
    v_mfma_f32_16x16x32_bf16 v[208:211], v[40:43], v[128:131], 0
    v_pk_mul_f32 v[90:91], v[180:181], v[132:133]
    v_pk_mul_f32 v[94:95], v[184:185], v[132:133]
    v_pk_mul_f32 v[92:93], v[182:183], v[134:135]
    v_pk_mul_f32 v[96:97], v[186:187], v[134:135]
    v_pk_fma_f32 v[90:91], v[184:185], v[136:137], v[90:91]
    v_pk_fma_f32 v[94:95], v[180:181], v[136:137], v[94:95] neg_lo:[1,0,0] neg_hi:[1,0,0]
    v_pk_fma_f32 v[92:93], v[186:187], v[138:139], v[92:93]
    v_pk_fma_f32 v[96:97], v[182:183], v[138:139], v[96:97] neg_lo:[1,0,0] neg_hi:[1,0,0]
    v_cvt_pk_bf16_f32 v44, v90, v91
    v_cvt_pk_bf16_f32 v48, v94, v95
    v_cvt_pk_bf16_f32 v45, v92, v93
    v_cvt_pk_bf16_f32 v49, v96, v97
    v_pk_mul_f32 v[90:91], v[188:189], v[140:141]
    v_pk_mul_f32 v[94:95], v[192:193], v[140:141]
    v_pk_mul_f32 v[92:93], v[190:191], v[142:143]
    v_pk_mul_f32 v[96:97], v[194:195], v[142:143]
    v_pk_fma_f32 v[90:91], v[192:193], v[144:145], v[90:91]
    v_pk_fma_f32 v[94:95], v[188:189], v[144:145], v[94:95] neg_lo:[1,0,0] neg_hi:[1,0,0]
    v_pk_fma_f32 v[92:93], v[194:195], v[146:147], v[92:93]
    v_pk_fma_f32 v[96:97], v[190:191], v[146:147], v[96:97] neg_lo:[1,0,0] neg_hi:[1,0,0]
    v_cvt_pk_bf16_f32 v46, v90, v91
    v_cvt_pk_bf16_f32 v50, v94, v95
    v_cvt_pk_bf16_f32 v47, v92, v93
    v_cvt_pk_bf16_f32 v51, v96, v97
    v_pk_mul_f32 v[90:91], v[196:197], v[132:133]
    v_pk_mul_f32 v[94:95], v[200:201], v[132:133]
    v_pk_mul_f32 v[92:93], v[198:199], v[134:135]
    v_pk_mul_f32 v[96:97], v[202:203], v[134:135]
    v_pk_fma_f32 v[90:91], v[200:201], v[136:137], v[90:91]
    v_pk_fma_f32 v[94:95], v[196:197], v[136:137], v[94:95] neg_lo:[1,0,0] neg_hi:[1,0,0]
    v_pk_fma_f32 v[92:93], v[202:203], v[138:139], v[92:93]
    v_pk_fma_f32 v[96:97], v[198:199], v[138:139], v[96:97] neg_lo:[1,0,0] neg_hi:[1,0,0]
    v_cvt_pk_bf16_f32 v52, v90, v91
    v_cvt_pk_bf16_f32 v56, v94, v95
    v_cvt_pk_bf16_f32 v53, v92, v93
    v_cvt_pk_bf16_f32 v57, v96, v97
    v_pk_mul_f32 v[90:91], v[204:205], v[140:141]
    v_pk_mul_f32 v[94:95], v[208:209], v[140:141]
    v_pk_mul_f32 v[92:93], v[206:207], v[142:143]
    v_pk_mul_f32 v[96:97], v[210:211], v[142:143]
    v_pk_fma_f32 v[90:91], v[208:209], v[144:145], v[90:91]
    v_pk_fma_f32 v[94:95], v[204:205], v[144:145], v[94:95] neg_lo:[1,0,0] neg_hi:[1,0,0]
    v_pk_fma_f32 v[92:93], v[210:211], v[146:147], v[92:93]
    v_pk_fma_f32 v[96:97], v[206:207], v[146:147], v[96:97] neg_lo:[1,0,0] neg_hi:[1,0,0]
    v_cvt_pk_bf16_f32 v54, v90, v91
    v_cvt_pk_bf16_f32 v58, v94, v95
    v_cvt_pk_bf16_f32 v55, v92, v93
    v_cvt_pk_bf16_f32 v59, v96, v97
    s_mov_b32 s48, 0x03ff03ff
    s_mov_b32 s49, 0x03ff03ff
    v_mfma_f32_16x16x32_bf16 v[212:215], v[148:151], v[44:47], 0
    v_mfma_f32_16x16x32_bf16 v[228:231], v[148:151], v[52:55], 0
    v_mfma_f32_16x16x32_bf16 v[212:215], v[152:155], v[48:51], v[212:215]
    v_mfma_f32_16x16x32_bf16 v[228:231], v[152:155], v[56:59], v[228:231]
    v_mfma_f32_16x16x32_bf16 v[216:219], v[156:159], v[44:47], 0
    v_mfma_f32_16x16x32_bf16 v[232:235], v[156:159], v[52:55], 0
    v_mfma_f32_16x16x32_bf16 v[216:219], v[160:163], v[48:51], v[216:219]
    v_mfma_f32_16x16x32_bf16 v[232:235], v[160:163], v[56:59], v[232:235]
    v_mfma_f32_16x16x32_bf16 v[220:223], v[164:167], v[44:47], 0
    v_mfma_f32_16x16x32_bf16 v[236:239], v[164:167], v[52:55], 0
    v_mfma_f32_16x16x32_bf16 v[220:223], v[168:171], v[48:51], v[220:223]
    v_mfma_f32_16x16x32_bf16 v[236:239], v[168:171], v[56:59], v[236:239]
    v_mfma_f32_16x16x32_bf16 v[224:227], v[172:175], v[44:47], 0
    v_mfma_f32_16x16x32_bf16 v[240:243], v[172:175], v[52:55], 0
    v_mfma_f32_16x16x32_bf16 v[224:227], v[176:179], v[48:51], v[224:227]
    v_mfma_f32_16x16x32_bf16 v[240:243], v[176:179], v[56:59], v[240:243]
    s_mov_b64 exec, s[48:49]
    v_cvt_pk_bf16_f32 v180, v212, v228
    v_cvt_pk_bf16_f32 v181, v213, v229
    v_cvt_pk_bf16_f32 v182, v214, v230
    v_cvt_pk_bf16_f32 v183, v215, v231
    ds_write_b32 v80, v180 offset:0
    ds_write_b32 v80, v181 offset:16
    ds_write_b32 v80, v182 offset:864
    ds_write_b32 v80, v183 offset:880
    v_cvt_pk_bf16_f32 v184, v216, v232
    v_cvt_pk_bf16_f32 v185, v217, v233
    v_cvt_pk_bf16_f32 v186, v218, v234
    v_cvt_pk_bf16_f32 v187, v219, v235
    ds_write_b32 v80, v184 offset:6912
    ds_write_b32 v80, v185 offset:6928
    ds_write_b32 v80, v186 offset:7776
    ds_write_b32 v80, v187 offset:7792
    v_cvt_pk_bf16_f32 v188, v220, v236
    v_cvt_pk_bf16_f32 v189, v221, v237
    v_cvt_pk_bf16_f32 v190, v222, v238
    v_cvt_pk_bf16_f32 v191, v223, v239
    ds_write_b32 v81, v188 offset:7776
    ds_write_b32 v81, v189 offset:7792
    ds_write_b32 v81, v190 offset:6912
    ds_write_b32 v81, v191 offset:6928
    v_cvt_pk_bf16_f32 v192, v224, v240
    v_cvt_pk_bf16_f32 v193, v225, v241
    v_cvt_pk_bf16_f32 v194, v226, v242
    v_cvt_pk_bf16_f32 v195, v227, v243
    ds_write_b32 v81, v192 offset:864
    ds_write_b32 v81, v193 offset:880
    ds_write_b32 v81, v194 offset:0
    ds_write_b32 v81, v195 offset:16
    s_mov_b64 exec, -1
    s_waitcnt lgkmcnt(0)
    s_barrier
    ds_read_b128 v[212:215], v82 offset:30848
    ds_read_b128 v[216:219], v83 offset:30848
    ds_read_b128 v[220:223], v84 offset:30848
    s_waitcnt lgkmcnt(2)
    buffer_store_dwordx4 v[212:215], v86, s[52:55], s40 offen
    s_waitcnt lgkmcnt(1)
    buffer_store_dwordx4 v[216:219], v87, s[52:55], s40 offen
    s_waitcnt lgkmcnt(0)
    buffer_store_dwordx4 v[220:223], v88, s[52:55], s40 offen
    s_endpgm
.p2align 12
k0_kernel_al1:
k0_kernel_extra:
    s_getpc_b64 s[28:29]
k0_kernel_pc3:
    s_sub_u32 s28, s28, k0_kernel_pc3-k0_kernel
    s_subb_u32 s29, s29, 0
    s_lshr_b32 s30, s2, 3
    s_add_u32 s30, s30, 0
    s_cmp_eq_u32 s24, 3
    s_cselect_b32 s30, s30, 99
    s_cmp_eq_u32 s30, 0
    s_cselect_b32 s30, 0, 99
    s_lshl_b32 s30, s30, 13
    v_lshl_add_u32 v12, v1, 7, s30
    s_mov_b32 s31, tabs_end-k0_kernel-128
    v_min_u32 v12, s31, v12
    v_mov_b32 v13, 0
    v_lshl_add_u64 v[14:15], v[12:13], 0, s[28:29]
    global_load_dword v12, v[14:15], off
    s_waitcnt lgkmcnt(0)
    s_mov_b32 s36, s8
    s_mov_b32 s37, s9
    s_mov_b32 s38, 1183744
    s_mov_b32 s39, 0x20000
    s_mov_b32 s40, s10
    s_mov_b32 s41, s11
    s_mov_b32 s42, 1183744
    s_mov_b32 s43, 0x20000
    s_add_u32 s44, s6, 1048576
    s_addc_u32 s45, s7, 0
    s_mov_b32 s46, 2367488
    s_mov_b32 s47, 0x20000
    s_and_b32 s32, s2, 3
    s_lshr_b32 s33, s2, 2
    s_lshl_b32 s33, s33, 4
    s_add_u32 s32, s32, s33
    s_lshl_b32 s33, s24, 2
    s_add_u32 s32, s32, s33
    s_mul_i32 s32, s32, 9248
    s_mul_i32 s33, s24, 9264
    v_lshlrev_b32 v4, 4, v1
    s_add_u32 m0, s33, 0
    s_add_u32 s34, s32, 0
    buffer_load_dwordx4 v4, s[36:39], s34 offen offset:0 lds
    buffer_load_dwordx4 v4, s[36:39], s34 offen offset:1024 lds
    buffer_load_dwordx4 v4, s[36:39], s34 offen offset:2048 lds
    buffer_load_dwordx4 v4, s[36:39], s34 offen offset:3072 lds
    s_add_u32 m0, s33, 4096
    s_add_u32 s34, s32, 4096
    buffer_load_dwordx4 v4, s[36:39], s34 offen offset:0 lds
    buffer_load_dwordx4 v4, s[36:39], s34 offen offset:1024 lds
    buffer_load_dwordx4 v4, s[36:39], s34 offen offset:2048 lds
    buffer_load_dwordx4 v4, s[36:39], s34 offen offset:3072 lds
    s_add_u32 m0, s33, 8192
    s_add_u32 s34, s32, 8192
    buffer_load_dwordx4 v4, s[36:39], s34 offen offset:0 lds
    s_mov_b64 exec, 3
    buffer_load_dwordx4 v4, s[36:39], s34 offen offset:1024 lds
    s_mov_b64 exec, -1
    s_add_u32 m0, s33, 37056
    s_add_u32 s34, s32, 0
    buffer_load_dwordx4 v4, s[40:43], s34 offen offset:0 lds
    buffer_load_dwordx4 v4, s[40:43], s34 offen offset:1024 lds
    buffer_load_dwordx4 v4, s[40:43], s34 offen offset:2048 lds
    buffer_load_dwordx4 v4, s[40:43], s34 offen offset:3072 lds
    s_add_u32 m0, s33, 41152
    s_add_u32 s34, s32, 4096
    buffer_load_dwordx4 v4, s[40:43], s34 offen offset:0 lds
    buffer_load_dwordx4 v4, s[40:43], s34 offen offset:1024 lds
    buffer_load_dwordx4 v4, s[40:43], s34 offen offset:2048 lds
    buffer_load_dwordx4 v4, s[40:43], s34 offen offset:3072 lds
    s_add_u32 m0, s33, 45248
    s_add_u32 s34, s32, 8192
    buffer_load_dwordx4 v4, s[40:43], s34 offen offset:0 lds
    s_mov_b64 exec, 3
    buffer_load_dwordx4 v4, s[40:43], s34 offen offset:1024 lds
    s_mov_b64 exec, -1
    s_lshr_b32 s32, s2, 3
    s_lshl_b32 s34, s32, 10
    s_bfe_u32 s32, s2, 0x10002
    s_lshl_b32 s32, s32, 9
    s_add_u32 s34, s34, s32
    s_and_b32 s32, s2, 3
    s_lshl_b32 s32, s32, 7
    s_add_u32 s34, s34, s32
    v_and_b32 v5, 7, v0
    v_bfe_u32 v6, v0, 3, 1
    v_lshrrev_b32 v7, 4, v0
    v_lshl_add_u32 v16, v5, 1, v6
    v_mul_u32_u24 v16, 578, v16
    v_lshl_add_u32 v16, v7, 1, v16
    v_lshlrev_b32 v17, 4, v5
    v_lshl_add_u32 v17, v6, 12, v17
    v_lshl_add_u32 v17, v7, 13, v17
    s_mov_b32 s50, 0xffff0000
    s_waitcnt vmcnt(0)
    s_barrier
    ds_read_u16 v20, v16 offset:0
    ds_read_u16 v36, v16 offset:37056
    ds_read_u16 v21, v16 offset:9264
    ds_read_u16 v37, v16 offset:46320
    ds_read_u16 v22, v16 offset:18528
    ds_read_u16 v38, v16 offset:55584
    ds_read_u16 v23, v16 offset:27792
    ds_read_u16 v39, v16 offset:64848
    ds_read_u16 v24, v16 offset:32
    ds_read_u16 v40, v16 offset:37088
    ds_read_u16 v25, v16 offset:9296
    ds_read_u16 v41, v16 offset:46352
    ds_read_u16 v26, v16 offset:18560
    ds_read_u16 v42, v16 offset:55616
    ds_read_u16 v27, v16 offset:27824
    ds_read_u16 v43, v16 offset:64880
    s_waitcnt lgkmcnt(14)
    v_lshl_or_b32 v20, v36, 16, v20
    s_waitcnt lgkmcnt(12)
    v_lshl_or_b32 v21, v37, 16, v21
    s_waitcnt lgkmcnt(10)
    v_lshl_or_b32 v22, v38, 16, v22
    s_waitcnt lgkmcnt(8)
    v_lshl_or_b32 v23, v39, 16, v23
    v_cmp_gt_u32 vcc, 16, v0
    s_nop 1
    s_and_saveexec_b64 s[48:49], vcc
    s_cbranch_execz k0_kernel_nohalf0
    v_lshlrev_b32 v52, 16, v20
    v_and_b32 v53, s50, v20
    v_mul_f32 v52, 0.5, v52
    v_mul_f32 v53, 0.5, v53
    v_cvt_pk_bf16_f32 v20, v52, v53
    v_lshlrev_b32 v52, 16, v21
    v_and_b32 v53, s50, v21
    v_mul_f32 v52, 0.5, v52
    v_mul_f32 v53, 0.5, v53
    v_cvt_pk_bf16_f32 v21, v52, v53
    v_lshlrev_b32 v52, 16, v22
    v_and_b32 v53, s50, v22
    v_mul_f32 v52, 0.5, v52
    v_mul_f32 v53, 0.5, v53
    v_cvt_pk_bf16_f32 v22, v52, v53
    v_lshlrev_b32 v52, 16, v23
    v_and_b32 v53, s50, v23
    v_mul_f32 v52, 0.5, v52
    v_mul_f32 v53, 0.5, v53
    v_cvt_pk_bf16_f32 v23, v52, v53
k0_kernel_nohalf0:
    s_mov_b64 exec, s[48:49]
    buffer_store_dwordx4 v[20:23], v17, s[44:47], s34 offen sc1
    s_add_u32 s34, s34, 131072
    ds_read_u16 v28, v16 offset:64
    ds_read_u16 v44, v16 offset:37120
    ds_read_u16 v29, v16 offset:9328
    ds_read_u16 v45, v16 offset:46384
    ds_read_u16 v30, v16 offset:18592
    ds_read_u16 v46, v16 offset:55648
    ds_read_u16 v31, v16 offset:27856
    ds_read_u16 v47, v16 offset:64912
    s_waitcnt lgkmcnt(14)
    v_lshl_or_b32 v24, v40, 16, v24
    s_waitcnt lgkmcnt(12)
    v_lshl_or_b32 v25, v41, 16, v25
    s_waitcnt lgkmcnt(10)
    v_lshl_or_b32 v26, v42, 16, v26
    s_waitcnt lgkmcnt(8)
    v_lshl_or_b32 v27, v43, 16, v27
    buffer_store_dwordx4 v[24:27], v17, s[44:47], s34 offen sc1
    s_add_u32 s34, s34, 131072
    ds_read_u16 v32, v16 offset:96
    ds_read_u16 v48, v16 offset:37152
    ds_read_u16 v33, v16 offset:9360
    ds_read_u16 v49, v16 offset:46416
    ds_read_u16 v34, v16 offset:18624
    ds_read_u16 v50, v16 offset:55680
    ds_read_u16 v35, v16 offset:27888
    ds_read_u16 v51, v16 offset:64944
    s_waitcnt lgkmcnt(14)
    v_lshl_or_b32 v28, v44, 16, v28
    s_waitcnt lgkmcnt(12)
    v_lshl_or_b32 v29, v45, 16, v29
    s_waitcnt lgkmcnt(10)
    v_lshl_or_b32 v30, v46, 16, v30
    s_waitcnt lgkmcnt(8)
    v_lshl_or_b32 v31, v47, 16, v31
    buffer_store_dwordx4 v[28:31], v17, s[44:47], s34 offen sc1
    s_add_u32 s34, s34, 131072
    ds_read_u16 v20, v16 offset:128
    ds_read_u16 v36, v16 offset:37184
    ds_read_u16 v21, v16 offset:9392
    ds_read_u16 v37, v16 offset:46448
    ds_read_u16 v22, v16 offset:18656
    ds_read_u16 v38, v16 offset:55712
    ds_read_u16 v23, v16 offset:27920
    ds_read_u16 v39, v16 offset:64976
    s_waitcnt lgkmcnt(14)
    v_lshl_or_b32 v32, v48, 16, v32
    s_waitcnt lgkmcnt(12)
    v_lshl_or_b32 v33, v49, 16, v33
    s_waitcnt lgkmcnt(10)
    v_lshl_or_b32 v34, v50, 16, v34
    s_waitcnt lgkmcnt(8)
    v_lshl_or_b32 v35, v51, 16, v35
    buffer_store_dwordx4 v[32:35], v17, s[44:47], s34 offen sc1
    s_add_u32 s34, s34, 131072
    ds_read_u16 v24, v16 offset:160
    ds_read_u16 v40, v16 offset:37216
    ds_read_u16 v25, v16 offset:9424
    ds_read_u16 v41, v16 offset:46480
    ds_read_u16 v26, v16 offset:18688
    ds_read_u16 v42, v16 offset:55744
    ds_read_u16 v27, v16 offset:27952
    ds_read_u16 v43, v16 offset:65008
    s_waitcnt lgkmcnt(14)
    v_lshl_or_b32 v20, v36, 16, v20
    s_waitcnt lgkmcnt(12)
    v_lshl_or_b32 v21, v37, 16, v21
    s_waitcnt lgkmcnt(10)
    v_lshl_or_b32 v22, v38, 16, v22
    s_waitcnt lgkmcnt(8)
    v_lshl_or_b32 v23, v39, 16, v23
    buffer_store_dwordx4 v[20:23], v17, s[44:47], s34 offen sc1
    s_add_u32 s34, s34, 131072
    ds_read_u16 v28, v16 offset:192
    ds_read_u16 v44, v16 offset:37248
    ds_read_u16 v29, v16 offset:9456
    ds_read_u16 v45, v16 offset:46512
    ds_read_u16 v30, v16 offset:18720
    ds_read_u16 v46, v16 offset:55776
    ds_read_u16 v31, v16 offset:27984
    ds_read_u16 v47, v16 offset:65040
    s_waitcnt lgkmcnt(14)
    v_lshl_or_b32 v24, v40, 16, v24
    s_waitcnt lgkmcnt(12)
    v_lshl_or_b32 v25, v41, 16, v25
    s_waitcnt lgkmcnt(10)
    v_lshl_or_b32 v26, v42, 16, v26
    s_waitcnt lgkmcnt(8)
    v_lshl_or_b32 v27, v43, 16, v27
    buffer_store_dwordx4 v[24:27], v17, s[44:47], s34 offen sc1
    s_add_u32 s34, s34, 131072
    ds_read_u16 v32, v16 offset:224
    ds_read_u16 v48, v16 offset:37280
    ds_read_u16 v33, v16 offset:9488
    ds_read_u16 v49, v16 offset:46544
    ds_read_u16 v34, v16 offset:18752
    ds_read_u16 v50, v16 offset:55808
    ds_read_u16 v35, v16 offset:28016
    ds_read_u16 v51, v16 offset:65072
    s_waitcnt lgkmcnt(14)
    v_lshl_or_b32 v28, v44, 16, v28
    s_waitcnt lgkmcnt(12)
    v_lshl_or_b32 v29, v45, 16, v29
    s_waitcnt lgkmcnt(10)
    v_lshl_or_b32 v30, v46, 16, v30
    s_waitcnt lgkmcnt(8)
    v_lshl_or_b32 v31, v47, 16, v31
    buffer_store_dwordx4 v[28:31], v17, s[44:47], s34 offen sc1
    s_add_u32 s34, s34, 131072
    ds_read_u16 v20, v16 offset:256
    ds_read_u16 v36, v16 offset:37312
    ds_read_u16 v21, v16 offset:9520
    ds_read_u16 v37, v16 offset:46576
    ds_read_u16 v22, v16 offset:18784
    ds_read_u16 v38, v16 offset:55840
    ds_read_u16 v23, v16 offset:28048
    ds_read_u16 v39, v16 offset:65104
    s_waitcnt lgkmcnt(14)
    v_lshl_or_b32 v32, v48, 16, v32
    s_waitcnt lgkmcnt(12)
    v_lshl_or_b32 v33, v49, 16, v33
    s_waitcnt lgkmcnt(10)
    v_lshl_or_b32 v34, v50, 16, v34
    s_waitcnt lgkmcnt(8)
    v_lshl_or_b32 v35, v51, 16, v35
    buffer_store_dwordx4 v[32:35], v17, s[44:47], s34 offen sc1
    s_add_u32 s34, s34, 131072
    ds_read_u16 v24, v16 offset:288
    ds_read_u16 v40, v16 offset:37344
    ds_read_u16 v25, v16 offset:9552
    ds_read_u16 v41, v16 offset:46608
    ds_read_u16 v26, v16 offset:18816
    ds_read_u16 v42, v16 offset:55872
    ds_read_u16 v27, v16 offset:28080
    ds_read_u16 v43, v16 offset:65136
    s_waitcnt lgkmcnt(14)
    v_lshl_or_b32 v20, v36, 16, v20
    s_waitcnt lgkmcnt(12)
    v_lshl_or_b32 v21, v37, 16, v21
    s_waitcnt lgkmcnt(10)
    v_lshl_or_b32 v22, v38, 16, v22
    s_waitcnt lgkmcnt(8)
    v_lshl_or_b32 v23, v39, 16, v23
    buffer_store_dwordx4 v[20:23], v17, s[44:47], s34 offen sc1
    s_add_u32 s34, s34, 131072
    ds_read_u16 v28, v16 offset:320
    ds_read_u16 v44, v16 offset:37376
    ds_read_u16 v29, v16 offset:9584
    ds_read_u16 v45, v16 offset:46640
    ds_read_u16 v30, v16 offset:18848
    ds_read_u16 v46, v16 offset:55904
    ds_read_u16 v31, v16 offset:28112
    ds_read_u16 v47, v16 offset:65168
    s_waitcnt lgkmcnt(14)
    v_lshl_or_b32 v24, v40, 16, v24
    s_waitcnt lgkmcnt(12)
    v_lshl_or_b32 v25, v41, 16, v25
    s_waitcnt lgkmcnt(10)
    v_lshl_or_b32 v26, v42, 16, v26
    s_waitcnt lgkmcnt(8)
    v_lshl_or_b32 v27, v43, 16, v27
    buffer_store_dwordx4 v[24:27], v17, s[44:47], s34 offen sc1
    s_add_u32 s34, s34, 131072
    ds_read_u16 v32, v16 offset:352
    ds_read_u16 v48, v16 offset:37408
    ds_read_u16 v33, v16 offset:9616
    ds_read_u16 v49, v16 offset:46672
    ds_read_u16 v34, v16 offset:18880
    ds_read_u16 v50, v16 offset:55936
    ds_read_u16 v35, v16 offset:28144
    ds_read_u16 v51, v16 offset:65200
    s_waitcnt lgkmcnt(14)
    v_lshl_or_b32 v28, v44, 16, v28
    s_waitcnt lgkmcnt(12)
    v_lshl_or_b32 v29, v45, 16, v29
    s_waitcnt lgkmcnt(10)
    v_lshl_or_b32 v30, v46, 16, v30
    s_waitcnt lgkmcnt(8)
    v_lshl_or_b32 v31, v47, 16, v31
    buffer_store_dwordx4 v[28:31], v17, s[44:47], s34 offen sc1
    s_add_u32 s34, s34, 131072
    ds_read_u16 v20, v16 offset:384
    ds_read_u16 v36, v16 offset:37440
    ds_read_u16 v21, v16 offset:9648
    ds_read_u16 v37, v16 offset:46704
    ds_read_u16 v22, v16 offset:18912
    ds_read_u16 v38, v16 offset:55968
    ds_read_u16 v23, v16 offset:28176
    ds_read_u16 v39, v16 offset:65232
    s_waitcnt lgkmcnt(14)
    v_lshl_or_b32 v32, v48, 16, v32
    s_waitcnt lgkmcnt(12)
    v_lshl_or_b32 v33, v49, 16, v33
    s_waitcnt lgkmcnt(10)
    v_lshl_or_b32 v34, v50, 16, v34
    s_waitcnt lgkmcnt(8)
    v_lshl_or_b32 v35, v51, 16, v35
    buffer_store_dwordx4 v[32:35], v17, s[44:47], s34 offen sc1
    s_add_u32 s34, s34, 131072
    ds_read_u16 v24, v16 offset:416
    ds_read_u16 v40, v16 offset:37472
    ds_read_u16 v25, v16 offset:9680
    ds_read_u16 v41, v16 offset:46736
    ds_read_u16 v26, v16 offset:18944
    ds_read_u16 v42, v16 offset:56000
    ds_read_u16 v27, v16 offset:28208
    ds_read_u16 v43, v16 offset:65264
    s_waitcnt lgkmcnt(14)
    v_lshl_or_b32 v20, v36, 16, v20
    s_waitcnt lgkmcnt(12)
    v_lshl_or_b32 v21, v37, 16, v21
    s_waitcnt lgkmcnt(10)
    v_lshl_or_b32 v22, v38, 16, v22
    s_waitcnt lgkmcnt(8)
    v_lshl_or_b32 v23, v39, 16, v23
    buffer_store_dwordx4 v[20:23], v17, s[44:47], s34 offen sc1
    s_add_u32 s34, s34, 131072
    ds_read_u16 v28, v16 offset:448
    ds_read_u16 v44, v16 offset:37504
    ds_read_u16 v29, v16 offset:9712
    ds_read_u16 v45, v16 offset:46768
    ds_read_u16 v30, v16 offset:18976
    ds_read_u16 v46, v16 offset:56032
    ds_read_u16 v31, v16 offset:28240
    ds_read_u16 v47, v16 offset:65296
    s_waitcnt lgkmcnt(14)
    v_lshl_or_b32 v24, v40, 16, v24
    s_waitcnt lgkmcnt(12)
    v_lshl_or_b32 v25, v41, 16, v25
    s_waitcnt lgkmcnt(10)
    v_lshl_or_b32 v26, v42, 16, v26
    s_waitcnt lgkmcnt(8)
    v_lshl_or_b32 v27, v43, 16, v27
    buffer_store_dwordx4 v[24:27], v17, s[44:47], s34 offen sc1
    s_add_u32 s34, s34, 131072
    ds_read_u16 v32, v16 offset:480
    ds_read_u16 v48, v16 offset:37536
    ds_read_u16 v33, v16 offset:9744
    ds_read_u16 v49, v16 offset:46800
    ds_read_u16 v34, v16 offset:19008
    ds_read_u16 v50, v16 offset:56064
    ds_read_u16 v35, v16 offset:28272
    ds_read_u16 v51, v16 offset:65328
    s_waitcnt lgkmcnt(14)
    v_lshl_or_b32 v28, v44, 16, v28
    s_waitcnt lgkmcnt(12)
    v_lshl_or_b32 v29, v45, 16, v29
    s_waitcnt lgkmcnt(10)
    v_lshl_or_b32 v30, v46, 16, v30
    s_waitcnt lgkmcnt(8)
    v_lshl_or_b32 v31, v47, 16, v31
    buffer_store_dwordx4 v[28:31], v17, s[44:47], s34 offen sc1
    s_add_u32 s34, s34, 131072
    ds_read_u16 v20, v16 offset:512
    ds_read_u16 v36, v16 offset:37568
    ds_read_u16 v21, v16 offset:9776
    ds_read_u16 v37, v16 offset:46832
    ds_read_u16 v22, v16 offset:19040
    ds_read_u16 v38, v16 offset:56096
    ds_read_u16 v23, v16 offset:28304
    ds_read_u16 v39, v16 offset:65360
    s_waitcnt lgkmcnt(14)
    v_lshl_or_b32 v32, v48, 16, v32
    s_waitcnt lgkmcnt(12)
    v_lshl_or_b32 v33, v49, 16, v33
    s_waitcnt lgkmcnt(10)
    v_lshl_or_b32 v34, v50, 16, v34
    s_waitcnt lgkmcnt(8)
    v_lshl_or_b32 v35, v51, 16, v35
    buffer_store_dwordx4 v[32:35], v17, s[44:47], s34 offen sc1
    s_add_u32 s34, s34, 131072
    ds_read_u16 v24, v16 offset:544
    ds_read_u16 v40, v16 offset:37600
    ds_read_u16 v25, v16 offset:9808
    ds_read_u16 v41, v16 offset:46864
    ds_read_u16 v26, v16 offset:19072
    ds_read_u16 v42, v16 offset:56128
    ds_read_u16 v27, v16 offset:28336
    ds_read_u16 v43, v16 offset:65392
    s_waitcnt lgkmcnt(14)
    v_lshl_or_b32 v20, v36, 16, v20
    s_waitcnt lgkmcnt(12)
    v_lshl_or_b32 v21, v37, 16, v21
    s_waitcnt lgkmcnt(10)
    v_lshl_or_b32 v22, v38, 16, v22
    s_waitcnt lgkmcnt(8)
    v_lshl_or_b32 v23, v39, 16, v23
    buffer_store_dwordx4 v[20:23], v17, s[44:47], s34 offen sc1
    s_add_u32 s34, s34, 131072
    ds_read_u16 v28, v16 offset:576
    ds_read_u16 v44, v16 offset:37632
    ds_read_u16 v29, v16 offset:9840
    ds_read_u16 v45, v16 offset:46896
    ds_read_u16 v30, v16 offset:19104
    ds_read_u16 v46, v16 offset:56160
    ds_read_u16 v31, v16 offset:28368
    ds_read_u16 v47, v16 offset:65424
    s_waitcnt lgkmcnt(14)
    v_lshl_or_b32 v24, v40, 16, v24
    s_waitcnt lgkmcnt(12)
    v_lshl_or_b32 v25, v41, 16, v25
    s_waitcnt lgkmcnt(10)
    v_lshl_or_b32 v26, v42, 16, v26
    s_waitcnt lgkmcnt(8)
    v_lshl_or_b32 v27, v43, 16, v27
    buffer_store_dwordx4 v[24:27], v17, s[44:47], s34 offen sc1
    s_add_u32 s34, s34, 131072
    s_waitcnt lgkmcnt(6)
    v_lshl_or_b32 v28, v44, 16, v28
    s_waitcnt lgkmcnt(4)
    v_lshl_or_b32 v29, v45, 16, v29
    s_waitcnt lgkmcnt(2)
    v_lshl_or_b32 v30, v46, 16, v30
    s_waitcnt lgkmcnt(0)
    v_lshl_or_b32 v31, v47, 16, v31
    v_cmp_gt_u32 vcc, 16, v0
    s_nop 1
    s_and_saveexec_b64 s[48:49], vcc
    s_cbranch_execz k0_kernel_nohalf18
    v_lshlrev_b32 v52, 16, v28
    v_and_b32 v53, s50, v28
    v_mul_f32 v52, 0.5, v52
    v_mul_f32 v53, 0.5, v53
    v_cvt_pk_bf16_f32 v28, v52, v53
    v_lshlrev_b32 v52, 16, v29
    v_and_b32 v53, s50, v29
    v_mul_f32 v52, 0.5, v52
    v_mul_f32 v53, 0.5, v53
    v_cvt_pk_bf16_f32 v29, v52, v53
    v_lshlrev_b32 v52, 16, v30
    v_and_b32 v53, s50, v30
    v_mul_f32 v52, 0.5, v52
    v_mul_f32 v53, 0.5, v53
    v_cvt_pk_bf16_f32 v30, v52, v53
    v_lshlrev_b32 v52, 16, v31
    v_and_b32 v53, s50, v31
    v_mul_f32 v52, 0.5, v52
    v_mul_f32 v53, 0.5, v53
    v_cvt_pk_bf16_f32 v31, v52, v53
k0_kernel_nohalf18:
    s_mov_b64 exec, s[48:49]
    buffer_store_dwordx4 v[28:31], v17, s[44:47], s34 offen sc1
    s_add_u32 s34, s34, 131072
    s_add_u32 s52, s6, 5120
    s_addc_u32 s53, s7, 0
    s_mov_b32 s54, 9216
    s_mov_b32 s55, 0x20000
    s_add_u32 s56, s6, 262144
    s_addc_u32 s57, s7, 0
    s_mov_b32 s58, 65536
    s_mov_b32 s59, 0x20000
    s_cmp_ge_u32 s2, 4
    s_cbranch_scc1 k0_kernel_nozero
    v_lshlrev_b32 v60, 4, v0
    s_lshl_b32 s60, s2, 14
    v_mov_b32 v56, 0
    v_mov_b32 v57, 0
    v_mov_b32 v58, 0
    v_mov_b32 v59, 0
    buffer_store_dwordx4 v[56:59], v60, s[56:59], s60 offen
    s_add_u32 s60, s60, 4096
    buffer_store_dwordx4 v[56:59], v60, s[56:59], s60 offen
    s_add_u32 s60, s60, 4096
    buffer_store_dwordx4 v[56:59], v60, s[56:59], s60 offen
    s_add_u32 s60, s60, 4096
    buffer_store_dwordx4 v[56:59], v60, s[56:59], s60 offen
    s_add_u32 s60, s60, 4096
    s_lshl_b32 s60, s2, 12
    buffer_store_dwordx4 v[56:59], v60, s[52:55], s60 offen
k0_kernel_nozero:
k0_kernel_end:
    s_endpgm
.p2align 12
.fill 832, 4, 0xbf800000
.globl k2_kernel
.p2align 8
.type k2_kernel,@function
k2_kernel:
    s_cmp_ge_u32 s2, 256
    s_cbranch_scc1 k2_kernel_end
    s_load_dwordx2 s[4:5], s[0:1], 88
    s_load_dwordx2 s[6:7], s[0:1], 56
    s_load_dwordx2 s[8:9], s[0:1], 64
    s_load_dwordx2 s[10:11], s[0:1], 32
    s_load_dwordx2 s[12:13], s[0:1], 40
    s_load_dwordx2 s[14:15], s[0:1], 48
    v_and_b32 v1, 63, v0
    v_lshlrev_b32 v2, 4, v1
    v_mov_b32 v3, 0
    v_lshrrev_b32 v4, 6, v0
    s_nop 0
    v_readfirstlane_b32 s16, v4
    s_getpc_b64 s[20:21]
k2_kernel_pc4:
    s_add_u32 s20, s20, tabs+14336-k2_kernel_pc4
    s_addc_u32 s21, s21, 0
    s_mul_i32 s22, s16, 3072
    s_add_u32 s20, s20, s22
    s_addc_u32 s21, s21, 0
    s_add_u32 m0, s22, 0
    v_lshl_add_u64 v[10:11], v[2:3], 0, s[20:21]
    global_load_lds_dwordx4 v[10:11], off offset:0
    global_load_lds_dwordx4 v[10:11], off offset:1024
    global_load_lds_dwordx4 v[10:11], off offset:2048
    s_lshr_b32 s18, s16, 1
    s_lshl_b32 s17, s18, 8
    s_add_u32 s17, s17, s2
    v_lshlrev_b32 v4, 2, v4
    ds_write_b32 v4, v3 offset:45056
    s_lshl_b32 s18, s18, 3
    s_add_u32 s18, s18, 45056
    v_mov_b32 v9, s18
    s_lshr_b32 s18, s16, 1
    s_lshl_b32 s18, s18, 13
    s_add_u32 s18, s18, 28672
    v_add_u32 v8, s18, v2
    s_cmp_ge_u32 s17, 289
    s_cbranch_scc1 k2_kernel_gv
    s_lshr_b32 s23, s17, 5
    s_lshl_b32 s23, s23, 3
    s_and_b32 s25, s17, 7
    s_add_u32 s25, s25, s23
    s_lshl_b32 s25, s25, 2
    s_bfe_u32 s23, s17, 0x20003
    s_add_u32 s25, s25, s23
    s_and_b32 s26, s16, 1
    s_lshl_b32 s23, s26, 12
    s_lshl_b32 s27, s25, 13
    s_add_u32 s27, s27, s23
    s_lshl_b32 s24, s16, 12
    s_add_u32 m0, s24, 12288
    v_and_b32 v4, 31, v1
    v_lshrrev_b32 v5, 5, v1
    v_lshlrev_b32 v5, 2, v5
    v_lshl_add_u32 v6, v4, 1, s26
    v_cvt_f32_u32 v44, v6
    v_mul_f32 v44, 0x3a000000, v44
    v_cvt_f32_u32 v46, v5
    v_mul_f32 v46, v46, v44
    v_fmamk_f32 v28, v44, 0x0, v46
    v_fmamk_f32 v29, v44, 0x3f800000, v46
    v_fmamk_f32 v30, v44, 0x40000000, v46
    v_fmamk_f32 v31, v44, 0x40400000, v46
    v_fmamk_f32 v32, v44, 0x41000000, v46
    v_fmamk_f32 v33, v44, 0x41100000, v46
    v_fmamk_f32 v34, v44, 0x41200000, v46
    v_fmamk_f32 v35, v44, 0x41300000, v46
    v_fmamk_f32 v36, v44, 0x41800000, v46
    v_fmamk_f32 v37, v44, 0x41880000, v46
    v_fmamk_f32 v38, v44, 0x41900000, v46
    v_fmamk_f32 v39, v44, 0x41980000, v46
    v_fmamk_f32 v40, v44, 0x41c00000, v46
    v_fmamk_f32 v41, v44, 0x41c80000, v46
    v_fmamk_f32 v42, v44, 0x41d00000, v46
    v_fmamk_f32 v43, v44, 0x41d80000, v46
    s_waitcnt lgkmcnt(0)
    s_add_u32 s28, s4, 4194304
    s_addc_u32 s29, s5, 0
    s_mov_b32 s30, 2367488
    s_mov_b32 s31, 0x20000
    buffer_load_dwordx4 v2, s[28:31], s27 offen offset:0 lds
    buffer_load_dwordx4 v2, s[28:31], s27 offen offset:1024 lds
    buffer_load_dwordx4 v2, s[28:31], s27 offen offset:2048 lds
    buffer_load_dwordx4 v2, s[28:31], s27 offen offset:3072 lds
    s_add_u32 s32, s4, 1048576
    s_addc_u32 s33, s5, 0
    s_mov_b32 s34, 2367488
    s_mov_b32 s35, 0x20000
    v_cos_f32 v12, v28
    v_sin_f32 v28, v28
    v_cos_f32 v13, v29
    v_sin_f32 v29, v29
    v_cos_f32 v14, v30
    v_sin_f32 v30, v30
    v_cos_f32 v15, v31
    v_sin_f32 v31, v31
    v_cos_f32 v16, v32
    v_sin_f32 v32, v32
    v_cos_f32 v17, v33
    v_sin_f32 v33, v33
    v_cos_f32 v18, v34
    v_sin_f32 v34, v34
    v_cos_f32 v19, v35
    v_sin_f32 v35, v35
    v_cos_f32 v20, v36
    v_sin_f32 v36, v36
    v_cos_f32 v21, v37
    v_sin_f32 v37, v37
    v_cos_f32 v22, v38
    v_sin_f32 v38, v38
    v_cos_f32 v23, v39
    v_sin_f32 v39, v39
    v_cos_f32 v24, v40
    v_sin_f32 v40, v40
    v_cos_f32 v25, v41
    v_sin_f32 v41, v41
    v_cos_f32 v26, v42
    v_sin_f32 v42, v42
    v_cos_f32 v27, v43
    v_sin_f32 v43, v43
    s_add_u32 s44, s4, 7340032
    s_addc_u32 s45, s5, 0
    s_mov_b32 s46, 2392064
    s_mov_b32 s47, 0x20000
    v_mul_u32_u24 v128, 37376, v4
    v_lshl_add_u32 v128, v5, 2, v128
    s_lshl_b32 s36, s25, 5
    s_mul_i32 s24, s26, 18688
    s_add_u32 s36, s36, s24
    s_add_u32 s37, s36, 9344
    s_add_u32 s38, s36, 1196032
    s_add_u32 s39, s36, 1205376
    v_add_u32 v130, s23, v2
    v_add_u32 v131, s23, v130
    s_lshr_b32 s24, s16, 1
    s_lshl_b32 s24, s24, 13
    v_lshl_add_u32 v129, v1, 5, s24
    v_cvt_f32_u32 v45, v4
    v_mul_f32 v45, 0x3a000000, v45
    v_lshl_add_u32 v6, v5, 1, s26
    v_cvt_f32_u32 v47, v6
    v_mul_f32 v47, v47, v45
    s_mul_i32 s40, s26, 0x80008000
    v_fmamk_f32 v64, v45, 0x0, v47
    v_fmamk_f32 v65, v45, 0x40000000, v47
    v_fmamk_f32 v66, v45, 0x40800000, v47
    v_fmamk_f32 v67, v45, 0x40c00000, v47
    v_fmamk_f32 v68, v45, 0x41800000, v47
    v_fmamk_f32 v69, v45, 0x41900000, v47
    v_fmamk_f32 v70, v45, 0x41a00000, v47
    v_fmamk_f32 v71, v45, 0x41b00000, v47
    v_fmamk_f32 v72, v45, 0x42000000, v47
    v_fmamk_f32 v73, v45, 0x42080000, v47
    v_fmamk_f32 v74, v45, 0x42100000, v47
    v_fmamk_f32 v75, v45, 0x42180000, v47
    v_fmamk_f32 v76, v45, 0x42400000, v47
    v_fmamk_f32 v77, v45, 0x42480000, v47
    v_fmamk_f32 v78, v45, 0x42500000, v47
    v_fmamk_f32 v79, v45, 0x42580000, v47
    buffer_load_dwordx4 v[112:115], v2, s[32:35], s27 offen offset:0
    buffer_load_dwordx4 v[116:119], v2, s[32:35], s27 offen offset:1024
    buffer_load_dwordx4 v[120:123], v2, s[32:35], s27 offen offset:2048
    buffer_load_dwordx4 v[124:127], v2, s[32:35], s27 offen offset:3072
    s_waitcnt vmcnt(4) lgkmcnt(0)
    s_barrier
    ds_read_b128 a[8:11], v130 offset:0
    ds_read_b128 a[12:15], v130 offset:1024
    ds_read_b128 v[148:151], v130 offset:2048
    ds_read_b128 v[152:155], v130 offset:3072
    ds_read_b128 v[80:83], v129 offset:12288
    ds_read_b128 v[96:99], v129 offset:12304
    ds_read_b128 v[84:87], v129 offset:14336
    ds_read_b128 v[100:103], v129 offset:14352
    ds_read_b128 v[88:91], v129 offset:16384
    ds_read_b128 v[104:107], v129 offset:16400
    ds_read_b128 v[92:95], v129 offset:18432
    ds_read_b128 v[108:111], v129 offset:18448
    s_waitcnt lgkmcnt(9)
    v_xor_b32 v156, 0x80008000, v148
    v_xor_b32 v157, 0x80008000, v149
    v_xor_b32 v158, 0x80008000, v150
    v_xor_b32 v159, 0x80008000, v151
    s_waitcnt lgkmcnt(8)
    v_xor_b32 v160, 0x80008000, v152
    v_xor_b32 v161, 0x80008000, v153
    v_xor_b32 v162, 0x80008000, v154
    v_xor_b32 v163, 0x80008000, v155
    s_mov_b32 s48, 0xffff0000
    s_waitcnt lgkmcnt(7)
    v_mfma_f32_32x32x16_bf16 v[180:195], v[80:83], a[8:11], 0
    s_waitcnt lgkmcnt(3)
    v_xor_b32 v88, s40, v88
    s_waitcnt lgkmcnt(2)
    v_xor_b32 v104, s40, v104
    v_xor_b32 v89, s40, v89
    v_xor_b32 v105, s40, v105
    v_mfma_f32_32x32x16_bf16 v[196:211], v[96:99], a[8:11], 0
    v_xor_b32 v90, s40, v90
    v_xor_b32 v106, s40, v106
    v_xor_b32 v91, s40, v91
    v_xor_b32 v107, s40, v107
    v_mfma_f32_32x32x16_bf16 v[180:195], v[96:99], v[148:151], v[180:195]
    s_waitcnt lgkmcnt(1)
    v_xor_b32 v92, s40, v92
    s_waitcnt lgkmcnt(0)
    v_xor_b32 v108, s40, v108
    v_xor_b32 v93, s40, v93
    v_xor_b32 v109, s40, v109
    v_mfma_f32_32x32x16_bf16 v[196:211], v[80:83], v[156:159], v[196:211]
    v_xor_b32 v94, s40, v94
    v_xor_b32 v110, s40, v110
    v_xor_b32 v95, s40, v95
    v_xor_b32 v111, s40, v111
    v_mfma_f32_32x32x16_bf16 v[180:195], v[84:87], a[12:15], v[180:195]
    ds_read_b128 a[0:3], v2 offset:0
    ds_read_b128 a[4:7], v2 offset:1024
    ds_read_b128 v[132:135], v2 offset:2048
    ds_read_b128 v[136:139], v2 offset:3072
    v_mfma_f32_32x32x16_bf16 v[196:211], v[100:103], a[12:15], v[196:211]
    ds_read_b128 a[16:19], v131 offset:0
    ds_read_b128 a[20:23], v131 offset:1024
    ds_read_b128 v[164:167], v131 offset:2048
    ds_read_b128 v[168:171], v131 offset:3072
    v_mfma_f32_32x32x16_bf16 v[180:195], v[100:103], v[152:155], v[180:195]
    v_cos_f32 v48, v64
    v_sin_f32 v64, v64
    v_cos_f32 v49, v65
    v_sin_f32 v65, v65
    v_mfma_f32_32x32x16_bf16 v[196:211], v[84:87], v[160:163], v[196:211]
    v_cos_f32 v50, v66
    v_sin_f32 v66, v66
    v_cos_f32 v51, v67
    v_sin_f32 v67, v67
    v_mfma_f32_32x32x16_bf16 v[180:195], v[88:91], a[8:11], v[180:195]
    v_cos_f32 v52, v68
    v_sin_f32 v68, v68
    v_cos_f32 v53, v69
    v_sin_f32 v69, v69
    v_mfma_f32_32x32x16_bf16 v[196:211], v[104:107], a[8:11], v[196:211]
    v_cos_f32 v54, v70
    v_sin_f32 v70, v70
    v_cos_f32 v55, v71
    v_sin_f32 v71, v71
    v_mfma_f32_32x32x16_bf16 v[180:195], v[104:107], v[148:151], v[180:195]
    v_cos_f32 v56, v72
    v_sin_f32 v72, v72
    v_cos_f32 v57, v73
    v_sin_f32 v73, v73
    v_mfma_f32_32x32x16_bf16 v[196:211], v[88:91], v[156:159], v[196:211]
    v_cos_f32 v58, v74
    v_sin_f32 v74, v74
    v_cos_f32 v59, v75
    v_sin_f32 v75, v75
    v_mfma_f32_32x32x16_bf16 v[180:195], v[92:95], a[12:15], v[180:195]
    v_cos_f32 v60, v76
    v_sin_f32 v76, v76
    v_cos_f32 v61, v77
    v_sin_f32 v77, v77
    v_mfma_f32_32x32x16_bf16 v[196:211], v[108:111], a[12:15], v[196:211]
    v_cos_f32 v62, v78
    v_sin_f32 v78, v78
    v_cos_f32 v63, v79
    v_sin_f32 v79, v79
    v_mfma_f32_32x32x16_bf16 v[180:195], v[108:111], v[152:155], v[180:195]
    s_waitcnt lgkmcnt(5)
    v_xor_b32 v140, 0x80008000, v132
    v_xor_b32 v141, 0x80008000, v133
    v_xor_b32 v142, 0x80008000, v134
    v_xor_b32 v143, 0x80008000, v135
    v_mfma_f32_32x32x16_bf16 v[196:211], v[92:95], v[160:163], v[196:211]
    s_waitcnt lgkmcnt(4)
    v_xor_b32 v144, 0x80008000, v136
    v_xor_b32 v145, 0x80008000, v137
    v_xor_b32 v146, 0x80008000, v138
    v_xor_b32 v147, 0x80008000, v139
    s_nop 0
    v_pk_mul_f32 v[80:81], v[180:181], v[12:13]
    s_nop 4
    v_pk_mul_f32 v[96:97], v[196:197], v[12:13]
    v_pk_fma_f32 v[80:81], v[196:197], v[28:29], v[80:81]
    v_pk_fma_f32 v[96:97], v[180:181], v[28:29], v[96:97] neg_lo:[1,0,0] neg_hi:[1,0,0]
    v_pk_mul_f32 v[82:83], v[182:183], v[14:15]
    v_pk_mul_f32 v[98:99], v[198:199], v[14:15]
    v_pk_fma_f32 v[82:83], v[198:199], v[30:31], v[82:83]
    v_pk_fma_f32 v[98:99], v[182:183], v[30:31], v[98:99] neg_lo:[1,0,0] neg_hi:[1,0,0]
    v_pk_mul_f32 v[84:85], v[184:185], v[16:17]
    v_pk_mul_f32 v[100:101], v[200:201], v[16:17]
    v_pk_fma_f32 v[84:85], v[200:201], v[32:33], v[84:85]
    v_pk_fma_f32 v[100:101], v[184:185], v[32:33], v[100:101] neg_lo:[1,0,0] neg_hi:[1,0,0]
    v_pk_mul_f32 v[86:87], v[186:187], v[18:19]
    v_pk_mul_f32 v[102:103], v[202:203], v[18:19]
    v_pk_fma_f32 v[86:87], v[202:203], v[34:35], v[86:87]
    v_pk_fma_f32 v[102:103], v[186:187], v[34:35], v[102:103] neg_lo:[1,0,0] neg_hi:[1,0,0]
    v_pk_mul_f32 v[88:89], v[188:189], v[20:21]
    v_pk_mul_f32 v[104:105], v[204:205], v[20:21]
    v_pk_fma_f32 v[88:89], v[204:205], v[36:37], v[88:89]
    v_pk_fma_f32 v[104:105], v[188:189], v[36:37], v[104:105] neg_lo:[1,0,0] neg_hi:[1,0,0]
    v_pk_mul_f32 v[90:91], v[190:191], v[22:23]
    v_pk_mul_f32 v[106:107], v[206:207], v[22:23]
    v_pk_fma_f32 v[90:91], v[206:207], v[38:39], v[90:91]
    v_pk_fma_f32 v[106:107], v[190:191], v[38:39], v[106:107] neg_lo:[1,0,0] neg_hi:[1,0,0]
    v_pk_mul_f32 v[92:93], v[192:193], v[24:25]
    v_pk_mul_f32 v[108:109], v[208:209], v[24:25]
    v_pk_fma_f32 v[92:93], v[208:209], v[40:41], v[92:93]
    v_pk_fma_f32 v[108:109], v[192:193], v[40:41], v[108:109] neg_lo:[1,0,0] neg_hi:[1,0,0]
    v_pk_mul_f32 v[94:95], v[194:195], v[26:27]
    v_pk_mul_f32 v[110:111], v[210:211], v[26:27]
    v_pk_fma_f32 v[94:95], v[210:211], v[42:43], v[94:95]
    v_pk_fma_f32 v[110:111], v[194:195], v[42:43], v[110:111] neg_lo:[1,0,0] neg_hi:[1,0,0]
    v_cvt_pk_bf16_f32 v212, v80, v81
    v_cvt_pk_bf16_f32 v213, v82, v83
    v_cvt_pk_bf16_f32 v214, v84, v85
    v_cvt_pk_bf16_f32 v215, v86, v87
    v_cvt_pk_bf16_f32 v216, v88, v89
    v_cvt_pk_bf16_f32 v217, v90, v91
    v_cvt_pk_bf16_f32 v218, v92, v93
    v_cvt_pk_bf16_f32 v219, v94, v95
    v_cvt_pk_bf16_f32 v220, v96, v97
    v_cvt_pk_bf16_f32 v221, v98, v99
    v_cvt_pk_bf16_f32 v222, v100, v101
    v_cvt_pk_bf16_f32 v223, v102, v103
    v_cvt_pk_bf16_f32 v224, v104, v105
    v_cvt_pk_bf16_f32 v225, v106, v107
    v_cvt_pk_bf16_f32 v226, v108, v109
    v_cvt_pk_bf16_f32 v227, v110, v111
    v_mfma_f32_32x32x16_bf16 v[180:195], a[0:3], v[212:215], 0
    s_waitcnt vmcnt(3)
    v_lshlrev_b32 v12, 16, v112
    v_and_b32 v28, s48, v112
    v_lshlrev_b32 v13, 16, v113
    v_and_b32 v29, s48, v113
    v_mfma_f32_32x32x16_bf16 v[196:211], a[0:3], v[220:223], 0
    v_lshlrev_b32 v14, 16, v114
    v_and_b32 v30, s48, v114
    v_lshlrev_b32 v15, 16, v115
    v_and_b32 v31, s48, v115
    v_mfma_f32_32x32x16_bf16 v[180:195], v[132:135], v[220:223], v[180:195]
    s_waitcnt vmcnt(2)
    v_lshlrev_b32 v16, 16, v116
    v_and_b32 v32, s48, v116
    v_lshlrev_b32 v17, 16, v117
    v_and_b32 v33, s48, v117
    v_mfma_f32_32x32x16_bf16 v[196:211], v[140:143], v[212:215], v[196:211]
    v_lshlrev_b32 v18, 16, v118
    v_and_b32 v34, s48, v118
    v_lshlrev_b32 v19, 16, v119
    v_and_b32 v35, s48, v119
    v_mfma_f32_32x32x16_bf16 v[180:195], a[4:7], v[216:219], v[180:195]
    s_waitcnt vmcnt(1)
    v_lshlrev_b32 v20, 16, v120
    v_and_b32 v36, s48, v120
    v_lshlrev_b32 v21, 16, v121
    v_and_b32 v37, s48, v121
    v_mfma_f32_32x32x16_bf16 v[196:211], a[4:7], v[224:227], v[196:211]
    v_lshlrev_b32 v22, 16, v122
    v_and_b32 v38, s48, v122
    v_lshlrev_b32 v23, 16, v123
    v_and_b32 v39, s48, v123
    v_mfma_f32_32x32x16_bf16 v[180:195], v[136:139], v[224:227], v[180:195]
    s_waitcnt vmcnt(0)
    v_lshlrev_b32 v24, 16, v124
    v_and_b32 v40, s48, v124
    v_lshlrev_b32 v25, 16, v125
    v_and_b32 v41, s48, v125
    v_mfma_f32_32x32x16_bf16 v[196:211], v[144:147], v[216:219], v[196:211]
    v_lshlrev_b32 v26, 16, v126
    v_and_b32 v42, s48, v126
    v_lshlrev_b32 v27, 16, v127
    v_and_b32 v43, s48, v127
    s_nop 1
    v_pk_mul_f32 v[80:81], v[180:181], v[12:13]
    s_nop 4
    v_pk_mul_f32 v[96:97], v[196:197], v[12:13]
    v_pk_fma_f32 v[80:81], v[196:197], v[28:29], v[80:81] neg_lo:[1,0,0] neg_hi:[1,0,0]
    v_pk_fma_f32 v[96:97], v[180:181], v[28:29], v[96:97]
    v_pk_mul_f32 v[82:83], v[182:183], v[14:15]
    v_pk_mul_f32 v[98:99], v[198:199], v[14:15]
    v_pk_fma_f32 v[82:83], v[198:199], v[30:31], v[82:83] neg_lo:[1,0,0] neg_hi:[1,0,0]
    v_pk_fma_f32 v[98:99], v[182:183], v[30:31], v[98:99]
    v_pk_mul_f32 v[84:85], v[184:185], v[16:17]
    v_pk_mul_f32 v[100:101], v[200:201], v[16:17]
    v_pk_fma_f32 v[84:85], v[200:201], v[32:33], v[84:85] neg_lo:[1,0,0] neg_hi:[1,0,0]
    v_pk_fma_f32 v[100:101], v[184:185], v[32:33], v[100:101]
    v_pk_mul_f32 v[86:87], v[186:187], v[18:19]
    v_pk_mul_f32 v[102:103], v[202:203], v[18:19]
    v_pk_fma_f32 v[86:87], v[202:203], v[34:35], v[86:87] neg_lo:[1,0,0] neg_hi:[1,0,0]
    v_pk_fma_f32 v[102:103], v[186:187], v[34:35], v[102:103]
    v_pk_mul_f32 v[88:89], v[188:189], v[20:21]
    v_pk_mul_f32 v[104:105], v[204:205], v[20:21]
    v_pk_fma_f32 v[88:89], v[204:205], v[36:37], v[88:89] neg_lo:[1,0,0] neg_hi:[1,0,0]
    v_pk_fma_f32 v[104:105], v[188:189], v[36:37], v[104:105]
    v_pk_mul_f32 v[90:91], v[190:191], v[22:23]
    v_pk_mul_f32 v[106:107], v[206:207], v[22:23]
    v_pk_fma_f32 v[90:91], v[206:207], v[38:39], v[90:91] neg_lo:[1,0,0] neg_hi:[1,0,0]
    v_pk_fma_f32 v[106:107], v[190:191], v[38:39], v[106:107]
    v_pk_mul_f32 v[92:93], v[192:193], v[24:25]
    v_pk_mul_f32 v[108:109], v[208:209], v[24:25]
    v_pk_fma_f32 v[92:93], v[208:209], v[40:41], v[92:93] neg_lo:[1,0,0] neg_hi:[1,0,0]
    v_pk_fma_f32 v[108:109], v[192:193], v[40:41], v[108:109]
    v_pk_mul_f32 v[94:95], v[194:195], v[26:27]
    v_pk_mul_f32 v[110:111], v[210:211], v[26:27]
    v_pk_fma_f32 v[94:95], v[210:211], v[42:43], v[94:95] neg_lo:[1,0,0] neg_hi:[1,0,0]
    v_pk_fma_f32 v[110:111], v[194:195], v[42:43], v[110:111]
    v_cvt_pk_bf16_f32 v212, v80, v81
    v_cvt_pk_bf16_f32 v213, v82, v83
    v_cvt_pk_bf16_f32 v214, v84, v85
    v_cvt_pk_bf16_f32 v215, v86, v87
    v_cvt_pk_bf16_f32 v216, v88, v89
    v_cvt_pk_bf16_f32 v217, v90, v91
    v_cvt_pk_bf16_f32 v218, v92, v93
    v_cvt_pk_bf16_f32 v219, v94, v95
    v_cvt_pk_bf16_f32 v220, v96, v97
    v_cvt_pk_bf16_f32 v221, v98, v99
    v_cvt_pk_bf16_f32 v222, v100, v101
    v_cvt_pk_bf16_f32 v223, v102, v103
    v_cvt_pk_bf16_f32 v224, v104, v105
    v_cvt_pk_bf16_f32 v225, v106, v107
    v_cvt_pk_bf16_f32 v226, v108, v109
    v_cvt_pk_bf16_f32 v227, v110, v111
    v_mfma_f32_32x32x16_bf16 v[180:195], v[212:215], a[0:3], 0
    s_waitcnt lgkmcnt(1)
    v_xor_b32 v172, 0x80008000, v164
    v_xor_b32 v173, 0x80008000, v165
    v_xor_b32 v174, 0x80008000, v166
    v_xor_b32 v175, 0x80008000, v167
    v_mfma_f32_32x32x16_bf16 v[196:211], v[220:223], a[0:3], 0
    s_waitcnt lgkmcnt(0)
    v_xor_b32 v176, 0x80008000, v168
    v_xor_b32 v177, 0x80008000, v169
    v_xor_b32 v178, 0x80008000, v170
    v_xor_b32 v179, 0x80008000, v171
    v_mfma_f32_32x32x16_bf16 v[180:195], v[220:223], v[140:143], v[180:195]
    v_mfma_f32_32x32x16_bf16 v[196:211], v[212:215], v[132:135], v[196:211]
    v_mfma_f32_32x32x16_bf16 v[180:195], v[216:219], a[4:7], v[180:195]
    v_mfma_f32_32x32x16_bf16 v[196:211], v[224:227], a[4:7], v[196:211]
    v_mfma_f32_32x32x16_bf16 v[180:195], v[224:227], v[144:147], v[180:195]
    v_mfma_f32_32x32x16_bf16 v[196:211], v[216:219], v[136:139], v[196:211]
    s_nop 10
    v_pk_mul_f32 v[80:81], v[180:181], v[48:49]
    v_pk_mul_f32 v[96:97], v[196:197], v[48:49]
    v_pk_fma_f32 v[80:81], v[196:197], v[64:65], v[80:81] neg_lo:[1,0,0] neg_hi:[1,0,0]
    v_pk_fma_f32 v[96:97], v[180:181], v[64:65], v[96:97]
    v_pk_mul_f32 v[82:83], v[182:183], v[50:51]
    v_pk_mul_f32 v[98:99], v[198:199], v[50:51]
    v_pk_fma_f32 v[82:83], v[198:199], v[66:67], v[82:83] neg_lo:[1,0,0] neg_hi:[1,0,0]
    v_pk_fma_f32 v[98:99], v[182:183], v[66:67], v[98:99]
    v_pk_mul_f32 v[84:85], v[184:185], v[52:53]
    v_pk_mul_f32 v[100:101], v[200:201], v[52:53]
    v_pk_fma_f32 v[84:85], v[200:201], v[68:69], v[84:85] neg_lo:[1,0,0] neg_hi:[1,0,0]
    v_pk_fma_f32 v[100:101], v[184:185], v[68:69], v[100:101]
    v_pk_mul_f32 v[86:87], v[186:187], v[54:55]
    v_pk_mul_f32 v[102:103], v[202:203], v[54:55]
    v_pk_fma_f32 v[86:87], v[202:203], v[70:71], v[86:87] neg_lo:[1,0,0] neg_hi:[1,0,0]
    v_pk_fma_f32 v[102:103], v[186:187], v[70:71], v[102:103]
    v_pk_mul_f32 v[88:89], v[188:189], v[56:57]
    v_pk_mul_f32 v[104:105], v[204:205], v[56:57]
    v_pk_fma_f32 v[88:89], v[204:205], v[72:73], v[88:89] neg_lo:[1,0,0] neg_hi:[1,0,0]
    v_pk_fma_f32 v[104:105], v[188:189], v[72:73], v[104:105]
    v_pk_mul_f32 v[90:91], v[190:191], v[58:59]
    v_pk_mul_f32 v[106:107], v[206:207], v[58:59]
    v_pk_fma_f32 v[90:91], v[206:207], v[74:75], v[90:91] neg_lo:[1,0,0] neg_hi:[1,0,0]
    v_pk_fma_f32 v[106:107], v[190:191], v[74:75], v[106:107]
    v_pk_mul_f32 v[92:93], v[192:193], v[60:61]
    v_pk_mul_f32 v[108:109], v[208:209], v[60:61]
    v_pk_fma_f32 v[92:93], v[208:209], v[76:77], v[92:93] neg_lo:[1,0,0] neg_hi:[1,0,0]
    v_pk_fma_f32 v[108:109], v[192:193], v[76:77], v[108:109]
    v_pk_mul_f32 v[94:95], v[194:195], v[62:63]
    v_pk_mul_f32 v[110:111], v[210:211], v[62:63]
    v_pk_fma_f32 v[94:95], v[210:211], v[78:79], v[94:95] neg_lo:[1,0,0] neg_hi:[1,0,0]
    v_pk_fma_f32 v[110:111], v[194:195], v[78:79], v[110:111]
    v_cvt_pk_bf16_f32 v212, v80, v81
    v_cvt_pk_bf16_f32 v213, v82, v83
    v_cvt_pk_bf16_f32 v214, v84, v85
    v_cvt_pk_bf16_f32 v215, v86, v87
    v_cvt_pk_bf16_f32 v216, v88, v89
    v_cvt_pk_bf16_f32 v217, v90, v91
    v_cvt_pk_bf16_f32 v218, v92, v93
    v_cvt_pk_bf16_f32 v219, v94, v95
    v_cvt_pk_bf16_f32 v220, v96, v97
    v_cvt_pk_bf16_f32 v221, v98, v99
    v_cvt_pk_bf16_f32 v222, v100, v101
    v_cvt_pk_bf16_f32 v223, v102, v103
    v_cvt_pk_bf16_f32 v224, v104, v105
    v_cvt_pk_bf16_f32 v225, v106, v107
    v_cvt_pk_bf16_f32 v226, v108, v109
    v_cvt_pk_bf16_f32 v227, v110, v111
    v_mfma_f32_32x32x16_bf16 v[180:195], v[212:215], a[16:19], 0
    v_mfma_f32_32x32x16_bf16 v[196:211], v[220:223], a[16:19], 0
    v_mfma_f32_32x32x16_bf16 v[180:195], v[220:223], v[172:175], v[180:195]
    v_mfma_f32_32x32x16_bf16 v[196:211], v[212:215], v[164:167], v[196:211]
    v_mfma_f32_32x32x16_bf16 v[180:195], v[216:219], a[20:23], v[180:195]
    v_mfma_f32_32x32x16_bf16 v[196:211], v[224:227], a[20:23], v[196:211]
    v_mfma_f32_32x32x16_bf16 v[180:195], v[224:227], v[176:179], v[180:195]
    v_mfma_f32_32x32x16_bf16 v[196:211], v[216:219], v[168:171], v[196:211]
    s_cmp_eq_u32 s26, 0
    s_cbranch_scc1 k2_kernel_even
    s_nop 8
    ds_write_b128 v8, v[180:183] offset:4096
    ds_write_b128 v8, v[196:199] offset:6144
    ds_write_b128 v8, v[184:187] offset:5120
    ds_write_b128 v8, v[200:203] offset:7168
    v_mov_b32 v4, 1
    ds_write_b32 v9, v4 offset:4
k2_kernel_spin1:
    ds_read_b32 v4, v9 offset:0
    s_waitcnt lgkmcnt(0)
    v_readfirstlane_b32 s23, v4
    s_nop 1
    s_cmp_eq_u32 s23, 0
    s_cbranch_scc1 k2_kernel_spin1
    ds_read_b128 v[80:83], v8 offset:0
    ds_read_b128 v[96:99], v8 offset:2048
    ds_read_b128 v[84:87], v8 offset:1024
    ds_read_b128 v[100:103], v8 offset:3072
    s_waitcnt lgkmcnt(3)
    v_pk_add_f32 v[12:13], v[188:189], v[80:81]
    s_waitcnt lgkmcnt(2)
    v_pk_add_f32 v[28:29], v[204:205], v[96:97]
    v_pk_add_f32 v[14:15], v[190:191], v[82:83]
    v_pk_add_f32 v[30:31], v[206:207], v[98:99]
    v_cvt_pk_bf16_f32 v112, v12, v28
    v_cvt_pk_bf16_f32 v113, v13, v29
    v_cvt_pk_bf16_f32 v114, v14, v30
    v_cvt_pk_bf16_f32 v115, v15, v31
    buffer_store_dwordx4 v[112:115], v128, s[44:47], s36 offen
    v_pk_add_f32 v[20:21], v[188:189], v[80:81] neg_lo:[1,0] neg_hi:[1,0]
    v_pk_add_f32 v[36:37], v[204:205], v[96:97] neg_lo:[1,0] neg_hi:[1,0]
    v_pk_add_f32 v[22:23], v[190:191], v[82:83] neg_lo:[1,0] neg_hi:[1,0]
    v_pk_add_f32 v[38:39], v[206:207], v[98:99] neg_lo:[1,0] neg_hi:[1,0]
    v_cvt_pk_bf16_f32 v116, v20, v36
    v_cvt_pk_bf16_f32 v117, v21, v37
    v_cvt_pk_bf16_f32 v118, v22, v38
    v_cvt_pk_bf16_f32 v119, v23, v39
    buffer_store_dwordx4 v[116:119], v128, s[44:47], s38 offen
    s_waitcnt lgkmcnt(1)
    v_pk_add_f32 v[16:17], v[192:193], v[84:85]
    s_waitcnt lgkmcnt(0)
    v_pk_add_f32 v[32:33], v[208:209], v[100:101]
    v_pk_add_f32 v[18:19], v[194:195], v[86:87]
    v_pk_add_f32 v[34:35], v[210:211], v[102:103]
    v_cvt_pk_bf16_f32 v120, v16, v32
    v_cvt_pk_bf16_f32 v121, v17, v33
    v_cvt_pk_bf16_f32 v122, v18, v34
    v_cvt_pk_bf16_f32 v123, v19, v35
    buffer_store_dwordx4 v[120:123], v128, s[44:47], s37 offen
    v_pk_add_f32 v[24:25], v[192:193], v[84:85] neg_lo:[1,0] neg_hi:[1,0]
    v_pk_add_f32 v[40:41], v[208:209], v[100:101] neg_lo:[1,0] neg_hi:[1,0]
    v_pk_add_f32 v[26:27], v[194:195], v[86:87] neg_lo:[1,0] neg_hi:[1,0]
    v_pk_add_f32 v[42:43], v[210:211], v[102:103] neg_lo:[1,0] neg_hi:[1,0]
    v_cvt_pk_bf16_f32 v124, v24, v40
    v_cvt_pk_bf16_f32 v125, v25, v41
    v_cvt_pk_bf16_f32 v126, v26, v42
    v_cvt_pk_bf16_f32 v127, v27, v43
    buffer_store_dwordx4 v[124:127], v128, s[44:47], s39 offen
    s_endpgm
k2_kernel_even:
    s_nop 8
    ds_write_b128 v8, v[188:191] offset:0
    ds_write_b128 v8, v[204:207] offset:2048
    ds_write_b128 v8, v[192:195] offset:1024
    ds_write_b128 v8, v[208:211] offset:3072
    v_mov_b32 v4, 1
    ds_write_b32 v9, v4 offset:0
k2_kernel_spin0:
    ds_read_b32 v4, v9 offset:4
    s_waitcnt lgkmcnt(0)
    v_readfirstlane_b32 s23, v4
    s_nop 1
    s_cmp_eq_u32 s23, 0
    s_cbranch_scc1 k2_kernel_spin0
    ds_read_b128 v[80:83], v8 offset:4096
    ds_read_b128 v[96:99], v8 offset:6144
    ds_read_b128 v[84:87], v8 offset:5120
    ds_read_b128 v[100:103], v8 offset:7168
    s_waitcnt lgkmcnt(3)
    v_pk_add_f32 v[12:13], v[180:181], v[80:81]
    s_waitcnt lgkmcnt(2)
    v_pk_add_f32 v[28:29], v[196:197], v[96:97]
    v_pk_add_f32 v[14:15], v[182:183], v[82:83]
    v_pk_add_f32 v[30:31], v[198:199], v[98:99]
    v_cvt_pk_bf16_f32 v112, v12, v28
    v_cvt_pk_bf16_f32 v113, v13, v29
    v_cvt_pk_bf16_f32 v114, v14, v30
    v_cvt_pk_bf16_f32 v115, v15, v31
    buffer_store_dwordx4 v[112:115], v128, s[44:47], s36 offen
    v_pk_add_f32 v[20:21], v[180:181], v[80:81] neg_lo:[0,1] neg_hi:[0,1]
    v_pk_add_f32 v[36:37], v[196:197], v[96:97] neg_lo:[0,1] neg_hi:[0,1]
    v_pk_add_f32 v[22:23], v[182:183], v[82:83] neg_lo:[0,1] neg_hi:[0,1]
    v_pk_add_f32 v[38:39], v[198:199], v[98:99] neg_lo:[0,1] neg_hi:[0,1]
    v_cvt_pk_bf16_f32 v116, v20, v36
    v_cvt_pk_bf16_f32 v117, v21, v37
    v_cvt_pk_bf16_f32 v118, v22, v38
    v_cvt_pk_bf16_f32 v119, v23, v39
    buffer_store_dwordx4 v[116:119], v128, s[44:47], s38 offen
    s_waitcnt lgkmcnt(1)
    v_pk_add_f32 v[16:17], v[184:185], v[84:85]
    s_waitcnt lgkmcnt(0)
    v_pk_add_f32 v[32:33], v[200:201], v[100:101]
    v_pk_add_f32 v[18:19], v[186:187], v[86:87]
    v_pk_add_f32 v[34:35], v[202:203], v[102:103]
    v_cvt_pk_bf16_f32 v120, v16, v32
    v_cvt_pk_bf16_f32 v121, v17, v33
    v_cvt_pk_bf16_f32 v122, v18, v34
    v_cvt_pk_bf16_f32 v123, v19, v35
    buffer_store_dwordx4 v[120:123], v128, s[44:47], s37 offen
    v_pk_add_f32 v[24:25], v[184:185], v[84:85] neg_lo:[0,1] neg_hi:[0,1]
    v_pk_add_f32 v[40:41], v[200:201], v[100:101] neg_lo:[0,1] neg_hi:[0,1]
    v_pk_add_f32 v[26:27], v[186:187], v[86:87] neg_lo:[0,1] neg_hi:[0,1]
    v_pk_add_f32 v[42:43], v[202:203], v[102:103] neg_lo:[0,1] neg_hi:[0,1]
    v_cvt_pk_bf16_f32 v124, v24, v40
    v_cvt_pk_bf16_f32 v125, v25, v41
    v_cvt_pk_bf16_f32 v126, v26, v42
    v_cvt_pk_bf16_f32 v127, v27, v43
    buffer_store_dwordx4 v[124:127], v128, s[44:47], s39 offen
    s_endpgm
.p2align 12
k2_kernel_al1:
k2_kernel_gv:
    s_sub_u32 s18, s17, 289
    s_lshl_b32 s18, s18, 1
    s_and_b32 s25, s16, 1
    s_add_u32 s18, s18, s25
    s_cmp_ge_u32 s18, 432
    s_cbranch_scc1 k2_kernel_end
    s_mul_i32 s24, s18, 1821
    s_lshr_b32 s24, s24, 16
    s_mul_i32 s25, s24, 36
    s_sub_u32 s26, s18, s25
    s_add_u32 s23, s26, 18
    s_waitcnt vmcnt(0) lgkmcnt(0)
    s_barrier
    s_mov_b32 s32, s6
    s_mov_b32 s33, s7
    s_mov_b32 s34, 1152
    s_mov_b32 s35, 0x20000
    s_mov_b32 s36, s8
    s_mov_b32 s37, s9
    s_mov_b32 s38, 3981312
    s_mov_b32 s39, 0x20000
    v_lshrrev_b32 v12, 3, v1
    s_mul_i32 s40, s16, 0
    s_mul_i32 s41, s24, 48
    s_add_u32 s40, s40, s41
    v_add_u32 v12, s40, v12
    v_mul_u32_u24 v13, 6912, v12
    v_and_b32 v4, 7, v1
    v_lshl_add_u32 v13, v4, 4, v13
    v_lshlrev_b32 v12, 1, v12
    s_lshl_b32 s41, s23, 7
    buffer_load_ushort v14, v12, s[32:35], 0 offen offset:0
    buffer_load_ushort v15, v12, s[32:35], 0 offen offset:16
    buffer_load_ushort v16, v12, s[32:35], 0 offen offset:32
    buffer_load_ushort v17, v12, s[32:35], 0 offen offset:48
    buffer_load_ushort v18, v12, s[32:35], 0 offen offset:64
    buffer_load_ushort v19, v12, s[32:35], 0 offen offset:80
    buffer_load_dwordx4 v[20:23], v13, s[36:39], s41 offen
    s_add_u32 s41, s41, 55296
    buffer_load_dwordx4 v[24:27], v13, s[36:39], s41 offen
    s_add_u32 s41, s41, 55296
    buffer_load_dwordx4 v[28:31], v13, s[36:39], s41 offen
    s_add_u32 s41, s41, 55296
    buffer_load_dwordx4 v[32:35], v13, s[36:39], s41 offen
    s_add_u32 s41, s41, 55296
    buffer_load_dwordx4 v[36:39], v13, s[36:39], s41 offen
    s_add_u32 s41, s41, 55296
    buffer_load_dwordx4 v[40:43], v13, s[36:39], s41 offen
    s_and_b32 s42, s16, 1
    s_lshr_b32 s48, s2, 3
    s_sub_u32 s48, s48, 5
    s_cmp_ge_u32 s48, 26
    s_cselect_b32 s48, 999, s48
    s_mul_i32 s49, s42, 26
    s_add_u32 s48, s48, s49
    s_add_u32 s48, s48, 84
    s_cmp_ge_u32 s48, 116
    s_cselect_b32 s46, 0, 5308416
    s_and_b32 s43, s2, 7
    s_mov_b32 s47, 0x20000
    s_cmp_ge_u32 s48, 162
    s_cbranch_scc1 k2_kernel_pfwdk2
    s_mul_i32 s49, s48, 7282
    s_lshr_b32 s49, s49, 16
    s_mul_i32 s50, s49, 9
    s_sub_u32 s50, s48, s50
    s_cmp_lt_u32 s48, 72
    s_cbranch_scc0 k2_kernel_pfgok2x
    s_and_b32 s49, s48, 7
    s_lshr_b32 s50, s48, 3
k2_kernel_pfgok2x:
    s_mov_b32 s48, s50
    s_mul_i32 s48, s48, 589824
    v_mul_u32_u24 v56, 9216, v1
    s_mul_i32 s43, s43, 1152
    s_add_u32 s43, s43, s48
    s_lshr_b32 s50, s49, 2
    s_lshl_b32 s50, s50, 7
    s_add_u32 s43, s43, s50
    s_bfe_u32 s50, s49, 0x10001
    s_mul_i32 s50, s50, 640
    s_add_u32 s43, s43, s50
    s_bitcmp1_b32 s49, 0
    s_cselect_b32 s44, s12, s10
    s_cselect_b32 s45, s13, s11
    s_branch k2_kernel_pfgok2
k2_kernel_pfwdk2:
    s_sub_u32 s48, s48, 162
    s_lshl_b32 s48, s48, 13
    s_mul_i32 s43, s43, 663552
    s_add_u32 s43, s43, s48
    v_lshlrev_b32 v56, 7, v1
    s_mov_b32 s44, s14
    s_mov_b32 s45, s15
k2_kernel_pfgok2:
    buffer_load_dword v56, v56, s[44:47], s43 offen
    s_mov_b32 s48, 0xffff0000
    s_mov_b32 s49, 0xbfb8aa3b
    v_mov_b32 v44, 0
    v_mov_b32 v45, 0
    v_mov_b32 v46, 0
    v_mov_b32 v47, 0
    v_mov_b32 v48, 0
    v_mov_b32 v49, 0
    v_mov_b32 v50, 0
    v_mov_b32 v51, 0
    v_and_b32 v4, 7, v1
    v_lshrrev_b32 v5, 3, v1
    v_lshl_add_u32 v4, v4, 3, v5
    s_mul_i32 s40, s16, 0
    v_lshl_add_u32 v57, v4, 2, s40
    v_and_b32 v4, 8, v1
    v_cmp_ne_u32 vcc, 0, v4
    s_waitcnt vmcnt(12)
    v_lshlrev_b32 v14, 16, v14
    s_waitcnt vmcnt(11)
    v_lshlrev_b32 v15, 16, v15
    s_waitcnt vmcnt(10)
    v_lshlrev_b32 v16, 16, v16
    s_waitcnt vmcnt(9)
    v_lshlrev_b32 v17, 16, v17
    s_waitcnt vmcnt(8)
    v_lshlrev_b32 v18, 16, v18
    s_waitcnt vmcnt(7)
    v_lshlrev_b32 v19, 16, v19
    v_mul_f32 v58, s49, v14
    v_mul_f32 v59, s49, v15
    v_mul_f32 v60, s49, v16
    v_mul_f32 v61, s49, v17
    v_mul_f32 v62, s49, v18
    v_mul_f32 v63, s49, v19
    v_exp_f32 v58, v58
    v_exp_f32 v59, v59
    v_exp_f32 v60, v60
    v_exp_f32 v61, v61
    v_exp_f32 v62, v62
    v_exp_f32 v63, v63
    v_add_f32 v58, 1.0, v58
    v_add_f32 v59, 1.0, v59
    v_add_f32 v60, 1.0, v60
    v_add_f32 v61, 1.0, v61
    v_add_f32 v62, 1.0, v62
    v_add_f32 v63, 1.0, v63
    v_rcp_f32 v58, v58
    v_rcp_f32 v59, v59
    v_rcp_f32 v60, v60
    v_rcp_f32 v61, v61
    v_rcp_f32 v62, v62
    v_rcp_f32 v63, v63
    v_mul_f32 v58, v58, v14
    v_mul_f32 v59, v59, v15
    v_mul_f32 v60, v60, v16
    v_mul_f32 v61, v61, v17
    v_mul_f32 v62, v62, v18
    v_mul_f32 v63, v63, v19
    v_cvt_pk_bf16_f32 v58, v58, v58
    v_cvt_pk_bf16_f32 v59, v59, v59
    v_cvt_pk_bf16_f32 v60, v60, v60
    v_cvt_pk_bf16_f32 v61, v61, v61
    v_cvt_pk_bf16_f32 v62, v62, v62
    v_cvt_pk_bf16_f32 v63, v63, v63
    v_and_b32 v64, s48, v58
    s_waitcnt vmcnt(6)
    v_lshlrev_b32 v52, 16, v20
    v_and_b32 v53, s48, v20
    v_pk_fma_f32 v[44:45], v[52:53], v[64:65], v[44:45] op_sel_hi:[1,0,1]
    v_lshlrev_b32 v54, 16, v21
    v_and_b32 v55, s48, v21
    v_pk_fma_f32 v[46:47], v[54:55], v[64:65], v[46:47] op_sel_hi:[1,0,1]
    v_lshlrev_b32 v52, 16, v22
    v_and_b32 v53, s48, v22
    v_pk_fma_f32 v[48:49], v[52:53], v[64:65], v[48:49] op_sel_hi:[1,0,1]
    v_lshlrev_b32 v54, 16, v23
    v_and_b32 v55, s48, v23
    v_pk_fma_f32 v[50:51], v[54:55], v[64:65], v[50:51] op_sel_hi:[1,0,1]
    v_and_b32 v64, s48, v59
    s_waitcnt vmcnt(5)
    v_lshlrev_b32 v52, 16, v24
    v_and_b32 v53, s48, v24
    v_pk_fma_f32 v[44:45], v[52:53], v[64:65], v[44:45] op_sel_hi:[1,0,1]
    v_lshlrev_b32 v54, 16, v25
    v_and_b32 v55, s48, v25
    v_pk_fma_f32 v[46:47], v[54:55], v[64:65], v[46:47] op_sel_hi:[1,0,1]
    v_lshlrev_b32 v52, 16, v26
    v_and_b32 v53, s48, v26
    v_pk_fma_f32 v[48:49], v[52:53], v[64:65], v[48:49] op_sel_hi:[1,0,1]
    v_lshlrev_b32 v54, 16, v27
    v_and_b32 v55, s48, v27
    v_pk_fma_f32 v[50:51], v[54:55], v[64:65], v[50:51] op_sel_hi:[1,0,1]
    v_and_b32 v64, s48, v60
    s_waitcnt vmcnt(4)
    v_lshlrev_b32 v52, 16, v28
    v_and_b32 v53, s48, v28
    v_pk_fma_f32 v[44:45], v[52:53], v[64:65], v[44:45] op_sel_hi:[1,0,1]
    v_lshlrev_b32 v54, 16, v29
    v_and_b32 v55, s48, v29
    v_pk_fma_f32 v[46:47], v[54:55], v[64:65], v[46:47] op_sel_hi:[1,0,1]
    v_lshlrev_b32 v52, 16, v30
    v_and_b32 v53, s48, v30
    v_pk_fma_f32 v[48:49], v[52:53], v[64:65], v[48:49] op_sel_hi:[1,0,1]
    v_lshlrev_b32 v54, 16, v31
    v_and_b32 v55, s48, v31
    v_pk_fma_f32 v[50:51], v[54:55], v[64:65], v[50:51] op_sel_hi:[1,0,1]
    v_and_b32 v64, s48, v61
    s_waitcnt vmcnt(3)
    v_lshlrev_b32 v52, 16, v32
    v_and_b32 v53, s48, v32
    v_pk_fma_f32 v[44:45], v[52:53], v[64:65], v[44:45] op_sel_hi:[1,0,1]
    v_lshlrev_b32 v54, 16, v33
    v_and_b32 v55, s48, v33
    v_pk_fma_f32 v[46:47], v[54:55], v[64:65], v[46:47] op_sel_hi:[1,0,1]
    v_lshlrev_b32 v52, 16, v34
    v_and_b32 v53, s48, v34
    v_pk_fma_f32 v[48:49], v[52:53], v[64:65], v[48:49] op_sel_hi:[1,0,1]
    v_lshlrev_b32 v54, 16, v35
    v_and_b32 v55, s48, v35
    v_pk_fma_f32 v[50:51], v[54:55], v[64:65], v[50:51] op_sel_hi:[1,0,1]
    v_and_b32 v64, s48, v62
    s_waitcnt vmcnt(2)
    v_lshlrev_b32 v52, 16, v36
    v_and_b32 v53, s48, v36
    v_pk_fma_f32 v[44:45], v[52:53], v[64:65], v[44:45] op_sel_hi:[1,0,1]
    v_lshlrev_b32 v54, 16, v37
    v_and_b32 v55, s48, v37
    v_pk_fma_f32 v[46:47], v[54:55], v[64:65], v[46:47] op_sel_hi:[1,0,1]
    v_lshlrev_b32 v52, 16, v38
    v_and_b32 v53, s48, v38
    v_pk_fma_f32 v[48:49], v[52:53], v[64:65], v[48:49] op_sel_hi:[1,0,1]
    v_lshlrev_b32 v54, 16, v39
    v_and_b32 v55, s48, v39
    v_pk_fma_f32 v[50:51], v[54:55], v[64:65], v[50:51] op_sel_hi:[1,0,1]
    v_and_b32 v64, s48, v63
    s_waitcnt vmcnt(1)
    v_lshlrev_b32 v52, 16, v40
    v_and_b32 v53, s48, v40
    v_pk_fma_f32 v[44:45], v[52:53], v[64:65], v[44:45] op_sel_hi:[1,0,1]
    v_lshlrev_b32 v54, 16, v41
    v_and_b32 v55, s48, v41
    v_pk_fma_f32 v[46:47], v[54:55], v[64:65], v[46:47] op_sel_hi:[1,0,1]
    v_lshlrev_b32 v52, 16, v42
    v_and_b32 v53, s48, v42
    v_pk_fma_f32 v[48:49], v[52:53], v[64:65], v[48:49] op_sel_hi:[1,0,1]
    v_lshlrev_b32 v54, 16, v43
    v_and_b32 v55, s48, v43
    v_pk_fma_f32 v[50:51], v[54:55], v[64:65], v[50:51] op_sel_hi:[1,0,1]
    v_permlane32_swap_b32 v44, v48
    v_permlane32_swap_b32 v45, v49
    v_permlane32_swap_b32 v46, v50
    v_permlane32_swap_b32 v47, v51
    v_add_f32 v44, v44, v48
    v_add_f32 v45, v45, v49
    v_add_f32 v46, v46, v50
    v_add_f32 v47, v47, v51
    s_nop 0
    v_permlane16_swap_b32 v44, v46
    v_permlane16_swap_b32 v45, v47
    v_add_f32 v44, v44, v46
    v_add_f32 v45, v45, v47
    s_nop 0
    v_add_f32_dpp v44, v44, v44 row_ror:8 row_mask:0xf bank_mask:0xf
    v_add_f32_dpp v45, v45, v45 row_ror:8 row_mask:0xf bank_mask:0xf
    v_cndmask_b32 v44, v44, v45, vcc
    v_mov_b32 v4, v57
    s_add_u32 s52, s4, 5120
    s_addc_u32 s53, s5, 0
    s_mov_b32 s54, 9216
    s_mov_b32 s55, 0x20000
    s_cmp_lt_u32 s26, 9
    s_cselect_b32 s28, 0x35e38e39, 1.0
    s_sub_u32 s18, s26, 18
    s_cmp_lt_u32 s18, 9
    s_cselect_b32 s27, 1.0, 0
    s_cmp_eq_u32 s24, 0
    s_cselect_b32 s27, s27, 0
    s_mul_i32 s25, s26, 57
    s_lshr_b32 s25, s25, 9
    s_mul_i32 s18, s25, 9
    s_sub_u32 s18, s26, s18
    v_lshrrev_b32 v4, 2, v4
    v_bfe_u32 v5, v4, 2, 3
    v_lshlrev_b32 v5, 8, v5
    v_lshrrev_b32 v6, 5, v4
    v_lshl_add_u32 v5, v6, 4, v5
    v_bfe_u32 v7, v4, 4, 1
    v_lshl_add_u32 v6, v7, 1, v6
    v_bfe_u32 v7, v4, 2, 2
    v_lshl_add_u32 v6, v7, 2, v6
    v_lshlrev_b32 v6, 4, v6
    s_cmp_eq_u32 s18, 8
    s_cselect_b64 vcc, -1, 0
    v_cndmask_b32 v5, v5, v6, vcc
    v_and_b32 v6, 3, v4
    v_lshl_add_u32 v5, v6, 2, v5
    v_lshlrev_b32 v4, 2, v4
    s_lshl_b32 s24, s18, 5
    s_cmp_eq_u32 s18, 8
    s_cselect_b32 s24, 2048, s24
    s_lshl_b32 s18, s18, 8
    s_cmp_eq_u32 s25, 3
    s_cselect_b32 s18, s18, s24
    s_cselect_b64 vcc, -1, 0
    v_cndmask_b32 v4, v5, v4, vcc
    s_mul_i32 s25, s25, 2304
    s_add_u32 s18, s18, s25
    v_add_f32 v44, s27, v44
    v_mul_f32 v44, s28, v44
    buffer_atomic_add_f32 v44, v4, s[52:55], s18 offen
k2_kernel_gv_done:
k2_kernel_end:
    s_endpgm
.p2align 12
.fill 832, 4, 0xbf800000
.globl k4_kernel
.p2align 8
.type k4_kernel,@function
k4_kernel:
    s_cmp_ge_u32 s2, 256
    s_cbranch_scc1 k4_kernel_end
    s_load_dwordx2 s[4:5], s[0:1], 88
    s_load_dwordx2 s[6:7], s[0:1], 0
    s_load_dwordx2 s[8:9], s[0:1], 32
    s_load_dwordx2 s[10:11], s[0:1], 40
    s_load_dwordx2 s[12:13], s[0:1], 48
    s_load_dwordx2 s[14:15], s[0:1], 72
    v_and_b32 v1, 63, v0
    v_lshlrev_b32 v2, 4, v1
    v_mov_b32 v3, 0
    v_lshrrev_b32 v4, 6, v0
    s_nop 0
    v_readfirstlane_b32 s16, v4
    s_and_b32 s19, s2, 7
    s_bfe_u32 s20, s2, 0x10003
    s_lshr_b32 s21, s2, 4
    s_lshr_b32 s22, s16, 1
    s_and_b32 s23, s16, 1
    s_getpc_b64 s[46:47]
k4_kernel_pc5:
    s_add_u32 s46, s46, tabs+26624-k4_kernel_pc5
    s_addc_u32 s47, s47, 0
    s_mul_i32 s48, s16, 3072
    s_add_u32 s46, s46, s48
    s_addc_u32 s47, s47, 0
    s_add_u32 m0, s48, 98304
    v_lshl_add_u64 v[44:45], v[2:3], 0, s[46:47]
    global_load_lds_dwordx4 v[44:45], off offset:0
    global_load_lds_dwordx4 v[44:45], off offset:1024
    global_load_lds_dwordx4 v[44:45], off offset:2048
    s_lshl_b32 s44, s21, 4
    s_lshl_b32 s17, s19, 1
    s_add_u32 s44, s44, s17
    s_add_u32 s44, s44, s20
    v_and_b32 v36, 15, v1
    v_lshrrev_b32 v37, 4, v1
    v_lshlrev_b32 v38, 2, v37
    v_lshl_add_u32 v46, v36, 5, v38
    v_and_b32 v39, 1, v1
    v_lshl_add_u32 v47, v39, 5, v38
    v_bfe_u32 v40, v1, 1, 1
    v_lshl_add_u32 v47, v40, 4, v47
    v_add_u32 v47, 512, v47
    v_lshlrev_b32 v48, 1, v46
    v_bfe_u32 v41, v1, 2, 1
    v_mul_u32_u24 v49, 1152, v41
    v_lshl_add_u32 v49, v47, 1, v49
    v_and_b32 v42, 8, v1
    v_lshlrev_b32 v42, 24, v42
    v_add_u32 v51, v49, v42
    s_lshl_b32 s49, s44, 3
    s_lshl_b32 s17, s16, 1
    s_add_u32 s49, s49, s17
    s_mul_i32 s49, s49, 1152
    s_add_u32 s50, s49, 1152
    s_mul_i32 s17, s44, 9344
    s_lshl_b32 s18, s16, 10
    s_add_u32 s17, s17, s18
    s_add_u32 m0, s18, 86016
    s_waitcnt lgkmcnt(0)
    s_add_u32 s56, s4, 7340032
    s_addc_u32 s57, s5, 0
    s_mov_b32 s58, 2396160
    s_mov_b32 s59, 0x20000
    buffer_load_dwordx4 v2, s[56:59], s17 offen lds
    s_add_u32 s17, s17, 4096
    s_add_u32 m0, m0, 4096
    s_nop 0
    buffer_load_dwordx4 v2, s[56:59], s17 offen lds
    s_add_u32 s17, s17, 4096
    s_add_u32 m0, m0, 4096
    s_nop 0
    buffer_load_dwordx4 v2, s[56:59], s17 offen lds
    s_add_u32 s60, s4, 5120
    s_addc_u32 s61, s5, 0
    s_mov_b32 s62, 9216
    s_mov_b32 s63, 0x20000
    s_mov_b32 s64, s6
    s_mov_b32 s65, s7
    s_mov_b32 s66, 2359296
    s_mov_b32 s67, 0x20000
    s_lshl_b32 s17, s16, 11
    s_add_u32 m0, s17, 110592
    s_nop 0
    buffer_load_dwordx4 v2, s[60:63], s17 offen lds
    buffer_load_dwordx4 v2, s[60:63], s17 offen offset:1024 lds
    s_add_u32 m0, s18, 159744
    s_add_u32 s17, s18, 6912
    buffer_load_dwordx4 v2, s[60:63], s17 offen lds
    buffer_load_dwordx2 v[24:25], v48, s[64:67], s49 offen offset:0
    buffer_load_dwordx2 v[26:27], v48, s[64:67], s49 offen offset:32
    buffer_load_dwordx2 v[28:29], v48, s[64:67], s50 offen offset:0
    buffer_load_dwordx2 v[30:31], v48, s[64:67], s50 offen offset:32
    buffer_load_dwordx2 v[32:33], v51, s[64:67], s49 offen
    s_mov_b64 exec, 0
    s_branch k4_kernel_pg0_0
k4_kernel_back0:
    s_mov_b64 exec, -1
    s_add_u32 s24, s4, 13631488
    s_addc_u32 s25, s5, 0
    s_mov_b32 s26, 2359296
    s_mov_b32 s27, 0x20000
    v_and_b32 v47, 3, v1
    v_add_u32 v47, v47, v38
    v_lshlrev_b32 v47, 4, v47
    s_lshl_b32 s17, s16, 5
    s_add_u32 s17, s17, 118784
    v_lshl_add_u32 v52, v37, 7, s17
    v_mul_u32_u24 v53, 528, v39
    v_add_u32 v53, v53, v52
    v_lshl_add_u32 v53, v41, 4, v53
    v_lshl_add_u32 v53, v40, 3, v53
    v_mul_u32_u24 v43, 528, v36
    v_add_u32 v52, v43, v52
    v_bfe_u32 v43, v1, 2, 2
    v_cmp_eq_u32 vcc, 0, v43
    s_nop 1
    v_cndmask_b32 v54, 0, 1.0, vcc
    v_cmp_eq_u32 vcc, 1, v43
    s_nop 1
    v_cndmask_b32 v55, 0, 1.0, vcc
    v_mul_u32_u24 v64, 0x8000, v39
    v_lshl_or_b32 v64, v64, 16, v64
    v_mov_b32 v62, 0
    v_mov_b32 v63, 0
    v_mov_b32 v38, 132096
    ds_write_b64 v38, v[62:63]
    v_lshrrev_b32 v36, 2, v1
    v_mul_u32_u24 v36, 18, v36
    v_and_b32 v37, 3, v1
    v_add_u32 v36, v36, v37
    s_lshl_b32 s51, s16, 3
    s_add_u32 s51, s51, 86016
    v_lshl_add_u32 v56, v36, 5, s51
    v_add_u32 v58, 128, v56
    v_add_u32 v60, 256, v56
    v_sub_u32 v36, 288, v36
    v_lshl_add_u32 v57, v36, 5, s51
    v_subrev_u32 v59, 128, v57
    v_subrev_u32 v61, 256, v57
    v_cmp_lt_u32 vcc, 1, v37
    s_nop 1
    v_cndmask_b32 v60, v60, v38, vcc
    v_cmp_lt_u32 vcc, 0, v37
    s_nop 1
    v_cndmask_b32 v61, v61, v38, vcc
    v_cmp_eq_u32 vcc, 0, v37
    v_cmp_ne_u32 s[52:53], 0, v1
    s_nop 1
    s_and_b64 vcc, vcc, s[52:53]
    v_cndmask_b32 v57, v57, v38, vcc
    v_lshrrev_b32 v65, 5, v0
    v_add_u32 v65, v65, v0
    v_lshlrev_b32 v65, 4, v65
    v_add_u32 v65, 118784, v65
    v_and_b32 v36, 7, v0
    v_bfe_u32 v37, v0, 3, 2
    v_lshlrev_b32 v36, 4, v36
    v_lshl_add_u32 v36, v37, 8, v36
    v_lshrrev_b32 v37, 5, v0
    v_lshl_add_u32 v66, v37, 12, v36
    v_add_u32 v67, 32768, v66
    v_mov_b32 v37, 0x40000000
    v_add_u32 v68, 65536, v66
    v_cmp_gt_u32 vcc, 64, v0
    s_nop 1
    v_cndmask_b32 v68, v37, v68, vcc
    v_add_u32 v46, 110592, v2
    v_add_u32 v47, 112640, v47
    s_lshr_b32 s76, s2, 3
    s_sub_u32 s76, s76, 0
    s_cmp_ge_u32 s76, 32
    s_cselect_b32 s76, 999, s76
    s_mul_i32 s77, s16, 32
    s_add_u32 s76, s76, s77
    s_add_u32 s76, s76, 0
    s_cmp_ge_u32 s76, 84
    s_cselect_b32 s74, 0, 5308416
    s_and_b32 s68, s2, 7
    s_mov_b32 s75, 0x20000
    s_cmp_ge_u32 s76, 162
    s_cbranch_scc1 k4_kernel_pfwdk3
    s_mul_i32 s77, s76, 7282
    s_lshr_b32 s77, s77, 16
    s_mul_i32 s78, s77, 9
    s_sub_u32 s78, s76, s78
    s_cmp_lt_u32 s76, 72
    s_cbranch_scc0 k4_kernel_pfgok3x
    s_and_b32 s77, s76, 7
    s_lshr_b32 s78, s76, 3
k4_kernel_pfgok3x:
    s_mov_b32 s76, s78
    s_mul_i32 s76, s76, 589824
    v_mul_u32_u24 v69, 9216, v1
    s_mul_i32 s68, s68, 1152
    s_add_u32 s68, s68, s76
    s_lshr_b32 s78, s77, 2
    s_lshl_b32 s78, s78, 7
    s_add_u32 s68, s68, s78
    s_bfe_u32 s78, s77, 0x10001
    s_mul_i32 s78, s78, 640
    s_add_u32 s68, s68, s78
    s_bitcmp1_b32 s77, 0
    s_cselect_b32 s72, s10, s8
    s_cselect_b32 s73, s11, s9
    s_branch k4_kernel_pfgok3
k4_kernel_pfwdk3:
    s_sub_u32 s76, s76, 162
    s_lshl_b32 s76, s76, 13
    s_mul_i32 s68, s68, 663552
    s_add_u32 s68, s68, s76
    v_lshlrev_b32 v69, 7, v1
    s_mov_b32 s72, s12
    s_mov_b32 s73, s13
k4_kernel_pfgok3:
    s_lshl_b32 s17, s21, 1
    s_add_u32 s17, s17, s22
    s_mul_i32 s28, s17, 73728
    s_lshl_b32 s18, s23, 11
    s_add_u32 s28, s28, s18
    s_lshl_b32 s29, s16, 11
    s_add_u32 s29, s29, 86016
    s_mul_i32 s30, s16, 3072
    s_mul_i32 s32, s19, 1152
    s_mul_i32 s17, s20, 64
    s_add_u32 s33, s32, s17
    s_mul_i32 s17, s23, 147456
    s_add_u32 s33, s33, s17
    s_mul_i32 s17, s20, 640
    s_add_u32 s32, s32, s17
    s_mul_i32 s17, s16, 73728
    s_add_u32 s32, s32, s17
    v_lshrrev_b32 v36, 3, v1
    v_bfe_u32 v37, v1, 1, 2
    v_lshrrev_b32 v38, 4, v1
    v_xor_b32 v37, v37, v38
    v_and_b32 v38, 1, v1
    v_lshl_add_u32 v37, v37, 1, v38
    v_lshlrev_b32 v37, 4, v37
    v_mul_u32_u24 v4, 9216, v36
    v_add_u32 v4, v4, v37
    v_mul_u32_u24 v5, 1152, v36
    v_add_u32 v5, v5, v37
    v_lshrrev_b32 v36, 2, v1
    v_bfe_u32 v37, v1, 1, 1
    v_bfe_u32 v38, v1, 4, 1
    v_xor_b32 v37, v37, v38
    v_and_b32 v39, 1, v1
    v_lshl_add_u32 v37, v37, 1, v39
    v_lshlrev_b32 v37, 4, v37
    v_mul_u32_u24 v6, 9216, v36
    v_add_u32 v6, v6, v37
    v_mul_u32_u24 v7, 1152, v36
    v_add_u32 v7, v7, v37
    v_xor_b32 v38, s23, v38
    v_lshlrev_b32 v38, 5, v38
    v_lshl_add_u32 v38, v36, 6, v38
    v_and_b32 v39, 3, v1
    v_lshl_add_u32 v12, v39, 3, v38
    v_add_u32 v13, 49152, v12
    v_lshrrev_b32 v36, 5, v1
    v_mul_u32_u24 v36, 3072, v36
    v_lshl_add_u32 v36, v39, 3, v36
    v_bfe_u32 v37, v1, 2, 3
    v_lshl_add_u32 v36, v37, 7, v36
    v_bfe_u32 v37, v1, 3, 2
    s_lshl_b32 s17, s23, 1
    v_xor_b32 v37, s17, v37
    v_lshl_add_u32 v8, v37, 5, v36
    v_xor_b32 v9, 32, v8
    v_add_u32 v10, 49152, v8
    v_add_u32 v11, 49152, v9
    s_lshl_b32 s17, s22, 12
    s_add_u32 s17, s17, 86016
    v_add_u32 v16, s17, v2
    v_add_u32 v17, 32768, v16
    s_lshl_b32 s18, s23, 13
    v_add_u32 v14, s18, v16
    s_lshl_b32 s18, s23, 3
    s_add_u32 s18, s18, 65536
    v_add_u32 v15, s18, v16
    s_add_u32 s17, s29, 65536
    v_add_u32 v18, s17, v2
    v_lshlrev_b32 v21, 2, v1
    v_and_b32 v21, 63, v21
    s_sub_u32 s36, s8, 2048
    s_subb_u32 s37, s9, 0
    s_mov_b32 s38, 5310464
    s_mov_b32 s39, 0x20000
    s_sub_u32 s40, s10, 2048
    s_subb_u32 s41, s11, 0
    s_mov_b32 s42, 5310464
    s_mov_b32 s43, 0x20000
    s_waitcnt vmcnt(8) lgkmcnt(0)
    s_barrier
    buffer_load_dword v69, v69, s[72:75], s68 offen
    v_add_u32 v220, 98304, v2
    ds_read_b64_tr_b16 v[72:73], v56
    ds_read_b64_tr_b16 v[74:75], v57
    ds_read_b64_tr_b16 v[76:77], v58
    ds_read_b64_tr_b16 v[78:79], v59
    ds_read_b64_tr_b16 v[80:81], v60
    ds_read_b64_tr_b16 v[82:83], v61
    ds_read_b128 v[136:139], v220 offset:0
    ds_read_b128 v[140:143], v220 offset:1024
    ds_read_b128 v[144:147], v220 offset:2048
    ds_read_b128 v[148:151], v220 offset:3072
    ds_read_b128 v[152:155], v220 offset:4096
    ds_read_b128 v[156:159], v220 offset:5120
    ds_read_b128 v[160:163], v220 offset:6144
    s_waitcnt lgkmcnt(11)
    v_xor_b32 v74, v64, v74
    v_xor_b32 v75, v64, v75
    s_waitcnt lgkmcnt(9)
    v_xor_b32 v78, v64, v78
    v_xor_b32 v79, v64, v79
    s_waitcnt lgkmcnt(7)
    v_xor_b32 v82, v64, v82
    v_xor_b32 v83, v64, v83
    s_waitcnt lgkmcnt(6)
    v_mfma_f32_16x16x32_bf16 v[88:91], v[72:75], v[136:139], 0
    s_waitcnt lgkmcnt(4)
    v_mfma_f32_16x16x32_bf16 v[112:115], v[72:75], v[144:147], 0
    v_mfma_f32_16x16x32_bf16 v[92:95], v[72:75], v[140:143], 0
    s_waitcnt lgkmcnt(3)
    v_mfma_f32_16x16x32_bf16 v[116:119], v[72:75], v[148:151], 0
    v_mfma_f32_16x16x32_bf16 v[96:99], v[76:79], v[136:139], 0
    v_mfma_f32_16x16x32_bf16 v[120:123], v[76:79], v[144:147], 0
    v_mfma_f32_16x16x32_bf16 v[100:103], v[76:79], v[140:143], 0
    v_mfma_f32_16x16x32_bf16 v[124:127], v[76:79], v[148:151], 0
    v_mfma_f32_16x16x32_bf16 v[104:107], v[80:83], v[136:139], 0
    v_mfma_f32_16x16x32_bf16 v[128:131], v[80:83], v[144:147], 0
    v_mfma_f32_16x16x32_bf16 v[108:111], v[80:83], v[140:143], 0
    v_mfma_f32_16x16x32_bf16 v[132:135], v[80:83], v[148:151], 0
    ds_read_b128 v[164:167], v220 offset:7168
    ds_read_b128 v[168:171], v220 offset:8192
    ds_read_b128 v[172:175], v220 offset:9216
    ds_read_b128 v[176:179], v220 offset:10240
    ds_read_b128 v[180:183], v220 offset:11264
    v_mov_b32 v75, 0
    v_mov_b32 v79, 0
    v_mov_b32 v83, 0
    v_mov_b32 v87, 0
    s_mov_b32 s76, 0xffff0000
    s_waitcnt vmcnt(5)
    v_lshlrev_b32 v222, 16, v24
    v_and_b32 v223, s76, v24
    v_lshlrev_b32 v224, 16, v25
    v_and_b32 v225, s76, v25
    s_waitcnt vmcnt(4)
    v_lshlrev_b32 v226, 16, v26
    v_and_b32 v227, s76, v26
    v_lshlrev_b32 v228, 16, v27
    v_and_b32 v229, s76, v27
    s_waitcnt vmcnt(3)
    v_lshlrev_b32 v230, 16, v28
    v_and_b32 v231, s76, v28
    v_lshlrev_b32 v232, 16, v29
    v_and_b32 v233, s76, v29
    s_waitcnt vmcnt(2)
    v_lshlrev_b32 v234, 16, v30
    v_and_b32 v235, s76, v30
    v_lshlrev_b32 v236, 16, v31
    v_and_b32 v237, s76, v31
    s_waitcnt vmcnt(1)
    v_lshlrev_b32 v238, 16, v32
    v_and_b32 v239, s76, v32
    v_lshlrev_b32 v240, 16, v33
    v_and_b32 v241, s76, v33
    v_pk_add_f32 v[88:89], v[88:89], v[112:113] op_sel:[0,1] op_sel_hi:[1,0] neg_lo:[0,1]
    v_pk_add_f32 v[90:91], v[90:91], v[114:115] op_sel:[0,1] op_sel_hi:[1,0] neg_lo:[0,1]
    s_waitcnt lgkmcnt(7)
    v_pk_mul_f32 v[112:113], v[88:89], v[152:153] op_sel_hi:[1,0]
    v_pk_mul_f32 v[114:115], v[90:91], v[152:153] op_sel_hi:[1,0]
    v_pk_fma_f32 v[112:113], v[88:89], v[152:153], v[112:113] op_sel:[1,1,0] op_sel_hi:[0,1,1] neg_lo:[0,1,0]
    v_pk_fma_f32 v[114:115], v[90:91], v[152:153], v[114:115] op_sel:[1,1,0] op_sel_hi:[0,1,1] neg_lo:[0,1,0]
    v_cvt_pk_bf16_f32 v72, v112, v113
    v_cvt_pk_bf16_f32 v80, v114, v115
    v_pk_add_f32 v[92:93], v[92:93], v[116:117] op_sel:[0,1] op_sel_hi:[1,0] neg_lo:[0,1]
    v_pk_add_f32 v[94:95], v[94:95], v[118:119] op_sel:[0,1] op_sel_hi:[1,0] neg_lo:[0,1]
    v_pk_mul_f32 v[116:117], v[92:93], v[154:155] op_sel_hi:[1,0]
    v_pk_mul_f32 v[118:119], v[94:95], v[154:155] op_sel_hi:[1,0]
    v_pk_fma_f32 v[116:117], v[92:93], v[154:155], v[116:117] op_sel:[1,1,0] op_sel_hi:[0,1,1] neg_lo:[0,1,0]
    v_pk_fma_f32 v[118:119], v[94:95], v[154:155], v[118:119] op_sel:[1,1,0] op_sel_hi:[0,1,1] neg_lo:[0,1,0]
    v_cvt_pk_bf16_f32 v76, v116, v117
    v_cvt_pk_bf16_f32 v84, v118, v119
    v_pk_add_f32 v[96:97], v[96:97], v[120:121] op_sel:[0,1] op_sel_hi:[1,0] neg_lo:[0,1]
    v_pk_add_f32 v[98:99], v[98:99], v[122:123] op_sel:[0,1] op_sel_hi:[1,0] neg_lo:[0,1]
    s_waitcnt lgkmcnt(6)
    v_pk_mul_f32 v[120:121], v[96:97], v[156:157] op_sel_hi:[1,0]
    v_pk_mul_f32 v[122:123], v[98:99], v[156:157] op_sel_hi:[1,0]
    v_pk_fma_f32 v[120:121], v[96:97], v[156:157], v[120:121] op_sel:[1,1,0] op_sel_hi:[0,1,1] neg_lo:[0,1,0]
    v_pk_fma_f32 v[122:123], v[98:99], v[156:157], v[122:123] op_sel:[1,1,0] op_sel_hi:[0,1,1] neg_lo:[0,1,0]
    v_cvt_pk_bf16_f32 v73, v120, v121
    v_cvt_pk_bf16_f32 v81, v122, v123
    v_pk_add_f32 v[100:101], v[100:101], v[124:125] op_sel:[0,1] op_sel_hi:[1,0] neg_lo:[0,1]
    v_pk_add_f32 v[102:103], v[102:103], v[126:127] op_sel:[0,1] op_sel_hi:[1,0] neg_lo:[0,1]
    v_pk_mul_f32 v[124:125], v[100:101], v[158:159] op_sel_hi:[1,0]
    v_pk_mul_f32 v[126:127], v[102:103], v[158:159] op_sel_hi:[1,0]
    v_pk_fma_f32 v[124:125], v[100:101], v[158:159], v[124:125] op_sel:[1,1,0] op_sel_hi:[0,1,1] neg_lo:[0,1,0]
    v_pk_fma_f32 v[126:127], v[102:103], v[158:159], v[126:127] op_sel:[1,1,0] op_sel_hi:[0,1,1] neg_lo:[0,1,0]
    v_cvt_pk_bf16_f32 v77, v124, v125
    v_cvt_pk_bf16_f32 v85, v126, v127
    v_pk_add_f32 v[104:105], v[104:105], v[128:129] op_sel:[0,1] op_sel_hi:[1,0] neg_lo:[0,1]
    v_pk_add_f32 v[106:107], v[106:107], v[130:131] op_sel:[0,1] op_sel_hi:[1,0] neg_lo:[0,1]
    s_waitcnt lgkmcnt(5)
    v_pk_mul_f32 v[128:129], v[104:105], v[160:161] op_sel_hi:[1,0]
    v_pk_mul_f32 v[130:131], v[106:107], v[160:161] op_sel_hi:[1,0]
    v_pk_fma_f32 v[128:129], v[104:105], v[160:161], v[128:129] op_sel:[1,1,0] op_sel_hi:[0,1,1] neg_lo:[0,1,0]
    v_pk_fma_f32 v[130:131], v[106:107], v[160:161], v[130:131] op_sel:[1,1,0] op_sel_hi:[0,1,1] neg_lo:[0,1,0]
    v_cvt_pk_bf16_f32 v74, v128, v129
    v_cvt_pk_bf16_f32 v82, v130, v131
    v_pk_add_f32 v[108:109], v[108:109], v[132:133] op_sel:[0,1] op_sel_hi:[1,0] neg_lo:[0,1]
    v_pk_add_f32 v[110:111], v[110:111], v[134:135] op_sel:[0,1] op_sel_hi:[1,0] neg_lo:[0,1]
    v_pk_mul_f32 v[132:133], v[108:109], v[162:163] op_sel_hi:[1,0]
    v_pk_mul_f32 v[134:135], v[110:111], v[162:163] op_sel_hi:[1,0]
    v_pk_fma_f32 v[132:133], v[108:109], v[162:163], v[132:133] op_sel:[1,1,0] op_sel_hi:[0,1,1] neg_lo:[0,1,0]
    v_pk_fma_f32 v[134:135], v[110:111], v[162:163], v[134:135] op_sel:[1,1,0] op_sel_hi:[0,1,1] neg_lo:[0,1,0]
    v_cvt_pk_bf16_f32 v78, v132, v133
    v_cvt_pk_bf16_f32 v86, v134, v135
    s_waitcnt vmcnt(1)
    s_barrier
    ds_read_b128 v[184:187], v46 offset:0
    ds_read_b128 v[188:191], v46 offset:1024
    ds_read_b128 v[192:195], v47 offset:0
    ds_read_b128 v[196:199], v46 offset:4608
    ds_read_b128 v[200:203], v46 offset:5632
    ds_read_b128 v[204:207], v47 offset:4608
    ds_read_b128 v[208:211], v46 offset:2304
    ds_read_b128 v[212:215], v46 offset:3328
    ds_read_b128 v[216:219], v47 offset:2304
    s_waitcnt lgkmcnt(12)
    v_mfma_f32_16x16x32_bf16 v[104:107], v[72:75], v[168:171], 0
    v_mfma_f32_16x16x32_bf16 v[88:91], v[72:75], v[164:167], 0
    s_waitcnt lgkmcnt(11)
    v_mfma_f32_16x16x32_bf16 v[104:107], v[76:79], v[172:175], v[104:107]
    v_mfma_f32_16x16x32_bf16 v[92:95], v[76:79], v[164:167], 0
    s_waitcnt lgkmcnt(10)
    v_mfma_f32_16x16x32_bf16 v[104:107], v[80:83], v[176:179], v[104:107]
    v_mfma_f32_16x16x32_bf16 v[96:99], v[80:83], v[164:167], 0
    s_waitcnt lgkmcnt(9)
    v_mfma_f32_16x16x32_bf16 v[104:107], v[84:87], v[180:183], v[104:107]
    v_mfma_f32_16x16x32_bf16 v[100:103], v[84:87], v[164:167], 0
    s_waitcnt lgkmcnt(8)
    v_pk_fma_f32 v[222:223], v[88:89], v[184:185], v[222:223]
    v_pk_fma_f32 v[224:225], v[90:91], v[186:187], v[224:225]
    s_waitcnt lgkmcnt(7)
    v_pk_fma_f32 v[226:227], v[92:93], v[188:189], v[226:227]
    v_pk_fma_f32 v[228:229], v[94:95], v[190:191], v[228:229]
    v_pk_fma_f32 v[230:231], v[96:97], v[184:185], v[230:231]
    v_pk_fma_f32 v[232:233], v[98:99], v[186:187], v[232:233]
    v_pk_fma_f32 v[234:235], v[100:101], v[188:189], v[234:235]
    v_pk_fma_f32 v[236:237], v[102:103], v[190:191], v[236:237]
    s_waitcnt lgkmcnt(6)
    v_pk_fma_f32 v[238:239], v[104:105], v[192:193], v[238:239]
    v_pk_fma_f32 v[240:241], v[106:107], v[194:195], v[240:241]
    v_cvt_pk_bf16_f32 v24, v222, v223
    v_cvt_pk_bf16_f32 v25, v224, v225
    v_cvt_pk_bf16_f32 v26, v226, v227
    v_cvt_pk_bf16_f32 v27, v228, v229
    v_cvt_pk_bf16_f32 v28, v230, v231
    v_cvt_pk_bf16_f32 v29, v232, v233
    v_cvt_pk_bf16_f32 v30, v234, v235
    v_cvt_pk_bf16_f32 v31, v236, v237
    v_cvt_pk_bf16_f32 v32, v238, v239
    v_cvt_pk_bf16_f32 v33, v240, v241
    s_mov_b32 s52, 0x00ff00ff
    s_mov_b32 s53, 0x00ff00ff
    v_readfirstlane_b32 s78, v222
    v_readfirstlane_b32 s79, v230
    s_nop 0
    v_mul_f32 v136, s78, v54
    v_fma_f32 v136, s79, v55, v136
    v_mov_b32 v152, s78
    v_mov_b32 v154, s79
    v_pk_add_f32 v[222:223], v[222:223], v[152:153] op_sel_hi:[1,0] neg_lo:[0,1] neg_hi:[0,1]
    v_pk_add_f32 v[224:225], v[224:225], v[152:153] op_sel_hi:[1,0] neg_lo:[0,1] neg_hi:[0,1]
    v_pk_add_f32 v[226:227], v[226:227], v[152:153] op_sel_hi:[1,0] neg_lo:[0,1] neg_hi:[0,1]
    v_pk_add_f32 v[228:229], v[228:229], v[152:153] op_sel_hi:[1,0] neg_lo:[0,1] neg_hi:[0,1]
    v_pk_add_f32 v[230:231], v[230:231], v[154:155] op_sel_hi:[1,0] neg_lo:[0,1] neg_hi:[0,1]
    v_pk_add_f32 v[232:233], v[232:233], v[154:155] op_sel_hi:[1,0] neg_lo:[0,1] neg_hi:[0,1]
    v_pk_add_f32 v[234:235], v[234:235], v[154:155] op_sel_hi:[1,0] neg_lo:[0,1] neg_hi:[0,1]
    v_pk_add_f32 v[236:237], v[236:237], v[154:155] op_sel_hi:[1,0] neg_lo:[0,1] neg_hi:[0,1]
    v_pk_add_f32 v[238:239], v[238:239], v[136:137] op_sel_hi:[1,0] neg_lo:[0,1] neg_hi:[0,1]
    v_pk_add_f32 v[240:241], v[240:241], v[136:137] op_sel_hi:[1,0] neg_lo:[0,1] neg_hi:[0,1]
    v_pk_add_f32 v[136:137], v[222:223], v[224:225]
    v_pk_mul_f32 v[142:143], v[222:223], v[222:223]
    v_pk_fma_f32 v[142:143], v[224:225], v[224:225], v[142:143]
    v_pk_add_f32 v[136:137], v[136:137], v[226:227]
    v_pk_fma_f32 v[142:143], v[226:227], v[226:227], v[142:143]
    v_pk_add_f32 v[136:137], v[136:137], v[228:229]
    v_pk_fma_f32 v[142:143], v[228:229], v[228:229], v[142:143]
    v_pk_add_f32 v[138:139], v[230:231], v[232:233]
    v_pk_mul_f32 v[144:145], v[230:231], v[230:231]
    v_pk_fma_f32 v[144:145], v[232:233], v[232:233], v[144:145]
    v_pk_add_f32 v[138:139], v[138:139], v[234:235]
    v_pk_fma_f32 v[144:145], v[234:235], v[234:235], v[144:145]
    v_pk_add_f32 v[138:139], v[138:139], v[236:237]
    v_pk_fma_f32 v[144:145], v[236:237], v[236:237], v[144:145]
    v_pk_add_f32 v[140:141], v[238:239], v[240:241]
    v_pk_mul_f32 v[146:147], v[238:239], v[238:239]
    v_pk_fma_f32 v[146:147], v[240:241], v[240:241], v[146:147]
    v_add_f32 v136, v136, v137
    v_add_f32 v138, v138, v139
    v_add_f32 v140, v140, v141
    v_add_f32 v142, v142, v143
    v_add_f32 v144, v144, v145
    v_add_f32 v146, v146, v147
    v_fma_f32 v152, v140, v54, v136
    v_fma_f32 v156, v146, v54, v142
    v_fma_f32 v154, v140, v55, v138
    v_fma_f32 v158, v146, v55, v144
    v_add_f32_dpp v152, v152, v152 quad_perm:[1,0,3,2] row_mask:0xf bank_mask:0xf
    v_add_f32_dpp v154, v154, v154 quad_perm:[1,0,3,2] row_mask:0xf bank_mask:0xf
    v_add_f32_dpp v156, v156, v156 quad_perm:[1,0,3,2] row_mask:0xf bank_mask:0xf
    v_add_f32_dpp v158, v158, v158 quad_perm:[1,0,3,2] row_mask:0xf bank_mask:0xf
    v_add_f32_dpp v152, v152, v152 quad_perm:[2,3,0,1] row_mask:0xf bank_mask:0xf
    v_add_f32_dpp v154, v154, v154 quad_perm:[2,3,0,1] row_mask:0xf bank_mask:0xf
    v_add_f32_dpp v156, v156, v156 quad_perm:[2,3,0,1] row_mask:0xf bank_mask:0xf
    v_add_f32_dpp v158, v158, v158 quad_perm:[2,3,0,1] row_mask:0xf bank_mask:0xf
    v_add_f32_dpp v152, v152, v152 row_half_mirror row_mask:0xf bank_mask:0xf
    v_add_f32_dpp v154, v154, v154 row_half_mirror row_mask:0xf bank_mask:0xf
    v_add_f32_dpp v156, v156, v156 row_half_mirror row_mask:0xf bank_mask:0xf
    v_add_f32_dpp v158, v158, v158 row_half_mirror row_mask:0xf bank_mask:0xf
    v_add_f32_dpp v152, v152, v152 row_mirror row_mask:0xf bank_mask:0xf
    v_add_f32_dpp v154, v154, v154 row_mirror row_mask:0xf bank_mask:0xf
    v_add_f32_dpp v156, v156, v156 row_mirror row_mask:0xf bank_mask:0xf
    v_add_f32_dpp v158, v158, v158 row_mirror row_mask:0xf bank_mask:0xf
    v_mov_b32 v160, v152
    v_mov_b32 v161, v154
    v_mov_b32 v162, v156
    v_mov_b32 v163, v158
    v_permlane16_swap_b32 v152, v160
    v_permlane16_swap_b32 v154, v161
    v_permlane16_swap_b32 v156, v162
    v_permlane16_swap_b32 v158, v163
    v_add_f32 v152, v152, v160
    v_add_f32 v154, v154, v161
    v_add_f32 v156, v156, v162
    v_add_f32 v158, v158, v163
    v_mov_b32 v160, v152
    v_mov_b32 v161, v154
    v_mov_b32 v162, v156
    v_mov_b32 v163, v158
    v_permlane32_swap_b32 v152, v160
    v_permlane32_swap_b32 v154, v161
    v_permlane32_swap_b32 v156, v162
    v_permlane32_swap_b32 v158, v163
    v_add_f32 v152, v152, v160
    v_add_f32 v154, v154, v161
    v_add_f32 v156, v156, v162
    v_add_f32 v158, v158, v163
    v_mul_f32 v152, 0x3ae38e39, v152
    v_mul_f32 v156, 0x3ae38e39, v156
    v_mul_f32 v154, 0x3ae38e39, v154
    v_mul_f32 v158, 0x3ae38e39, v158
    v_fma_f32 v156, -v152, v152, v156
    v_fma_f32 v158, -v154, v154, v158
    v_max_f32 v156, 0, v156
    v_max_f32 v158, 0, v158
    v_add_f32 v156, 0x3727c5ac, v156
    v_add_f32 v158, 0x3727c5ac, v158
    v_rsq_f32 v156, v156
    v_rsq_f32 v158, v158
    v_mul_f32 v152, v152, v156
    v_mul_f32 v154, v154, v158
    v_mul_f32 v136, v152, v54
    v_mul_f32 v138, v156, v54
    v_fmac_f32 v136, v154, v55
    v_fmac_f32 v138, v158, v55
    v_pk_fma_f32 v[222:223], v[222:223], v[156:157], v[152:153] op_sel_hi:[1,0,0] neg_lo:[0,0,1] neg_hi:[0,0,1]
    v_pk_fma_f32 v[224:225], v[224:225], v[156:157], v[152:153] op_sel_hi:[1,0,0] neg_lo:[0,0,1] neg_hi:[0,0,1]
    v_pk_fma_f32 v[226:227], v[226:227], v[156:157], v[152:153] op_sel_hi:[1,0,0] neg_lo:[0,0,1] neg_hi:[0,0,1]
    v_pk_fma_f32 v[228:229], v[228:229], v[156:157], v[152:153] op_sel_hi:[1,0,0] neg_lo:[0,0,1] neg_hi:[0,0,1]
    v_pk_fma_f32 v[230:231], v[230:231], v[158:159], v[154:155] op_sel_hi:[1,0,0] neg_lo:[0,0,1] neg_hi:[0,0,1]
    v_pk_fma_f32 v[232:233], v[232:233], v[158:159], v[154:155] op_sel_hi:[1,0,0] neg_lo:[0,0,1] neg_hi:[0,0,1]
    v_pk_fma_f32 v[234:235], v[234:235], v[158:159], v[154:155] op_sel_hi:[1,0,0] neg_lo:[0,0,1] neg_hi:[0,0,1]
    v_pk_fma_f32 v[236:237], v[236:237], v[158:159], v[154:155] op_sel_hi:[1,0,0] neg_lo:[0,0,1] neg_hi:[0,0,1]
    v_pk_fma_f32 v[238:239], v[238:239], v[138:139], v[136:137] op_sel_hi:[1,0,0] neg_lo:[0,0,1] neg_hi:[0,0,1]
    v_pk_fma_f32 v[240:241], v[240:241], v[138:139], v[136:137] op_sel_hi:[1,0,0] neg_lo:[0,0,1] neg_hi:[0,0,1]
    s_waitcnt lgkmcnt(2)
    v_pk_fma_f32 v[222:223], v[222:223], v[196:197], v[208:209]
    v_pk_fma_f32 v[224:225], v[224:225], v[198:199], v[210:211]
    s_waitcnt lgkmcnt(1)
    v_pk_fma_f32 v[226:227], v[226:227], v[200:201], v[212:213]
    v_pk_fma_f32 v[228:229], v[228:229], v[202:203], v[214:215]
    v_pk_fma_f32 v[230:231], v[230:231], v[196:197], v[208:209]
    v_pk_fma_f32 v[232:233], v[232:233], v[198:199], v[210:211]
    v_pk_fma_f32 v[234:235], v[234:235], v[200:201], v[212:213]
    v_pk_fma_f32 v[236:237], v[236:237], v[202:203], v[214:215]
    s_waitcnt lgkmcnt(0)
    v_pk_fma_f32 v[238:239], v[238:239], v[204:205], v[216:217]
    v_pk_fma_f32 v[240:241], v[240:241], v[206:207], v[218:219]
    v_cvt_pk_bf16_f32 v112, v222, v223
    v_cvt_pk_bf16_f32 v113, v224, v225
    v_cvt_pk_bf16_f32 v114, v226, v227
    v_cvt_pk_bf16_f32 v115, v228, v229
    v_cvt_pk_bf16_f32 v116, v230, v231
    v_cvt_pk_bf16_f32 v117, v232, v233
    v_cvt_pk_bf16_f32 v118, v234, v235
    v_cvt_pk_bf16_f32 v119, v236, v237
    v_cvt_pk_bf16_f32 v120, v238, v239
    v_cvt_pk_bf16_f32 v121, v240, v241
    ds_write_b128 v52, v[112:115] offset:0
    ds_write_b128 v52, v[116:119] offset:16
    s_mov_b64 exec, s[52:53]
    ds_write_b64 v53, v[120:121] offset:8448
    s_mov_b64 exec, -1
    s_lshl_b32 s17, s21, 1
    s_lshr_b32 s18, s19, 2
    s_add_u32 s17, s17, s18
    s_mul_i32 s17, s17, 73728
    s_and_b32 s18, s19, 3
    s_lshl_b32 s18, s18, 10
    s_add_u32 s17, s17, s18
    s_lshl_b32 s18, s20, 7
    s_add_u32 s17, s17, s18
    s_waitcnt lgkmcnt(0)
    s_barrier
    ds_read_b128 v[88:91], v65 offset:0
    ds_read_b128 v[92:95], v65 offset:4224
    ds_read_b128 v[96:99], v65 offset:8448
    s_waitcnt lgkmcnt(2)
    buffer_store_dwordx4 v[88:91], v66, s[24:27], s17 offen sc1
    s_waitcnt lgkmcnt(1)
    buffer_store_dwordx4 v[92:95], v67, s[24:27], s17 offen sc1
    s_waitcnt lgkmcnt(0)
    buffer_store_dwordx4 v[96:99], v68, s[24:27], s17 offen sc1
    s_cmp_eq_u32 s22, 1
    s_cselect_b32 s48, s40, s36
    s_cselect_b32 s49, s41, s37
    s_mov_b32 s50, 5310464
    s_mov_b32 s51, 0x20000
    s_sub_u32 s52, s12, 2048
    s_subb_u32 s53, s13, 0
    s_mov_b32 s54, 5310464
    s_mov_b32 s55, 0x20000
    s_add_u32 s64, s4, 37748736
    s_addc_u32 s65, s5, 0
    s_mov_b32 s66, 18874368
    s_mov_b32 s67, 0x20000
    s_add_u32 s68, s4, 262144
    s_addc_u32 s69, s5, 0
    s_mov_b32 s70, 65536
    s_mov_b32 s71, 0x20000
    s_add_u32 s72, s4, 16777216
    s_addc_u32 s73, s5, 0
    s_mov_b32 s74, 18874368
    s_mov_b32 s75, 0x20000
    s_mul_i32 s80, s19, 663552
    s_mul_i32 s17, s20, 640
    s_add_u32 s17, s17, s80
    s_mul_i32 s18, s16, 9216
    s_add_u32 s17, s17, s18
    s_mul_i32 s18, s20, 368640
    s_add_u32 s56, s17, s18
    s_sub_u32 s18, 368640, s18
k4_kernel_pg0_0:
    s_cbranch_execz k4_kernel_back0
    s_add_u32 s57, s17, s18
    s_add_u32 s17, s17, 294912
    s_mul_i32 s18, s20, 36864
    s_add_u32 s58, s17, s18
    s_sub_u32 s18, 36864, s18
    s_add_u32 s59, s17, s18
    s_mul_i32 s17, s20, 64
    s_add_u32 s80, s80, s17
    s_add_u32 s80, s80, 512
    s_mul_i32 s17, s16, 18432
    s_add_u32 s17, s17, s80
    s_mul_i32 s18, s20, 368640
    s_add_u32 s60, s17, s18
    s_sub_u32 s18, 368640, s18
    s_add_u32 s61, s17, s18
    s_xor_b32 s17, s20, s22
    s_lshl_b32 s17, s17, 1
    s_add_u32 s17, s17, s23
    s_mul_i32 s17, s17, 18432
    s_add_u32 s62, s80, s17
    s_add_u32 s62, s62, 294912
    s_mul_i32 s17, s2, 73728
    s_lshl_b32 s18, s16, 11
    s_add_u32 s7, s17, s18
    s_lshl_b32 s80, s22, 12
    s_add_u32 s3, s17, s80
    s_lshl_b32 s80, s23, 13
    s_add_u32 s3, s3, s80
    s_xor_b32 s17, s2, 8
    s_lshl_b32 s77, s17, 7
    s_add_u32 s77, s77, 8192
    s_mul_i32 s6, s17, 73728
    s_add_u32 s6, s6, s18
    s_lshl_b32 s76, s2, 7
    s_add_u32 s76, s76, 8192
    s_lshl_b32 s81, s21, 8
    s_and_b32 s80, s2, 15
    s_lshl_b32 s80, s80, 2
    s_add_u32 s82, s81, s80
    s_cmp_eq_u32 s16, 0
    s_cselect_b32 s76, s76, 0x40000000
    s_cselect_b32 s82, s82, 0x40000000
    s_lshr_b32 s17, s2, 3
    s_mul_i32 s17, s17, 73728
    s_mul_i32 s80, s19, 2359296
    s_add_u32 s17, s17, s80
    s_add_u32 s79, s17, s18
    s_add_u32 s78, s79, s18
    s_lshr_b32 s88, s2, 3
    s_sub_u32 s88, s88, 0
    s_cmp_ge_u32 s88, 32
    s_cselect_b32 s88, 999, s88
    s_mul_i32 s89, s16, 32
    s_add_u32 s88, s88, s89
    s_add_u32 s88, s88, 116
    s_cmp_ge_u32 s88, 243
    s_cselect_b32 s86, 0, 5308416
    s_and_b32 s83, s2, 7
    s_mov_b32 s87, 0x20000
    s_cmp_ge_u32 s88, 162
    s_cbranch_scc1 k4_kernel_pfwdk4a
    s_mul_i32 s89, s88, 7282
    s_lshr_b32 s89, s89, 16
    s_mul_i32 s90, s89, 9
    s_sub_u32 s90, s88, s90
    s_cmp_lt_u32 s88, 72
    s_cbranch_scc0 k4_kernel_pfgok4ax
    s_and_b32 s89, s88, 7
    s_lshr_b32 s90, s88, 3
k4_kernel_pfgok4ax:
    s_mov_b32 s88, s90
    s_mul_i32 s88, s88, 589824
    v_mul_u32_u24 v22, 9216, v1
    s_mul_i32 s83, s83, 1152
    s_add_u32 s83, s83, s88
    s_lshr_b32 s90, s89, 2
    s_lshl_b32 s90, s90, 7
    s_add_u32 s83, s83, s90
    s_bfe_u32 s90, s89, 0x10001
    s_mul_i32 s90, s90, 640
    s_add_u32 s83, s83, s90
    s_bitcmp1_b32 s89, 0
    s_cselect_b32 s84, s10, s8
    s_cselect_b32 s85, s11, s9
    s_branch k4_kernel_pfgok4a
k4_kernel_pfwdk4a:
    s_sub_u32 s88, s88, 162
    s_lshl_b32 s88, s88, 13
    s_mul_i32 s83, s83, 663552
    s_add_u32 s83, s83, s88
    v_lshlrev_b32 v22, 7, v1
    s_mov_b32 s84, s12
    s_mov_b32 s85, s13
k4_kernel_pfgok4a:
    s_waitcnt vmcnt(0)
    s_barrier
    v_mov_b32 v20, 1
    buffer_store_dword v20, v3, s[68:71], s82 offen offset:0 sc1
    s_add_u32 m0, s30, 0
    s_add_u32 s31, s32, 2048
    buffer_load_dwordx4 v4, s[36:39], s31 offen offset:0 lds
    s_add_u32 s31, s32, 1024
    buffer_load_dwordx4 v4, s[40:43], s31 offen offset:1024 lds
    s_add_u32 s31, s32, 128
    buffer_load_dwordx4 v4, s[36:39], s31 offen offset:2048 lds
    s_add_u32 m0, s30, 12288
    s_add_u32 s31, s32, 2176
    buffer_load_dwordx4 v4, s[40:43], s31 offen offset:0 lds
    s_add_u32 s31, s32, 295936
    buffer_load_dwordx4 v4, s[36:39], s31 offen offset:1024 lds
    s_add_u32 s31, s32, 294912
    buffer_load_dwordx4 v4, s[40:43], s31 offen offset:2048 lds
    s_add_u32 m0, s30, 24576
    s_add_u32 s31, s32, 297088
    buffer_load_dwordx4 v4, s[36:39], s31 offen offset:0 lds
    s_add_u32 s31, s32, 296064
    buffer_load_dwordx4 v4, s[40:43], s31 offen offset:1024 lds
    s_add_u32 s31, s32, 589824
    buffer_load_dwordx4 v4, s[36:39], s31 offen offset:2048 lds
    s_mov_b64 exec, 0
    s_cmp_eq_u32 s16, 0
    s_cbranch_scc1 k4_kernel_pg1_0
    s_cmp_eq_u32 s16, 1
    s_cbranch_scc1 k4_kernel_pg1_1
    s_cmp_eq_u32 s16, 2
    s_cbranch_scc1 k4_kernel_pg1_2
    s_branch k4_kernel_pg1_3
k4_kernel_back1:
    s_mov_b64 exec, -1
    s_cmp_lg_u32 s16, 0
    s_cbranch_scc1 k4_kernel_h2go
    s_mov_b32 s17, 0
k4_kernel_h2w:
    buffer_load_dword v19, v21, s[68:71], s81 offen offset:0 sc1
    s_add_u32 s17, s17, 1
    s_cmp_ge_u32 s17, 400000
    s_waitcnt vmcnt(0)
    s_cbranch_scc1 k4_kernel_h2wx
    v_cmp_gt_u32 vcc, 1, v19
    s_nop 1
    s_cbranch_vccz k4_kernel_h2wx
    s_sleep 1
    s_branch k4_kernel_h2w
k4_kernel_h2wx:
k4_kernel_h2go:
    s_barrier
    s_add_u32 m0, s29, 0
    s_add_u32 s44, s28, 0
    buffer_load_dwordx4 v2, s[24:27], s44 offen offset:0 sc1 lds
    buffer_load_dwordx4 v2, s[24:27], s44 offen offset:1024 sc1 lds
    s_add_u32 m0, s29, 8192
    s_add_u32 s44, s28, 4096
    buffer_load_dwordx4 v2, s[24:27], s44 offen offset:0 sc1 lds
    buffer_load_dwordx4 v2, s[24:27], s44 offen offset:1024 sc1 lds
    s_add_u32 m0, s30, 36864
    s_add_u32 s31, s32, 591872
    buffer_load_dwordx4 v4, s[40:43], s31 offen offset:0 lds
    s_add_u32 s31, s32, 590976
    buffer_load_dwordx4 v4, s[36:39], s31 offen offset:1024 lds
    s_add_u32 s31, s32, 589952
    buffer_load_dwordx4 v4, s[40:43], s31 offen offset:2048 lds
    s_add_u32 m0, s29, 16384
    s_add_u32 s44, s28, 8192
    buffer_load_dwordx4 v2, s[24:27], s44 offen offset:0 sc1 lds
    buffer_load_dwordx4 v2, s[24:27], s44 offen offset:1024 sc1 lds
    s_add_u32 m0, s30, 49152
    s_add_u32 s31, s32, 886784
    buffer_load_dwordx4 v4, s[36:39], s31 offen offset:0 lds
    s_add_u32 s31, s32, 1180672
    buffer_load_dwordx4 v4, s[36:39], s31 offen offset:1024 lds
    s_add_u32 s31, s32, 1474560
    buffer_load_dwordx4 v4, s[36:39], s31 offen offset:2048 lds
    s_add_u32 m0, s29, 24576
    s_add_u32 s44, s28, 12288
    buffer_load_dwordx4 v2, s[24:27], s44 offen offset:0 sc1 lds
    buffer_load_dwordx4 v2, s[24:27], s44 offen offset:1024 sc1 lds
    s_add_u32 m0, s29, 32768
    s_add_u32 s44, s28, 16384
    buffer_load_dwordx4 v2, s[24:27], s44 offen offset:0 sc1 lds
    buffer_load_dwordx4 v2, s[24:27], s44 offen offset:1024 sc1 lds
    s_waitcnt vmcnt(14)
    s_barrier
    ds_read_b128 a[0:3], v16 offset:0
    ds_read_b128 a[4:7], v16 offset:1024
    ds_read_b128 a[8:11], v16 offset:2048
    ds_read_b128 a[12:15], v16 offset:3072
    ds_read_b64_tr_b16 v[220:221], v8 offset:0
    ds_read_b64_tr_b16 v[222:223], v8 offset:6144
    ds_read_b64_tr_b16 v[224:225], v9 offset:0
    ds_read_b64_tr_b16 v[226:227], v9 offset:6144
    ds_read_b64_tr_b16 v[228:229], v8 offset:1024
    ds_read_b64_tr_b16 v[230:231], v8 offset:7168
    ds_read_b64_tr_b16 v[232:233], v9 offset:1024
    ds_read_b64_tr_b16 v[234:235], v9 offset:7168
    ds_read_b64_tr_b16 v[236:237], v8 offset:2048
    ds_read_b64_tr_b16 v[238:239], v8 offset:8192
    ds_read_b64_tr_b16 v[240:241], v9 offset:2048
    ds_read_b64_tr_b16 v[242:243], v9 offset:8192
    s_waitcnt vmcnt(12) lgkmcnt(0)
    s_barrier
    v_mfma_f32_16x16x32_bf16 v[92:95], v[224:227], a[0:3], 0
    ds_read_b64_tr_b16 v[244:245], v8 offset:12288
    v_mfma_f32_16x16x32_bf16 v[76:79], v[220:223], a[0:3], 0
    s_add_u32 m0, s30, 61440
    s_add_u32 s31, s32, 886784
    v_mfma_f32_16x16x32_bf16 v[80:83], v[220:223], a[4:7], 0
    buffer_load_dwordx4 v4, s[40:43], s31 offen offset:0 lds
    v_mfma_f32_16x16x32_bf16 v[96:99], v[224:227], a[4:7], 0
    s_add_u32 s31, s32, 1180672
    ds_read_b64_tr_b16 v[246:247], v8 offset:18432
    v_mfma_f32_16x16x32_bf16 v[100:103], v[224:227], a[8:11], 0
    buffer_load_dwordx4 v4, s[40:43], s31 offen offset:1024 lds
    v_mfma_f32_16x16x32_bf16 v[84:87], v[220:223], a[8:11], 0
    s_add_u32 s31, s32, 1474560
    ds_read_b64_tr_b16 v[248:249], v9 offset:12288
    v_mfma_f32_16x16x32_bf16 v[88:91], v[220:223], a[12:15], 0
    buffer_load_dwordx4 v4, s[40:43], s31 offen offset:2048 lds
    v_mfma_f32_16x16x32_bf16 v[104:107], v[224:227], a[12:15], 0
    s_add_u32 m0, s30, 73728
    s_add_u32 s31, s32, 886912
    v_mfma_f32_16x16x32_bf16 v[136:139], v[232:235], a[12:15], 0
    buffer_load_dwordx4 v4, s[36:39], s31 offen offset:0 lds
    v_mfma_f32_16x16x32_bf16 v[120:123], v[228:231], a[12:15], 0
    s_add_u32 s31, s32, 1180800
    ds_read_b64_tr_b16 v[250:251], v9 offset:18432
    v_mfma_f32_16x16x32_bf16 v[116:119], v[228:231], a[8:11], 0
    buffer_load_dwordx4 v4, s[36:39], s31 offen offset:1024 lds
    v_mfma_f32_16x16x32_bf16 v[132:135], v[232:235], a[8:11], 0
    ds_read_b64_tr_b16 v[252:253], v8 offset:13312
    v_mfma_f32_16x16x32_bf16 v[128:131], v[232:235], a[4:7], 0
    s_add_u32 s31, s32, 1474688
    ds_read_b64_tr_b16 v[254:255], v8 offset:19456
    v_mfma_f32_16x16x32_bf16 v[112:115], v[228:231], a[4:7], 0
    buffer_load_dwordx4 v4, s[36:39], s31 offen offset:2048 lds
    v_mfma_f32_16x16x32_bf16 v[108:111], v[228:231], a[0:3], 0
    s_add_u32 m0, s29, 40960
    s_add_u32 s44, s28, 20480
    v_mfma_f32_16x16x32_bf16 v[124:127], v[232:235], a[0:3], 0
    buffer_load_dwordx4 v2, s[24:27], s44 offen offset:0 sc1 lds
    v_mfma_f32_16x16x32_bf16 v[156:159], v[240:243], a[0:3], 0
    ds_read_b64_tr_b16 v[220:221], v9 offset:13312
    ds_read_b64_tr_b16 v[222:223], v9 offset:19456
    v_mfma_f32_16x16x32_bf16 v[140:143], v[236:239], a[0:3], 0
    buffer_load_dwordx4 v2, s[24:27], s44 offen offset:1024 sc1 lds
    v_mfma_f32_16x16x32_bf16 v[144:147], v[236:239], a[4:7], 0
    s_add_u32 m0, s29, 49152
    s_add_u32 s44, s28, 24576
    ds_read_b64_tr_b16 v[224:225], v8 offset:14336
    v_mfma_f32_16x16x32_bf16 v[160:163], v[240:243], a[4:7], 0
    buffer_load_dwordx4 v2, s[24:27], s44 offen offset:0 sc1 lds
    ds_read_b64_tr_b16 v[226:227], v8 offset:20480
    ds_read_b64_tr_b16 v[228:229], v9 offset:14336
    ds_read_b64_tr_b16 v[230:231], v9 offset:20480
    v_mfma_f32_16x16x32_bf16 v[164:167], v[240:243], a[8:11], 0
    ds_read_b128 a[16:19], v16 offset:8192
    ds_read_b128 a[20:23], v16 offset:9216
    ds_read_b128 a[24:27], v16 offset:10240
    ds_read_b128 a[28:31], v16 offset:11264
    v_mfma_f32_16x16x32_bf16 v[148:151], v[236:239], a[8:11], 0
    buffer_load_dwordx4 v2, s[24:27], s44 offen offset:1024 sc1 lds
    v_mfma_f32_16x16x32_bf16 v[152:155], v[236:239], a[12:15], 0
    v_mfma_f32_16x16x32_bf16 v[168:171], v[240:243], a[12:15], 0
    s_waitcnt vmcnt(17) lgkmcnt(0)
    s_barrier
    v_mfma_f32_16x16x32_bf16 v[200:203], v[248:251], a[12:15], 0
    ds_read_b64_tr_b16 v[232:233], v8 offset:24576
    v_mfma_f32_16x16x32_bf16 v[184:187], v[244:247], a[12:15], 0
    s_add_u32 m0, s30, 0
    s_add_u32 s31, s32, 886912
    v_mfma_f32_16x16x32_bf16 v[180:183], v[244:247], a[8:11], 0
    buffer_load_dwordx4 v4, s[40:43], s31 offen offset:0 lds
    v_mfma_f32_16x16x32_bf16 v[196:199], v[248:251], a[8:11], 0
    s_add_u32 s31, s32, 1180800
    ds_read_b64_tr_b16 v[234:235], v8 offset:30720
    v_mfma_f32_16x16x32_bf16 v[192:195], v[248:251], a[4:7], 0
    buffer_load_dwordx4 v4, s[40:43], s31 offen offset:1024 lds
    v_mfma_f32_16x16x32_bf16 v[176:179], v[244:247], a[4:7], 0
    ds_read_b64_tr_b16 v[236:237], v9 offset:24576
    v_mfma_f32_16x16x32_bf16 v[172:175], v[244:247], a[0:3], 0
    s_add_u32 s31, s32, 1474688
    ds_read_b64_tr_b16 v[238:239], v9 offset:30720
    v_mfma_f32_16x16x32_bf16 v[188:191], v[248:251], a[0:3], 0
    buffer_load_dwordx4 v4, s[40:43], s31 offen offset:2048 lds
    v_mfma_f32_16x16x32_bf16 v[92:95], v[220:223], a[16:19], v[92:95]
    ds_read_b64_tr_b16 v[240:241], v8 offset:25600
    v_mfma_f32_16x16x32_bf16 v[76:79], v[252:255], a[16:19], v[76:79]
    s_add_u32 m0, s30, 12288
    s_add_u32 s31, s32, 1771520
    v_mfma_f32_16x16x32_bf16 v[80:83], v[252:255], a[20:23], v[80:83]
    buffer_load_dwordx4 v4, s[36:39], s31 offen offset:0 lds
    v_mfma_f32_16x16x32_bf16 v[96:99], v[220:223], a[20:23], v[96:99]
    ds_read_b64_tr_b16 v[242:243], v8 offset:31744
    v_mfma_f32_16x16x32_bf16 v[100:103], v[220:223], a[24:27], v[100:103]
    s_add_u32 s31, s32, 2065408
    ds_read_b64_tr_b16 v[244:245], v9 offset:25600
    v_mfma_f32_16x16x32_bf16 v[84:87], v[252:255], a[24:27], v[84:87]
    buffer_load_dwordx4 v4, s[36:39], s31 offen offset:1024 lds
    v_mfma_f32_16x16x32_bf16 v[88:91], v[252:255], a[28:31], v[88:91]
    s_add_u32 s31, s32, 2359296
    ds_read_b64_tr_b16 v[246:247], v9 offset:31744
    v_mfma_f32_16x16x32_bf16 v[104:107], v[220:223], a[28:31], v[104:107]
    buffer_load_dwordx4 v4, s[36:39], s31 offen offset:2048 lds
    v_mfma_f32_16x16x32_bf16 v[136:139], v[228:231], a[28:31], v[136:139]
    ds_read_b64_tr_b16 v[248:249], v8 offset:26624
    v_mfma_f32_16x16x32_bf16 v[120:123], v[224:227], a[28:31], v[120:123]
    s_add_u32 m0, s29, 57344
    s_add_u32 s44, s28, 28672
    v_mfma_f32_16x16x32_bf16 v[116:119], v[224:227], a[24:27], v[116:119]
    buffer_load_dwordx4 v2, s[24:27], s44 offen offset:0 sc1 lds
    v_mfma_f32_16x16x32_bf16 v[132:135], v[228:231], a[24:27], v[132:135]
    ds_read_b64_tr_b16 v[250:251], v8 offset:32768
    ds_read_b64_tr_b16 v[252:253], v9 offset:26624
    ds_read_b64_tr_b16 v[254:255], v9 offset:32768
    v_mfma_f32_16x16x32_bf16 v[128:131], v[228:231], a[20:23], v[128:131]
    ds_read_b128 a[32:35], v16 offset:16384
    ds_read_b128 a[36:39], v16 offset:17408
    ds_read_b128 a[40:43], v16 offset:18432
    ds_read_b128 a[44:47], v16 offset:19456
    v_mfma_f32_16x16x32_bf16 v[112:115], v[224:227], a[20:23], v[112:115]
    buffer_load_dwordx4 v2, s[24:27], s44 offen offset:1024 sc1 lds
    v_mfma_f32_16x16x32_bf16 v[108:111], v[224:227], a[16:19], v[108:111]
    v_mfma_f32_16x16x32_bf16 v[124:127], v[228:231], a[16:19], v[124:127]
    s_waitcnt vmcnt(20) lgkmcnt(0)
    s_barrier
    v_mfma_f32_16x16x32_bf16 v[156:159], v[236:239], a[16:19], v[156:159]
    ds_read_b64_tr_b16 v[220:221], v8 offset:36864
    v_mfma_f32_16x16x32_bf16 v[140:143], v[232:235], a[16:19], v[140:143]
    s_add_u32 m0, s30, 24576
    s_add_u32 s31, s32, 1771520
    v_mfma_f32_16x16x32_bf16 v[144:147], v[232:235], a[20:23], v[144:147]
    buffer_load_dwordx4 v4, s[40:43], s31 offen offset:0 lds
    v_mfma_f32_16x16x32_bf16 v[160:163], v[236:239], a[20:23], v[160:163]
    ds_read_b64_tr_b16 v[222:223], v8 offset:43008
    v_mfma_f32_16x16x32_bf16 v[164:167], v[236:239], a[24:27], v[164:167]
    ds_read_b64_tr_b16 v[224:225], v9 offset:36864
    v_mfma_f32_16x16x32_bf16 v[148:151], v[232:235], a[24:27], v[148:151]
    s_add_u32 s31, s32, 2065408
    ds_read_b64_tr_b16 v[226:227], v9 offset:43008
    v_mfma_f32_16x16x32_bf16 v[152:155], v[232:235], a[28:31], v[152:155]
    buffer_load_dwordx4 v4, s[40:43], s31 offen offset:1024 lds
    v_mfma_f32_16x16x32_bf16 v[168:171], v[236:239], a[28:31], v[168:171]
    ds_read_b64_tr_b16 v[228:229], v8 offset:37888
    v_mfma_f32_16x16x32_bf16 v[200:203], v[244:247], a[28:31], v[200:203]
    ds_read_b64_tr_b16 v[230:231], v8 offset:44032
    v_mfma_f32_16x16x32_bf16 v[184:187], v[240:243], a[28:31], v[184:187]
    s_add_u32 s31, s32, 2359296
    ds_read_b64_tr_b16 v[232:233], v9 offset:37888
    v_mfma_f32_16x16x32_bf16 v[180:183], v[240:243], a[24:27], v[180:183]
    buffer_load_dwordx4 v4, s[40:43], s31 offen offset:2048 lds
    v_mfma_f32_16x16x32_bf16 v[196:199], v[244:247], a[24:27], v[196:199]
    ds_read_b64_tr_b16 v[234:235], v9 offset:44032
    v_mfma_f32_16x16x32_bf16 v[192:195], v[244:247], a[20:23], v[192:195]
    ds_read_b64_tr_b16 v[236:237], v8 offset:38912
    v_mfma_f32_16x16x32_bf16 v[176:179], v[240:243], a[20:23], v[176:179]
    ds_read_b64_tr_b16 v[238:239], v8 offset:45056
    v_mfma_f32_16x16x32_bf16 v[172:175], v[240:243], a[16:19], v[172:175]
    s_add_u32 m0, s29, 65536
    s_add_u32 s44, s28, 32768
    v_mfma_f32_16x16x32_bf16 v[188:191], v[244:247], a[16:19], v[188:191]
    buffer_load_dwordx4 v2, s[24:27], s44 offen offset:0 sc1 lds
    v_mfma_f32_16x16x32_bf16 v[92:95], v[252:255], a[32:35], v[92:95]
    ds_read_b64_tr_b16 v[240:241], v9 offset:38912
    v_mfma_f32_16x16x32_bf16 v[76:79], v[248:251], a[32:35], v[76:79]
    ds_read_b64_tr_b16 v[242:243], v9 offset:45056
    v_mfma_f32_16x16x32_bf16 v[80:83], v[248:251], a[36:39], v[80:83]
    ds_read_b128 a[48:51], v16 offset:24576
    v_mfma_f32_16x16x32_bf16 v[96:99], v[252:255], a[36:39], v[96:99]
    buffer_load_dwordx4 v2, s[24:27], s44 offen offset:1024 sc1 lds
    v_mfma_f32_16x16x32_bf16 v[100:103], v[252:255], a[40:43], v[100:103]
    ds_read_b128 a[52:55], v16 offset:25600
    ds_read_b128 a[56:59], v16 offset:26624
    ds_read_b128 a[60:63], v16 offset:27648
    v_mfma_f32_16x16x32_bf16 v[84:87], v[248:251], a[40:43], v[84:87]
    v_mfma_f32_16x16x32_bf16 v[88:91], v[248:251], a[44:47], v[88:91]
    v_mfma_f32_16x16x32_bf16 v[104:107], v[252:255], a[44:47], v[104:107]
    s_waitcnt vmcnt(15) lgkmcnt(0)
    s_barrier
    v_mfma_f32_16x16x32_bf16 v[136:139], v[224:227], a[44:47], v[136:139]
    ds_read_b64_tr_b16 v[244:245], v10 offset:0
    v_mfma_f32_16x16x32_bf16 v[120:123], v[220:223], a[44:47], v[120:123]
    ds_read_b64_tr_b16 v[246:247], v10 offset:6144
    v_mfma_f32_16x16x32_bf16 v[116:119], v[220:223], a[40:43], v[116:119]
    s_add_u32 m0, s30, 36864
    s_add_u32 s31, s32, 1771648
    v_mfma_f32_16x16x32_bf16 v[132:135], v[224:227], a[40:43], v[132:135]
    buffer_load_dwordx4 v4, s[36:39], s31 offen offset:0 lds
    v_mfma_f32_16x16x32_bf16 v[128:131], v[224:227], a[36:39], v[128:131]
    ds_read_b64_tr_b16 v[248:249], v10 offset:1024
    v_mfma_f32_16x16x32_bf16 v[112:115], v[220:223], a[36:39], v[112:115]
    ds_read_b64_tr_b16 v[250:251], v10 offset:7168
    v_mfma_f32_16x16x32_bf16 v[108:111], v[220:223], a[32:35], v[108:111]
    ds_read_b64_tr_b16 v[252:253], v10 offset:2048
    v_mfma_f32_16x16x32_bf16 v[124:127], v[224:227], a[32:35], v[124:127]
    ds_read_b64_tr_b16 v[254:255], v10 offset:8192
    v_mfma_f32_16x16x32_bf16 v[156:159], v[232:235], a[32:35], v[156:159]
    ds_read_b64_tr_b16 v[220:221], v11 offset:0
    v_mfma_f32_16x16x32_bf16 v[140:143], v[228:231], a[32:35], v[140:143]
    s_add_u32 s31, s32, 2065536
    ds_read_b64_tr_b16 v[222:223], v11 offset:6144
    v_mfma_f32_16x16x32_bf16 v[144:147], v[228:231], a[36:39], v[144:147]
    buffer_load_dwordx4 v4, s[36:39], s31 offen offset:1024 lds
    v_mfma_f32_16x16x32_bf16 v[160:163], v[232:235], a[36:39], v[160:163]
    ds_read_b64_tr_b16 v[224:225], v11 offset:1024
    v_mfma_f32_16x16x32_bf16 v[164:167], v[232:235], a[40:43], v[164:167]
    ds_read_b64_tr_b16 v[226:227], v11 offset:7168
    v_mfma_f32_16x16x32_bf16 v[148:151], v[228:231], a[40:43], v[148:151]
    ds_read_b128 a[64:67], v17 offset:0
    v_mfma_f32_16x16x32_bf16 v[152:155], v[228:231], a[44:47], v[152:155]
    ds_read_b64_tr_b16 v[228:229], v11 offset:2048
    v_mfma_f32_16x16x32_bf16 v[168:171], v[232:235], a[44:47], v[168:171]
    ds_read_b64_tr_b16 v[230:231], v11 offset:8192
    v_mfma_f32_16x16x32_bf16 v[200:203], v[240:243], a[44:47], v[200:203]
    s_add_u32 s31, s32, 2359424
    ds_read_b128 a[68:71], v17 offset:1024
    v_mfma_f32_16x16x32_bf16 v[184:187], v[236:239], a[44:47], v[184:187]
    buffer_load_dwordx4 v4, s[36:39], s31 offen offset:2048 lds
    v_mfma_f32_16x16x32_bf16 v[180:183], v[236:239], a[40:43], v[180:183]
    ds_read_b128 a[72:75], v17 offset:2048
    v_mfma_f32_16x16x32_bf16 v[196:199], v[240:243], a[40:43], v[196:199]
    ds_read_b128 a[76:79], v17 offset:3072
    v_mfma_f32_16x16x32_bf16 v[192:195], v[240:243], a[36:39], v[192:195]
    ds_read_b128 a[80:83], v17 offset:8192
    ds_read_b128 a[84:87], v17 offset:9216
    ds_read_b128 a[88:91], v17 offset:10240
    ds_read_b128 a[92:95], v17 offset:11264
    v_mfma_f32_16x16x32_bf16 v[176:179], v[236:239], a[36:39], v[176:179]
    v_mfma_f32_16x16x32_bf16 v[172:175], v[236:239], a[32:35], v[172:175]
    v_mfma_f32_16x16x32_bf16 v[188:191], v[240:243], a[32:35], v[188:191]
    s_waitcnt vmcnt(23) lgkmcnt(0)
    s_barrier
    v_mfma_f32_16x16x32_bf16 v[76:79], v[244:247], a[48:51], v[76:79]
    ds_read_b64_tr_b16 v[232:233], v10 offset:12288
    v_mfma_f32_16x16x32_bf16 v[76:79], v[248:251], a[64:67], v[76:79]
    s_add_u32 m0, s30, 49152
    s_add_u32 s31, s32, 1771648
    v_mfma_f32_16x16x32_bf16 v[76:79], v[252:255], a[80:83], v[76:79]
    buffer_load_dwordx4 v4, s[40:43], s31 offen offset:0 lds
    v_mfma_f32_16x16x32_bf16 v[80:83], v[252:255], a[84:87], v[80:83]
    ds_read_b64_tr_b16 v[234:235], v10 offset:18432
    v_mfma_f32_16x16x32_bf16 v[80:83], v[248:251], a[68:71], v[80:83]
    s_add_u32 s31, s32, 2065536
    ds_read_b64_tr_b16 v[236:237], v10 offset:13312
    v_mfma_f32_16x16x32_bf16 v[80:83], v[244:247], a[52:55], v[80:83]
    buffer_load_dwordx4 v4, s[40:43], s31 offen offset:1024 lds
    v_mfma_f32_16x16x32_bf16 v[84:87], v[244:247], a[56:59], v[84:87]
    ds_read_b64_tr_b16 v[238:239], v10 offset:19456
    v_mfma_f32_16x16x32_bf16 v[84:87], v[248:251], a[72:75], v[84:87]
    ds_read_b64_tr_b16 v[240:241], v10 offset:14336
    v_mfma_f32_16x16x32_bf16 v[84:87], v[252:255], a[88:91], v[84:87]
    s_add_u32 s31, s32, 2359424
    ds_read_b64_tr_b16 v[242:243], v10 offset:20480
    v_mfma_f32_16x16x32_bf16 v[88:91], v[252:255], a[92:95], v[88:91]
    buffer_load_dwordx4 v4, s[40:43], s31 offen offset:2048 lds
    v_mfma_f32_16x16x32_bf16 v[88:91], v[248:251], a[76:79], v[88:91]
    v_mfma_f32_16x16x32_bf16 v[88:91], v[244:247], a[60:63], v[88:91]
    ds_read_b64_tr_b16 v[244:245], v11 offset:12288
    v_mfma_f32_16x16x32_bf16 v[104:107], v[220:223], a[60:63], v[104:107]
    s_add_u32 m0, s29, 0
    s_add_u32 s44, s28, 36864
    v_mfma_f32_16x16x32_bf16 v[104:107], v[224:227], a[76:79], v[104:107]
    buffer_load_dwordx4 v2, s[24:27], s44 offen offset:0 sc1 lds
    v_mfma_f32_16x16x32_bf16 v[104:107], v[228:231], a[92:95], v[104:107]
    ds_read_b64_tr_b16 v[246:247], v11 offset:18432
    v_mfma_f32_16x16x32_bf16 v[100:103], v[228:231], a[88:91], v[100:103]
    ds_read_b64_tr_b16 v[248:249], v11 offset:13312
    v_mfma_f32_16x16x32_bf16 v[100:103], v[224:227], a[72:75], v[100:103]
    buffer_load_dwordx4 v2, s[24:27], s44 offen offset:1024 sc1 lds
    v_mfma_f32_16x16x32_bf16 v[100:103], v[220:223], a[56:59], v[100:103]
    ds_read_b64_tr_b16 v[250:251], v11 offset:19456
    v_mfma_f32_16x16x32_bf16 v[96:99], v[220:223], a[52:55], v[96:99]
    ds_read_b64_tr_b16 v[252:253], v11 offset:14336
    v_mfma_f32_16x16x32_bf16 v[96:99], v[224:227], a[68:71], v[96:99]
    s_cmp_eq_u32 s16, 0
    s_cselect_b32 s44, s83, 0x40000000
    ds_read_b64_tr_b16 v[254:255], v11 offset:20480
    v_mfma_f32_16x16x32_bf16 v[96:99], v[228:231], a[84:87], v[96:99]
    s_mov_b32 exec_hi, 0
    buffer_load_dword v19, v22, s[84:87], s44 offen
    s_mov_b32 exec_hi, -1
    v_mfma_f32_16x16x32_bf16 v[92:95], v[228:231], a[80:83], v[92:95]
    v_mfma_f32_16x16x32_bf16 v[92:95], v[224:227], a[64:67], v[92:95]
    v_mfma_f32_16x16x32_bf16 v[92:95], v[220:223], a[48:51], v[92:95]
    s_waitcnt vmcnt(22) lgkmcnt(0)
    s_barrier
    v_mfma_f32_16x16x32_bf16 v[108:111], v[232:235], a[48:51], v[108:111]
    ds_read_b64_tr_b16 v[220:221], v10 offset:24576
    v_mfma_f32_16x16x32_bf16 v[108:111], v[236:239], a[64:67], v[108:111]
    s_add_u32 m0, s30, 61440
    s_add_u32 s31, s32, 2656256
    v_mfma_f32_16x16x32_bf16 v[108:111], v[240:243], a[80:83], v[108:111]
    buffer_load_dwordx4 v4, s[36:39], s31 offen offset:0 lds
    v_mfma_f32_16x16x32_bf16 v[112:115], v[240:243], a[84:87], v[112:115]
    ds_read_b64_tr_b16 v[222:223], v10 offset:30720
    v_mfma_f32_16x16x32_bf16 v[112:115], v[236:239], a[68:71], v[112:115]
    ds_read_b64_tr_b16 v[224:225], v10 offset:25600
    v_mfma_f32_16x16x32_bf16 v[112:115], v[232:235], a[52:55], v[112:115]
    s_add_u32 s31, s32, 2950144
    ds_read_b64_tr_b16 v[226:227], v10 offset:31744
    v_mfma_f32_16x16x32_bf16 v[116:119], v[232:235], a[56:59], v[116:119]
    buffer_load_dwordx4 v4, s[36:39], s31 offen offset:1024 lds
    v_mfma_f32_16x16x32_bf16 v[116:119], v[236:239], a[72:75], v[116:119]
    ds_read_b64_tr_b16 v[228:229], v10 offset:26624
    v_mfma_f32_16x16x32_bf16 v[116:119], v[240:243], a[88:91], v[116:119]
    ds_read_b64_tr_b16 v[230:231], v10 offset:32768
    v_mfma_f32_16x16x32_bf16 v[120:123], v[240:243], a[92:95], v[120:123]
    s_add_u32 s31, s32, 3244032
    ds_read_b128 a[96:99], v17 offset:16384
    v_mfma_f32_16x16x32_bf16 v[120:123], v[236:239], a[76:79], v[120:123]
    buffer_load_dwordx4 v4, s[36:39], s31 offen offset:2048 lds
    v_mfma_f32_16x16x32_bf16 v[120:123], v[232:235], a[60:63], v[120:123]
    ds_read_b64_tr_b16 v[232:233], v11 offset:24576
    v_mfma_f32_16x16x32_bf16 v[136:139], v[244:247], a[60:63], v[136:139]
    ds_read_b64_tr_b16 v[234:235], v11 offset:30720
    v_mfma_f32_16x16x32_bf16 v[136:139], v[248:251], a[76:79], v[136:139]
    ds_read_b64_tr_b16 v[236:237], v11 offset:25600
    v_mfma_f32_16x16x32_bf16 v[136:139], v[252:255], a[92:95], v[136:139]
    s_add_u32 m0, s29, 8192
    s_add_u32 s44, s28, 40960
    v_mfma_f32_16x16x32_bf16 v[132:135], v[252:255], a[88:91], v[132:135]
    buffer_load_dwordx4 v2, s[24:27], s44 offen offset:0 sc1 lds
    v_mfma_f32_16x16x32_bf16 v[132:135], v[248:251], a[72:75], v[132:135]
    ds_read_b64_tr_b16 v[238:239], v11 offset:31744
    v_mfma_f32_16x16x32_bf16 v[132:135], v[244:247], a[56:59], v[132:135]
    ds_read_b64_tr_b16 v[240:241], v11 offset:26624
    v_mfma_f32_16x16x32_bf16 v[128:131], v[244:247], a[52:55], v[128:131]
    ds_read_b64_tr_b16 v[242:243], v11 offset:32768
    v_mfma_f32_16x16x32_bf16 v[128:131], v[248:251], a[68:71], v[128:131]
    buffer_load_dwordx4 v2, s[24:27], s44 offen offset:1024 sc1 lds
    v_mfma_f32_16x16x32_bf16 v[128:131], v[252:255], a[84:87], v[128:131]
    ds_read_b128 a[100:103], v17 offset:17408
    ds_read_b128 a[104:107], v17 offset:18432
    ds_read_b128 a[108:111], v17 offset:19456
    v_mfma_f32_16x16x32_bf16 v[124:127], v[252:255], a[80:83], v[124:127]
    v_mfma_f32_16x16x32_bf16 v[124:127], v[248:251], a[64:67], v[124:127]
    v_mfma_f32_16x16x32_bf16 v[124:127], v[244:247], a[48:51], v[124:127]
    s_waitcnt vmcnt(14) lgkmcnt(0)
    s_barrier
    v_mfma_f32_16x16x32_bf16 v[140:143], v[220:223], a[48:51], v[140:143]
    ds_read_b64_tr_b16 v[244:245], v8 offset:0
    v_mfma_f32_16x16x32_bf16 v[140:143], v[224:227], a[64:67], v[140:143]
    ds_read_b64_tr_b16 v[246:247], v8 offset:6144
    v_mfma_f32_16x16x32_bf16 v[140:143], v[228:231], a[80:83], v[140:143]
    s_add_u32 m0, s29, 16384
    s_add_u32 s44, s28, 45056
    v_mfma_f32_16x16x32_bf16 v[144:147], v[228:231], a[84:87], v[144:147]
    buffer_load_dwordx4 v2, s[24:27], s44 offen offset:0 sc1 lds
    v_mfma_f32_16x16x32_bf16 v[144:147], v[224:227], a[68:71], v[144:147]
    ds_read_b64_tr_b16 v[248:249], v8 offset:1024
    v_mfma_f32_16x16x32_bf16 v[144:147], v[220:223], a[52:55], v[144:147]
    ds_read_b64_tr_b16 v[250:251], v8 offset:7168
    v_mfma_f32_16x16x32_bf16 v[148:151], v[220:223], a[56:59], v[148:151]
    ds_read_b64_tr_b16 v[252:253], v8 offset:2048
    v_mfma_f32_16x16x32_bf16 v[148:151], v[224:227], a[72:75], v[148:151]
    ds_read_b64_tr_b16 v[254:255], v8 offset:8192
    v_mfma_f32_16x16x32_bf16 v[148:151], v[228:231], a[88:91], v[148:151]
    ds_read_b128 a[112:115], v17 offset:24576
    v_mfma_f32_16x16x32_bf16 v[152:155], v[228:231], a[92:95], v[152:155]
    ds_read_b128 a[116:119], v17 offset:25600
    v_mfma_f32_16x16x32_bf16 v[152:155], v[224:227], a[76:79], v[152:155]
    ds_read_b128 a[120:123], v17 offset:26624
    v_mfma_f32_16x16x32_bf16 v[152:155], v[220:223], a[60:63], v[152:155]
    ds_read_b64_tr_b16 v[220:221], v9 offset:0
    v_mfma_f32_16x16x32_bf16 v[168:171], v[232:235], a[60:63], v[168:171]
    ds_read_b64_tr_b16 v[222:223], v9 offset:6144
    v_mfma_f32_16x16x32_bf16 v[168:171], v[236:239], a[76:79], v[168:171]
    buffer_load_dwordx4 v2, s[24:27], s44 offen offset:1024 sc1 lds
    v_mfma_f32_16x16x32_bf16 v[168:171], v[240:243], a[92:95], v[168:171]
    ds_read_b64_tr_b16 v[224:225], v9 offset:1024
    v_mfma_f32_16x16x32_bf16 v[164:167], v[240:243], a[88:91], v[164:167]
    ds_read_b64_tr_b16 v[226:227], v9 offset:7168
    v_mfma_f32_16x16x32_bf16 v[164:167], v[236:239], a[72:75], v[164:167]
    ds_read_b64_tr_b16 v[228:229], v9 offset:2048
    v_mfma_f32_16x16x32_bf16 v[164:167], v[232:235], a[56:59], v[164:167]
k4_kernel_pg1_0:
    s_cbranch_execz k4_kernel_pg1_4
    ds_read_b64_tr_b16 v[230:231], v9 offset:8192
    v_mfma_f32_16x16x32_bf16 v[160:163], v[232:235], a[52:55], v[160:163]
    ds_read_b128 a[124:127], v17 offset:27648
    v_mfma_f32_16x16x32_bf16 v[160:163], v[236:239], a[68:71], v[160:163]
    v_mfma_f32_16x16x32_bf16 v[160:163], v[240:243], a[84:87], v[160:163]
    v_mfma_f32_16x16x32_bf16 v[156:159], v[240:243], a[80:83], v[156:159]
    v_mfma_f32_16x16x32_bf16 v[156:159], v[236:239], a[64:67], v[156:159]
    v_mfma_f32_16x16x32_bf16 v[156:159], v[232:235], a[48:51], v[156:159]
    s_waitcnt lgkmcnt(0)
    v_mfma_f32_16x16x32_bf16 v[172:175], v[244:247], a[48:51], v[172:175]
    ds_read_b64_tr_b16 v[232:233], v8 offset:12288
    v_mfma_f32_16x16x32_bf16 v[172:175], v[248:251], a[64:67], v[172:175]
    ds_read_b64_tr_b16 v[234:235], v8 offset:18432
    v_mfma_f32_16x16x32_bf16 v[172:175], v[252:255], a[80:83], v[172:175]
    s_add_u32 m0, s30, 73728
    s_add_u32 s31, s32, 2656256
    v_mfma_f32_16x16x32_bf16 v[176:179], v[252:255], a[84:87], v[176:179]
    buffer_load_dwordx4 v4, s[40:43], s31 offen offset:0 lds
    v_mfma_f32_16x16x32_bf16 v[176:179], v[248:251], a[68:71], v[176:179]
    ds_read_b64_tr_b16 v[236:237], v8 offset:13312
    v_mfma_f32_16x16x32_bf16 v[176:179], v[244:247], a[52:55], v[176:179]
    ds_read_b64_tr_b16 v[238:239], v8 offset:19456
    v_mfma_f32_16x16x32_bf16 v[180:183], v[244:247], a[56:59], v[180:183]
    ds_read_b64_tr_b16 v[240:241], v8 offset:14336
    v_mfma_f32_16x16x32_bf16 v[180:183], v[248:251], a[72:75], v[180:183]
    s_add_u32 s31, s32, 2950144
    ds_read_b64_tr_b16 v[242:243], v8 offset:20480
    v_mfma_f32_16x16x32_bf16 v[180:183], v[252:255], a[88:91], v[180:183]
    buffer_load_dwordx4 v4, s[40:43], s31 offen offset:1024 lds
    v_mfma_f32_16x16x32_bf16 v[184:187], v[252:255], a[92:95], v[184:187]
    ds_read_b128 a[128:131], v17 offset:32768
    v_mfma_f32_16x16x32_bf16 v[184:187], v[248:251], a[76:79], v[184:187]
    ds_read_b128 a[132:135], v17 offset:33792
    v_mfma_f32_16x16x32_bf16 v[184:187], v[244:247], a[60:63], v[184:187]
    ds_read_b64_tr_b16 v[244:245], v9 offset:12288
    v_mfma_f32_16x16x32_bf16 v[200:203], v[220:223], a[60:63], v[200:203]
    s_add_u32 s31, s32, 3244032
    ds_read_b64_tr_b16 v[246:247], v9 offset:18432
    v_mfma_f32_16x16x32_bf16 v[200:203], v[224:227], a[76:79], v[200:203]
    buffer_load_dwordx4 v4, s[40:43], s31 offen offset:2048 lds
    v_mfma_f32_16x16x32_bf16 v[200:203], v[228:231], a[92:95], v[200:203]
    ds_read_b64_tr_b16 v[248:249], v9 offset:13312
    v_mfma_f32_16x16x32_bf16 v[196:199], v[228:231], a[88:91], v[196:199]
    ds_read_b64_tr_b16 v[250:251], v9 offset:19456
    v_mfma_f32_16x16x32_bf16 v[196:199], v[224:227], a[72:75], v[196:199]
    ds_read_b64_tr_b16 v[252:253], v9 offset:14336
    v_mfma_f32_16x16x32_bf16 v[196:199], v[220:223], a[56:59], v[196:199]
    s_cmp_eq_u32 s16, 0
    s_cselect_b32 s44, s83, 0x40000000
    ds_read_b64_tr_b16 v[254:255], v9 offset:20480
    v_mfma_f32_16x16x32_bf16 v[192:195], v[220:223], a[52:55], v[192:195]
    s_mov_b32 exec_lo, 0
    buffer_load_dword v19, v22, s[84:87], s44 offen
    s_mov_b32 exec_lo, -1
    v_mfma_f32_16x16x32_bf16 v[192:195], v[224:227], a[68:71], v[192:195]
    ds_read_b128 a[136:139], v17 offset:34816
    v_mfma_f32_16x16x32_bf16 v[192:195], v[228:231], a[84:87], v[192:195]
    ds_read_b128 a[140:143], v17 offset:35840
    v_mfma_f32_16x16x32_bf16 v[188:191], v[228:231], a[80:83], v[188:191]
    v_mfma_f32_16x16x32_bf16 v[188:191], v[224:227], a[64:67], v[188:191]
    v_mfma_f32_16x16x32_bf16 v[188:191], v[220:223], a[48:51], v[188:191]
    s_waitcnt vmcnt(12) lgkmcnt(0)
    s_barrier
    v_mfma_f32_16x16x32_bf16 v[76:79], v[232:235], a[96:99], v[76:79]
    ds_read_b64_tr_b16 v[220:221], v8 offset:24576
    v_mfma_f32_16x16x32_bf16 v[76:79], v[236:239], a[112:115], v[76:79]
    s_add_u32 m0, s30, 0
    s_add_u32 s31, s32, 2656384
    v_mfma_f32_16x16x32_bf16 v[76:79], v[240:243], a[128:131], v[76:79]
    buffer_load_dwordx4 v4, s[36:39], s31 offen offset:0 lds
    v_mfma_f32_16x16x32_bf16 v[80:83], v[240:243], a[132:135], v[80:83]
    ds_read_b64_tr_b16 v[222:223], v8 offset:30720
    v_mfma_f32_16x16x32_bf16 v[80:83], v[236:239], a[116:119], v[80:83]
    ds_read_b64_tr_b16 v[224:225], v8 offset:25600
    v_mfma_f32_16x16x32_bf16 v[80:83], v[232:235], a[100:103], v[80:83]
    s_add_u32 s31, s32, 2950272
    ds_read_b64_tr_b16 v[226:227], v8 offset:31744
    v_mfma_f32_16x16x32_bf16 v[84:87], v[232:235], a[104:107], v[84:87]
    buffer_load_dwordx4 v4, s[36:39], s31 offen offset:1024 lds
    v_mfma_f32_16x16x32_bf16 v[84:87], v[236:239], a[120:123], v[84:87]
    ds_read_b64_tr_b16 v[228:229], v8 offset:26624
    v_mfma_f32_16x16x32_bf16 v[84:87], v[240:243], a[136:139], v[84:87]
    ds_read_b64_tr_b16 v[230:231], v8 offset:32768
    v_mfma_f32_16x16x32_bf16 v[88:91], v[240:243], a[140:143], v[88:91]
    s_add_u32 s31, s32, 3244160
    v_mfma_f32_16x16x32_bf16 v[88:91], v[236:239], a[124:127], v[88:91]
    buffer_load_dwordx4 v4, s[36:39], s31 offen offset:2048 lds
    v_mfma_f32_16x16x32_bf16 v[88:91], v[232:235], a[108:111], v[88:91]
    ds_read_b64_tr_b16 v[232:233], v9 offset:24576
    v_mfma_f32_16x16x32_bf16 v[104:107], v[244:247], a[108:111], v[104:107]
    ds_read_b64_tr_b16 v[234:235], v9 offset:30720
    v_mfma_f32_16x16x32_bf16 v[104:107], v[248:251], a[124:127], v[104:107]
    ds_read_b64_tr_b16 v[236:237], v9 offset:25600
    v_mfma_f32_16x16x32_bf16 v[104:107], v[252:255], a[140:143], v[104:107]
    s_add_u32 m0, s29, 24576
    s_add_u32 s44, s28, 49152
    v_mfma_f32_16x16x32_bf16 v[100:103], v[252:255], a[136:139], v[100:103]
    buffer_load_dwordx4 v2, s[24:27], s44 offen offset:0 sc1 lds
    v_mfma_f32_16x16x32_bf16 v[100:103], v[248:251], a[120:123], v[100:103]
    ds_read_b64_tr_b16 v[238:239], v9 offset:31744
    v_mfma_f32_16x16x32_bf16 v[100:103], v[244:247], a[104:107], v[100:103]
    ds_read_b64_tr_b16 v[240:241], v9 offset:26624
    v_mfma_f32_16x16x32_bf16 v[96:99], v[244:247], a[100:103], v[96:99]
    ds_read_b64_tr_b16 v[242:243], v9 offset:32768
    v_mfma_f32_16x16x32_bf16 v[96:99], v[248:251], a[116:119], v[96:99]
    buffer_load_dwordx4 v2, s[24:27], s44 offen offset:1024 sc1 lds
    v_mfma_f32_16x16x32_bf16 v[96:99], v[252:255], a[132:135], v[96:99]
    v_mfma_f32_16x16x32_bf16 v[92:95], v[252:255], a[128:131], v[92:95]
    v_mfma_f32_16x16x32_bf16 v[92:95], v[248:251], a[112:115], v[92:95]
    v_mfma_f32_16x16x32_bf16 v[92:95], v[244:247], a[96:99], v[92:95]
    s_waitcnt lgkmcnt(0)
    v_mfma_f32_16x16x32_bf16 v[108:111], v[220:223], a[96:99], v[108:111]
    ds_read_b64_tr_b16 v[244:245], v8 offset:36864
    v_mfma_f32_16x16x32_bf16 v[108:111], v[224:227], a[112:115], v[108:111]
    s_add_u32 m0, s30, 12288
    s_add_u32 s31, s32, 2656384
    v_mfma_f32_16x16x32_bf16 v[108:111], v[228:231], a[128:131], v[108:111]
    buffer_load_dwordx4 v4, s[40:43], s31 offen offset:0 lds
    v_mfma_f32_16x16x32_bf16 v[112:115], v[228:231], a[132:135], v[112:115]
    ds_read_b64_tr_b16 v[246:247], v8 offset:43008
    v_mfma_f32_16x16x32_bf16 v[112:115], v[224:227], a[116:119], v[112:115]
    ds_read_b64_tr_b16 v[248:249], v8 offset:37888
    v_mfma_f32_16x16x32_bf16 v[112:115], v[220:223], a[100:103], v[112:115]
    s_add_u32 s31, s32, 2950272
    ds_read_b64_tr_b16 v[250:251], v8 offset:44032
    v_mfma_f32_16x16x32_bf16 v[116:119], v[220:223], a[104:107], v[116:119]
    buffer_load_dwordx4 v4, s[40:43], s31 offen offset:1024 lds
    v_mfma_f32_16x16x32_bf16 v[116:119], v[224:227], a[120:123], v[116:119]
    ds_read_b64_tr_b16 v[252:253], v8 offset:38912
    v_mfma_f32_16x16x32_bf16 v[116:119], v[228:231], a[136:139], v[116:119]
    ds_read_b64_tr_b16 v[254:255], v8 offset:45056
    v_mfma_f32_16x16x32_bf16 v[120:123], v[228:231], a[140:143], v[120:123]
    s_add_u32 s31, s32, 3244160
    ds_read_b128 a[144:147], v16 offset:0
    v_mfma_f32_16x16x32_bf16 v[120:123], v[224:227], a[124:127], v[120:123]
    buffer_load_dwordx4 v4, s[40:43], s31 offen offset:2048 lds
    v_mfma_f32_16x16x32_bf16 v[120:123], v[220:223], a[108:111], v[120:123]
    ds_read_b64_tr_b16 v[220:221], v9 offset:36864
    v_mfma_f32_16x16x32_bf16 v[136:139], v[232:235], a[108:111], v[136:139]
    ds_read_b64_tr_b16 v[222:223], v9 offset:43008
    v_mfma_f32_16x16x32_bf16 v[136:139], v[236:239], a[124:127], v[136:139]
    ds_read_b64_tr_b16 v[224:225], v9 offset:37888
    v_mfma_f32_16x16x32_bf16 v[136:139], v[240:243], a[140:143], v[136:139]
    s_add_u32 m0, s29, 32768
    s_add_u32 s44, s28, 53248
    v_mfma_f32_16x16x32_bf16 v[132:135], v[240:243], a[136:139], v[132:135]
    buffer_load_dwordx4 v2, s[24:27], s44 offen offset:0 sc1 lds
    v_mfma_f32_16x16x32_bf16 v[132:135], v[236:239], a[120:123], v[132:135]
    ds_read_b64_tr_b16 v[226:227], v9 offset:44032
    v_mfma_f32_16x16x32_bf16 v[132:135], v[232:235], a[104:107], v[132:135]
    ds_read_b64_tr_b16 v[228:229], v9 offset:38912
    v_mfma_f32_16x16x32_bf16 v[128:131], v[232:235], a[100:103], v[128:131]
    ds_read_b64_tr_b16 v[230:231], v9 offset:45056
    v_mfma_f32_16x16x32_bf16 v[128:131], v[236:239], a[116:119], v[128:131]
    buffer_load_dwordx4 v2, s[24:27], s44 offen offset:1024 sc1 lds
    v_mfma_f32_16x16x32_bf16 v[128:131], v[240:243], a[132:135], v[128:131]
    ds_read_b128 a[148:151], v16 offset:1024
    ds_read_b128 a[152:155], v16 offset:2048
    ds_read_b128 a[156:159], v16 offset:3072
    v_mfma_f32_16x16x32_bf16 v[124:127], v[240:243], a[128:131], v[124:127]
    v_mfma_f32_16x16x32_bf16 v[124:127], v[236:239], a[112:115], v[124:127]
    v_mfma_f32_16x16x32_bf16 v[124:127], v[232:235], a[96:99], v[124:127]
    s_waitcnt vmcnt(14) lgkmcnt(0)
    s_barrier
    v_mfma_f32_16x16x32_bf16 v[140:143], v[244:247], a[96:99], v[140:143]
    ds_read_b64_tr_b16 v[232:233], v10 offset:0
    v_mfma_f32_16x16x32_bf16 v[140:143], v[248:251], a[112:115], v[140:143]
    s_add_u32 m0, s30, 24576
    s_add_u32 s31, s32, 3540992
    v_mfma_f32_16x16x32_bf16 v[140:143], v[252:255], a[128:131], v[140:143]
    buffer_load_dwordx4 v4, s[36:39], s31 offen offset:0 lds
    v_mfma_f32_16x16x32_bf16 v[144:147], v[252:255], a[132:135], v[144:147]
    s_add_u32 s31, s32, 3834880
    ds_read_b64_tr_b16 v[234:235], v10 offset:6144
    v_mfma_f32_16x16x32_bf16 v[144:147], v[248:251], a[116:119], v[144:147]
    buffer_load_dwordx4 v4, s[36:39], s31 offen offset:1024 lds
    v_mfma_f32_16x16x32_bf16 v[144:147], v[244:247], a[100:103], v[144:147]
    ds_read_b64_tr_b16 v[236:237], v10 offset:1024
    v_mfma_f32_16x16x32_bf16 v[148:151], v[244:247], a[104:107], v[148:151]
    s_add_u32 s31, s32, 4128768
    ds_read_b64_tr_b16 v[238:239], v10 offset:7168
    v_mfma_f32_16x16x32_bf16 v[148:151], v[248:251], a[120:123], v[148:151]
    buffer_load_dwordx4 v4, s[36:39], s31 offen offset:2048 lds
    v_mfma_f32_16x16x32_bf16 v[148:151], v[252:255], a[136:139], v[148:151]
    ds_read_b64_tr_b16 v[240:241], v10 offset:2048
    v_mfma_f32_16x16x32_bf16 v[152:155], v[252:255], a[140:143], v[152:155]
    s_add_u32 m0, s29, 40960
    s_add_u32 s44, s28, 57344
    v_mfma_f32_16x16x32_bf16 v[152:155], v[248:251], a[124:127], v[152:155]
    buffer_load_dwordx4 v2, s[24:27], s44 offen offset:0 sc1 lds
    v_mfma_f32_16x16x32_bf16 v[152:155], v[244:247], a[108:111], v[152:155]
    ds_read_b64_tr_b16 v[242:243], v10 offset:8192
    v_mfma_f32_16x16x32_bf16 v[168:171], v[220:223], a[108:111], v[168:171]
    ds_read_b64_tr_b16 v[244:245], v11 offset:0
    v_mfma_f32_16x16x32_bf16 v[168:171], v[224:227], a[124:127], v[168:171]
    buffer_load_dwordx4 v2, s[24:27], s44 offen offset:1024 sc1 lds
    v_mfma_f32_16x16x32_bf16 v[168:171], v[228:231], a[140:143], v[168:171]
    s_add_u32 m0, s29, 49152
    s_add_u32 s44, s28, 61440
    v_mfma_f32_16x16x32_bf16 v[164:167], v[228:231], a[136:139], v[164:167]
    buffer_load_dwordx4 v2, s[24:27], s44 offen offset:0 sc1 lds
    v_mfma_f32_16x16x32_bf16 v[164:167], v[224:227], a[120:123], v[164:167]
    ds_read_b64_tr_b16 v[246:247], v11 offset:6144
    v_mfma_f32_16x16x32_bf16 v[164:167], v[220:223], a[104:107], v[164:167]
    ds_read_b64_tr_b16 v[248:249], v11 offset:1024
    v_mfma_f32_16x16x32_bf16 v[160:163], v[220:223], a[100:103], v[160:163]
    buffer_load_dwordx4 v2, s[24:27], s44 offen offset:1024 sc1 lds
    v_mfma_f32_16x16x32_bf16 v[160:163], v[224:227], a[116:119], v[160:163]
    ds_read_b64_tr_b16 v[250:251], v11 offset:7168
    ds_read_b64_tr_b16 v[252:253], v11 offset:2048
    ds_read_b64_tr_b16 v[254:255], v11 offset:8192
    v_mfma_f32_16x16x32_bf16 v[160:163], v[228:231], a[132:135], v[160:163]
    s_cmp_eq_u32 s16, 1
    s_cselect_b32 s44, s83, 0x40000000
    ds_read_b128 a[160:163], v16 offset:8192
    ds_read_b128 a[164:167], v16 offset:9216
    ds_read_b128 a[168:171], v16 offset:10240
    ds_read_b128 a[172:175], v16 offset:11264
    v_mfma_f32_16x16x32_bf16 v[156:159], v[228:231], a[128:131], v[156:159]
    s_mov_b32 exec_hi, 0
    buffer_load_dword v19, v22, s[84:87], s44 offen
    s_mov_b32 exec_hi, -1
    v_mfma_f32_16x16x32_bf16 v[156:159], v[224:227], a[112:115], v[156:159]
    v_mfma_f32_16x16x32_bf16 v[156:159], v[220:223], a[96:99], v[156:159]
    s_waitcnt lgkmcnt(0)
    v_mfma_f32_16x16x32_bf16 v[172:175], v[232:235], a[96:99], v[172:175]
    ds_read_b64_tr_b16 v[220:221], v10 offset:12288
    v_mfma_f32_16x16x32_bf16 v[172:175], v[236:239], a[112:115], v[172:175]
    s_add_u32 m0, s30, 36864
    s_add_u32 s31, s32, 3540992
    v_mfma_f32_16x16x32_bf16 v[172:175], v[240:243], a[128:131], v[172:175]
    buffer_load_dwordx4 v4, s[40:43], s31 offen offset:0 lds
    v_mfma_f32_16x16x32_bf16 v[176:179], v[240:243], a[132:135], v[176:179]
    ds_read_b64_tr_b16 v[222:223], v10 offset:18432
    v_mfma_f32_16x16x32_bf16 v[176:179], v[236:239], a[116:119], v[176:179]
    ds_read_b64_tr_b16 v[224:225], v10 offset:13312
    v_mfma_f32_16x16x32_bf16 v[176:179], v[232:235], a[100:103], v[176:179]
    s_add_u32 s31, s32, 3834880
    ds_read_b64_tr_b16 v[226:227], v10 offset:19456
    v_mfma_f32_16x16x32_bf16 v[180:183], v[232:235], a[104:107], v[180:183]
    buffer_load_dwordx4 v4, s[40:43], s31 offen offset:1024 lds
    v_mfma_f32_16x16x32_bf16 v[180:183], v[236:239], a[120:123], v[180:183]
    ds_read_b64_tr_b16 v[228:229], v10 offset:14336
    v_mfma_f32_16x16x32_bf16 v[180:183], v[240:243], a[136:139], v[180:183]
    ds_read_b64_tr_b16 v[230:231], v10 offset:20480
    v_mfma_f32_16x16x32_bf16 v[184:187], v[240:243], a[140:143], v[184:187]
    s_add_u32 s31, s32, 4128768
    ds_read_b128 a[176:179], v16 offset:16384
    v_mfma_f32_16x16x32_bf16 v[184:187], v[236:239], a[124:127], v[184:187]
    buffer_load_dwordx4 v4, s[40:43], s31 offen offset:2048 lds
    v_mfma_f32_16x16x32_bf16 v[184:187], v[232:235], a[108:111], v[184:187]
    ds_read_b64_tr_b16 v[232:233], v11 offset:12288
    v_mfma_f32_16x16x32_bf16 v[200:203], v[244:247], a[108:111], v[200:203]
    ds_read_b64_tr_b16 v[234:235], v11 offset:18432
    v_mfma_f32_16x16x32_bf16 v[200:203], v[248:251], a[124:127], v[200:203]
    ds_read_b64_tr_b16 v[236:237], v11 offset:13312
    v_mfma_f32_16x16x32_bf16 v[200:203], v[252:255], a[140:143], v[200:203]
    s_add_u32 m0, s29, 57344
    s_add_u32 s44, s28, 65536
    v_mfma_f32_16x16x32_bf16 v[196:199], v[252:255], a[136:139], v[196:199]
    buffer_load_dwordx4 v2, s[24:27], s44 offen offset:0 sc1 lds
    v_mfma_f32_16x16x32_bf16 v[196:199], v[248:251], a[120:123], v[196:199]
    ds_read_b64_tr_b16 v[238:239], v11 offset:19456
    v_mfma_f32_16x16x32_bf16 v[196:199], v[244:247], a[104:107], v[196:199]
    ds_read_b64_tr_b16 v[240:241], v11 offset:14336
    v_mfma_f32_16x16x32_bf16 v[192:195], v[244:247], a[100:103], v[192:195]
    ds_read_b64_tr_b16 v[242:243], v11 offset:20480
    v_mfma_f32_16x16x32_bf16 v[192:195], v[248:251], a[116:119], v[192:195]
    buffer_load_dwordx4 v2, s[24:27], s44 offen offset:1024 sc1 lds
    v_mfma_f32_16x16x32_bf16 v[192:195], v[252:255], a[132:135], v[192:195]
    ds_read_b128 a[180:183], v16 offset:17408
    ds_read_b128 a[184:187], v16 offset:18432
    ds_read_b128 a[188:191], v16 offset:19456
    v_mfma_f32_16x16x32_bf16 v[188:191], v[252:255], a[128:131], v[188:191]
    v_mfma_f32_16x16x32_bf16 v[188:191], v[248:251], a[112:115], v[188:191]
    v_mfma_f32_16x16x32_bf16 v[188:191], v[244:247], a[96:99], v[188:191]
    s_waitcnt vmcnt(18) lgkmcnt(0)
    s_barrier
    v_mfma_f32_16x16x32_bf16 v[76:79], v[220:223], a[144:147], v[76:79]
    ds_read_b64_tr_b16 v[244:245], v10 offset:24576
    v_mfma_f32_16x16x32_bf16 v[76:79], v[224:227], a[160:163], v[76:79]
    s_add_u32 m0, s30, 49152
    s_add_u32 s31, s32, 4425728
    v_mfma_f32_16x16x32_bf16 v[76:79], v[228:231], a[176:179], v[76:79]
    buffer_load_dwordx4 v4, s[36:39], s31 offen offset:0 lds
    v_mfma_f32_16x16x32_bf16 v[80:83], v[228:231], a[180:183], v[80:83]
    ds_read_b64_tr_b16 v[246:247], v10 offset:30720
    v_mfma_f32_16x16x32_bf16 v[80:83], v[224:227], a[164:167], v[80:83]
    ds_read_b64_tr_b16 v[248:249], v10 offset:25600
    v_mfma_f32_16x16x32_bf16 v[80:83], v[220:223], a[148:151], v[80:83]
    s_add_u32 s31, s32, 4719616
    ds_read_b64_tr_b16 v[250:251], v10 offset:31744
    v_mfma_f32_16x16x32_bf16 v[84:87], v[220:223], a[152:155], v[84:87]
    buffer_load_dwordx4 v4, s[36:39], s31 offen offset:1024 lds
    v_mfma_f32_16x16x32_bf16 v[84:87], v[224:227], a[168:171], v[84:87]
    ds_read_b64_tr_b16 v[252:253], v10 offset:26624
    v_mfma_f32_16x16x32_bf16 v[84:87], v[228:231], a[184:187], v[84:87]
    ds_read_b64_tr_b16 v[254:255], v10 offset:32768
    v_mfma_f32_16x16x32_bf16 v[88:91], v[228:231], a[188:191], v[88:91]
    s_add_u32 s31, s32, 5013504
    v_mfma_f32_16x16x32_bf16 v[88:91], v[224:227], a[172:175], v[88:91]
    buffer_load_dwordx4 v4, s[36:39], s31 offen offset:2048 lds
    v_mfma_f32_16x16x32_bf16 v[88:91], v[220:223], a[156:159], v[88:91]
    ds_read_b64_tr_b16 v[220:221], v11 offset:24576
    v_mfma_f32_16x16x32_bf16 v[104:107], v[232:235], a[156:159], v[104:107]
    ds_read_b64_tr_b16 v[222:223], v11 offset:30720
    v_mfma_f32_16x16x32_bf16 v[104:107], v[236:239], a[172:175], v[104:107]
    ds_read_b64_tr_b16 v[224:225], v11 offset:25600
    v_mfma_f32_16x16x32_bf16 v[104:107], v[240:243], a[188:191], v[104:107]
    s_add_u32 m0, s29, 65536
    s_add_u32 s44, s28, 69632
    v_mfma_f32_16x16x32_bf16 v[100:103], v[240:243], a[184:187], v[100:103]
    buffer_load_dwordx4 v2, s[24:27], s44 offen offset:0 sc1 lds
    v_mfma_f32_16x16x32_bf16 v[100:103], v[236:239], a[168:171], v[100:103]
    ds_read_b64_tr_b16 v[226:227], v11 offset:31744
    v_mfma_f32_16x16x32_bf16 v[100:103], v[232:235], a[152:155], v[100:103]
    ds_read_b64_tr_b16 v[228:229], v11 offset:26624
    v_mfma_f32_16x16x32_bf16 v[96:99], v[232:235], a[148:151], v[96:99]
    ds_read_b64_tr_b16 v[230:231], v11 offset:32768
    v_mfma_f32_16x16x32_bf16 v[96:99], v[236:239], a[164:167], v[96:99]
    buffer_load_dwordx4 v2, s[24:27], s44 offen offset:1024 sc1 lds
    v_mfma_f32_16x16x32_bf16 v[96:99], v[240:243], a[180:183], v[96:99]
    v_mfma_f32_16x16x32_bf16 v[92:95], v[240:243], a[176:179], v[92:95]
    v_mfma_f32_16x16x32_bf16 v[92:95], v[236:239], a[160:163], v[92:95]
    v_mfma_f32_16x16x32_bf16 v[92:95], v[232:235], a[144:147], v[92:95]
    s_waitcnt lgkmcnt(0)
    v_mfma_f32_16x16x32_bf16 v[108:111], v[244:247], a[144:147], v[108:111]
    ds_read_b64_tr_b16 v[232:233], v8 offset:0
    v_mfma_f32_16x16x32_bf16 v[108:111], v[248:251], a[160:163], v[108:111]
    ds_read_b64_tr_b16 v[234:235], v8 offset:6144
    v_mfma_f32_16x16x32_bf16 v[108:111], v[252:255], a[176:179], v[108:111]
    s_add_u32 m0, s30, 61440
    s_add_u32 s31, s32, 4425728
    v_mfma_f32_16x16x32_bf16 v[112:115], v[252:255], a[180:183], v[112:115]
    buffer_load_dwordx4 v4, s[40:43], s31 offen offset:0 lds
    v_mfma_f32_16x16x32_bf16 v[112:115], v[248:251], a[164:167], v[112:115]
    ds_read_b64_tr_b16 v[236:237], v8 offset:1024
    v_mfma_f32_16x16x32_bf16 v[112:115], v[244:247], a[148:151], v[112:115]
    ds_read_b64_tr_b16 v[238:239], v8 offset:7168
    v_mfma_f32_16x16x32_bf16 v[116:119], v[244:247], a[152:155], v[116:119]
    ds_read_b64_tr_b16 v[240:241], v8 offset:2048
    v_mfma_f32_16x16x32_bf16 v[116:119], v[248:251], a[168:171], v[116:119]
    s_add_u32 s31, s32, 4719616
    ds_read_b64_tr_b16 v[242:243], v8 offset:8192
    v_mfma_f32_16x16x32_bf16 v[116:119], v[252:255], a[184:187], v[116:119]
    buffer_load_dwordx4 v4, s[40:43], s31 offen offset:1024 lds
    v_mfma_f32_16x16x32_bf16 v[120:123], v[252:255], a[188:191], v[120:123]
    ds_read_b128 a[192:195], v16 offset:24576
    v_mfma_f32_16x16x32_bf16 v[120:123], v[248:251], a[172:175], v[120:123]
    ds_read_b128 a[196:199], v16 offset:25600
    v_mfma_f32_16x16x32_bf16 v[120:123], v[244:247], a[156:159], v[120:123]
    ds_read_b64_tr_b16 v[244:245], v9 offset:0
    v_mfma_f32_16x16x32_bf16 v[136:139], v[220:223], a[156:159], v[136:139]
    s_add_u32 s31, s32, 5013504
    ds_read_b64_tr_b16 v[246:247], v9 offset:6144
    v_mfma_f32_16x16x32_bf16 v[136:139], v[224:227], a[172:175], v[136:139]
    buffer_load_dwordx4 v4, s[40:43], s31 offen offset:2048 lds
    v_mfma_f32_16x16x32_bf16 v[136:139], v[228:231], a[188:191], v[136:139]
    ds_read_b64_tr_b16 v[248:249], v9 offset:1024
    v_mfma_f32_16x16x32_bf16 v[132:135], v[228:231], a[184:187], v[132:135]
    ds_read_b64_tr_b16 v[250:251], v9 offset:7168
    v_mfma_f32_16x16x32_bf16 v[132:135], v[224:227], a[168:171], v[132:135]
    ds_read_b64_tr_b16 v[252:253], v9 offset:2048
    v_mfma_f32_16x16x32_bf16 v[132:135], v[220:223], a[152:155], v[132:135]
    s_cmp_eq_u32 s16, 1
    s_cselect_b32 s44, s83, 0x40000000
    ds_read_b64_tr_b16 v[254:255], v9 offset:8192
    v_mfma_f32_16x16x32_bf16 v[128:131], v[220:223], a[148:151], v[128:131]
    s_mov_b32 exec_lo, 0
    buffer_load_dword v19, v22, s[84:87], s44 offen
    s_mov_b32 exec_lo, -1
    v_mfma_f32_16x16x32_bf16 v[128:131], v[224:227], a[164:167], v[128:131]
    ds_read_b128 a[200:203], v16 offset:26624
    v_mfma_f32_16x16x32_bf16 v[128:131], v[228:231], a[180:183], v[128:131]
    ds_read_b128 a[204:207], v16 offset:27648
    v_mfma_f32_16x16x32_bf16 v[124:127], v[228:231], a[176:179], v[124:127]
    v_mfma_f32_16x16x32_bf16 v[124:127], v[224:227], a[160:163], v[124:127]
    v_mfma_f32_16x16x32_bf16 v[124:127], v[220:223], a[144:147], v[124:127]
    s_waitcnt vmcnt(15) lgkmcnt(0)
    s_barrier
    v_mfma_f32_16x16x32_bf16 v[140:143], v[232:235], a[144:147], v[140:143]
    ds_read_b64_tr_b16 v[220:221], v8 offset:12288
    v_mfma_f32_16x16x32_bf16 v[140:143], v[236:239], a[160:163], v[140:143]
    ds_read_b64_tr_b16 v[222:223], v8 offset:18432
    v_mfma_f32_16x16x32_bf16 v[140:143], v[240:243], a[176:179], v[140:143]
    s_add_u32 m0, s30, 73728
    s_add_u32 s31, s32, 3541120
    v_mfma_f32_16x16x32_bf16 v[144:147], v[240:243], a[180:183], v[144:147]
    buffer_load_dwordx4 v4, s[36:39], s31 offen offset:0 lds
    v_mfma_f32_16x16x32_bf16 v[144:147], v[236:239], a[164:167], v[144:147]
    ds_read_b64_tr_b16 v[224:225], v8 offset:13312
    v_mfma_f32_16x16x32_bf16 v[144:147], v[232:235], a[148:151], v[144:147]
    ds_read_b64_tr_b16 v[226:227], v8 offset:19456
    v_mfma_f32_16x16x32_bf16 v[148:151], v[232:235], a[152:155], v[148:151]
    ds_read_b64_tr_b16 v[228:229], v8 offset:14336
    v_mfma_f32_16x16x32_bf16 v[148:151], v[236:239], a[168:171], v[148:151]
    ds_read_b64_tr_b16 v[230:231], v8 offset:20480
    v_mfma_f32_16x16x32_bf16 v[148:151], v[240:243], a[184:187], v[148:151]
    ds_read_b128 a[208:211], v17 offset:0
    v_mfma_f32_16x16x32_bf16 v[152:155], v[240:243], a[188:191], v[152:155]
    s_add_u32 s31, s32, 3835008
    ds_read_b128 a[212:215], v17 offset:1024
    v_mfma_f32_16x16x32_bf16 v[152:155], v[236:239], a[172:175], v[152:155]
    buffer_load_dwordx4 v4, s[36:39], s31 offen offset:1024 lds
    v_mfma_f32_16x16x32_bf16 v[152:155], v[232:235], a[156:159], v[152:155]
    ds_read_b64_tr_b16 v[232:233], v9 offset:12288
    v_mfma_f32_16x16x32_bf16 v[168:171], v[244:247], a[156:159], v[168:171]
    ds_read_b64_tr_b16 v[234:235], v9 offset:18432
    v_mfma_f32_16x16x32_bf16 v[168:171], v[248:251], a[172:175], v[168:171]
    ds_read_b64_tr_b16 v[236:237], v9 offset:13312
    v_mfma_f32_16x16x32_bf16 v[168:171], v[252:255], a[188:191], v[168:171]
    ds_read_b64_tr_b16 v[238:239], v9 offset:19456
    v_mfma_f32_16x16x32_bf16 v[164:167], v[252:255], a[184:187], v[164:167]
    ds_read_b64_tr_b16 v[240:241], v9 offset:14336
    v_mfma_f32_16x16x32_bf16 v[164:167], v[248:251], a[168:171], v[164:167]
    s_add_u32 s31, s32, 4128896
    ds_read_b64_tr_b16 v[242:243], v9 offset:20480
    v_mfma_f32_16x16x32_bf16 v[164:167], v[244:247], a[152:155], v[164:167]
    buffer_load_dwordx4 v4, s[36:39], s31 offen offset:2048 lds
    v_mfma_f32_16x16x32_bf16 v[160:163], v[244:247], a[148:151], v[160:163]
    ds_read_b128 a[216:219], v17 offset:2048
    v_mfma_f32_16x16x32_bf16 v[160:163], v[248:251], a[164:167], v[160:163]
    ds_read_b128 a[220:223], v17 offset:3072
    v_mfma_f32_16x16x32_bf16 v[160:163], v[252:255], a[180:183], v[160:163]
    v_mfma_f32_16x16x32_bf16 v[156:159], v[252:255], a[176:179], v[156:159]
    v_mfma_f32_16x16x32_bf16 v[156:159], v[248:251], a[160:163], v[156:159]
    v_mfma_f32_16x16x32_bf16 v[156:159], v[244:247], a[144:147], v[156:159]
    s_waitcnt lgkmcnt(0)
    v_mfma_f32_16x16x32_bf16 v[172:175], v[220:223], a[144:147], v[172:175]
    ds_read_b64_tr_b16 v[244:245], v8 offset:24576
    v_mfma_f32_16x16x32_bf16 v[172:175], v[224:227], a[160:163], v[172:175]
    ds_read_b64_tr_b16 v[246:247], v8 offset:30720
    v_mfma_f32_16x16x32_bf16 v[172:175], v[228:231], a[176:179], v[172:175]
    s_add_u32 m0, s30, 0
    s_add_u32 s31, s32, 3541120
    v_mfma_f32_16x16x32_bf16 v[176:179], v[228:231], a[180:183], v[176:179]
    buffer_load_dwordx4 v4, s[40:43], s31 offen offset:0 lds
    v_mfma_f32_16x16x32_bf16 v[176:179], v[224:227], a[164:167], v[176:179]
    ds_read_b64_tr_b16 v[248:249], v8 offset:25600
    v_mfma_f32_16x16x32_bf16 v[176:179], v[220:223], a[148:151], v[176:179]
    ds_read_b64_tr_b16 v[250:251], v8 offset:31744
    v_mfma_f32_16x16x32_bf16 v[180:183], v[220:223], a[152:155], v[180:183]
    ds_read_b64_tr_b16 v[252:253], v8 offset:26624
    v_mfma_f32_16x16x32_bf16 v[180:183], v[224:227], a[168:171], v[180:183]
    ds_read_b64_tr_b16 v[254:255], v8 offset:32768
    v_mfma_f32_16x16x32_bf16 v[180:183], v[228:231], a[184:187], v[180:183]
    ds_read_b128 a[224:227], v17 offset:8192
    v_mfma_f32_16x16x32_bf16 v[184:187], v[228:231], a[188:191], v[184:187]
    s_add_u32 s31, s32, 3835008
    ds_read_b128 a[228:231], v17 offset:9216
    v_mfma_f32_16x16x32_bf16 v[184:187], v[224:227], a[172:175], v[184:187]
    buffer_load_dwordx4 v4, s[40:43], s31 offen offset:1024 lds
    v_mfma_f32_16x16x32_bf16 v[184:187], v[220:223], a[156:159], v[184:187]
    ds_read_b64_tr_b16 v[220:221], v9 offset:24576
    v_mfma_f32_16x16x32_bf16 v[200:203], v[232:235], a[156:159], v[200:203]
    ds_read_b64_tr_b16 v[222:223], v9 offset:30720
    v_mfma_f32_16x16x32_bf16 v[200:203], v[236:239], a[172:175], v[200:203]
    ds_read_b64_tr_b16 v[224:225], v9 offset:25600
    v_mfma_f32_16x16x32_bf16 v[200:203], v[240:243], a[188:191], v[200:203]
    ds_read_b64_tr_b16 v[226:227], v9 offset:31744
    v_mfma_f32_16x16x32_bf16 v[196:199], v[240:243], a[184:187], v[196:199]
    ds_read_b64_tr_b16 v[228:229], v9 offset:26624
    v_mfma_f32_16x16x32_bf16 v[196:199], v[236:239], a[168:171], v[196:199]
    s_add_u32 s31, s32, 4128896
    ds_read_b64_tr_b16 v[230:231], v9 offset:32768
    v_mfma_f32_16x16x32_bf16 v[196:199], v[232:235], a[152:155], v[196:199]
    buffer_load_dwordx4 v4, s[40:43], s31 offen offset:2048 lds
    v_mfma_f32_16x16x32_bf16 v[192:195], v[232:235], a[148:151], v[192:195]
    ds_read_b128 a[232:235], v17 offset:10240
    v_mfma_f32_16x16x32_bf16 v[192:195], v[236:239], a[164:167], v[192:195]
    ds_read_b128 a[236:239], v17 offset:11264
    v_mfma_f32_16x16x32_bf16 v[192:195], v[240:243], a[180:183], v[192:195]
    ds_read_b128 a[240:243], v17 offset:16384
    ds_read_b128 a[244:247], v17 offset:17408
    ds_read_b128 a[248:251], v17 offset:18432
    ds_read_b128 a[252:255], v17 offset:19456
    v_mfma_f32_16x16x32_bf16 v[188:191], v[240:243], a[176:179], v[188:191]
    v_mfma_f32_16x16x32_bf16 v[188:191], v[236:239], a[160:163], v[188:191]
    v_mfma_f32_16x16x32_bf16 v[188:191], v[232:235], a[144:147], v[188:191]
    s_waitcnt vmcnt(10) lgkmcnt(0)
    s_barrier
    v_mfma_f32_16x16x32_bf16 v[76:79], v[244:247], a[192:195], v[76:79]
    ds_read_b64_tr_b16 v[232:233], v8 offset:36864
    v_mfma_f32_16x16x32_bf16 v[76:79], v[248:251], a[208:211], v[76:79]
    ds_read_b64_tr_b16 v[234:235], v8 offset:43008
    v_mfma_f32_16x16x32_bf16 v[76:79], v[252:255], a[224:227], v[76:79]
    s_add_u32 m0, s30, 12288
    s_add_u32 s31, s32, 4425856
    v_mfma_f32_16x16x32_bf16 v[80:83], v[252:255], a[228:231], v[80:83]
    buffer_load_dwordx4 v4, s[36:39], s31 offen offset:0 lds
    v_mfma_f32_16x16x32_bf16 v[80:83], v[248:251], a[212:215], v[80:83]
    ds_read_b64_tr_b16 v[236:237], v8 offset:37888
    v_mfma_f32_16x16x32_bf16 v[80:83], v[244:247], a[196:199], v[80:83]
    ds_read_b64_tr_b16 v[238:239], v8 offset:44032
    v_mfma_f32_16x16x32_bf16 v[84:87], v[244:247], a[200:203], v[84:87]
    ds_read_b64_tr_b16 v[240:241], v8 offset:38912
    v_mfma_f32_16x16x32_bf16 v[84:87], v[248:251], a[216:219], v[84:87]
    s_add_u32 s31, s32, 4719744
    ds_read_b64_tr_b16 v[242:243], v8 offset:45056
    v_mfma_f32_16x16x32_bf16 v[84:87], v[252:255], a[232:235], v[84:87]
    buffer_load_dwordx4 v4, s[36:39], s31 offen offset:1024 lds
    v_mfma_f32_16x16x32_bf16 v[88:91], v[252:255], a[236:239], v[88:91]
    ds_read_b128 v[44:47], v17 offset:24576
    v_mfma_f32_16x16x32_bf16 v[88:91], v[248:251], a[220:223], v[88:91]
    ds_read_b128 v[48:51], v17 offset:25600
    v_mfma_f32_16x16x32_bf16 v[88:91], v[244:247], a[204:207], v[88:91]
    ds_read_b64_tr_b16 v[244:245], v9 offset:36864
    v_mfma_f32_16x16x32_bf16 v[104:107], v[220:223], a[204:207], v[104:107]
    s_add_u32 s31, s32, 5013632
    ds_read_b64_tr_b16 v[246:247], v9 offset:43008
    v_mfma_f32_16x16x32_bf16 v[104:107], v[224:227], a[220:223], v[104:107]
    buffer_load_dwordx4 v4, s[36:39], s31 offen offset:2048 lds
    v_mfma_f32_16x16x32_bf16 v[104:107], v[228:231], a[236:239], v[104:107]
    ds_read_b64_tr_b16 v[248:249], v9 offset:37888
    v_mfma_f32_16x16x32_bf16 v[100:103], v[228:231], a[232:235], v[100:103]
    ds_read_b64_tr_b16 v[250:251], v9 offset:44032
    v_mfma_f32_16x16x32_bf16 v[100:103], v[224:227], a[216:219], v[100:103]
    ds_read_b64_tr_b16 v[252:253], v9 offset:38912
    v_mfma_f32_16x16x32_bf16 v[100:103], v[220:223], a[200:203], v[100:103]
    s_cmp_eq_u32 s16, 2
    s_cselect_b32 s44, s83, 0x40000000
    ds_read_b64_tr_b16 v[254:255], v9 offset:45056
    v_mfma_f32_16x16x32_bf16 v[96:99], v[220:223], a[196:199], v[96:99]
    s_mov_b32 exec_hi, 0
    buffer_load_dword v19, v22, s[84:87], s44 offen
    s_mov_b32 exec_hi, -1
    v_mfma_f32_16x16x32_bf16 v[96:99], v[224:227], a[212:215], v[96:99]
    ds_read_b128 v[52:55], v17 offset:26624
k4_kernel_pg1_1:
    s_cbranch_execz k4_kernel_pg1_5
    v_mfma_f32_16x16x32_bf16 v[96:99], v[228:231], a[228:231], v[96:99]
    ds_read_b128 v[56:59], v17 offset:27648
    v_mfma_f32_16x16x32_bf16 v[92:95], v[228:231], a[224:227], v[92:95]
    v_mfma_f32_16x16x32_bf16 v[92:95], v[224:227], a[208:211], v[92:95]
    v_mfma_f32_16x16x32_bf16 v[92:95], v[220:223], a[192:195], v[92:95]
    s_waitcnt lgkmcnt(0)
    v_mfma_f32_16x16x32_bf16 v[108:111], v[232:235], a[192:195], v[108:111]
    ds_read_b64_tr_b16 v[220:221], v10 offset:0
    v_mfma_f32_16x16x32_bf16 v[108:111], v[236:239], a[208:211], v[108:111]
    ds_read_b64_tr_b16 v[222:223], v10 offset:6144
    v_mfma_f32_16x16x32_bf16 v[108:111], v[240:243], a[224:227], v[108:111]
    s_add_u32 m0, s30, 24576
    s_add_u32 s31, s32, 4425856
    v_mfma_f32_16x16x32_bf16 v[112:115], v[240:243], a[228:231], v[112:115]
    buffer_load_dwordx4 v4, s[40:43], s31 offen offset:0 lds
    v_mfma_f32_16x16x32_bf16 v[112:115], v[236:239], a[212:215], v[112:115]
    ds_read_b64_tr_b16 v[224:225], v10 offset:1024
    v_mfma_f32_16x16x32_bf16 v[112:115], v[232:235], a[196:199], v[112:115]
    ds_read_b64_tr_b16 v[226:227], v10 offset:7168
    v_mfma_f32_16x16x32_bf16 v[116:119], v[232:235], a[200:203], v[116:119]
    ds_read_b64_tr_b16 v[228:229], v10 offset:2048
    v_mfma_f32_16x16x32_bf16 v[116:119], v[236:239], a[216:219], v[116:119]
    ds_read_b64_tr_b16 v[230:231], v10 offset:8192
    v_mfma_f32_16x16x32_bf16 v[116:119], v[240:243], a[232:235], v[116:119]
    ds_read_b128 v[60:63], v17 offset:32768
    v_mfma_f32_16x16x32_bf16 v[120:123], v[240:243], a[236:239], v[120:123]
    s_add_u32 s31, s32, 4719744
    ds_read_b128 v[64:67], v17 offset:33792
    v_mfma_f32_16x16x32_bf16 v[120:123], v[236:239], a[220:223], v[120:123]
    buffer_load_dwordx4 v4, s[40:43], s31 offen offset:1024 lds
    v_mfma_f32_16x16x32_bf16 v[120:123], v[232:235], a[204:207], v[120:123]
    ds_read_b64_tr_b16 v[232:233], v11 offset:0
    v_mfma_f32_16x16x32_bf16 v[136:139], v[244:247], a[204:207], v[136:139]
    ds_read_b64_tr_b16 v[234:235], v11 offset:6144
    v_mfma_f32_16x16x32_bf16 v[136:139], v[248:251], a[220:223], v[136:139]
    ds_read_b64_tr_b16 v[236:237], v11 offset:1024
    v_mfma_f32_16x16x32_bf16 v[136:139], v[252:255], a[236:239], v[136:139]
    ds_read_b64_tr_b16 v[238:239], v11 offset:7168
    v_mfma_f32_16x16x32_bf16 v[132:135], v[252:255], a[232:235], v[132:135]
    ds_read_b64_tr_b16 v[240:241], v11 offset:2048
    v_mfma_f32_16x16x32_bf16 v[132:135], v[248:251], a[216:219], v[132:135]
    s_add_u32 s31, s32, 5013632
    ds_read_b64_tr_b16 v[242:243], v11 offset:8192
    v_mfma_f32_16x16x32_bf16 v[132:135], v[244:247], a[200:203], v[132:135]
    buffer_load_dwordx4 v4, s[40:43], s31 offen offset:2048 lds
    v_mfma_f32_16x16x32_bf16 v[128:131], v[244:247], a[196:199], v[128:131]
    ds_read_b128 v[68:71], v17 offset:34816
    v_mfma_f32_16x16x32_bf16 v[128:131], v[248:251], a[212:215], v[128:131]
    ds_read_b128 v[72:75], v17 offset:35840
    v_mfma_f32_16x16x32_bf16 v[128:131], v[252:255], a[228:231], v[128:131]
    v_mfma_f32_16x16x32_bf16 v[124:127], v[252:255], a[224:227], v[124:127]
    v_mfma_f32_16x16x32_bf16 v[124:127], v[248:251], a[208:211], v[124:127]
    v_mfma_f32_16x16x32_bf16 v[124:127], v[244:247], a[192:195], v[124:127]
    s_waitcnt vmcnt(10) lgkmcnt(0)
    s_barrier
    v_mfma_f32_16x16x32_bf16 v[76:79], v[220:223], a[240:243], v[76:79]
    ds_read_b64_tr_b16 v[244:245], v10 offset:12288
    v_mfma_f32_16x16x32_bf16 v[76:79], v[224:227], v[44:47], v[76:79]
    ds_read_b64_tr_b16 v[246:247], v10 offset:18432
    v_mfma_f32_16x16x32_bf16 v[76:79], v[228:231], v[60:63], v[76:79]
    s_add_u32 m0, s30, 36864
    s_add_u32 s31, s32, 2304
    v_mfma_f32_16x16x32_bf16 v[80:83], v[228:231], v[64:67], v[80:83]
    buffer_load_dwordx4 v4, s[36:39], s31 offen offset:0 lds
    v_mfma_f32_16x16x32_bf16 v[80:83], v[224:227], v[48:51], v[80:83]
    ds_read_b64_tr_b16 v[248:249], v10 offset:13312
    v_mfma_f32_16x16x32_bf16 v[80:83], v[220:223], a[244:247], v[80:83]
    ds_read_b64_tr_b16 v[250:251], v10 offset:19456
    v_mfma_f32_16x16x32_bf16 v[84:87], v[220:223], a[248:251], v[84:87]
    ds_read_b64_tr_b16 v[252:253], v10 offset:14336
    v_mfma_f32_16x16x32_bf16 v[84:87], v[224:227], v[52:55], v[84:87]
    s_add_u32 s31, s32, 296192
    ds_read_b64_tr_b16 v[254:255], v10 offset:20480
    v_mfma_f32_16x16x32_bf16 v[84:87], v[228:231], v[68:71], v[84:87]
    buffer_load_dwordx4 v4, s[36:39], s31 offen offset:1024 lds
    v_mfma_f32_16x16x32_bf16 v[88:91], v[228:231], v[72:75], v[88:91]
    v_mfma_f32_16x16x32_bf16 v[88:91], v[224:227], v[56:59], v[88:91]
    v_mfma_f32_16x16x32_bf16 v[88:91], v[220:223], a[252:255], v[88:91]
    ds_read_b64_tr_b16 v[220:221], v11 offset:12288
    v_mfma_f32_16x16x32_bf16 v[104:107], v[232:235], a[252:255], v[104:107]
    s_add_u32 s31, s32, 590080
    ds_read_b64_tr_b16 v[222:223], v11 offset:18432
    v_mfma_f32_16x16x32_bf16 v[104:107], v[236:239], v[56:59], v[104:107]
    buffer_load_dwordx4 v4, s[36:39], s31 offen offset:2048 lds
    v_mfma_f32_16x16x32_bf16 v[104:107], v[240:243], v[72:75], v[104:107]
    ds_read_b64_tr_b16 v[224:225], v11 offset:13312
    v_mfma_f32_16x16x32_bf16 v[100:103], v[240:243], v[68:71], v[100:103]
    ds_read_b64_tr_b16 v[226:227], v11 offset:19456
    v_mfma_f32_16x16x32_bf16 v[100:103], v[236:239], v[52:55], v[100:103]
    ds_read_b64_tr_b16 v[228:229], v11 offset:14336
    v_mfma_f32_16x16x32_bf16 v[100:103], v[232:235], a[248:251], v[100:103]
    s_cmp_eq_u32 s16, 2
    s_cselect_b32 s44, s83, 0x40000000
    ds_read_b64_tr_b16 v[230:231], v11 offset:20480
    v_mfma_f32_16x16x32_bf16 v[96:99], v[232:235], a[244:247], v[96:99]
    s_mov_b32 exec_lo, 0
    buffer_load_dword v19, v22, s[84:87], s44 offen
    s_mov_b32 exec_lo, -1
    v_mfma_f32_16x16x32_bf16 v[96:99], v[236:239], v[48:51], v[96:99]
    v_mfma_f32_16x16x32_bf16 v[96:99], v[240:243], v[64:67], v[96:99]
    v_mfma_f32_16x16x32_bf16 v[92:95], v[240:243], v[60:63], v[92:95]
    v_mfma_f32_16x16x32_bf16 v[92:95], v[236:239], v[44:47], v[92:95]
    v_mfma_f32_16x16x32_bf16 v[92:95], v[232:235], a[240:243], v[92:95]
    s_waitcnt lgkmcnt(0)
    v_mfma_f32_16x16x32_bf16 v[108:111], v[244:247], a[240:243], v[108:111]
    ds_read_b64_tr_b16 v[232:233], v10 offset:24576
    v_mfma_f32_16x16x32_bf16 v[108:111], v[248:251], v[44:47], v[108:111]
    ds_read_b64_tr_b16 v[234:235], v10 offset:30720
    v_mfma_f32_16x16x32_bf16 v[108:111], v[252:255], v[60:63], v[108:111]
    s_add_u32 m0, s30, 49152
    s_add_u32 s31, s32, 2304
    v_mfma_f32_16x16x32_bf16 v[112:115], v[252:255], v[64:67], v[112:115]
    buffer_load_dwordx4 v4, s[40:43], s31 offen offset:0 lds
    v_mfma_f32_16x16x32_bf16 v[112:115], v[248:251], v[48:51], v[112:115]
    ds_read_b64_tr_b16 v[236:237], v10 offset:25600
    v_mfma_f32_16x16x32_bf16 v[112:115], v[244:247], a[244:247], v[112:115]
    ds_read_b64_tr_b16 v[238:239], v10 offset:31744
    v_mfma_f32_16x16x32_bf16 v[116:119], v[244:247], a[248:251], v[116:119]
    ds_read_b64_tr_b16 v[240:241], v10 offset:26624
    v_mfma_f32_16x16x32_bf16 v[116:119], v[248:251], v[52:55], v[116:119]
    ds_read_b64_tr_b16 v[242:243], v10 offset:32768
    v_mfma_f32_16x16x32_bf16 v[116:119], v[252:255], v[68:71], v[116:119]
    v_mfma_f32_16x16x32_bf16 v[120:123], v[252:255], v[72:75], v[120:123]
    s_add_u32 s31, s32, 296192
    v_mfma_f32_16x16x32_bf16 v[120:123], v[248:251], v[56:59], v[120:123]
    buffer_load_dwordx4 v4, s[40:43], s31 offen offset:1024 lds
    v_mfma_f32_16x16x32_bf16 v[120:123], v[244:247], a[252:255], v[120:123]
    ds_read_b64_tr_b16 v[244:245], v11 offset:24576
    v_mfma_f32_16x16x32_bf16 v[136:139], v[220:223], a[252:255], v[136:139]
    ds_read_b64_tr_b16 v[246:247], v11 offset:30720
    v_mfma_f32_16x16x32_bf16 v[136:139], v[224:227], v[56:59], v[136:139]
    ds_read_b64_tr_b16 v[248:249], v11 offset:25600
    v_mfma_f32_16x16x32_bf16 v[136:139], v[228:231], v[72:75], v[136:139]
    ds_read_b64_tr_b16 v[250:251], v11 offset:31744
    v_mfma_f32_16x16x32_bf16 v[132:135], v[228:231], v[68:71], v[132:135]
    ds_read_b64_tr_b16 v[252:253], v11 offset:26624
    v_mfma_f32_16x16x32_bf16 v[132:135], v[224:227], v[52:55], v[132:135]
    s_add_u32 s31, s32, 590080
    ds_read_b64_tr_b16 v[254:255], v11 offset:32768
    v_mfma_f32_16x16x32_bf16 v[132:135], v[220:223], a[248:251], v[132:135]
    buffer_load_dwordx4 v4, s[40:43], s31 offen offset:2048 lds
    v_mfma_f32_16x16x32_bf16 v[128:131], v[220:223], a[244:247], v[128:131]
    v_mfma_f32_16x16x32_bf16 v[128:131], v[224:227], v[48:51], v[128:131]
    v_mfma_f32_16x16x32_bf16 v[128:131], v[228:231], v[64:67], v[128:131]
    v_mfma_f32_16x16x32_bf16 v[124:127], v[228:231], v[60:63], v[124:127]
    v_mfma_f32_16x16x32_bf16 v[124:127], v[224:227], v[44:47], v[124:127]
    v_mfma_f32_16x16x32_bf16 v[124:127], v[220:223], a[240:243], v[124:127]
    s_waitcnt vmcnt(11) lgkmcnt(0)
    s_barrier
    v_mfma_f32_16x16x32_bf16 v[140:143], v[232:235], a[192:195], v[140:143]
    ds_read_b64_tr_b16 v[220:221], v8 offset:0
    v_mfma_f32_16x16x32_bf16 v[140:143], v[236:239], a[208:211], v[140:143]
    ds_read_b64_tr_b16 v[222:223], v8 offset:6144
    v_mfma_f32_16x16x32_bf16 v[140:143], v[240:243], a[224:227], v[140:143]
    s_add_u32 m0, s30, 61440
    s_add_u32 s31, s32, 887040
    v_mfma_f32_16x16x32_bf16 v[144:147], v[240:243], a[228:231], v[144:147]
    buffer_load_dwordx4 v4, s[36:39], s31 offen offset:0 lds
    v_mfma_f32_16x16x32_bf16 v[144:147], v[236:239], a[212:215], v[144:147]
    ds_read_b64_tr_b16 v[224:225], v8 offset:1024
    v_max_f32 v76, 0, v76
    v_mfma_f32_16x16x32_bf16 v[144:147], v[232:235], a[196:199], v[144:147]
    ds_read_b64_tr_b16 v[226:227], v8 offset:7168
    v_max_f32 v77, 0, v77
    v_mfma_f32_16x16x32_bf16 v[148:151], v[232:235], a[200:203], v[148:151]
    ds_read_b64_tr_b16 v[228:229], v8 offset:2048
    v_max_f32 v78, 0, v78
    v_mfma_f32_16x16x32_bf16 v[148:151], v[236:239], a[216:219], v[148:151]
    s_add_u32 s31, s32, 1180928
    ds_read_b64_tr_b16 v[230:231], v8 offset:8192
    v_mfma_f32_16x16x32_bf16 v[148:151], v[240:243], a[232:235], v[148:151]
    buffer_load_dwordx4 v4, s[36:39], s31 offen offset:1024 lds
    v_mfma_f32_16x16x32_bf16 v[152:155], v[240:243], a[236:239], v[152:155]
    v_max_f32 v79, 0, v79
    v_mul_f32 v76, v76, v108
    v_mfma_f32_16x16x32_bf16 v[152:155], v[236:239], a[220:223], v[152:155]
    v_mul_f32 v77, v77, v109
    v_mul_f32 v78, v78, v110
    v_mfma_f32_16x16x32_bf16 v[152:155], v[232:235], a[204:207], v[152:155]
    ds_read_b64_tr_b16 v[232:233], v9 offset:0
    v_mul_f32 v79, v79, v111
    v_mfma_f32_16x16x32_bf16 v[168:171], v[244:247], a[204:207], v[168:171]
    s_add_u32 s31, s32, 1474816
    ds_read_b64_tr_b16 v[234:235], v9 offset:6144
    v_mfma_f32_16x16x32_bf16 v[168:171], v[248:251], a[220:223], v[168:171]
    buffer_load_dwordx4 v4, s[36:39], s31 offen offset:2048 lds
    v_mfma_f32_16x16x32_bf16 v[168:171], v[252:255], a[236:239], v[168:171]
    ds_read_b64_tr_b16 v[236:237], v9 offset:1024
    v_cvt_pk_bf16_f32 v36, v76, v77
    v_mfma_f32_16x16x32_bf16 v[164:167], v[252:255], a[232:235], v[164:167]
    ds_read_b64_tr_b16 v[238:239], v9 offset:7168
    v_cvt_pk_bf16_f32 v37, v78, v79
    v_mfma_f32_16x16x32_bf16 v[164:167], v[248:251], a[216:219], v[164:167]
    ds_read_b64_tr_b16 v[240:241], v9 offset:2048
    v_max_f32 v92, 0, v92
    v_mfma_f32_16x16x32_bf16 v[164:167], v[244:247], a[200:203], v[164:167]
    s_cmp_eq_u32 s16, 3
    s_cselect_b32 s44, s83, 0x40000000
    ds_read_b64_tr_b16 v[242:243], v9 offset:8192
    v_mfma_f32_16x16x32_bf16 v[160:163], v[244:247], a[196:199], v[160:163]
    s_mov_b32 exec_hi, 0
    buffer_load_dword v19, v22, s[84:87], s44 offen
    s_mov_b32 exec_hi, -1
    v_mfma_f32_16x16x32_bf16 v[160:163], v[248:251], a[212:215], v[160:163]
    v_max_f32 v93, 0, v93
    v_max_f32 v94, 0, v94
    v_mfma_f32_16x16x32_bf16 v[160:163], v[252:255], a[228:231], v[160:163]
    v_max_f32 v95, 0, v95
    v_mul_f32 v92, v92, v124
    v_mfma_f32_16x16x32_bf16 v[156:159], v[252:255], a[224:227], v[156:159]
    v_mul_f32 v93, v93, v125
    v_mul_f32 v94, v94, v126
    v_mfma_f32_16x16x32_bf16 v[156:159], v[248:251], a[208:211], v[156:159]
    v_mul_f32 v95, v95, v127
    v_cvt_pk_bf16_f32 v38, v92, v93
    v_mfma_f32_16x16x32_bf16 v[156:159], v[244:247], a[192:195], v[156:159]
    v_cvt_pk_bf16_f32 v39, v94, v95
    ds_write_b128 v14, v[36:39] offset:0
    s_waitcnt lgkmcnt(0)
    v_mfma_f32_16x16x32_bf16 v[172:175], v[220:223], a[192:195], v[172:175]
    ds_read_b64_tr_b16 v[244:245], v8 offset:12288
    v_mfma_f32_16x16x32_bf16 v[172:175], v[224:227], a[208:211], v[172:175]
    ds_read_b64_tr_b16 v[246:247], v8 offset:18432
    v_mfma_f32_16x16x32_bf16 v[172:175], v[228:231], a[224:227], v[172:175]
    s_add_u32 m0, s30, 73728
    s_add_u32 s31, s32, 887040
    v_mfma_f32_16x16x32_bf16 v[176:179], v[228:231], a[228:231], v[176:179]
    buffer_load_dwordx4 v4, s[40:43], s31 offen offset:0 lds
    v_mfma_f32_16x16x32_bf16 v[176:179], v[224:227], a[212:215], v[176:179]
    ds_read_b64_tr_b16 v[248:249], v8 offset:13312
    v_max_f32 v80, 0, v80
    v_mfma_f32_16x16x32_bf16 v[176:179], v[220:223], a[196:199], v[176:179]
    ds_read_b64_tr_b16 v[250:251], v8 offset:19456
    v_max_f32 v81, 0, v81
    v_mfma_f32_16x16x32_bf16 v[180:183], v[220:223], a[200:203], v[180:183]
    ds_read_b64_tr_b16 v[252:253], v8 offset:14336
    v_max_f32 v82, 0, v82
    v_mfma_f32_16x16x32_bf16 v[180:183], v[224:227], a[216:219], v[180:183]
    ds_read_b64_tr_b16 v[254:255], v8 offset:20480
    v_max_f32 v83, 0, v83
    v_mfma_f32_16x16x32_bf16 v[180:183], v[228:231], a[232:235], v[180:183]
    v_mul_f32 v80, v80, v112
    v_mul_f32 v81, v81, v113
    v_mfma_f32_16x16x32_bf16 v[184:187], v[228:231], a[236:239], v[184:187]
    s_add_u32 s31, s32, 1180928
    v_mul_f32 v82, v82, v114
    v_mfma_f32_16x16x32_bf16 v[184:187], v[224:227], a[220:223], v[184:187]
    buffer_load_dwordx4 v4, s[40:43], s31 offen offset:1024 lds
    v_mfma_f32_16x16x32_bf16 v[184:187], v[220:223], a[204:207], v[184:187]
    ds_read_b64_tr_b16 v[220:221], v9 offset:12288
    v_mul_f32 v83, v83, v115
    v_mfma_f32_16x16x32_bf16 v[200:203], v[232:235], a[204:207], v[200:203]
    ds_read_b64_tr_b16 v[222:223], v9 offset:18432
    v_cvt_pk_bf16_f32 v40, v80, v81
    v_mfma_f32_16x16x32_bf16 v[200:203], v[236:239], a[220:223], v[200:203]
    ds_read_b64_tr_b16 v[224:225], v9 offset:13312
    v_cvt_pk_bf16_f32 v41, v82, v83
    v_mfma_f32_16x16x32_bf16 v[200:203], v[240:243], a[236:239], v[200:203]
    ds_read_b64_tr_b16 v[226:227], v9 offset:19456
    v_max_f32 v96, 0, v96
    v_mfma_f32_16x16x32_bf16 v[196:199], v[240:243], a[232:235], v[196:199]
    ds_read_b64_tr_b16 v[228:229], v9 offset:14336
    v_max_f32 v97, 0, v97
    v_mfma_f32_16x16x32_bf16 v[196:199], v[236:239], a[216:219], v[196:199]
    s_add_u32 s31, s32, 1474816
    ds_read_b64_tr_b16 v[230:231], v9 offset:20480
    v_mfma_f32_16x16x32_bf16 v[196:199], v[232:235], a[200:203], v[196:199]
    buffer_load_dwordx4 v4, s[40:43], s31 offen offset:2048 lds
    v_mfma_f32_16x16x32_bf16 v[192:195], v[232:235], a[196:199], v[192:195]
    v_max_f32 v98, 0, v98
    v_max_f32 v99, 0, v99
    v_mfma_f32_16x16x32_bf16 v[192:195], v[236:239], a[212:215], v[192:195]
    v_mul_f32 v96, v96, v128
    v_mul_f32 v97, v97, v129
    v_mfma_f32_16x16x32_bf16 v[192:195], v[240:243], a[228:231], v[192:195]
    v_mul_f32 v98, v98, v130
    v_mul_f32 v99, v99, v131
    v_mfma_f32_16x16x32_bf16 v[188:191], v[240:243], a[224:227], v[188:191]
    v_cvt_pk_bf16_f32 v42, v96, v97
    v_cvt_pk_bf16_f32 v43, v98, v99
    v_mfma_f32_16x16x32_bf16 v[188:191], v[236:239], a[208:211], v[188:191]
    ds_write_b128 v14, v[40:43] offset:1024
    v_mfma_f32_16x16x32_bf16 v[188:191], v[232:235], a[192:195], v[188:191]
    s_waitcnt vmcnt(11) lgkmcnt(0)
    s_barrier
    v_mfma_f32_16x16x32_bf16 v[140:143], v[244:247], a[240:243], v[140:143]
    ds_read_b64_tr_b16 v[232:233], v8 offset:24576
    v_mfma_f32_16x16x32_bf16 v[140:143], v[248:251], v[44:47], v[140:143]
    ds_read_b64_tr_b16 v[234:235], v8 offset:30720
    v_mfma_f32_16x16x32_bf16 v[140:143], v[252:255], v[60:63], v[140:143]
    s_add_u32 m0, s30, 0
    s_add_u32 s31, s32, 1771776
    v_mfma_f32_16x16x32_bf16 v[144:147], v[252:255], v[64:67], v[144:147]
    buffer_load_dwordx4 v4, s[36:39], s31 offen offset:0 lds
    v_mfma_f32_16x16x32_bf16 v[144:147], v[248:251], v[48:51], v[144:147]
    ds_read_b64_tr_b16 v[236:237], v8 offset:25600
    v_max_f32 v84, 0, v84
    v_mfma_f32_16x16x32_bf16 v[144:147], v[244:247], a[244:247], v[144:147]
    ds_read_b64_tr_b16 v[238:239], v8 offset:31744
    v_max_f32 v85, 0, v85
    v_mfma_f32_16x16x32_bf16 v[148:151], v[244:247], a[248:251], v[148:151]
    ds_read_b64_tr_b16 v[240:241], v8 offset:26624
    v_max_f32 v86, 0, v86
    v_mfma_f32_16x16x32_bf16 v[148:151], v[248:251], v[52:55], v[148:151]
    s_add_u32 s31, s32, 2065664
    ds_read_b64_tr_b16 v[242:243], v8 offset:32768
    v_mfma_f32_16x16x32_bf16 v[148:151], v[252:255], v[68:71], v[148:151]
    buffer_load_dwordx4 v4, s[36:39], s31 offen offset:1024 lds
    v_mfma_f32_16x16x32_bf16 v[152:155], v[252:255], v[72:75], v[152:155]
    v_max_f32 v87, 0, v87
    v_mul_f32 v84, v84, v116
    v_mfma_f32_16x16x32_bf16 v[152:155], v[248:251], v[56:59], v[152:155]
    v_mul_f32 v85, v85, v117
    v_mul_f32 v86, v86, v118
    v_mfma_f32_16x16x32_bf16 v[152:155], v[244:247], a[252:255], v[152:155]
    ds_read_b64_tr_b16 v[244:245], v9 offset:24576
    v_mul_f32 v87, v87, v119
    v_mfma_f32_16x16x32_bf16 v[168:171], v[220:223], a[252:255], v[168:171]
    s_add_u32 s31, s32, 2359552
    ds_read_b64_tr_b16 v[246:247], v9 offset:30720
    v_mfma_f32_16x16x32_bf16 v[168:171], v[224:227], v[56:59], v[168:171]
    buffer_load_dwordx4 v4, s[36:39], s31 offen offset:2048 lds
    v_mfma_f32_16x16x32_bf16 v[168:171], v[228:231], v[72:75], v[168:171]
    ds_read_b64_tr_b16 v[248:249], v9 offset:25600
    v_cvt_pk_bf16_f32 v36, v84, v85
    v_mfma_f32_16x16x32_bf16 v[164:167], v[228:231], v[68:71], v[164:167]
    ds_read_b64_tr_b16 v[250:251], v9 offset:31744
    v_cvt_pk_bf16_f32 v37, v86, v87
    v_mfma_f32_16x16x32_bf16 v[164:167], v[224:227], v[52:55], v[164:167]
    ds_read_b64_tr_b16 v[252:253], v9 offset:26624
    v_max_f32 v100, 0, v100
    v_mfma_f32_16x16x32_bf16 v[164:167], v[220:223], a[248:251], v[164:167]
    s_cmp_eq_u32 s16, 3
    s_cselect_b32 s44, s83, 0x40000000
    ds_read_b64_tr_b16 v[254:255], v9 offset:32768
    v_mfma_f32_16x16x32_bf16 v[160:163], v[220:223], a[244:247], v[160:163]
    s_mov_b32 exec_lo, 0
    buffer_load_dword v19, v22, s[84:87], s44 offen
    s_mov_b32 exec_lo, -1
    v_mfma_f32_16x16x32_bf16 v[160:163], v[224:227], v[48:51], v[160:163]
    v_max_f32 v101, 0, v101
    v_max_f32 v102, 0, v102
    v_mfma_f32_16x16x32_bf16 v[160:163], v[228:231], v[64:67], v[160:163]
    v_max_f32 v103, 0, v103
    v_mul_f32 v100, v100, v132
    v_mfma_f32_16x16x32_bf16 v[156:159], v[228:231], v[60:63], v[156:159]
    v_mul_f32 v101, v101, v133
    v_mul_f32 v102, v102, v134
    v_mfma_f32_16x16x32_bf16 v[156:159], v[224:227], v[44:47], v[156:159]
    v_mul_f32 v103, v103, v135
    v_cvt_pk_bf16_f32 v38, v100, v101
    v_mfma_f32_16x16x32_bf16 v[156:159], v[220:223], a[240:243], v[156:159]
    v_cvt_pk_bf16_f32 v39, v102, v103
    ds_write_b128 v14, v[36:39] offset:2048
    s_waitcnt lgkmcnt(0)
    v_mfma_f32_16x16x32_bf16 v[172:175], v[232:235], a[240:243], v[172:175]
    ds_read_b64_tr_b16 v[220:221], v8 offset:36864
    v_mfma_f32_16x16x32_bf16 v[172:175], v[236:239], v[44:47], v[172:175]
    ds_read_b64_tr_b16 v[222:223], v8 offset:43008
    v_mfma_f32_16x16x32_bf16 v[172:175], v[240:243], v[60:63], v[172:175]
    s_add_u32 m0, s30, 12288
    s_add_u32 s31, s32, 1771776
    v_mfma_f32_16x16x32_bf16 v[176:179], v[240:243], v[64:67], v[176:179]
    buffer_load_dwordx4 v4, s[40:43], s31 offen offset:0 lds
    v_mfma_f32_16x16x32_bf16 v[176:179], v[236:239], v[48:51], v[176:179]
    ds_read_b64_tr_b16 v[224:225], v8 offset:37888
    v_max_f32 v88, 0, v88
    v_mfma_f32_16x16x32_bf16 v[176:179], v[232:235], a[244:247], v[176:179]
    ds_read_b64_tr_b16 v[226:227], v8 offset:44032
    v_max_f32 v89, 0, v89
    v_mfma_f32_16x16x32_bf16 v[180:183], v[232:235], a[248:251], v[180:183]
    ds_read_b64_tr_b16 v[228:229], v8 offset:38912
    v_max_f32 v90, 0, v90
    v_mfma_f32_16x16x32_bf16 v[180:183], v[236:239], v[52:55], v[180:183]
    ds_read_b64_tr_b16 v[230:231], v8 offset:45056
    v_max_f32 v91, 0, v91
    v_mfma_f32_16x16x32_bf16 v[180:183], v[240:243], v[68:71], v[180:183]
    v_mul_f32 v88, v88, v120
    v_mul_f32 v89, v89, v121
    v_mfma_f32_16x16x32_bf16 v[184:187], v[240:243], v[72:75], v[184:187]
    s_add_u32 s31, s32, 2065664
    v_mul_f32 v90, v90, v122
    v_mfma_f32_16x16x32_bf16 v[184:187], v[236:239], v[56:59], v[184:187]
    buffer_load_dwordx4 v4, s[40:43], s31 offen offset:1024 lds
    v_mfma_f32_16x16x32_bf16 v[184:187], v[232:235], a[252:255], v[184:187]
    ds_read_b64_tr_b16 v[232:233], v9 offset:36864
    v_mul_f32 v91, v91, v123
    v_mfma_f32_16x16x32_bf16 v[200:203], v[244:247], a[252:255], v[200:203]
    ds_read_b64_tr_b16 v[234:235], v9 offset:43008
    v_cvt_pk_bf16_f32 v40, v88, v89
    v_mfma_f32_16x16x32_bf16 v[200:203], v[248:251], v[56:59], v[200:203]
    ds_read_b64_tr_b16 v[236:237], v9 offset:37888
    v_cvt_pk_bf16_f32 v41, v90, v91
    v_mfma_f32_16x16x32_bf16 v[200:203], v[252:255], v[72:75], v[200:203]
    ds_read_b64_tr_b16 v[238:239], v9 offset:44032
    v_max_f32 v104, 0, v104
    v_mfma_f32_16x16x32_bf16 v[196:199], v[252:255], v[68:71], v[196:199]
    ds_read_b64_tr_b16 v[240:241], v9 offset:38912
    v_max_f32 v105, 0, v105
    v_mfma_f32_16x16x32_bf16 v[196:199], v[248:251], v[52:55], v[196:199]
    s_add_u32 s31, s32, 2359552
    ds_read_b64_tr_b16 v[242:243], v9 offset:45056
    v_mfma_f32_16x16x32_bf16 v[196:199], v[244:247], a[248:251], v[196:199]
    buffer_load_dwordx4 v4, s[40:43], s31 offen offset:2048 lds
    v_mfma_f32_16x16x32_bf16 v[192:195], v[244:247], a[244:247], v[192:195]
    v_max_f32 v106, 0, v106
    v_max_f32 v107, 0, v107
    v_mfma_f32_16x16x32_bf16 v[192:195], v[248:251], v[48:51], v[192:195]
    v_mul_f32 v104, v104, v136
    v_mul_f32 v105, v105, v137
    v_mfma_f32_16x16x32_bf16 v[192:195], v[252:255], v[64:67], v[192:195]
    v_mul_f32 v106, v106, v138
    v_mul_f32 v107, v107, v139
    v_mfma_f32_16x16x32_bf16 v[188:191], v[252:255], v[60:63], v[188:191]
    v_cvt_pk_bf16_f32 v42, v104, v105
    v_cvt_pk_bf16_f32 v43, v106, v107
    v_mfma_f32_16x16x32_bf16 v[188:191], v[248:251], v[44:47], v[188:191]
    ds_write_b128 v14, v[40:43] offset:3072
    v_mfma_f32_16x16x32_bf16 v[188:191], v[244:247], a[240:243], v[188:191]
    s_waitcnt vmcnt(11) lgkmcnt(0)
    s_barrier
    v_mfma_f32_16x16x32_bf16 v[76:79], v[220:223], a[0:3], 0
    ds_read_b64_tr_b16 v[244:245], v10 offset:0
    v_mfma_f32_16x16x32_bf16 v[76:79], v[224:227], a[16:19], v[76:79]
    ds_read_b64_tr_b16 v[246:247], v10 offset:6144
    v_mfma_f32_16x16x32_bf16 v[76:79], v[228:231], a[32:35], v[76:79]
    s_add_u32 m0, s30, 24576
    s_add_u32 s31, s32, 2656512
    v_mfma_f32_16x16x32_bf16 v[80:83], v[228:231], a[36:39], 0
    buffer_load_dwordx4 v4, s[36:39], s31 offen offset:0 lds
    v_mfma_f32_16x16x32_bf16 v[80:83], v[224:227], a[20:23], v[80:83]
    ds_read_b64_tr_b16 v[248:249], v10 offset:1024
    v_mfma_f32_16x16x32_bf16 v[80:83], v[220:223], a[4:7], v[80:83]
    ds_read_b64_tr_b16 v[250:251], v10 offset:7168
    v_mfma_f32_16x16x32_bf16 v[84:87], v[220:223], a[8:11], 0
    ds_read_b64_tr_b16 v[252:253], v10 offset:2048
    v_mfma_f32_16x16x32_bf16 v[84:87], v[224:227], a[24:27], v[84:87]
    ds_read_b64_tr_b16 v[254:255], v10 offset:8192
    v_mfma_f32_16x16x32_bf16 v[84:87], v[228:231], a[40:43], v[84:87]
    ds_read_b128 v[204:207], v14 offset:0
    v_mfma_f32_16x16x32_bf16 v[88:91], v[228:231], a[44:47], 0
    s_add_u32 s31, s32, 2950400
    ds_read_b128 v[208:211], v14 offset:1024
    v_mfma_f32_16x16x32_bf16 v[88:91], v[224:227], a[28:31], v[88:91]
    buffer_load_dwordx4 v4, s[36:39], s31 offen offset:1024 lds
    v_mfma_f32_16x16x32_bf16 v[88:91], v[220:223], a[12:15], v[88:91]
    ds_read_b64_tr_b16 v[220:221], v11 offset:0
    v_mfma_f32_16x16x32_bf16 v[104:107], v[232:235], a[12:15], 0
    ds_read_b64_tr_b16 v[222:223], v11 offset:6144
    v_mfma_f32_16x16x32_bf16 v[104:107], v[236:239], a[28:31], v[104:107]
    ds_read_b64_tr_b16 v[224:225], v11 offset:1024
    v_mfma_f32_16x16x32_bf16 v[104:107], v[240:243], a[44:47], v[104:107]
    ds_read_b64_tr_b16 v[226:227], v11 offset:7168
    v_mfma_f32_16x16x32_bf16 v[100:103], v[240:243], a[40:43], 0
    ds_read_b64_tr_b16 v[228:229], v11 offset:2048
    v_mfma_f32_16x16x32_bf16 v[100:103], v[236:239], a[24:27], v[100:103]
    s_add_u32 s31, s32, 3244288
    ds_read_b64_tr_b16 v[230:231], v11 offset:8192
    v_mfma_f32_16x16x32_bf16 v[100:103], v[232:235], a[8:11], v[100:103]
    buffer_load_dwordx4 v4, s[36:39], s31 offen offset:2048 lds
    v_mfma_f32_16x16x32_bf16 v[96:99], v[232:235], a[4:7], 0
    ds_read_b128 v[212:215], v14 offset:2048
    v_mfma_f32_16x16x32_bf16 v[96:99], v[236:239], a[20:23], v[96:99]
    ds_read_b128 v[216:219], v14 offset:3072
    v_mfma_f32_16x16x32_bf16 v[96:99], v[240:243], a[36:39], v[96:99]
    v_mfma_f32_16x16x32_bf16 v[92:95], v[240:243], a[32:35], 0
    v_mfma_f32_16x16x32_bf16 v[92:95], v[236:239], a[16:19], v[92:95]
    v_mfma_f32_16x16x32_bf16 v[92:95], v[232:235], a[0:3], v[92:95]
    s_waitcnt lgkmcnt(0)
    v_mfma_f32_16x16x32_bf16 v[108:111], v[244:247], a[0:3], 0
    ds_read_b64_tr_b16 v[232:233], v10 offset:12288
    v_mfma_f32_16x16x32_bf16 v[108:111], v[248:251], a[16:19], v[108:111]
    ds_read_b64_tr_b16 v[234:235], v10 offset:18432
    v_mfma_f32_16x16x32_bf16 v[108:111], v[252:255], a[32:35], v[108:111]
    s_add_u32 m0, s30, 36864
    s_add_u32 s31, s32, 2656512
    v_mfma_f32_16x16x32_bf16 v[112:115], v[252:255], a[36:39], 0
    buffer_load_dwordx4 v4, s[40:43], s31 offen offset:0 lds
    v_mfma_f32_16x16x32_bf16 v[112:115], v[248:251], a[20:23], v[112:115]
    ds_read_b64_tr_b16 v[236:237], v10 offset:13312
    v_max_f32 v140, 0, v140
    v_mfma_f32_16x16x32_bf16 v[112:115], v[244:247], a[4:7], v[112:115]
    ds_read_b64_tr_b16 v[238:239], v10 offset:19456
    v_max_f32 v141, 0, v141
    v_mfma_f32_16x16x32_bf16 v[116:119], v[244:247], a[8:11], 0
    ds_read_b64_tr_b16 v[240:241], v10 offset:14336
    v_max_f32 v142, 0, v142
    v_mfma_f32_16x16x32_bf16 v[116:119], v[248:251], a[24:27], v[116:119]
    ds_read_b64_tr_b16 v[242:243], v10 offset:20480
    v_max_f32 v143, 0, v143
    v_mfma_f32_16x16x32_bf16 v[116:119], v[252:255], a[40:43], v[116:119]
    v_mul_f32 v140, v140, v172
    v_mul_f32 v141, v141, v173
    v_mfma_f32_16x16x32_bf16 v[120:123], v[252:255], a[44:47], 0
    s_add_u32 s31, s32, 2950400
    v_mul_f32 v142, v142, v174
    v_mfma_f32_16x16x32_bf16 v[120:123], v[248:251], a[28:31], v[120:123]
    buffer_load_dwordx4 v4, s[40:43], s31 offen offset:1024 lds
    v_mfma_f32_16x16x32_bf16 v[120:123], v[244:247], a[12:15], v[120:123]
    ds_read_b64_tr_b16 v[244:245], v11 offset:12288
    v_mul_f32 v143, v143, v175
    v_mfma_f32_16x16x32_bf16 v[136:139], v[220:223], a[12:15], 0
    ds_read_b64_tr_b16 v[246:247], v11 offset:18432
    v_cvt_pk_bf16_f32 v36, v140, v141
    v_mfma_f32_16x16x32_bf16 v[136:139], v[224:227], a[28:31], v[136:139]
    ds_read_b64_tr_b16 v[248:249], v11 offset:13312
    v_cvt_pk_bf16_f32 v37, v142, v143
    v_mfma_f32_16x16x32_bf16 v[136:139], v[228:231], a[44:47], v[136:139]
    ds_read_b64_tr_b16 v[250:251], v11 offset:19456
    v_max_f32 v156, 0, v156
    v_mfma_f32_16x16x32_bf16 v[132:135], v[228:231], a[40:43], 0
    ds_read_b64_tr_b16 v[252:253], v11 offset:14336
    v_max_f32 v157, 0, v157
    v_mfma_f32_16x16x32_bf16 v[132:135], v[224:227], a[24:27], v[132:135]
    s_add_u32 s31, s32, 3244288
    ds_read_b64_tr_b16 v[254:255], v11 offset:20480
    v_mfma_f32_16x16x32_bf16 v[132:135], v[220:223], a[8:11], v[132:135]
    buffer_load_dwordx4 v4, s[40:43], s31 offen offset:2048 lds
    v_mfma_f32_16x16x32_bf16 v[128:131], v[220:223], a[4:7], 0
    v_max_f32 v158, 0, v158
    v_max_f32 v159, 0, v159
    v_mfma_f32_16x16x32_bf16 v[128:131], v[224:227], a[20:23], v[128:131]
    v_mul_f32 v156, v156, v188
    v_mul_f32 v157, v157, v189
    v_mfma_f32_16x16x32_bf16 v[128:131], v[228:231], a[36:39], v[128:131]
    v_mul_f32 v158, v158, v190
    v_mul_f32 v159, v159, v191
    v_mfma_f32_16x16x32_bf16 v[124:127], v[228:231], a[32:35], 0
    v_cvt_pk_bf16_f32 v38, v156, v157
    v_cvt_pk_bf16_f32 v39, v158, v159
    v_mfma_f32_16x16x32_bf16 v[124:127], v[224:227], a[16:19], v[124:127]
    ds_write_b128 v14, v[36:39] offset:16384
    v_mfma_f32_16x16x32_bf16 v[124:127], v[220:223], a[0:3], v[124:127]
    s_add_u32 s45, s3, 16384
    buffer_store_dwordx4 v[36:39], v2, s[64:67], s45 offen offset:0 sc1
    s_waitcnt vmcnt(11) lgkmcnt(0)
    s_barrier
    v_mfma_f32_16x16x32_bf16 v[76:79], v[232:235], a[48:51], v[76:79]
    ds_read_b64_tr_b16 v[220:221], v10 offset:24576
    v_mfma_f32_16x16x32_bf16 v[76:79], v[236:239], a[64:67], v[76:79]
    ds_read_b64_tr_b16 v[222:223], v10 offset:30720
    v_mfma_f32_16x16x32_bf16 v[76:79], v[240:243], a[80:83], v[76:79]
    s_add_u32 m0, s30, 49152
    s_add_u32 s31, s32, 3541248
    v_mfma_f32_16x16x32_bf16 v[80:83], v[240:243], a[84:87], v[80:83]
    buffer_load_dwordx4 v4, s[36:39], s31 offen offset:0 lds
    v_mfma_f32_16x16x32_bf16 v[80:83], v[236:239], a[68:71], v[80:83]
    ds_read_b64_tr_b16 v[224:225], v10 offset:25600
    s_add_u32 s45, s3, 0
    v_mfma_f32_16x16x32_bf16 v[80:83], v[232:235], a[52:55], v[80:83]
    ds_read_b64_tr_b16 v[226:227], v10 offset:31744
    v_mfma_f32_16x16x32_bf16 v[84:87], v[232:235], a[56:59], v[84:87]
    ds_read_b64_tr_b16 v[228:229], v10 offset:26624
    v_mfma_f32_16x16x32_bf16 v[84:87], v[236:239], a[72:75], v[84:87]
    ds_read_b64_tr_b16 v[230:231], v10 offset:32768
    v_mfma_f32_16x16x32_bf16 v[84:87], v[240:243], a[88:91], v[84:87]
    buffer_store_dwordx4 v[204:207], v2, s[64:67], s45 offen offset:0 sc1
    v_mfma_f32_16x16x32_bf16 v[88:91], v[240:243], a[92:95], v[88:91]
    s_add_u32 s31, s32, 3835136
    v_mfma_f32_16x16x32_bf16 v[88:91], v[236:239], a[76:79], v[88:91]
    buffer_load_dwordx4 v4, s[36:39], s31 offen offset:1024 lds
    v_mfma_f32_16x16x32_bf16 v[88:91], v[232:235], a[60:63], v[88:91]
    ds_read_b64_tr_b16 v[232:233], v11 offset:24576
    v_mfma_f32_16x16x32_bf16 v[104:107], v[244:247], a[60:63], v[104:107]
    ds_read_b64_tr_b16 v[234:235], v11 offset:30720
    v_mfma_f32_16x16x32_bf16 v[104:107], v[248:251], a[76:79], v[104:107]
k4_kernel_pg1_2:
    s_cbranch_execz k4_kernel_pg1_6
    ds_read_b64_tr_b16 v[236:237], v11 offset:25600
    v_mfma_f32_16x16x32_bf16 v[104:107], v[252:255], a[92:95], v[104:107]
    ds_read_b64_tr_b16 v[238:239], v11 offset:31744
    v_mfma_f32_16x16x32_bf16 v[100:103], v[252:255], a[88:91], v[100:103]
    ds_read_b64_tr_b16 v[240:241], v11 offset:26624
    v_mfma_f32_16x16x32_bf16 v[100:103], v[248:251], a[72:75], v[100:103]
    s_add_u32 s31, s32, 4129024
    ds_read_b64_tr_b16 v[242:243], v11 offset:32768
    v_mfma_f32_16x16x32_bf16 v[100:103], v[244:247], a[56:59], v[100:103]
    buffer_load_dwordx4 v4, s[36:39], s31 offen offset:2048 lds
    v_mfma_f32_16x16x32_bf16 v[96:99], v[244:247], a[52:55], v[96:99]
    v_mfma_f32_16x16x32_bf16 v[96:99], v[248:251], a[68:71], v[96:99]
    v_mfma_f32_16x16x32_bf16 v[96:99], v[252:255], a[84:87], v[96:99]
    v_mfma_f32_16x16x32_bf16 v[92:95], v[252:255], a[80:83], v[92:95]
    v_mfma_f32_16x16x32_bf16 v[92:95], v[248:251], a[64:67], v[92:95]
    v_mfma_f32_16x16x32_bf16 v[92:95], v[244:247], a[48:51], v[92:95]
    s_waitcnt lgkmcnt(0)
    v_mfma_f32_16x16x32_bf16 v[108:111], v[220:223], a[48:51], v[108:111]
    ds_read_b64_tr_b16 v[244:245], v8 offset:0
    v_mfma_f32_16x16x32_bf16 v[108:111], v[224:227], a[64:67], v[108:111]
    ds_read_b64_tr_b16 v[246:247], v8 offset:6144
    v_mfma_f32_16x16x32_bf16 v[108:111], v[228:231], a[80:83], v[108:111]
    s_add_u32 m0, s30, 61440
    s_add_u32 s31, s32, 3541248
    v_mfma_f32_16x16x32_bf16 v[112:115], v[228:231], a[84:87], v[112:115]
    buffer_load_dwordx4 v4, s[40:43], s31 offen offset:0 lds
    v_mfma_f32_16x16x32_bf16 v[112:115], v[224:227], a[68:71], v[112:115]
    ds_read_b64_tr_b16 v[248:249], v8 offset:1024
    v_mfma_f32_16x16x32_bf16 v[112:115], v[220:223], a[52:55], v[112:115]
    ds_read_b64_tr_b16 v[250:251], v8 offset:7168
    v_mfma_f32_16x16x32_bf16 v[116:119], v[220:223], a[56:59], v[116:119]
    ds_read_b64_tr_b16 v[252:253], v8 offset:2048
    v_mfma_f32_16x16x32_bf16 v[116:119], v[224:227], a[72:75], v[116:119]
    ds_read_b64_tr_b16 v[254:255], v8 offset:8192
    v_mfma_f32_16x16x32_bf16 v[116:119], v[228:231], a[88:91], v[116:119]
    v_mfma_f32_16x16x32_bf16 v[120:123], v[228:231], a[92:95], v[120:123]
    s_add_u32 s31, s32, 3835136
    v_mfma_f32_16x16x32_bf16 v[120:123], v[224:227], a[76:79], v[120:123]
    buffer_load_dwordx4 v4, s[40:43], s31 offen offset:1024 lds
    v_mfma_f32_16x16x32_bf16 v[120:123], v[220:223], a[60:63], v[120:123]
    ds_read_b64_tr_b16 v[220:221], v9 offset:0
    v_mfma_f32_16x16x32_bf16 v[136:139], v[232:235], a[60:63], v[136:139]
    ds_read_b64_tr_b16 v[222:223], v9 offset:6144
    v_mfma_f32_16x16x32_bf16 v[136:139], v[236:239], a[76:79], v[136:139]
    ds_read_b64_tr_b16 v[224:225], v9 offset:1024
    v_mfma_f32_16x16x32_bf16 v[136:139], v[240:243], a[92:95], v[136:139]
    ds_read_b64_tr_b16 v[226:227], v9 offset:7168
    v_mfma_f32_16x16x32_bf16 v[132:135], v[240:243], a[88:91], v[132:135]
    ds_read_b64_tr_b16 v[228:229], v9 offset:2048
    v_mfma_f32_16x16x32_bf16 v[132:135], v[236:239], a[72:75], v[132:135]
    s_add_u32 s31, s32, 4129024
    ds_read_b64_tr_b16 v[230:231], v9 offset:8192
    v_mfma_f32_16x16x32_bf16 v[132:135], v[232:235], a[56:59], v[132:135]
    buffer_load_dwordx4 v4, s[40:43], s31 offen offset:2048 lds
    v_mfma_f32_16x16x32_bf16 v[128:131], v[232:235], a[52:55], v[128:131]
    v_mfma_f32_16x16x32_bf16 v[128:131], v[236:239], a[68:71], v[128:131]
    v_mfma_f32_16x16x32_bf16 v[128:131], v[240:243], a[84:87], v[128:131]
    v_mfma_f32_16x16x32_bf16 v[124:127], v[240:243], a[80:83], v[124:127]
    v_mfma_f32_16x16x32_bf16 v[124:127], v[236:239], a[64:67], v[124:127]
    v_mfma_f32_16x16x32_bf16 v[124:127], v[232:235], a[48:51], v[124:127]
    s_waitcnt vmcnt(11) lgkmcnt(0)
    s_barrier
    v_mfma_f32_16x16x32_bf16 v[76:79], v[244:247], a[96:99], v[76:79]
    ds_read_b64_tr_b16 v[232:233], v8 offset:12288
    v_mfma_f32_16x16x32_bf16 v[76:79], v[248:251], a[112:115], v[76:79]
    ds_read_b64_tr_b16 v[234:235], v8 offset:18432
    v_mfma_f32_16x16x32_bf16 v[76:79], v[252:255], a[128:131], v[76:79]
    s_add_u32 m0, s30, 73728
    s_add_u32 s31, s32, 4425984
    v_mfma_f32_16x16x32_bf16 v[80:83], v[252:255], a[132:135], v[80:83]
    buffer_load_dwordx4 v4, s[36:39], s31 offen offset:0 lds
    v_mfma_f32_16x16x32_bf16 v[80:83], v[248:251], a[116:119], v[80:83]
    ds_read_b64_tr_b16 v[236:237], v8 offset:13312
    v_max_f32 v144, 0, v144
    v_mfma_f32_16x16x32_bf16 v[80:83], v[244:247], a[100:103], v[80:83]
    ds_read_b64_tr_b16 v[238:239], v8 offset:19456
    v_max_f32 v145, 0, v145
    v_mfma_f32_16x16x32_bf16 v[84:87], v[244:247], a[104:107], v[84:87]
    ds_read_b64_tr_b16 v[240:241], v8 offset:14336
    v_max_f32 v146, 0, v146
    v_mfma_f32_16x16x32_bf16 v[84:87], v[248:251], a[120:123], v[84:87]
    ds_read_b64_tr_b16 v[242:243], v8 offset:20480
    v_max_f32 v147, 0, v147
    v_mfma_f32_16x16x32_bf16 v[84:87], v[252:255], a[136:139], v[84:87]
    v_mul_f32 v144, v144, v176
    v_mul_f32 v145, v145, v177
    v_mfma_f32_16x16x32_bf16 v[88:91], v[252:255], a[140:143], v[88:91]
    s_add_u32 s31, s32, 4719872
    v_mul_f32 v146, v146, v178
    v_mfma_f32_16x16x32_bf16 v[88:91], v[248:251], a[124:127], v[88:91]
    buffer_load_dwordx4 v4, s[36:39], s31 offen offset:1024 lds
    v_mfma_f32_16x16x32_bf16 v[88:91], v[244:247], a[108:111], v[88:91]
    ds_read_b64_tr_b16 v[244:245], v9 offset:12288
    v_mul_f32 v147, v147, v179
    v_mfma_f32_16x16x32_bf16 v[104:107], v[220:223], a[108:111], v[104:107]
    ds_read_b64_tr_b16 v[246:247], v9 offset:18432
    v_cvt_pk_bf16_f32 v40, v144, v145
    v_mfma_f32_16x16x32_bf16 v[104:107], v[224:227], a[124:127], v[104:107]
    ds_read_b64_tr_b16 v[248:249], v9 offset:13312
    v_cvt_pk_bf16_f32 v41, v146, v147
    v_mfma_f32_16x16x32_bf16 v[104:107], v[228:231], a[140:143], v[104:107]
    ds_read_b64_tr_b16 v[250:251], v9 offset:19456
    v_max_f32 v160, 0, v160
    v_mfma_f32_16x16x32_bf16 v[100:103], v[228:231], a[136:139], v[100:103]
    ds_read_b64_tr_b16 v[252:253], v9 offset:14336
    v_max_f32 v161, 0, v161
    v_mfma_f32_16x16x32_bf16 v[100:103], v[224:227], a[120:123], v[100:103]
    s_add_u32 s31, s32, 5013760
    ds_read_b64_tr_b16 v[254:255], v9 offset:20480
    v_mfma_f32_16x16x32_bf16 v[100:103], v[220:223], a[104:107], v[100:103]
    buffer_load_dwordx4 v4, s[36:39], s31 offen offset:2048 lds
    v_mfma_f32_16x16x32_bf16 v[96:99], v[220:223], a[100:103], v[96:99]
    v_max_f32 v162, 0, v162
    v_max_f32 v163, 0, v163
    v_mfma_f32_16x16x32_bf16 v[96:99], v[224:227], a[116:119], v[96:99]
    v_mul_f32 v160, v160, v192
    v_mul_f32 v161, v161, v193
    v_mfma_f32_16x16x32_bf16 v[96:99], v[228:231], a[132:135], v[96:99]
    v_mul_f32 v162, v162, v194
    v_mul_f32 v163, v163, v195
    v_mfma_f32_16x16x32_bf16 v[92:95], v[228:231], a[128:131], v[92:95]
    v_cvt_pk_bf16_f32 v42, v160, v161
    v_cvt_pk_bf16_f32 v43, v162, v163
    v_mfma_f32_16x16x32_bf16 v[92:95], v[224:227], a[112:115], v[92:95]
    ds_write_b128 v14, v[40:43] offset:17408
    v_mfma_f32_16x16x32_bf16 v[92:95], v[220:223], a[96:99], v[92:95]
    s_add_u32 s45, s3, 16384
    buffer_store_dwordx4 v[40:43], v2, s[64:67], s45 offen offset:1024 sc1
    s_waitcnt lgkmcnt(0)
    v_mfma_f32_16x16x32_bf16 v[108:111], v[232:235], a[96:99], v[108:111]
    ds_read_b64_tr_b16 v[220:221], v8 offset:24576
    v_mfma_f32_16x16x32_bf16 v[108:111], v[236:239], a[112:115], v[108:111]
    ds_read_b64_tr_b16 v[222:223], v8 offset:30720
    v_mfma_f32_16x16x32_bf16 v[108:111], v[240:243], a[128:131], v[108:111]
    s_add_u32 m0, s30, 0
    s_add_u32 s31, s32, 4425984
    v_mfma_f32_16x16x32_bf16 v[112:115], v[240:243], a[132:135], v[112:115]
    buffer_load_dwordx4 v4, s[40:43], s31 offen offset:0 lds
    v_mfma_f32_16x16x32_bf16 v[112:115], v[236:239], a[116:119], v[112:115]
    ds_read_b64_tr_b16 v[224:225], v8 offset:25600
    s_add_u32 s45, s3, 0
    v_mfma_f32_16x16x32_bf16 v[112:115], v[232:235], a[100:103], v[112:115]
    ds_read_b64_tr_b16 v[226:227], v8 offset:31744
    v_mfma_f32_16x16x32_bf16 v[116:119], v[232:235], a[104:107], v[116:119]
    ds_read_b64_tr_b16 v[228:229], v8 offset:26624
    v_mfma_f32_16x16x32_bf16 v[116:119], v[236:239], a[120:123], v[116:119]
    ds_read_b64_tr_b16 v[230:231], v8 offset:32768
    v_mfma_f32_16x16x32_bf16 v[116:119], v[240:243], a[136:139], v[116:119]
    buffer_store_dwordx4 v[208:211], v2, s[64:67], s45 offen offset:1024 sc1
    v_mfma_f32_16x16x32_bf16 v[120:123], v[240:243], a[140:143], v[120:123]
    s_add_u32 s31, s32, 4719872
    v_mfma_f32_16x16x32_bf16 v[120:123], v[236:239], a[124:127], v[120:123]
    buffer_load_dwordx4 v4, s[40:43], s31 offen offset:1024 lds
    v_mfma_f32_16x16x32_bf16 v[120:123], v[232:235], a[108:111], v[120:123]
    ds_read_b64_tr_b16 v[232:233], v9 offset:24576
    v_mfma_f32_16x16x32_bf16 v[136:139], v[244:247], a[108:111], v[136:139]
    ds_read_b64_tr_b16 v[234:235], v9 offset:30720
    v_mfma_f32_16x16x32_bf16 v[136:139], v[248:251], a[124:127], v[136:139]
    ds_read_b64_tr_b16 v[236:237], v9 offset:25600
    v_mfma_f32_16x16x32_bf16 v[136:139], v[252:255], a[140:143], v[136:139]
    ds_read_b64_tr_b16 v[238:239], v9 offset:31744
    v_mfma_f32_16x16x32_bf16 v[132:135], v[252:255], a[136:139], v[132:135]
    ds_read_b64_tr_b16 v[240:241], v9 offset:26624
    v_mfma_f32_16x16x32_bf16 v[132:135], v[248:251], a[120:123], v[132:135]
    s_add_u32 s31, s32, 5013760
    ds_read_b64_tr_b16 v[242:243], v9 offset:32768
    v_mfma_f32_16x16x32_bf16 v[132:135], v[244:247], a[104:107], v[132:135]
    buffer_load_dwordx4 v4, s[40:43], s31 offen offset:2048 lds
    v_mfma_f32_16x16x32_bf16 v[128:131], v[244:247], a[100:103], v[128:131]
    v_mfma_f32_16x16x32_bf16 v[128:131], v[248:251], a[116:119], v[128:131]
    v_mfma_f32_16x16x32_bf16 v[128:131], v[252:255], a[132:135], v[128:131]
    v_mfma_f32_16x16x32_bf16 v[124:127], v[252:255], a[128:131], v[124:127]
    v_mfma_f32_16x16x32_bf16 v[124:127], v[248:251], a[112:115], v[124:127]
    v_mfma_f32_16x16x32_bf16 v[124:127], v[244:247], a[96:99], v[124:127]
    s_waitcnt vmcnt(11) lgkmcnt(0)
    s_barrier
    v_mfma_f32_16x16x32_bf16 v[76:79], v[220:223], a[144:147], v[76:79]
    ds_read_b64_tr_b16 v[244:245], v8 offset:36864
    v_mfma_f32_16x16x32_bf16 v[76:79], v[224:227], a[160:163], v[76:79]
    ds_read_b64_tr_b16 v[246:247], v8 offset:43008
    v_mfma_f32_16x16x32_bf16 v[76:79], v[228:231], a[176:179], v[76:79]
    s_add_u32 m0, s30, 12288
    s_add_u32 s31, s32, 2432
    v_mfma_f32_16x16x32_bf16 v[80:83], v[228:231], a[180:183], v[80:83]
    buffer_load_dwordx4 v4, s[36:39], s31 offen offset:0 lds
    v_mfma_f32_16x16x32_bf16 v[80:83], v[224:227], a[164:167], v[80:83]
    ds_read_b64_tr_b16 v[248:249], v8 offset:37888
    v_mfma_f32_16x16x32_bf16 v[80:83], v[220:223], a[148:151], v[80:83]
    ds_read_b64_tr_b16 v[250:251], v8 offset:44032
    v_mfma_f32_16x16x32_bf16 v[84:87], v[220:223], a[152:155], v[84:87]
    ds_read_b64_tr_b16 v[252:253], v8 offset:38912
    v_mfma_f32_16x16x32_bf16 v[84:87], v[224:227], a[168:171], v[84:87]
    ds_read_b64_tr_b16 v[254:255], v8 offset:45056
    v_mfma_f32_16x16x32_bf16 v[84:87], v[228:231], a[184:187], v[84:87]
    v_mfma_f32_16x16x32_bf16 v[88:91], v[228:231], a[188:191], v[88:91]
    s_add_u32 s31, s32, 296320
    v_mfma_f32_16x16x32_bf16 v[88:91], v[224:227], a[172:175], v[88:91]
    buffer_load_dwordx4 v4, s[36:39], s31 offen offset:1024 lds
    v_mfma_f32_16x16x32_bf16 v[88:91], v[220:223], a[156:159], v[88:91]
    ds_read_b64_tr_b16 v[220:221], v9 offset:36864
    v_mfma_f32_16x16x32_bf16 v[104:107], v[232:235], a[156:159], v[104:107]
    ds_read_b64_tr_b16 v[222:223], v9 offset:43008
    v_mfma_f32_16x16x32_bf16 v[104:107], v[236:239], a[172:175], v[104:107]
    ds_read_b64_tr_b16 v[224:225], v9 offset:37888
    v_mfma_f32_16x16x32_bf16 v[104:107], v[240:243], a[188:191], v[104:107]
    ds_read_b64_tr_b16 v[226:227], v9 offset:44032
    v_mfma_f32_16x16x32_bf16 v[100:103], v[240:243], a[184:187], v[100:103]
    ds_read_b64_tr_b16 v[228:229], v9 offset:38912
    v_mfma_f32_16x16x32_bf16 v[100:103], v[236:239], a[168:171], v[100:103]
    s_add_u32 s31, s32, 590208
    ds_read_b64_tr_b16 v[230:231], v9 offset:45056
    v_mfma_f32_16x16x32_bf16 v[100:103], v[232:235], a[152:155], v[100:103]
    buffer_load_dwordx4 v4, s[36:39], s31 offen offset:2048 lds
    v_mfma_f32_16x16x32_bf16 v[96:99], v[232:235], a[148:151], v[96:99]
    v_mfma_f32_16x16x32_bf16 v[96:99], v[236:239], a[164:167], v[96:99]
    v_mfma_f32_16x16x32_bf16 v[96:99], v[240:243], a[180:183], v[96:99]
    v_mfma_f32_16x16x32_bf16 v[92:95], v[240:243], a[176:179], v[92:95]
    v_mfma_f32_16x16x32_bf16 v[92:95], v[236:239], a[160:163], v[92:95]
    v_mfma_f32_16x16x32_bf16 v[92:95], v[232:235], a[144:147], v[92:95]
    s_waitcnt lgkmcnt(0)
    v_mfma_f32_16x16x32_bf16 v[108:111], v[244:247], a[144:147], v[108:111]
    ds_read_b64_tr_b16 v[232:233], v10 offset:0
    v_mfma_f32_16x16x32_bf16 v[108:111], v[248:251], a[160:163], v[108:111]
    ds_read_b64_tr_b16 v[234:235], v10 offset:6144
    v_mfma_f32_16x16x32_bf16 v[108:111], v[252:255], a[176:179], v[108:111]
    s_add_u32 m0, s30, 24576
    s_add_u32 s31, s32, 2432
    v_mfma_f32_16x16x32_bf16 v[112:115], v[252:255], a[180:183], v[112:115]
    buffer_load_dwordx4 v4, s[40:43], s31 offen offset:0 lds
    v_mfma_f32_16x16x32_bf16 v[112:115], v[248:251], a[164:167], v[112:115]
    ds_read_b64_tr_b16 v[236:237], v10 offset:1024
    v_max_f32 v148, 0, v148
    v_mfma_f32_16x16x32_bf16 v[112:115], v[244:247], a[148:151], v[112:115]
    ds_read_b64_tr_b16 v[238:239], v10 offset:7168
    v_max_f32 v149, 0, v149
    v_mfma_f32_16x16x32_bf16 v[116:119], v[244:247], a[152:155], v[116:119]
    ds_read_b64_tr_b16 v[240:241], v10 offset:2048
    v_max_f32 v150, 0, v150
    v_mfma_f32_16x16x32_bf16 v[116:119], v[248:251], a[168:171], v[116:119]
    ds_read_b64_tr_b16 v[242:243], v10 offset:8192
    v_max_f32 v151, 0, v151
    v_mfma_f32_16x16x32_bf16 v[116:119], v[252:255], a[184:187], v[116:119]
    v_mul_f32 v148, v148, v180
    v_mul_f32 v149, v149, v181
    v_mfma_f32_16x16x32_bf16 v[120:123], v[252:255], a[188:191], v[120:123]
    s_add_u32 s31, s32, 296320
    v_mul_f32 v150, v150, v182
    v_mfma_f32_16x16x32_bf16 v[120:123], v[248:251], a[172:175], v[120:123]
    buffer_load_dwordx4 v4, s[40:43], s31 offen offset:1024 lds
    v_mfma_f32_16x16x32_bf16 v[120:123], v[244:247], a[156:159], v[120:123]
    ds_read_b64_tr_b16 v[244:245], v11 offset:0
    v_mul_f32 v151, v151, v183
    v_mfma_f32_16x16x32_bf16 v[136:139], v[220:223], a[156:159], v[136:139]
    ds_read_b64_tr_b16 v[246:247], v11 offset:6144
    v_cvt_pk_bf16_f32 v36, v148, v149
    v_mfma_f32_16x16x32_bf16 v[136:139], v[224:227], a[172:175], v[136:139]
    ds_read_b64_tr_b16 v[248:249], v11 offset:1024
    v_cvt_pk_bf16_f32 v37, v150, v151
    v_mfma_f32_16x16x32_bf16 v[136:139], v[228:231], a[188:191], v[136:139]
    ds_read_b64_tr_b16 v[250:251], v11 offset:7168
    v_max_f32 v164, 0, v164
    v_mfma_f32_16x16x32_bf16 v[132:135], v[228:231], a[184:187], v[132:135]
    ds_read_b64_tr_b16 v[252:253], v11 offset:2048
    v_max_f32 v165, 0, v165
    v_mfma_f32_16x16x32_bf16 v[132:135], v[224:227], a[168:171], v[132:135]
    s_add_u32 s31, s32, 590208
    ds_read_b64_tr_b16 v[254:255], v11 offset:8192
    v_mfma_f32_16x16x32_bf16 v[132:135], v[220:223], a[152:155], v[132:135]
    buffer_load_dwordx4 v4, s[40:43], s31 offen offset:2048 lds
    v_mfma_f32_16x16x32_bf16 v[128:131], v[220:223], a[148:151], v[128:131]
    v_max_f32 v166, 0, v166
    v_max_f32 v167, 0, v167
    v_mfma_f32_16x16x32_bf16 v[128:131], v[224:227], a[164:167], v[128:131]
    v_mul_f32 v164, v164, v196
    v_mul_f32 v165, v165, v197
    v_mfma_f32_16x16x32_bf16 v[128:131], v[228:231], a[180:183], v[128:131]
    v_mul_f32 v166, v166, v198
    v_mul_f32 v167, v167, v199
    v_mfma_f32_16x16x32_bf16 v[124:127], v[228:231], a[176:179], v[124:127]
    v_cvt_pk_bf16_f32 v38, v164, v165
    v_cvt_pk_bf16_f32 v39, v166, v167
    v_mfma_f32_16x16x32_bf16 v[124:127], v[224:227], a[160:163], v[124:127]
    ds_write_b128 v14, v[36:39] offset:18432
    v_mfma_f32_16x16x32_bf16 v[124:127], v[220:223], a[144:147], v[124:127]
    s_add_u32 s45, s3, 16384
    buffer_store_dwordx4 v[36:39], v2, s[64:67], s45 offen offset:2048 sc1
    s_waitcnt vmcnt(12) lgkmcnt(0)
    s_barrier
    v_mfma_f32_16x16x32_bf16 v[76:79], v[232:235], a[192:195], v[76:79]
    ds_read_b64_tr_b16 v[220:221], v10 offset:12288
    v_mfma_f32_16x16x32_bf16 v[76:79], v[236:239], a[208:211], v[76:79]
    ds_read_b64_tr_b16 v[222:223], v10 offset:18432
    v_mfma_f32_16x16x32_bf16 v[76:79], v[240:243], a[224:227], v[76:79]
    s_add_u32 m0, s30, 36864
    s_add_u32 s31, s32, 887168
    v_mfma_f32_16x16x32_bf16 v[80:83], v[240:243], a[228:231], v[80:83]
    buffer_load_dwordx4 v4, s[36:39], s31 offen offset:0 lds
    v_mfma_f32_16x16x32_bf16 v[80:83], v[236:239], a[212:215], v[80:83]
    ds_read_b64_tr_b16 v[224:225], v10 offset:13312
    s_add_u32 s45, s3, 0
    v_mfma_f32_16x16x32_bf16 v[80:83], v[232:235], a[196:199], v[80:83]
    ds_read_b64_tr_b16 v[226:227], v10 offset:19456
    v_mfma_f32_16x16x32_bf16 v[84:87], v[232:235], a[200:203], v[84:87]
    ds_read_b64_tr_b16 v[228:229], v10 offset:14336
    v_mfma_f32_16x16x32_bf16 v[84:87], v[236:239], a[216:219], v[84:87]
    ds_read_b64_tr_b16 v[230:231], v10 offset:20480
    v_mfma_f32_16x16x32_bf16 v[84:87], v[240:243], a[232:235], v[84:87]
    buffer_store_dwordx4 v[212:215], v2, s[64:67], s45 offen offset:2048 sc1
    v_mfma_f32_16x16x32_bf16 v[88:91], v[240:243], a[236:239], v[88:91]
    s_add_u32 s31, s32, 1181056
    v_mfma_f32_16x16x32_bf16 v[88:91], v[236:239], a[220:223], v[88:91]
    buffer_load_dwordx4 v4, s[36:39], s31 offen offset:1024 lds
    v_mfma_f32_16x16x32_bf16 v[88:91], v[232:235], a[204:207], v[88:91]
    ds_read_b64_tr_b16 v[232:233], v11 offset:12288
    v_mfma_f32_16x16x32_bf16 v[104:107], v[244:247], a[204:207], v[104:107]
    ds_read_b64_tr_b16 v[234:235], v11 offset:18432
    v_mfma_f32_16x16x32_bf16 v[104:107], v[248:251], a[220:223], v[104:107]
    ds_read_b64_tr_b16 v[236:237], v11 offset:13312
    v_mfma_f32_16x16x32_bf16 v[104:107], v[252:255], a[236:239], v[104:107]
    ds_read_b64_tr_b16 v[238:239], v11 offset:19456
    v_mfma_f32_16x16x32_bf16 v[100:103], v[252:255], a[232:235], v[100:103]
    ds_read_b64_tr_b16 v[240:241], v11 offset:14336
    v_mfma_f32_16x16x32_bf16 v[100:103], v[248:251], a[216:219], v[100:103]
    s_add_u32 s31, s32, 1474944
    ds_read_b64_tr_b16 v[242:243], v11 offset:20480
    v_mfma_f32_16x16x32_bf16 v[100:103], v[244:247], a[200:203], v[100:103]
    buffer_load_dwordx4 v4, s[36:39], s31 offen offset:2048 lds
    v_mfma_f32_16x16x32_bf16 v[96:99], v[244:247], a[196:199], v[96:99]
    v_mfma_f32_16x16x32_bf16 v[96:99], v[248:251], a[212:215], v[96:99]
    v_mfma_f32_16x16x32_bf16 v[96:99], v[252:255], a[228:231], v[96:99]
    v_mfma_f32_16x16x32_bf16 v[92:95], v[252:255], a[224:227], v[92:95]
    v_mfma_f32_16x16x32_bf16 v[92:95], v[248:251], a[208:211], v[92:95]
    v_mfma_f32_16x16x32_bf16 v[92:95], v[244:247], a[192:195], v[92:95]
    s_waitcnt lgkmcnt(0)
    v_mfma_f32_16x16x32_bf16 v[108:111], v[220:223], a[192:195], v[108:111]
    ds_read_b64_tr_b16 v[244:245], v10 offset:24576
    v_mfma_f32_16x16x32_bf16 v[108:111], v[224:227], a[208:211], v[108:111]
    ds_read_b64_tr_b16 v[246:247], v10 offset:30720
    v_mfma_f32_16x16x32_bf16 v[108:111], v[228:231], a[224:227], v[108:111]
    s_add_u32 m0, s30, 49152
    s_add_u32 s31, s32, 887168
    v_mfma_f32_16x16x32_bf16 v[112:115], v[228:231], a[228:231], v[112:115]
    buffer_load_dwordx4 v4, s[40:43], s31 offen offset:0 lds
    v_mfma_f32_16x16x32_bf16 v[112:115], v[224:227], a[212:215], v[112:115]
    ds_read_b64_tr_b16 v[248:249], v10 offset:25600
    v_mfma_f32_16x16x32_bf16 v[112:115], v[220:223], a[196:199], v[112:115]
    ds_read_b64_tr_b16 v[250:251], v10 offset:31744
    v_mfma_f32_16x16x32_bf16 v[116:119], v[220:223], a[200:203], v[116:119]
    ds_read_b64_tr_b16 v[252:253], v10 offset:26624
    v_mfma_f32_16x16x32_bf16 v[116:119], v[224:227], a[216:219], v[116:119]
    ds_read_b64_tr_b16 v[254:255], v10 offset:32768
    v_mfma_f32_16x16x32_bf16 v[116:119], v[228:231], a[232:235], v[116:119]
    v_mfma_f32_16x16x32_bf16 v[120:123], v[228:231], a[236:239], v[120:123]
    s_add_u32 s31, s32, 1181056
    v_mfma_f32_16x16x32_bf16 v[120:123], v[224:227], a[220:223], v[120:123]
    buffer_load_dwordx4 v4, s[40:43], s31 offen offset:1024 lds
    v_mfma_f32_16x16x32_bf16 v[120:123], v[220:223], a[204:207], v[120:123]
    ds_read_b64_tr_b16 v[220:221], v11 offset:24576
    v_mfma_f32_16x16x32_bf16 v[136:139], v[232:235], a[204:207], v[136:139]
    ds_read_b64_tr_b16 v[222:223], v11 offset:30720
    v_mfma_f32_16x16x32_bf16 v[136:139], v[236:239], a[220:223], v[136:139]
    ds_read_b64_tr_b16 v[224:225], v11 offset:25600
    v_mfma_f32_16x16x32_bf16 v[136:139], v[240:243], a[236:239], v[136:139]
    ds_read_b64_tr_b16 v[226:227], v11 offset:31744
    v_mfma_f32_16x16x32_bf16 v[132:135], v[240:243], a[232:235], v[132:135]
    ds_read_b64_tr_b16 v[228:229], v11 offset:26624
    v_mfma_f32_16x16x32_bf16 v[132:135], v[236:239], a[216:219], v[132:135]
    s_add_u32 s31, s32, 1474944
    ds_read_b64_tr_b16 v[230:231], v11 offset:32768
    v_mfma_f32_16x16x32_bf16 v[132:135], v[232:235], a[200:203], v[132:135]
    buffer_load_dwordx4 v4, s[40:43], s31 offen offset:2048 lds
    v_mfma_f32_16x16x32_bf16 v[128:131], v[232:235], a[196:199], v[128:131]
    v_mfma_f32_16x16x32_bf16 v[128:131], v[236:239], a[212:215], v[128:131]
    v_mfma_f32_16x16x32_bf16 v[128:131], v[240:243], a[228:231], v[128:131]
    v_mfma_f32_16x16x32_bf16 v[124:127], v[240:243], a[224:227], v[124:127]
    v_mfma_f32_16x16x32_bf16 v[124:127], v[236:239], a[208:211], v[124:127]
    v_mfma_f32_16x16x32_bf16 v[124:127], v[232:235], a[192:195], v[124:127]
    s_waitcnt vmcnt(11) lgkmcnt(0)
    s_barrier
    v_mfma_f32_16x16x32_bf16 v[76:79], v[244:247], a[240:243], v[76:79]
    ds_read_b64_tr_b16 v[232:233], v8 offset:0
    v_mfma_f32_16x16x32_bf16 v[76:79], v[248:251], v[44:47], v[76:79]
    ds_read_b64_tr_b16 v[234:235], v8 offset:6144
    v_mfma_f32_16x16x32_bf16 v[76:79], v[252:255], v[60:63], v[76:79]
    s_add_u32 m0, s30, 61440
    s_add_u32 s31, s32, 1771904
    v_mfma_f32_16x16x32_bf16 v[80:83], v[252:255], v[64:67], v[80:83]
    buffer_load_dwordx4 v4, s[36:39], s31 offen offset:0 lds
    v_mfma_f32_16x16x32_bf16 v[80:83], v[248:251], v[48:51], v[80:83]
    ds_read_b64_tr_b16 v[236:237], v8 offset:1024
    v_max_f32 v152, 0, v152
    v_mfma_f32_16x16x32_bf16 v[80:83], v[244:247], a[244:247], v[80:83]
    ds_read_b64_tr_b16 v[238:239], v8 offset:7168
    v_max_f32 v153, 0, v153
    v_mfma_f32_16x16x32_bf16 v[84:87], v[244:247], a[248:251], v[84:87]
    ds_read_b64_tr_b16 v[240:241], v8 offset:2048
    v_max_f32 v154, 0, v154
    v_mfma_f32_16x16x32_bf16 v[84:87], v[248:251], v[52:55], v[84:87]
    ds_read_b64_tr_b16 v[242:243], v8 offset:8192
    v_max_f32 v155, 0, v155
    v_mfma_f32_16x16x32_bf16 v[84:87], v[252:255], v[68:71], v[84:87]
    v_mul_f32 v152, v152, v184
    v_mul_f32 v153, v153, v185
    v_mfma_f32_16x16x32_bf16 v[88:91], v[252:255], v[72:75], v[88:91]
    s_add_u32 s31, s32, 2065792
    v_mul_f32 v154, v154, v186
    v_mfma_f32_16x16x32_bf16 v[88:91], v[248:251], v[56:59], v[88:91]
    buffer_load_dwordx4 v4, s[36:39], s31 offen offset:1024 lds
    v_mfma_f32_16x16x32_bf16 v[88:91], v[244:247], a[252:255], v[88:91]
    ds_read_b64_tr_b16 v[244:245], v9 offset:0
    v_mul_f32 v155, v155, v187
    v_mfma_f32_16x16x32_bf16 v[104:107], v[220:223], a[252:255], v[104:107]
    ds_read_b64_tr_b16 v[246:247], v9 offset:6144
    v_cvt_pk_bf16_f32 v40, v152, v153
    v_mfma_f32_16x16x32_bf16 v[104:107], v[224:227], v[56:59], v[104:107]
    ds_read_b64_tr_b16 v[248:249], v9 offset:1024
    v_cvt_pk_bf16_f32 v41, v154, v155
    v_mfma_f32_16x16x32_bf16 v[104:107], v[228:231], v[72:75], v[104:107]
    ds_read_b64_tr_b16 v[250:251], v9 offset:7168
    v_max_f32 v168, 0, v168
    v_mfma_f32_16x16x32_bf16 v[100:103], v[228:231], v[68:71], v[100:103]
    ds_read_b64_tr_b16 v[252:253], v9 offset:2048
    v_max_f32 v169, 0, v169
    v_mfma_f32_16x16x32_bf16 v[100:103], v[224:227], v[52:55], v[100:103]
    s_add_u32 s31, s32, 2359680
    ds_read_b64_tr_b16 v[254:255], v9 offset:8192
    v_mfma_f32_16x16x32_bf16 v[100:103], v[220:223], a[248:251], v[100:103]
    buffer_load_dwordx4 v4, s[36:39], s31 offen offset:2048 lds
    v_mfma_f32_16x16x32_bf16 v[96:99], v[220:223], a[244:247], v[96:99]
    v_max_f32 v170, 0, v170
    v_max_f32 v171, 0, v171
    v_mfma_f32_16x16x32_bf16 v[96:99], v[224:227], v[48:51], v[96:99]
    v_mul_f32 v168, v168, v200
    v_mul_f32 v169, v169, v201
    v_mfma_f32_16x16x32_bf16 v[96:99], v[228:231], v[64:67], v[96:99]
    v_mul_f32 v170, v170, v202
    v_mul_f32 v171, v171, v203
    v_mfma_f32_16x16x32_bf16 v[92:95], v[228:231], v[60:63], v[92:95]
    v_cvt_pk_bf16_f32 v42, v168, v169
    v_cvt_pk_bf16_f32 v43, v170, v171
    v_mfma_f32_16x16x32_bf16 v[92:95], v[224:227], v[44:47], v[92:95]
    ds_write_b128 v14, v[40:43] offset:19456
    v_mfma_f32_16x16x32_bf16 v[92:95], v[220:223], a[240:243], v[92:95]
    s_add_u32 s45, s3, 16384
    buffer_store_dwordx4 v[40:43], v2, s[64:67], s45 offen offset:3072 sc1
    s_add_u32 s45, s3, 0
    buffer_store_dwordx4 v[216:219], v2, s[64:67], s45 offen offset:3072 sc1
    s_waitcnt lgkmcnt(0)
    v_mfma_f32_16x16x32_bf16 v[108:111], v[232:235], a[240:243], v[108:111]
    ds_read_b64_tr_b16 v[220:221], v8 offset:12288
    v_mfma_f32_16x16x32_bf16 v[108:111], v[236:239], v[44:47], v[108:111]
    ds_read_b64_tr_b16 v[222:223], v8 offset:18432
    v_mfma_f32_16x16x32_bf16 v[108:111], v[240:243], v[60:63], v[108:111]
    s_add_u32 m0, s30, 73728
    s_add_u32 s31, s32, 1771904
    v_mfma_f32_16x16x32_bf16 v[112:115], v[240:243], v[64:67], v[112:115]
    buffer_load_dwordx4 v4, s[40:43], s31 offen offset:0 lds
    v_mfma_f32_16x16x32_bf16 v[112:115], v[236:239], v[48:51], v[112:115]
    ds_read_b64_tr_b16 v[224:225], v8 offset:13312
    v_mfma_f32_16x16x32_bf16 v[112:115], v[232:235], a[244:247], v[112:115]
    ds_read_b64_tr_b16 v[226:227], v8 offset:19456
    v_mfma_f32_16x16x32_bf16 v[116:119], v[232:235], a[248:251], v[116:119]
    ds_read_b64_tr_b16 v[228:229], v8 offset:14336
    v_mfma_f32_16x16x32_bf16 v[116:119], v[236:239], v[52:55], v[116:119]
    ds_read_b64_tr_b16 v[230:231], v8 offset:20480
    v_mfma_f32_16x16x32_bf16 v[116:119], v[240:243], v[68:71], v[116:119]
    v_mfma_f32_16x16x32_bf16 v[120:123], v[240:243], v[72:75], v[120:123]
    s_add_u32 s31, s32, 2065792
    v_mfma_f32_16x16x32_bf16 v[120:123], v[236:239], v[56:59], v[120:123]
    buffer_load_dwordx4 v4, s[40:43], s31 offen offset:1024 lds
    v_mfma_f32_16x16x32_bf16 v[120:123], v[232:235], a[252:255], v[120:123]
    ds_read_b64_tr_b16 v[232:233], v9 offset:12288
    v_mfma_f32_16x16x32_bf16 v[136:139], v[244:247], a[252:255], v[136:139]
    ds_read_b64_tr_b16 v[234:235], v9 offset:18432
    v_mfma_f32_16x16x32_bf16 v[136:139], v[248:251], v[56:59], v[136:139]
    ds_read_b64_tr_b16 v[236:237], v9 offset:13312
    v_mfma_f32_16x16x32_bf16 v[136:139], v[252:255], v[72:75], v[136:139]
    ds_read_b64_tr_b16 v[238:239], v9 offset:19456
    v_mfma_f32_16x16x32_bf16 v[132:135], v[252:255], v[68:71], v[132:135]
    ds_read_b64_tr_b16 v[240:241], v9 offset:14336
    v_mfma_f32_16x16x32_bf16 v[132:135], v[248:251], v[52:55], v[132:135]
    s_add_u32 s31, s32, 2359680
    ds_read_b64_tr_b16 v[242:243], v9 offset:20480
    v_mfma_f32_16x16x32_bf16 v[132:135], v[244:247], a[248:251], v[132:135]
    buffer_load_dwordx4 v4, s[40:43], s31 offen offset:2048 lds
    v_mfma_f32_16x16x32_bf16 v[128:131], v[244:247], a[244:247], v[128:131]
    v_mfma_f32_16x16x32_bf16 v[128:131], v[248:251], v[48:51], v[128:131]
    v_mfma_f32_16x16x32_bf16 v[128:131], v[252:255], v[64:67], v[128:131]
    v_mfma_f32_16x16x32_bf16 v[124:127], v[252:255], v[60:63], v[124:127]
    v_mfma_f32_16x16x32_bf16 v[124:127], v[248:251], v[44:47], v[124:127]
    v_mfma_f32_16x16x32_bf16 v[124:127], v[244:247], a[240:243], v[124:127]
    s_waitcnt vmcnt(11) lgkmcnt(0)
    s_barrier
    v_mfma_f32_16x16x32_bf16 v[140:143], v[220:223], a[0:3], 0
    ds_read_b64_tr_b16 v[244:245], v8 offset:24576
    v_mfma_f32_16x16x32_bf16 v[140:143], v[224:227], a[16:19], v[140:143]
    ds_read_b64_tr_b16 v[246:247], v8 offset:30720
    v_mfma_f32_16x16x32_bf16 v[140:143], v[228:231], a[32:35], v[140:143]
    s_add_u32 m0, s30, 0
    s_add_u32 s31, s32, 2656640
    v_mfma_f32_16x16x32_bf16 v[144:147], v[228:231], a[36:39], 0
    buffer_load_dwordx4 v4, s[36:39], s31 offen offset:0 lds
    v_mfma_f32_16x16x32_bf16 v[144:147], v[224:227], a[20:23], v[144:147]
    ds_read_b64_tr_b16 v[248:249], v8 offset:25600
    v_max_f32 v76, 0, v76
    v_mfma_f32_16x16x32_bf16 v[144:147], v[220:223], a[4:7], v[144:147]
    ds_read_b64_tr_b16 v[250:251], v8 offset:31744
    v_max_f32 v77, 0, v77
    v_mfma_f32_16x16x32_bf16 v[148:151], v[220:223], a[8:11], 0
    ds_read_b64_tr_b16 v[252:253], v8 offset:26624
    v_max_f32 v78, 0, v78
    v_mfma_f32_16x16x32_bf16 v[148:151], v[224:227], a[24:27], v[148:151]
    ds_read_b64_tr_b16 v[254:255], v8 offset:32768
    v_max_f32 v79, 0, v79
    v_mfma_f32_16x16x32_bf16 v[148:151], v[228:231], a[40:43], v[148:151]
    v_mul_f32 v76, v76, v108
    v_mul_f32 v77, v77, v109
    v_mfma_f32_16x16x32_bf16 v[152:155], v[228:231], a[44:47], 0
    s_add_u32 s31, s32, 2950528
    v_mul_f32 v78, v78, v110
    v_mfma_f32_16x16x32_bf16 v[152:155], v[224:227], a[28:31], v[152:155]
    buffer_load_dwordx4 v4, s[36:39], s31 offen offset:1024 lds
    v_mfma_f32_16x16x32_bf16 v[152:155], v[220:223], a[12:15], v[152:155]
    ds_read_b64_tr_b16 v[220:221], v9 offset:24576
    v_mul_f32 v79, v79, v111
    v_mfma_f32_16x16x32_bf16 v[168:171], v[232:235], a[12:15], 0
    ds_read_b64_tr_b16 v[222:223], v9 offset:30720
    v_cvt_pk_bf16_f32 v36, v76, v77
    v_mfma_f32_16x16x32_bf16 v[168:171], v[236:239], a[28:31], v[168:171]
    ds_read_b64_tr_b16 v[224:225], v9 offset:25600
    v_cvt_pk_bf16_f32 v37, v78, v79
    v_mfma_f32_16x16x32_bf16 v[168:171], v[240:243], a[44:47], v[168:171]
    ds_read_b64_tr_b16 v[226:227], v9 offset:31744
    v_max_f32 v92, 0, v92
    v_mfma_f32_16x16x32_bf16 v[164:167], v[240:243], a[40:43], 0
    ds_read_b64_tr_b16 v[228:229], v9 offset:26624
    v_max_f32 v93, 0, v93
    v_mfma_f32_16x16x32_bf16 v[164:167], v[236:239], a[24:27], v[164:167]
    s_add_u32 s31, s32, 3244416
    ds_read_b64_tr_b16 v[230:231], v9 offset:32768
    v_mfma_f32_16x16x32_bf16 v[164:167], v[232:235], a[8:11], v[164:167]
    buffer_load_dwordx4 v4, s[36:39], s31 offen offset:2048 lds
    v_mfma_f32_16x16x32_bf16 v[160:163], v[232:235], a[4:7], 0
    v_max_f32 v94, 0, v94
    v_max_f32 v95, 0, v95
    v_mfma_f32_16x16x32_bf16 v[160:163], v[236:239], a[20:23], v[160:163]
    v_mul_f32 v92, v92, v124
    v_mul_f32 v93, v93, v125
    v_mfma_f32_16x16x32_bf16 v[160:163], v[240:243], a[36:39], v[160:163]
    v_mul_f32 v94, v94, v126
    v_mul_f32 v95, v95, v127
    v_mfma_f32_16x16x32_bf16 v[156:159], v[240:243], a[32:35], 0
    v_cvt_pk_bf16_f32 v38, v92, v93
    v_cvt_pk_bf16_f32 v39, v94, v95
k4_kernel_pg1_3:
    s_cbranch_execz k4_kernel_pg1_7
    v_mfma_f32_16x16x32_bf16 v[156:159], v[236:239], a[16:19], v[156:159]
    ds_write_b128 v14, v[36:39] offset:32768
    v_mfma_f32_16x16x32_bf16 v[156:159], v[232:235], a[0:3], v[156:159]
    s_add_u32 s45, s3, 32768
    buffer_store_dwordx4 v[36:39], v2, s[64:67], s45 offen offset:0 sc1
    s_waitcnt lgkmcnt(0)
    v_mfma_f32_16x16x32_bf16 v[172:175], v[244:247], a[0:3], 0
    ds_read_b64_tr_b16 v[232:233], v8 offset:36864
    v_mfma_f32_16x16x32_bf16 v[172:175], v[248:251], a[16:19], v[172:175]
    ds_read_b64_tr_b16 v[234:235], v8 offset:43008
    v_mfma_f32_16x16x32_bf16 v[172:175], v[252:255], a[32:35], v[172:175]
    s_add_u32 m0, s30, 12288
    s_add_u32 s31, s32, 2656640
    v_mfma_f32_16x16x32_bf16 v[176:179], v[252:255], a[36:39], 0
    buffer_load_dwordx4 v4, s[40:43], s31 offen offset:0 lds
    v_mfma_f32_16x16x32_bf16 v[176:179], v[248:251], a[20:23], v[176:179]
    ds_read_b64_tr_b16 v[236:237], v8 offset:37888
    v_max_f32 v80, 0, v80
    v_mfma_f32_16x16x32_bf16 v[176:179], v[244:247], a[4:7], v[176:179]
    ds_read_b64_tr_b16 v[238:239], v8 offset:44032
    v_max_f32 v81, 0, v81
    v_mfma_f32_16x16x32_bf16 v[180:183], v[244:247], a[8:11], 0
    ds_read_b64_tr_b16 v[240:241], v8 offset:38912
    v_max_f32 v82, 0, v82
    v_mfma_f32_16x16x32_bf16 v[180:183], v[248:251], a[24:27], v[180:183]
    ds_read_b64_tr_b16 v[242:243], v8 offset:45056
    v_max_f32 v83, 0, v83
    v_mfma_f32_16x16x32_bf16 v[180:183], v[252:255], a[40:43], v[180:183]
    v_mul_f32 v80, v80, v112
    v_mul_f32 v81, v81, v113
    v_mfma_f32_16x16x32_bf16 v[184:187], v[252:255], a[44:47], 0
    s_add_u32 s31, s32, 2950528
    v_mul_f32 v82, v82, v114
    v_mfma_f32_16x16x32_bf16 v[184:187], v[248:251], a[28:31], v[184:187]
    buffer_load_dwordx4 v4, s[40:43], s31 offen offset:1024 lds
    v_mfma_f32_16x16x32_bf16 v[184:187], v[244:247], a[12:15], v[184:187]
    ds_read_b64_tr_b16 v[244:245], v9 offset:36864
    v_mul_f32 v83, v83, v115
    v_mfma_f32_16x16x32_bf16 v[200:203], v[220:223], a[12:15], 0
    ds_read_b64_tr_b16 v[246:247], v9 offset:43008
    v_cvt_pk_bf16_f32 v40, v80, v81
    v_mfma_f32_16x16x32_bf16 v[200:203], v[224:227], a[28:31], v[200:203]
    ds_read_b64_tr_b16 v[248:249], v9 offset:37888
    v_cvt_pk_bf16_f32 v41, v82, v83
    v_mfma_f32_16x16x32_bf16 v[200:203], v[228:231], a[44:47], v[200:203]
    ds_read_b64_tr_b16 v[250:251], v9 offset:44032
    v_max_f32 v96, 0, v96
    v_mfma_f32_16x16x32_bf16 v[196:199], v[228:231], a[40:43], 0
    ds_read_b64_tr_b16 v[252:253], v9 offset:38912
    v_max_f32 v97, 0, v97
    v_mfma_f32_16x16x32_bf16 v[196:199], v[224:227], a[24:27], v[196:199]
    s_add_u32 s31, s32, 3244416
    ds_read_b64_tr_b16 v[254:255], v9 offset:45056
    v_mfma_f32_16x16x32_bf16 v[196:199], v[220:223], a[8:11], v[196:199]
    buffer_load_dwordx4 v4, s[40:43], s31 offen offset:2048 lds
    v_mfma_f32_16x16x32_bf16 v[192:195], v[220:223], a[4:7], 0
    v_max_f32 v98, 0, v98
    v_max_f32 v99, 0, v99
    v_mfma_f32_16x16x32_bf16 v[192:195], v[224:227], a[20:23], v[192:195]
    v_mul_f32 v96, v96, v128
    v_mul_f32 v97, v97, v129
    v_mfma_f32_16x16x32_bf16 v[192:195], v[228:231], a[36:39], v[192:195]
    v_mul_f32 v98, v98, v130
    v_mul_f32 v99, v99, v131
    v_mfma_f32_16x16x32_bf16 v[188:191], v[228:231], a[32:35], 0
    v_cvt_pk_bf16_f32 v42, v96, v97
    v_cvt_pk_bf16_f32 v43, v98, v99
    v_mfma_f32_16x16x32_bf16 v[188:191], v[224:227], a[16:19], v[188:191]
    ds_write_b128 v14, v[40:43] offset:33792
    v_mfma_f32_16x16x32_bf16 v[188:191], v[220:223], a[0:3], v[188:191]
    s_add_u32 s45, s3, 32768
    buffer_store_dwordx4 v[40:43], v2, s[64:67], s45 offen offset:1024 sc1
    s_waitcnt vmcnt(13) lgkmcnt(0)
    s_barrier
    v_mfma_f32_16x16x32_bf16 v[140:143], v[232:235], a[48:51], v[140:143]
    ds_read_b64_tr_b16 v[220:221], v10 offset:0
    v_mfma_f32_16x16x32_bf16 v[140:143], v[236:239], a[64:67], v[140:143]
    ds_read_b64_tr_b16 v[222:223], v10 offset:6144
    v_mfma_f32_16x16x32_bf16 v[140:143], v[240:243], a[80:83], v[140:143]
    s_add_u32 m0, s30, 24576
    s_add_u32 s31, s32, 3541376
    v_mfma_f32_16x16x32_bf16 v[144:147], v[240:243], a[84:87], v[144:147]
    buffer_load_dwordx4 v4, s[36:39], s31 offen offset:0 lds
    v_mfma_f32_16x16x32_bf16 v[144:147], v[236:239], a[68:71], v[144:147]
    ds_read_b64_tr_b16 v[224:225], v10 offset:1024
    v_max_f32 v84, 0, v84
    v_mfma_f32_16x16x32_bf16 v[144:147], v[232:235], a[52:55], v[144:147]
    ds_read_b64_tr_b16 v[226:227], v10 offset:7168
    v_max_f32 v85, 0, v85
    v_mfma_f32_16x16x32_bf16 v[148:151], v[232:235], a[56:59], v[148:151]
    ds_read_b64_tr_b16 v[228:229], v10 offset:2048
    v_max_f32 v86, 0, v86
    v_mfma_f32_16x16x32_bf16 v[148:151], v[236:239], a[72:75], v[148:151]
    ds_read_b64_tr_b16 v[230:231], v10 offset:8192
    v_max_f32 v87, 0, v87
    v_mfma_f32_16x16x32_bf16 v[148:151], v[240:243], a[88:91], v[148:151]
    v_mul_f32 v84, v84, v116
    v_mul_f32 v85, v85, v117
    v_mfma_f32_16x16x32_bf16 v[152:155], v[240:243], a[92:95], v[152:155]
    s_add_u32 s31, s32, 3835264
    v_mul_f32 v86, v86, v118
    v_mfma_f32_16x16x32_bf16 v[152:155], v[236:239], a[76:79], v[152:155]
    buffer_load_dwordx4 v4, s[36:39], s31 offen offset:1024 lds
    v_mfma_f32_16x16x32_bf16 v[152:155], v[232:235], a[60:63], v[152:155]
    ds_read_b64_tr_b16 v[232:233], v11 offset:0
    v_mul_f32 v87, v87, v119
    v_mfma_f32_16x16x32_bf16 v[168:171], v[244:247], a[60:63], v[168:171]
    ds_read_b64_tr_b16 v[234:235], v11 offset:6144
    v_cvt_pk_bf16_f32 v36, v84, v85
    v_mfma_f32_16x16x32_bf16 v[168:171], v[248:251], a[76:79], v[168:171]
    ds_read_b64_tr_b16 v[236:237], v11 offset:1024
    v_cvt_pk_bf16_f32 v37, v86, v87
    v_mfma_f32_16x16x32_bf16 v[168:171], v[252:255], a[92:95], v[168:171]
    ds_read_b64_tr_b16 v[238:239], v11 offset:7168
    v_max_f32 v100, 0, v100
    v_mfma_f32_16x16x32_bf16 v[164:167], v[252:255], a[88:91], v[164:167]
    ds_read_b64_tr_b16 v[240:241], v11 offset:2048
    v_max_f32 v101, 0, v101
    v_mfma_f32_16x16x32_bf16 v[164:167], v[248:251], a[72:75], v[164:167]
    s_add_u32 s31, s32, 4129152
    ds_read_b64_tr_b16 v[242:243], v11 offset:8192
    v_mfma_f32_16x16x32_bf16 v[164:167], v[244:247], a[56:59], v[164:167]
    buffer_load_dwordx4 v4, s[36:39], s31 offen offset:2048 lds
    v_mfma_f32_16x16x32_bf16 v[160:163], v[244:247], a[52:55], v[160:163]
    v_max_f32 v102, 0, v102
    v_max_f32 v103, 0, v103
    v_mfma_f32_16x16x32_bf16 v[160:163], v[248:251], a[68:71], v[160:163]
    v_mul_f32 v100, v100, v132
    v_mul_f32 v101, v101, v133
    v_mfma_f32_16x16x32_bf16 v[160:163], v[252:255], a[84:87], v[160:163]
    v_mul_f32 v102, v102, v134
    v_mul_f32 v103, v103, v135
    v_mfma_f32_16x16x32_bf16 v[156:159], v[252:255], a[80:83], v[156:159]
    v_cvt_pk_bf16_f32 v38, v100, v101
    v_cvt_pk_bf16_f32 v39, v102, v103
    v_mfma_f32_16x16x32_bf16 v[156:159], v[248:251], a[64:67], v[156:159]
    ds_write_b128 v14, v[36:39] offset:34816
    v_mfma_f32_16x16x32_bf16 v[156:159], v[244:247], a[48:51], v[156:159]
    s_add_u32 s45, s3, 32768
    buffer_store_dwordx4 v[36:39], v2, s[64:67], s45 offen offset:2048 sc1
    s_waitcnt lgkmcnt(0)
    v_mfma_f32_16x16x32_bf16 v[172:175], v[220:223], a[48:51], v[172:175]
    ds_read_b64_tr_b16 v[244:245], v10 offset:12288
    v_mfma_f32_16x16x32_bf16 v[172:175], v[224:227], a[64:67], v[172:175]
    ds_read_b64_tr_b16 v[246:247], v10 offset:18432
    v_mfma_f32_16x16x32_bf16 v[172:175], v[228:231], a[80:83], v[172:175]
    s_add_u32 m0, s30, 36864
    s_add_u32 s31, s32, 3541376
    v_mfma_f32_16x16x32_bf16 v[176:179], v[228:231], a[84:87], v[176:179]
    buffer_load_dwordx4 v4, s[40:43], s31 offen offset:0 lds
    v_mfma_f32_16x16x32_bf16 v[176:179], v[224:227], a[68:71], v[176:179]
    ds_read_b64_tr_b16 v[248:249], v10 offset:13312
    v_max_f32 v88, 0, v88
    v_mfma_f32_16x16x32_bf16 v[176:179], v[220:223], a[52:55], v[176:179]
    ds_read_b64_tr_b16 v[250:251], v10 offset:19456
    v_max_f32 v89, 0, v89
    v_mfma_f32_16x16x32_bf16 v[180:183], v[220:223], a[56:59], v[180:183]
    ds_read_b64_tr_b16 v[252:253], v10 offset:14336
    v_max_f32 v90, 0, v90
    v_mfma_f32_16x16x32_bf16 v[180:183], v[224:227], a[72:75], v[180:183]
    ds_read_b64_tr_b16 v[254:255], v10 offset:20480
    v_max_f32 v91, 0, v91
    v_mfma_f32_16x16x32_bf16 v[180:183], v[228:231], a[88:91], v[180:183]
    v_mul_f32 v88, v88, v120
    v_mul_f32 v89, v89, v121
    v_mfma_f32_16x16x32_bf16 v[184:187], v[228:231], a[92:95], v[184:187]
    s_add_u32 s31, s32, 3835264
    v_mul_f32 v90, v90, v122
    v_mfma_f32_16x16x32_bf16 v[184:187], v[224:227], a[76:79], v[184:187]
    buffer_load_dwordx4 v4, s[40:43], s31 offen offset:1024 lds
    v_mfma_f32_16x16x32_bf16 v[184:187], v[220:223], a[60:63], v[184:187]
    ds_read_b64_tr_b16 v[220:221], v11 offset:12288
    v_mul_f32 v91, v91, v123
    v_mfma_f32_16x16x32_bf16 v[200:203], v[232:235], a[60:63], v[200:203]
    ds_read_b64_tr_b16 v[222:223], v11 offset:18432
    v_cvt_pk_bf16_f32 v40, v88, v89
    v_mfma_f32_16x16x32_bf16 v[200:203], v[236:239], a[76:79], v[200:203]
    ds_read_b64_tr_b16 v[224:225], v11 offset:13312
    v_cvt_pk_bf16_f32 v41, v90, v91
    v_mfma_f32_16x16x32_bf16 v[200:203], v[240:243], a[92:95], v[200:203]
    ds_read_b64_tr_b16 v[226:227], v11 offset:19456
    v_max_f32 v104, 0, v104
    v_mfma_f32_16x16x32_bf16 v[196:199], v[240:243], a[88:91], v[196:199]
    ds_read_b64_tr_b16 v[228:229], v11 offset:14336
    v_max_f32 v105, 0, v105
    v_mfma_f32_16x16x32_bf16 v[196:199], v[236:239], a[72:75], v[196:199]
    s_add_u32 s31, s32, 4129152
    ds_read_b64_tr_b16 v[230:231], v11 offset:20480
    v_mfma_f32_16x16x32_bf16 v[196:199], v[232:235], a[56:59], v[196:199]
    buffer_load_dwordx4 v4, s[40:43], s31 offen offset:2048 lds
    v_mfma_f32_16x16x32_bf16 v[192:195], v[232:235], a[52:55], v[192:195]
    v_max_f32 v106, 0, v106
    v_max_f32 v107, 0, v107
    v_mfma_f32_16x16x32_bf16 v[192:195], v[236:239], a[68:71], v[192:195]
    v_mul_f32 v104, v104, v136
    v_mul_f32 v105, v105, v137
    v_mfma_f32_16x16x32_bf16 v[192:195], v[240:243], a[84:87], v[192:195]
    v_mul_f32 v106, v106, v138
    v_mul_f32 v107, v107, v139
    v_mfma_f32_16x16x32_bf16 v[188:191], v[240:243], a[80:83], v[188:191]
    v_cvt_pk_bf16_f32 v42, v104, v105
    v_cvt_pk_bf16_f32 v43, v106, v107
    v_mfma_f32_16x16x32_bf16 v[188:191], v[236:239], a[64:67], v[188:191]
    ds_write_b128 v14, v[40:43] offset:35840
    v_mfma_f32_16x16x32_bf16 v[188:191], v[232:235], a[48:51], v[188:191]
    s_add_u32 s45, s3, 32768
    buffer_store_dwordx4 v[40:43], v2, s[64:67], s45 offen offset:3072 sc1
    s_waitcnt vmcnt(13) lgkmcnt(0)
    s_barrier
    v_mfma_f32_16x16x32_bf16 v[140:143], v[244:247], a[96:99], v[140:143]
    ds_read_b64_tr_b16 v[232:233], v10 offset:24576
    v_mfma_f32_16x16x32_bf16 v[140:143], v[248:251], a[112:115], v[140:143]
    ds_read_b64_tr_b16 v[234:235], v10 offset:30720
    v_mfma_f32_16x16x32_bf16 v[140:143], v[252:255], a[128:131], v[140:143]
    s_add_u32 m0, s30, 49152
    s_add_u32 s31, s32, 4426112
    v_mfma_f32_16x16x32_bf16 v[144:147], v[252:255], a[132:135], v[144:147]
    buffer_load_dwordx4 v4, s[36:39], s31 offen offset:0 lds
    v_mfma_f32_16x16x32_bf16 v[144:147], v[248:251], a[116:119], v[144:147]
    ds_read_b64_tr_b16 v[236:237], v10 offset:25600
    v_mfma_f32_16x16x32_bf16 v[144:147], v[244:247], a[100:103], v[144:147]
    ds_read_b64_tr_b16 v[238:239], v10 offset:31744
    v_mfma_f32_16x16x32_bf16 v[148:151], v[244:247], a[104:107], v[148:151]
    ds_read_b64_tr_b16 v[240:241], v10 offset:26624
    v_mfma_f32_16x16x32_bf16 v[148:151], v[248:251], a[120:123], v[148:151]
    ds_read_b64_tr_b16 v[242:243], v10 offset:32768
    v_mfma_f32_16x16x32_bf16 v[148:151], v[252:255], a[136:139], v[148:151]
    v_mfma_f32_16x16x32_bf16 v[152:155], v[252:255], a[140:143], v[152:155]
    s_add_u32 s31, s32, 4720000
    v_mfma_f32_16x16x32_bf16 v[152:155], v[248:251], a[124:127], v[152:155]
    buffer_load_dwordx4 v4, s[36:39], s31 offen offset:1024 lds
    v_mfma_f32_16x16x32_bf16 v[152:155], v[244:247], a[108:111], v[152:155]
    ds_read_b64_tr_b16 v[244:245], v11 offset:24576
    v_mfma_f32_16x16x32_bf16 v[168:171], v[220:223], a[108:111], v[168:171]
    ds_read_b64_tr_b16 v[246:247], v11 offset:30720
    v_mfma_f32_16x16x32_bf16 v[168:171], v[224:227], a[124:127], v[168:171]
    ds_read_b64_tr_b16 v[248:249], v11 offset:25600
    v_mfma_f32_16x16x32_bf16 v[168:171], v[228:231], a[140:143], v[168:171]
    ds_read_b64_tr_b16 v[250:251], v11 offset:31744
    v_mfma_f32_16x16x32_bf16 v[164:167], v[228:231], a[136:139], v[164:167]
    ds_read_b64_tr_b16 v[252:253], v11 offset:26624
    v_mfma_f32_16x16x32_bf16 v[164:167], v[224:227], a[120:123], v[164:167]
    s_add_u32 s31, s32, 5013888
    ds_read_b64_tr_b16 v[254:255], v11 offset:32768
    v_mfma_f32_16x16x32_bf16 v[164:167], v[220:223], a[104:107], v[164:167]
    buffer_load_dwordx4 v4, s[36:39], s31 offen offset:2048 lds
    v_mfma_f32_16x16x32_bf16 v[160:163], v[220:223], a[100:103], v[160:163]
    v_mfma_f32_16x16x32_bf16 v[160:163], v[224:227], a[116:119], v[160:163]
    v_mfma_f32_16x16x32_bf16 v[160:163], v[228:231], a[132:135], v[160:163]
    v_mfma_f32_16x16x32_bf16 v[156:159], v[228:231], a[128:131], v[156:159]
    v_mfma_f32_16x16x32_bf16 v[156:159], v[224:227], a[112:115], v[156:159]
    v_mfma_f32_16x16x32_bf16 v[156:159], v[220:223], a[96:99], v[156:159]
    s_waitcnt lgkmcnt(0)
    v_mfma_f32_16x16x32_bf16 v[172:175], v[232:235], a[96:99], v[172:175]
    ds_read_b64_tr_b16 v[220:221], v8 offset:0
    v_mfma_f32_16x16x32_bf16 v[172:175], v[236:239], a[112:115], v[172:175]
    ds_read_b64_tr_b16 v[222:223], v8 offset:6144
    v_mfma_f32_16x16x32_bf16 v[172:175], v[240:243], a[128:131], v[172:175]
    s_add_u32 m0, s30, 61440
    s_add_u32 s31, s32, 4426112
    v_mfma_f32_16x16x32_bf16 v[176:179], v[240:243], a[132:135], v[176:179]
    buffer_load_dwordx4 v4, s[40:43], s31 offen offset:0 lds
    v_mfma_f32_16x16x32_bf16 v[176:179], v[236:239], a[116:119], v[176:179]
    ds_read_b64_tr_b16 v[224:225], v8 offset:1024
    v_mfma_f32_16x16x32_bf16 v[176:179], v[232:235], a[100:103], v[176:179]
    ds_read_b64_tr_b16 v[226:227], v8 offset:7168
    v_mfma_f32_16x16x32_bf16 v[180:183], v[232:235], a[104:107], v[180:183]
    ds_read_b64_tr_b16 v[228:229], v8 offset:2048
    v_mfma_f32_16x16x32_bf16 v[180:183], v[236:239], a[120:123], v[180:183]
    ds_read_b64_tr_b16 v[230:231], v8 offset:8192
    v_mfma_f32_16x16x32_bf16 v[180:183], v[240:243], a[136:139], v[180:183]
    v_mfma_f32_16x16x32_bf16 v[184:187], v[240:243], a[140:143], v[184:187]
    s_add_u32 s31, s32, 4720000
    v_mfma_f32_16x16x32_bf16 v[184:187], v[236:239], a[124:127], v[184:187]
    buffer_load_dwordx4 v4, s[40:43], s31 offen offset:1024 lds
    v_mfma_f32_16x16x32_bf16 v[184:187], v[232:235], a[108:111], v[184:187]
    ds_read_b64_tr_b16 v[232:233], v9 offset:0
    v_mfma_f32_16x16x32_bf16 v[200:203], v[244:247], a[108:111], v[200:203]
    ds_read_b64_tr_b16 v[234:235], v9 offset:6144
    v_mfma_f32_16x16x32_bf16 v[200:203], v[248:251], a[124:127], v[200:203]
    ds_read_b64_tr_b16 v[236:237], v9 offset:1024
    v_mfma_f32_16x16x32_bf16 v[200:203], v[252:255], a[140:143], v[200:203]
    ds_read_b64_tr_b16 v[238:239], v9 offset:7168
    v_mfma_f32_16x16x32_bf16 v[196:199], v[252:255], a[136:139], v[196:199]
    ds_read_b64_tr_b16 v[240:241], v9 offset:2048
    v_mfma_f32_16x16x32_bf16 v[196:199], v[248:251], a[120:123], v[196:199]
    s_add_u32 s31, s32, 5013888
    ds_read_b64_tr_b16 v[242:243], v9 offset:8192
    v_mfma_f32_16x16x32_bf16 v[196:199], v[244:247], a[104:107], v[196:199]
    buffer_load_dwordx4 v4, s[40:43], s31 offen offset:2048 lds
    v_mfma_f32_16x16x32_bf16 v[192:195], v[244:247], a[100:103], v[192:195]
    v_mfma_f32_16x16x32_bf16 v[192:195], v[248:251], a[116:119], v[192:195]
    v_mfma_f32_16x16x32_bf16 v[192:195], v[252:255], a[132:135], v[192:195]
    v_mfma_f32_16x16x32_bf16 v[188:191], v[252:255], a[128:131], v[188:191]
    v_mfma_f32_16x16x32_bf16 v[188:191], v[248:251], a[112:115], v[188:191]
    v_mfma_f32_16x16x32_bf16 v[188:191], v[244:247], a[96:99], v[188:191]
    s_waitcnt vmcnt(11) lgkmcnt(0)
    s_barrier
    v_mfma_f32_16x16x32_bf16 v[140:143], v[220:223], a[144:147], v[140:143]
    ds_read_b64_tr_b16 v[244:245], v8 offset:12288
    v_mfma_f32_16x16x32_bf16 v[140:143], v[224:227], a[160:163], v[140:143]
    ds_read_b64_tr_b16 v[246:247], v8 offset:18432
    v_mfma_f32_16x16x32_bf16 v[140:143], v[228:231], a[176:179], v[140:143]
    s_add_u32 m0, s30, 73728
    s_add_u32 s31, s33, 2560
    v_mfma_f32_16x16x32_bf16 v[144:147], v[228:231], a[180:183], v[144:147]
    buffer_load_dwordx4 v6, s[48:51], s31 offen offset:0 lds
    v_mfma_f32_16x16x32_bf16 v[144:147], v[224:227], a[164:167], v[144:147]
    ds_read_b64_tr_b16 v[248:249], v8 offset:13312
    v_mfma_f32_16x16x32_bf16 v[144:147], v[220:223], a[148:151], v[144:147]
    ds_read_b64_tr_b16 v[250:251], v8 offset:19456
    v_mfma_f32_16x16x32_bf16 v[148:151], v[220:223], a[152:155], v[148:151]
    ds_read_b64_tr_b16 v[252:253], v8 offset:14336
    v_mfma_f32_16x16x32_bf16 v[148:151], v[224:227], a[168:171], v[148:151]
    ds_read_b64_tr_b16 v[254:255], v8 offset:20480
    v_mfma_f32_16x16x32_bf16 v[148:151], v[228:231], a[184:187], v[148:151]
    v_mfma_f32_16x16x32_bf16 v[152:155], v[228:231], a[188:191], v[152:155]
    s_add_u32 s31, s33, 296448
    v_mfma_f32_16x16x32_bf16 v[152:155], v[224:227], a[172:175], v[152:155]
    buffer_load_dwordx4 v6, s[48:51], s31 offen offset:1024 lds
    v_mfma_f32_16x16x32_bf16 v[152:155], v[220:223], a[156:159], v[152:155]
    ds_read_b64_tr_b16 v[220:221], v9 offset:12288
    v_mfma_f32_16x16x32_bf16 v[168:171], v[232:235], a[156:159], v[168:171]
    ds_read_b64_tr_b16 v[222:223], v9 offset:18432
    v_mfma_f32_16x16x32_bf16 v[168:171], v[236:239], a[172:175], v[168:171]
    ds_read_b64_tr_b16 v[224:225], v9 offset:13312
    v_mfma_f32_16x16x32_bf16 v[168:171], v[240:243], a[188:191], v[168:171]
    ds_read_b64_tr_b16 v[226:227], v9 offset:19456
    v_mfma_f32_16x16x32_bf16 v[164:167], v[240:243], a[184:187], v[164:167]
    ds_read_b64_tr_b16 v[228:229], v9 offset:14336
    v_mfma_f32_16x16x32_bf16 v[164:167], v[236:239], a[168:171], v[164:167]
    s_add_u32 s31, s33, 590336
    ds_read_b64_tr_b16 v[230:231], v9 offset:20480
    v_mfma_f32_16x16x32_bf16 v[164:167], v[232:235], a[152:155], v[164:167]
    buffer_load_dwordx4 v6, s[48:51], s31 offen offset:2048 lds
    v_mfma_f32_16x16x32_bf16 v[160:163], v[232:235], a[148:151], v[160:163]
    v_mfma_f32_16x16x32_bf16 v[160:163], v[236:239], a[164:167], v[160:163]
    v_mfma_f32_16x16x32_bf16 v[160:163], v[240:243], a[180:183], v[160:163]
    v_mfma_f32_16x16x32_bf16 v[156:159], v[240:243], a[176:179], v[156:159]
    v_mfma_f32_16x16x32_bf16 v[156:159], v[236:239], a[160:163], v[156:159]
    v_mfma_f32_16x16x32_bf16 v[156:159], v[232:235], a[144:147], v[156:159]
    s_waitcnt lgkmcnt(0)
    v_mfma_f32_16x16x32_bf16 v[172:175], v[244:247], a[144:147], v[172:175]
    ds_read_b64_tr_b16 v[232:233], v8 offset:24576
    v_mfma_f32_16x16x32_bf16 v[172:175], v[248:251], a[160:163], v[172:175]
    ds_read_b64_tr_b16 v[234:235], v8 offset:30720
    v_mfma_f32_16x16x32_bf16 v[172:175], v[252:255], a[176:179], v[172:175]
    s_add_u32 m0, s30, 0
    s_add_u32 s31, s33, 887296
    v_mfma_f32_16x16x32_bf16 v[176:179], v[252:255], a[180:183], v[176:179]
    buffer_load_dwordx4 v6, s[48:51], s31 offen offset:0 lds
    v_mfma_f32_16x16x32_bf16 v[176:179], v[248:251], a[164:167], v[176:179]
    ds_read_b64_tr_b16 v[236:237], v8 offset:25600
    v_mfma_f32_16x16x32_bf16 v[176:179], v[244:247], a[148:151], v[176:179]
    ds_read_b64_tr_b16 v[238:239], v8 offset:31744
    v_mfma_f32_16x16x32_bf16 v[180:183], v[244:247], a[152:155], v[180:183]
    ds_read_b64_tr_b16 v[240:241], v8 offset:26624
    v_mfma_f32_16x16x32_bf16 v[180:183], v[248:251], a[168:171], v[180:183]
    ds_read_b64_tr_b16 v[242:243], v8 offset:32768
    v_mfma_f32_16x16x32_bf16 v[180:183], v[252:255], a[184:187], v[180:183]
    v_mfma_f32_16x16x32_bf16 v[184:187], v[252:255], a[188:191], v[184:187]
    s_add_u32 s31, s33, 1181184
    v_mfma_f32_16x16x32_bf16 v[184:187], v[248:251], a[172:175], v[184:187]
    buffer_load_dwordx4 v6, s[48:51], s31 offen offset:1024 lds
    v_mfma_f32_16x16x32_bf16 v[184:187], v[244:247], a[156:159], v[184:187]
    ds_read_b64_tr_b16 v[244:245], v9 offset:24576
    v_mfma_f32_16x16x32_bf16 v[200:203], v[220:223], a[156:159], v[200:203]
    ds_read_b64_tr_b16 v[246:247], v9 offset:30720
    v_mfma_f32_16x16x32_bf16 v[200:203], v[224:227], a[172:175], v[200:203]
    ds_read_b64_tr_b16 v[248:249], v9 offset:25600
    v_mfma_f32_16x16x32_bf16 v[200:203], v[228:231], a[188:191], v[200:203]
    ds_read_b64_tr_b16 v[250:251], v9 offset:31744
    v_mfma_f32_16x16x32_bf16 v[196:199], v[228:231], a[184:187], v[196:199]
    ds_read_b64_tr_b16 v[252:253], v9 offset:26624
    v_mfma_f32_16x16x32_bf16 v[196:199], v[224:227], a[168:171], v[196:199]
    s_add_u32 s31, s33, 1475072
    ds_read_b64_tr_b16 v[254:255], v9 offset:32768
    v_mfma_f32_16x16x32_bf16 v[196:199], v[220:223], a[152:155], v[196:199]
    buffer_load_dwordx4 v6, s[48:51], s31 offen offset:2048 lds
    v_mfma_f32_16x16x32_bf16 v[192:195], v[220:223], a[148:151], v[192:195]
    v_mfma_f32_16x16x32_bf16 v[192:195], v[224:227], a[164:167], v[192:195]
    v_mfma_f32_16x16x32_bf16 v[192:195], v[228:231], a[180:183], v[192:195]
    v_mfma_f32_16x16x32_bf16 v[188:191], v[228:231], a[176:179], v[188:191]
    v_mfma_f32_16x16x32_bf16 v[188:191], v[224:227], a[160:163], v[188:191]
    v_mfma_f32_16x16x32_bf16 v[188:191], v[220:223], a[144:147], v[188:191]
    s_waitcnt vmcnt(9) lgkmcnt(0)
    s_barrier
    v_mfma_f32_16x16x32_bf16 v[140:143], v[232:235], a[192:195], v[140:143]
    ds_read_b64_tr_b16 v[220:221], v8 offset:36864
    v_mfma_f32_16x16x32_bf16 v[140:143], v[236:239], a[208:211], v[140:143]
    ds_read_b64_tr_b16 v[222:223], v8 offset:43008
    v_mfma_f32_16x16x32_bf16 v[140:143], v[240:243], a[224:227], v[140:143]
    s_add_u32 m0, s30, 12288
    s_add_u32 s31, s33, 1772032
    v_mfma_f32_16x16x32_bf16 v[144:147], v[240:243], a[228:231], v[144:147]
    buffer_load_dwordx4 v6, s[48:51], s31 offen offset:0 lds
    v_mfma_f32_16x16x32_bf16 v[144:147], v[236:239], a[212:215], v[144:147]
    ds_read_b64_tr_b16 v[224:225], v8 offset:37888
    v_mfma_f32_16x16x32_bf16 v[144:147], v[232:235], a[196:199], v[144:147]
    ds_read_b64_tr_b16 v[226:227], v8 offset:44032
    v_mfma_f32_16x16x32_bf16 v[148:151], v[232:235], a[200:203], v[148:151]
    ds_read_b64_tr_b16 v[228:229], v8 offset:38912
    v_mfma_f32_16x16x32_bf16 v[148:151], v[236:239], a[216:219], v[148:151]
    s_add_u32 s31, s33, 2065920
    ds_read_b64_tr_b16 v[230:231], v8 offset:45056
    v_mfma_f32_16x16x32_bf16 v[148:151], v[240:243], a[232:235], v[148:151]
    buffer_load_dwordx4 v6, s[48:51], s31 offen offset:1024 lds
    v_mfma_f32_16x16x32_bf16 v[152:155], v[240:243], a[236:239], v[152:155]
    v_mfma_f32_16x16x32_bf16 v[152:155], v[236:239], a[220:223], v[152:155]
    v_mfma_f32_16x16x32_bf16 v[152:155], v[232:235], a[204:207], v[152:155]
    ds_read_b64_tr_b16 v[232:233], v9 offset:36864
    v_mfma_f32_16x16x32_bf16 v[168:171], v[244:247], a[204:207], v[168:171]
    s_add_u32 s31, s33, 2359808
    ds_read_b64_tr_b16 v[234:235], v9 offset:43008
    v_mfma_f32_16x16x32_bf16 v[168:171], v[248:251], a[220:223], v[168:171]
    buffer_load_dwordx4 v6, s[48:51], s31 offen offset:2048 lds
    v_mfma_f32_16x16x32_bf16 v[168:171], v[252:255], a[236:239], v[168:171]
    ds_read_b64_tr_b16 v[236:237], v9 offset:37888
    v_mfma_f32_16x16x32_bf16 v[164:167], v[252:255], a[232:235], v[164:167]
    ds_read_b64_tr_b16 v[238:239], v9 offset:44032
    v_mfma_f32_16x16x32_bf16 v[164:167], v[248:251], a[216:219], v[164:167]
    ds_read_b64_tr_b16 v[240:241], v9 offset:38912
    v_mfma_f32_16x16x32_bf16 v[164:167], v[244:247], a[200:203], v[164:167]
    v_mov_b32 v20, 1
    ds_read_b64_tr_b16 v[242:243], v9 offset:45056
    v_mfma_f32_16x16x32_bf16 v[160:163], v[244:247], a[196:199], v[160:163]
    buffer_store_dword v20, v3, s[68:71], s76 offen sc1
    v_mfma_f32_16x16x32_bf16 v[160:163], v[248:251], a[212:215], v[160:163]
    v_mfma_f32_16x16x32_bf16 v[160:163], v[252:255], a[228:231], v[160:163]
    v_mfma_f32_16x16x32_bf16 v[156:159], v[252:255], a[224:227], v[156:159]
    v_mfma_f32_16x16x32_bf16 v[156:159], v[248:251], a[208:211], v[156:159]
    v_mfma_f32_16x16x32_bf16 v[156:159], v[244:247], a[192:195], v[156:159]
    s_waitcnt lgkmcnt(0)
    v_mfma_f32_16x16x32_bf16 v[172:175], v[220:223], a[192:195], v[172:175]
    ds_read_b64_tr_b16 v[244:245], v10 offset:0
    v_mfma_f32_16x16x32_bf16 v[172:175], v[224:227], a[208:211], v[172:175]
    ds_read_b64_tr_b16 v[246:247], v10 offset:6144
    v_mfma_f32_16x16x32_bf16 v[172:175], v[228:231], a[224:227], v[172:175]
    s_add_u32 m0, s30, 24576
    s_add_u32 s31, s33, 2656768
    v_mfma_f32_16x16x32_bf16 v[176:179], v[228:231], a[228:231], v[176:179]
    buffer_load_dwordx4 v6, s[48:51], s31 offen offset:0 lds
    v_mfma_f32_16x16x32_bf16 v[176:179], v[224:227], a[212:215], v[176:179]
    ds_read_b64_tr_b16 v[248:249], v10 offset:1024
    s_lshl_b32 s17, s21, 10
    v_mfma_f32_16x16x32_bf16 v[176:179], v[220:223], a[196:199], v[176:179]
    ds_read_b64_tr_b16 v[250:251], v10 offset:7168
    s_add_u32 s17, s17, 40960
    v_mfma_f32_16x16x32_bf16 v[180:183], v[220:223], a[200:203], v[180:183]
    ds_read_b64_tr_b16 v[252:253], v10 offset:2048
    s_lshl_b32 s18, s20, 2
    v_mfma_f32_16x16x32_bf16 v[180:183], v[224:227], a[216:219], v[180:183]
    ds_read_b64_tr_b16 v[254:255], v10 offset:8192
    s_add_u32 s18, s18, s16
    v_mfma_f32_16x16x32_bf16 v[180:183], v[228:231], a[232:235], v[180:183]
    s_lshl_b32 s18, s18, 7
    s_add_u32 s82, s17, s18
    v_mfma_f32_16x16x32_bf16 v[184:187], v[228:231], a[236:239], v[184:187]
    s_add_u32 s31, s33, 2950656
    s_lshl_b32 s18, s19, 2
    v_mfma_f32_16x16x32_bf16 v[184:187], v[224:227], a[220:223], v[184:187]
    buffer_load_dwordx4 v6, s[48:51], s31 offen offset:1024 lds
    v_mfma_f32_16x16x32_bf16 v[184:187], v[220:223], a[204:207], v[184:187]
    ds_read_b64_tr_b16 v[220:221], v11 offset:0
    s_add_u32 s82, s82, s18
    v_mfma_f32_16x16x32_bf16 v[200:203], v[232:235], a[204:207], v[200:203]
    ds_read_b64_tr_b16 v[222:223], v11 offset:6144
    s_lshl_b32 s18, s22, 1
    v_mfma_f32_16x16x32_bf16 v[200:203], v[236:239], a[220:223], v[200:203]
    ds_read_b64_tr_b16 v[224:225], v11 offset:1024
    s_lshr_b32 s80, s19, 2
    v_mfma_f32_16x16x32_bf16 v[200:203], v[240:243], a[236:239], v[200:203]
    ds_read_b64_tr_b16 v[226:227], v11 offset:7168
    s_add_u32 s18, s18, s80
    v_mfma_f32_16x16x32_bf16 v[196:199], v[240:243], a[232:235], v[196:199]
    ds_read_b64_tr_b16 v[228:229], v11 offset:2048
    s_lshl_b32 s18, s18, 1
    v_mfma_f32_16x16x32_bf16 v[196:199], v[236:239], a[216:219], v[196:199]
    s_add_u32 s31, s33, 3244544
    ds_read_b64_tr_b16 v[230:231], v11 offset:8192
    v_mfma_f32_16x16x32_bf16 v[196:199], v[232:235], a[200:203], v[196:199]
    buffer_load_dwordx4 v6, s[48:51], s31 offen offset:2048 lds
    v_mfma_f32_16x16x32_bf16 v[192:195], v[232:235], a[196:199], v[192:195]
    s_add_u32 s18, s18, s23
    s_lshl_b32 s18, s18, 7
    v_mfma_f32_16x16x32_bf16 v[192:195], v[236:239], a[212:215], v[192:195]
    s_add_u32 s81, s17, s18
    v_and_b32 v21, 28, v21
    v_mfma_f32_16x16x32_bf16 v[192:195], v[240:243], a[228:231], v[192:195]
    v_mfma_f32_16x16x32_bf16 v[188:191], v[240:243], a[224:227], v[188:191]
    v_mfma_f32_16x16x32_bf16 v[188:191], v[236:239], a[208:211], v[188:191]
    v_mfma_f32_16x16x32_bf16 v[188:191], v[232:235], a[192:195], v[188:191]
    s_waitcnt vmcnt(10) lgkmcnt(0)
    s_barrier
    v_mfma_f32_16x16x32_bf16 v[140:143], v[244:247], a[240:243], v[140:143]
    ds_read_b64_tr_b16 v[232:233], v10 offset:12288
    v_mfma_f32_16x16x32_bf16 v[140:143], v[248:251], v[44:47], v[140:143]
    ds_read_b64_tr_b16 v[234:235], v10 offset:18432
    v_mfma_f32_16x16x32_bf16 v[140:143], v[252:255], v[60:63], v[140:143]
    s_add_u32 m0, s30, 36864
    s_add_u32 s31, s33, 3541504
    v_mfma_f32_16x16x32_bf16 v[144:147], v[252:255], v[64:67], v[144:147]
    buffer_load_dwordx4 v6, s[48:51], s31 offen offset:0 lds
    v_mfma_f32_16x16x32_bf16 v[144:147], v[248:251], v[48:51], v[144:147]
    ds_read_b64_tr_b16 v[236:237], v10 offset:13312
    v_mfma_f32_16x16x32_bf16 v[144:147], v[244:247], a[244:247], v[144:147]
    ds_read_b64_tr_b16 v[238:239], v10 offset:19456
    v_mfma_f32_16x16x32_bf16 v[148:151], v[244:247], a[248:251], v[148:151]
    ds_read_b64_tr_b16 v[240:241], v10 offset:14336
    v_mfma_f32_16x16x32_bf16 v[148:151], v[248:251], v[52:55], v[148:151]
    ds_read_b64_tr_b16 v[242:243], v10 offset:20480
    v_mfma_f32_16x16x32_bf16 v[148:151], v[252:255], v[68:71], v[148:151]
    v_mfma_f32_16x16x32_bf16 v[152:155], v[252:255], v[72:75], v[152:155]
    s_add_u32 s31, s33, 3835392
    v_mfma_f32_16x16x32_bf16 v[152:155], v[248:251], v[56:59], v[152:155]
    buffer_load_dwordx4 v6, s[48:51], s31 offen offset:1024 lds
    v_mfma_f32_16x16x32_bf16 v[152:155], v[244:247], a[252:255], v[152:155]
    ds_read_b64_tr_b16 v[244:245], v11 offset:12288
    v_mfma_f32_16x16x32_bf16 v[168:171], v[220:223], a[252:255], v[168:171]
    ds_read_b64_tr_b16 v[246:247], v11 offset:18432
    v_mfma_f32_16x16x32_bf16 v[168:171], v[224:227], v[56:59], v[168:171]
    ds_read_b64_tr_b16 v[248:249], v11 offset:13312
    v_mfma_f32_16x16x32_bf16 v[168:171], v[228:231], v[72:75], v[168:171]
    ds_read_b64_tr_b16 v[250:251], v11 offset:19456
    v_mfma_f32_16x16x32_bf16 v[164:167], v[228:231], v[68:71], v[164:167]
    ds_read_b64_tr_b16 v[252:253], v11 offset:14336
    v_mfma_f32_16x16x32_bf16 v[164:167], v[224:227], v[52:55], v[164:167]
    s_add_u32 s31, s33, 4129280
    ds_read_b64_tr_b16 v[254:255], v11 offset:20480
    v_mfma_f32_16x16x32_bf16 v[164:167], v[220:223], a[248:251], v[164:167]
    buffer_load_dwordx4 v6, s[48:51], s31 offen offset:2048 lds
    v_mfma_f32_16x16x32_bf16 v[160:163], v[220:223], a[244:247], v[160:163]
    v_mfma_f32_16x16x32_bf16 v[160:163], v[224:227], v[48:51], v[160:163]
    v_mfma_f32_16x16x32_bf16 v[160:163], v[228:231], v[64:67], v[160:163]
    v_mfma_f32_16x16x32_bf16 v[156:159], v[228:231], v[60:63], v[156:159]
    v_mfma_f32_16x16x32_bf16 v[156:159], v[224:227], v[44:47], v[156:159]
    v_mfma_f32_16x16x32_bf16 v[156:159], v[220:223], a[240:243], v[156:159]
    s_waitcnt lgkmcnt(0)
    v_mfma_f32_16x16x32_bf16 v[172:175], v[232:235], a[240:243], v[172:175]
    ds_read_b64_tr_b16 v[220:221], v13 offset:24576
    v_mfma_f32_16x16x32_bf16 v[172:175], v[236:239], v[44:47], v[172:175]
    ds_read_b64_tr_b16 v[222:223], v13 offset:27648
    v_mfma_f32_16x16x32_bf16 v[172:175], v[240:243], v[60:63], v[172:175]
    s_add_u32 m0, s30, 49152
    s_add_u32 s31, s33, 4426240
    v_mfma_f32_16x16x32_bf16 v[176:179], v[240:243], v[64:67], v[176:179]
    buffer_load_dwordx4 v6, s[48:51], s31 offen offset:0 lds
    v_mfma_f32_16x16x32_bf16 v[176:179], v[236:239], v[48:51], v[176:179]
    ds_read_b64_tr_b16 v[224:225], v13 offset:25600
    v_lshrrev_b32 v36, 5, v1
    v_mfma_f32_16x16x32_bf16 v[176:179], v[232:235], a[244:247], v[176:179]
    ds_read_b64_tr_b16 v[226:227], v13 offset:28672
k4_kernel_pg1_4:
    s_cbranch_execz k4_kernel_pg1_8
    v_bfe_u32 v37, v1, 3, 2
    v_mfma_f32_16x16x32_bf16 v[180:183], v[232:235], a[248:251], v[180:183]
    ds_read_b64_tr_b16 v[228:229], v13 offset:26624
    v_and_b32 v38, 7, v1
    v_mfma_f32_16x16x32_bf16 v[180:183], v[236:239], v[52:55], v[180:183]
    ds_read_b64_tr_b16 v[230:231], v13 offset:29696
    s_mov_b32 s17, 2359296
    v_mfma_f32_16x16x32_bf16 v[180:183], v[240:243], v[68:71], v[180:183]
    v_mul_lo_u32 v4, v36, s17
    v_lshl_add_u32 v4, v37, 8, v4
    v_mfma_f32_16x16x32_bf16 v[184:187], v[240:243], v[72:75], v[184:187]
    s_add_u32 s31, s33, 4720128
    v_lshl_add_u32 v4, v38, 4, v4
    v_mfma_f32_16x16x32_bf16 v[184:187], v[236:239], v[56:59], v[184:187]
    buffer_load_dwordx4 v6, s[48:51], s31 offen offset:1024 lds
    v_mfma_f32_16x16x32_bf16 v[184:187], v[232:235], a[252:255], v[184:187]
    ds_read_b64_tr_b16 v[232:233], v13 offset:30720
    s_lshl_b32 s17, s21, 1
    v_mfma_f32_16x16x32_bf16 v[200:203], v[244:247], a[252:255], v[200:203]
    ds_read_b64_tr_b16 v[234:235], v13 offset:33792
    s_add_u32 s17, s17, s22
    v_mfma_f32_16x16x32_bf16 v[200:203], v[248:251], v[56:59], v[200:203]
    ds_read_b64_tr_b16 v[236:237], v13 offset:31744
    s_mul_i32 s17, s17, 73728
    v_mfma_f32_16x16x32_bf16 v[200:203], v[252:255], v[72:75], v[200:203]
    ds_read_b64_tr_b16 v[238:239], v13 offset:34816
    s_lshl_b32 s18, s20, 7
    v_mfma_f32_16x16x32_bf16 v[196:199], v[252:255], v[68:71], v[196:199]
    ds_read_b64_tr_b16 v[240:241], v13 offset:32768
    s_add_u32 s17, s17, s18
    v_mfma_f32_16x16x32_bf16 v[196:199], v[248:251], v[52:55], v[196:199]
    s_add_u32 s31, s33, 5014016
    ds_read_b64_tr_b16 v[242:243], v13 offset:35840
    v_mfma_f32_16x16x32_bf16 v[196:199], v[244:247], a[248:251], v[196:199]
    buffer_load_dwordx4 v6, s[48:51], s31 offen offset:2048 lds
    v_mfma_f32_16x16x32_bf16 v[192:195], v[244:247], a[244:247], v[192:195]
    s_lshr_b32 s18, s19, 2
    s_lshl_b32 s18, s18, 1
    v_mfma_f32_16x16x32_bf16 v[192:195], v[248:251], v[48:51], v[192:195]
    s_add_u32 s18, s18, s23
    s_lshl_b32 s80, s18, 12
    v_mfma_f32_16x16x32_bf16 v[192:195], v[252:255], v[64:67], v[192:195]
    s_add_u32 s32, s17, s80
    s_and_b32 s80, s19, 3
    v_mfma_f32_16x16x32_bf16 v[188:191], v[252:255], v[60:63], v[188:191]
    s_lshl_b32 s80, s80, 10
    s_add_u32 s32, s32, s80
    v_mfma_f32_16x16x32_bf16 v[188:191], v[248:251], v[44:47], v[188:191]
    s_lshl_b32 s18, s18, 11
    s_add_u32 s33, s17, s18
    v_mfma_f32_16x16x32_bf16 v[188:191], v[244:247], a[240:243], v[188:191]
    s_bfe_u32 s18, s19, 0x10001
    s_lshl_b32 s18, s18, 10
    s_add_u32 s33, s33, s18
    s_and_b32 s18, s19, 1
    s_lshl_b32 s18, s18, 8
    s_add_u32 s33, s33, s18
    s_add_u32 s33, s33, 65536
    s_waitcnt vmcnt(13) lgkmcnt(0)
    s_barrier
    v_mfma_f32_16x16x32_bf16 v[204:207], v[220:223], a[0:3], 0
    ds_read_b64_tr_b16 v[244:245], v12 offset:0
    v_mfma_f32_16x16x32_bf16 v[204:207], v[224:227], a[16:19], v[204:207]
    s_add_u32 m0, s30, 61440
    s_add_u32 s31, s56, 2048
    v_mfma_f32_16x16x32_bf16 v[204:207], v[228:231], a[32:35], v[204:207]
    buffer_load_dwordx4 v5, s[52:55], s31 offen offset:0 lds
    v_mfma_f32_16x16x32_bf16 v[208:211], v[228:231], a[36:39], 0
    ds_read_b64_tr_b16 v[246:247], v12 offset:3072
    v_max_f32 v140, 0, v140
    v_mfma_f32_16x16x32_bf16 v[208:211], v[224:227], a[20:23], v[208:211]
    s_add_u32 s31, s56, 1152
    ds_read_b64_tr_b16 v[248:249], v12 offset:1024
    v_mfma_f32_16x16x32_bf16 v[208:211], v[220:223], a[4:7], v[208:211]
    buffer_load_dwordx4 v5, s[52:55], s31 offen offset:1024 lds
    v_mfma_f32_16x16x32_bf16 v[212:215], v[220:223], a[8:11], 0
    ds_read_b64_tr_b16 v[250:251], v12 offset:4096
    v_max_f32 v141, 0, v141
    v_mfma_f32_16x16x32_bf16 v[212:215], v[224:227], a[24:27], v[212:215]
    ds_read_b64_tr_b16 v[252:253], v12 offset:2048
    v_max_f32 v142, 0, v142
    v_mfma_f32_16x16x32_bf16 v[212:215], v[228:231], a[40:43], v[212:215]
    s_add_u32 s31, s56, 36864
    ds_read_b64_tr_b16 v[254:255], v12 offset:5120
    v_mfma_f32_16x16x32_bf16 v[216:219], v[228:231], a[44:47], 0
    buffer_load_dwordx4 v5, s[52:55], s31 offen offset:2048 lds
    v_mfma_f32_16x16x32_bf16 v[216:219], v[224:227], a[28:31], v[216:219]
    v_max_f32 v143, 0, v143
    v_mul_f32 v140, v140, v172
    v_mfma_f32_16x16x32_bf16 v[216:219], v[220:223], a[12:15], v[216:219]
    ds_read_b64_tr_b16 v[220:221], v12 offset:6144
    v_mul_f32 v141, v141, v173
    v_mfma_f32_16x16x32_bf16 v[88:91], v[232:235], a[12:15], 0
    s_add_u32 m0, s30, 73728
    s_add_u32 s31, s56, 39040
    v_mfma_f32_16x16x32_bf16 v[88:91], v[236:239], a[28:31], v[88:91]
    buffer_load_dwordx4 v5, s[52:55], s31 offen offset:0 lds
    v_mfma_f32_16x16x32_bf16 v[88:91], v[240:243], a[44:47], v[88:91]
    ds_read_b64_tr_b16 v[222:223], v12 offset:9216
    v_mul_f32 v142, v142, v174
    v_mfma_f32_16x16x32_bf16 v[84:87], v[240:243], a[40:43], 0
    s_add_u32 s31, s56, 74752
    ds_read_b64_tr_b16 v[224:225], v12 offset:7168
    v_mfma_f32_16x16x32_bf16 v[84:87], v[236:239], a[24:27], v[84:87]
    buffer_load_dwordx4 v5, s[52:55], s31 offen offset:1024 lds
    v_mfma_f32_16x16x32_bf16 v[84:87], v[232:235], a[8:11], v[84:87]
    ds_read_b64_tr_b16 v[226:227], v12 offset:10240
    v_mul_f32 v143, v143, v175
    v_mfma_f32_16x16x32_bf16 v[80:83], v[232:235], a[4:7], 0
    ds_read_b64_tr_b16 v[228:229], v12 offset:8192
    v_cvt_pk_bf16_f32 v36, v140, v141
    v_mfma_f32_16x16x32_bf16 v[80:83], v[236:239], a[20:23], v[80:83]
    s_add_u32 s31, s56, 73856
    ds_read_b64_tr_b16 v[230:231], v12 offset:11264
    v_mfma_f32_16x16x32_bf16 v[80:83], v[240:243], a[36:39], v[80:83]
    buffer_load_dwordx4 v5, s[52:55], s31 offen offset:2048 lds
    v_mfma_f32_16x16x32_bf16 v[76:79], v[240:243], a[32:35], 0
    v_cvt_pk_bf16_f32 v37, v142, v143
    v_max_f32 v156, 0, v156
    v_mfma_f32_16x16x32_bf16 v[76:79], v[236:239], a[16:19], v[76:79]
    v_max_f32 v157, 0, v157
    v_max_f32 v158, 0, v158
    v_mfma_f32_16x16x32_bf16 v[76:79], v[232:235], a[0:3], v[76:79]
    v_max_f32 v159, 0, v159
    v_mul_f32 v156, v156, v188
    v_mul_f32 v157, v157, v189
    s_waitcnt vmcnt(16) lgkmcnt(0)
    s_barrier
    v_mfma_f32_16x16x32_bf16 v[204:207], v[244:247], a[48:51], v[204:207]
    ds_read_b64_tr_b16 v[232:233], v12 offset:12288
    v_mfma_f32_16x16x32_bf16 v[204:207], v[248:251], a[64:67], v[204:207]
    ds_read_b64_tr_b16 v[234:235], v12 offset:15360
    v_mfma_f32_16x16x32_bf16 v[204:207], v[252:255], a[80:83], v[204:207]
    s_add_u32 m0, s30, 0
    s_add_u32 s31, s56, 112640
    v_mfma_f32_16x16x32_bf16 v[208:211], v[252:255], a[84:87], v[208:211]
    buffer_load_dwordx4 v5, s[52:55], s31 offen offset:0 lds
    v_mfma_f32_16x16x32_bf16 v[208:211], v[248:251], a[68:71], v[208:211]
    ds_read_b64_tr_b16 v[236:237], v12 offset:13312
    v_mul_f32 v158, v158, v190
    v_mfma_f32_16x16x32_bf16 v[208:211], v[244:247], a[52:55], v[208:211]
    ds_read_b64_tr_b16 v[238:239], v12 offset:16384
    v_mul_f32 v159, v159, v191
    v_mfma_f32_16x16x32_bf16 v[212:215], v[244:247], a[56:59], v[212:215]
    ds_read_b64_tr_b16 v[240:241], v12 offset:14336
    v_cvt_pk_bf16_f32 v38, v156, v157
    v_mfma_f32_16x16x32_bf16 v[212:215], v[248:251], a[72:75], v[212:215]
    s_add_u32 s31, s56, 111744
    ds_read_b64_tr_b16 v[242:243], v12 offset:17408
    v_mfma_f32_16x16x32_bf16 v[212:215], v[252:255], a[88:91], v[212:215]
    buffer_load_dwordx4 v5, s[52:55], s31 offen offset:1024 lds
    v_mfma_f32_16x16x32_bf16 v[216:219], v[252:255], a[92:95], v[216:219]
    v_cvt_pk_bf16_f32 v39, v158, v159
    v_mfma_f32_16x16x32_bf16 v[216:219], v[248:251], a[76:79], v[216:219]
    ds_write_b128 v14, v[36:39] offset:49152
    v_mfma_f32_16x16x32_bf16 v[216:219], v[244:247], a[60:63], v[216:219]
    ds_read_b64_tr_b16 v[244:245], v12 offset:18432
    s_add_u32 s45, s3, 49152
    v_mfma_f32_16x16x32_bf16 v[88:91], v[220:223], a[60:63], v[88:91]
    s_add_u32 s31, s56, 147456
    ds_read_b64_tr_b16 v[246:247], v12 offset:21504
    v_mfma_f32_16x16x32_bf16 v[88:91], v[224:227], a[76:79], v[88:91]
    buffer_load_dwordx4 v5, s[52:55], s31 offen offset:2048 lds
    v_mfma_f32_16x16x32_bf16 v[88:91], v[228:231], a[92:95], v[88:91]
    ds_read_b64_tr_b16 v[248:249], v12 offset:19456
    v_mfma_f32_16x16x32_bf16 v[84:87], v[228:231], a[88:91], v[84:87]
    ds_read_b64_tr_b16 v[250:251], v12 offset:22528
    v_mfma_f32_16x16x32_bf16 v[84:87], v[224:227], a[72:75], v[84:87]
    ds_read_b64_tr_b16 v[252:253], v12 offset:20480
    v_mfma_f32_16x16x32_bf16 v[84:87], v[220:223], a[56:59], v[84:87]
    ds_read_b64_tr_b16 v[254:255], v12 offset:23552
    v_mfma_f32_16x16x32_bf16 v[80:83], v[220:223], a[52:55], v[80:83]
    buffer_load_dword v19, v3, s[68:71], s77 offen sc1
    v_mfma_f32_16x16x32_bf16 v[80:83], v[224:227], a[68:71], v[80:83]
    buffer_store_dwordx4 v[36:39], v2, s[64:67], s45 offen offset:0 sc1
    v_mfma_f32_16x16x32_bf16 v[80:83], v[228:231], a[84:87], v[80:83]
    v_max_f32 v144, 0, v144
    v_max_f32 v145, 0, v145
    v_mfma_f32_16x16x32_bf16 v[76:79], v[228:231], a[80:83], v[76:79]
    v_max_f32 v146, 0, v146
    v_max_f32 v147, 0, v147
    v_mfma_f32_16x16x32_bf16 v[76:79], v[224:227], a[64:67], v[76:79]
    v_mul_f32 v144, v144, v176
    v_mul_f32 v145, v145, v177
    v_mfma_f32_16x16x32_bf16 v[76:79], v[220:223], a[48:51], v[76:79]
    v_mul_f32 v146, v146, v178
    v_mul_f32 v147, v147, v179
    s_waitcnt vmcnt(17) lgkmcnt(0)
    s_barrier
    v_mfma_f32_16x16x32_bf16 v[204:207], v[232:235], a[96:99], v[204:207]
    ds_read_b64_tr_b16 v[220:221], v12 offset:24576
    v_mfma_f32_16x16x32_bf16 v[204:207], v[236:239], a[112:115], v[204:207]
    ds_read_b64_tr_b16 v[222:223], v12 offset:27648
    v_mfma_f32_16x16x32_bf16 v[204:207], v[240:243], a[128:131], v[204:207]
    s_add_u32 m0, s30, 12288
    s_add_u32 s31, s56, 149632
    v_mfma_f32_16x16x32_bf16 v[208:211], v[240:243], a[132:135], v[208:211]
    buffer_load_dwordx4 v5, s[52:55], s31 offen offset:0 lds
    v_mfma_f32_16x16x32_bf16 v[208:211], v[236:239], a[116:119], v[208:211]
    ds_read_b64_tr_b16 v[224:225], v12 offset:25600
    v_cvt_pk_bf16_f32 v40, v144, v145
    v_mfma_f32_16x16x32_bf16 v[208:211], v[232:235], a[100:103], v[208:211]
    ds_read_b64_tr_b16 v[226:227], v12 offset:28672
    v_cvt_pk_bf16_f32 v41, v146, v147
    v_mfma_f32_16x16x32_bf16 v[212:215], v[232:235], a[104:107], v[212:215]
    ds_read_b64_tr_b16 v[228:229], v12 offset:26624
    v_max_f32 v160, 0, v160
    v_mfma_f32_16x16x32_bf16 v[212:215], v[236:239], a[120:123], v[212:215]
    ds_read_b64_tr_b16 v[230:231], v12 offset:29696
    v_max_f32 v161, 0, v161
    v_mfma_f32_16x16x32_bf16 v[212:215], v[240:243], a[136:139], v[212:215]
    ds_read_b128 a[0:3], v16 offset:0
    v_max_f32 v162, 0, v162
    v_mfma_f32_16x16x32_bf16 v[216:219], v[240:243], a[140:143], v[216:219]
    s_add_u32 s31, s56, 185344
    ds_read_b128 a[4:7], v16 offset:1024
    v_mfma_f32_16x16x32_bf16 v[216:219], v[236:239], a[124:127], v[216:219]
    buffer_load_dwordx4 v5, s[52:55], s31 offen offset:1024 lds
    v_mfma_f32_16x16x32_bf16 v[216:219], v[232:235], a[108:111], v[216:219]
    ds_read_b64_tr_b16 v[232:233], v12 offset:30720
    v_max_f32 v163, 0, v163
    v_mfma_f32_16x16x32_bf16 v[88:91], v[244:247], a[108:111], v[88:91]
    ds_read_b64_tr_b16 v[234:235], v12 offset:33792
    v_mul_f32 v160, v160, v192
    v_mfma_f32_16x16x32_bf16 v[88:91], v[248:251], a[124:127], v[88:91]
    ds_read_b64_tr_b16 v[236:237], v12 offset:31744
    v_mul_f32 v161, v161, v193
    v_mfma_f32_16x16x32_bf16 v[88:91], v[252:255], a[140:143], v[88:91]
    ds_read_b64_tr_b16 v[238:239], v12 offset:34816
    v_mul_f32 v162, v162, v194
    v_mfma_f32_16x16x32_bf16 v[84:87], v[252:255], a[136:139], v[84:87]
    ds_read_b64_tr_b16 v[240:241], v12 offset:32768
    v_mul_f32 v163, v163, v195
    v_mfma_f32_16x16x32_bf16 v[84:87], v[248:251], a[120:123], v[84:87]
    s_add_u32 s31, s56, 184448
    ds_read_b64_tr_b16 v[242:243], v12 offset:35840
    v_mfma_f32_16x16x32_bf16 v[84:87], v[244:247], a[104:107], v[84:87]
    buffer_load_dwordx4 v5, s[52:55], s31 offen offset:2048 lds
    v_mfma_f32_16x16x32_bf16 v[80:83], v[244:247], a[100:103], v[80:83]
    ds_read_b128 a[8:11], v16 offset:2048
    v_cvt_pk_bf16_f32 v42, v160, v161
    v_mfma_f32_16x16x32_bf16 v[80:83], v[248:251], a[116:119], v[80:83]
    ds_read_b128 a[12:15], v16 offset:3072
    v_cvt_pk_bf16_f32 v43, v162, v163
    v_mfma_f32_16x16x32_bf16 v[80:83], v[252:255], a[132:135], v[80:83]
    ds_write_b128 v14, v[40:43] offset:50176
    v_mfma_f32_16x16x32_bf16 v[76:79], v[252:255], a[128:131], v[76:79]
    s_add_u32 s45, s3, 49152
    v_mfma_f32_16x16x32_bf16 v[76:79], v[248:251], a[112:115], v[76:79]
    buffer_store_dwordx4 v[40:43], v2, s[64:67], s45 offen offset:1024 sc1
    v_mfma_f32_16x16x32_bf16 v[76:79], v[244:247], a[96:99], v[76:79]
    s_waitcnt vmcnt(18) lgkmcnt(0)
    s_barrier
    v_mfma_f32_16x16x32_bf16 v[204:207], v[220:223], a[144:147], v[204:207]
    ds_read_b64_tr_b16 v[244:245], v12 offset:36864
    v_mfma_f32_16x16x32_bf16 v[204:207], v[224:227], a[160:163], v[204:207]
    ds_read_b64_tr_b16 v[246:247], v12 offset:39936
    v_mfma_f32_16x16x32_bf16 v[204:207], v[228:231], a[176:179], v[204:207]
    s_add_u32 m0, s30, 24576
    s_add_u32 s31, s56, 223232
    v_mfma_f32_16x16x32_bf16 v[208:211], v[228:231], a[180:183], v[208:211]
    buffer_load_dwordx4 v5, s[52:55], s31 offen offset:0 lds
    v_mfma_f32_16x16x32_bf16 v[208:211], v[224:227], a[164:167], v[208:211]
    ds_read_b64_tr_b16 v[248:249], v12 offset:37888
    v_max_f32 v148, 0, v148
    v_mfma_f32_16x16x32_bf16 v[208:211], v[220:223], a[148:151], v[208:211]
    ds_read_b64_tr_b16 v[250:251], v12 offset:40960
    v_max_f32 v149, 0, v149
    v_mfma_f32_16x16x32_bf16 v[212:215], v[220:223], a[152:155], v[212:215]
    ds_read_b64_tr_b16 v[252:253], v12 offset:38912
    v_max_f32 v150, 0, v150
    v_mfma_f32_16x16x32_bf16 v[212:215], v[224:227], a[168:171], v[212:215]
    ds_read_b64_tr_b16 v[254:255], v12 offset:41984
    v_max_f32 v151, 0, v151
    v_mfma_f32_16x16x32_bf16 v[212:215], v[228:231], a[184:187], v[212:215]
    ds_read_b128 a[16:19], v16 offset:8192
    v_mul_f32 v148, v148, v180
    v_mfma_f32_16x16x32_bf16 v[216:219], v[228:231], a[188:191], v[216:219]
    s_add_u32 s31, s56, 222336
    ds_read_b128 a[20:23], v16 offset:9216
    v_mfma_f32_16x16x32_bf16 v[216:219], v[224:227], a[172:175], v[216:219]
    buffer_load_dwordx4 v5, s[52:55], s31 offen offset:1024 lds
    v_mfma_f32_16x16x32_bf16 v[216:219], v[220:223], a[156:159], v[216:219]
    ds_read_b64_tr_b16 v[220:221], v12 offset:43008
    v_mul_f32 v149, v149, v181
    v_mfma_f32_16x16x32_bf16 v[88:91], v[232:235], a[156:159], v[88:91]
    ds_read_b64_tr_b16 v[222:223], v12 offset:46080
    v_mul_f32 v150, v150, v182
    v_mfma_f32_16x16x32_bf16 v[88:91], v[236:239], a[172:175], v[88:91]
    ds_read_b64_tr_b16 v[224:225], v12 offset:44032
    v_mul_f32 v151, v151, v183
    v_mfma_f32_16x16x32_bf16 v[88:91], v[240:243], a[188:191], v[88:91]
    ds_read_b64_tr_b16 v[226:227], v12 offset:47104
    v_cvt_pk_bf16_f32 v36, v148, v149
    v_mfma_f32_16x16x32_bf16 v[84:87], v[240:243], a[184:187], v[84:87]
    ds_read_b64_tr_b16 v[228:229], v12 offset:45056
    v_cvt_pk_bf16_f32 v37, v150, v151
    v_mfma_f32_16x16x32_bf16 v[84:87], v[236:239], a[168:171], v[84:87]
    s_add_u32 s31, s56, 258048
    ds_read_b64_tr_b16 v[230:231], v12 offset:48128
    v_mfma_f32_16x16x32_bf16 v[84:87], v[232:235], a[152:155], v[84:87]
    buffer_load_dwordx4 v5, s[52:55], s31 offen offset:2048 lds
    v_mfma_f32_16x16x32_bf16 v[80:83], v[232:235], a[148:151], v[80:83]
    ds_read_b128 a[24:27], v16 offset:10240
    v_max_f32 v164, 0, v164
    v_mfma_f32_16x16x32_bf16 v[80:83], v[236:239], a[164:167], v[80:83]
    ds_read_b128 a[28:31], v16 offset:11264
    v_max_f32 v165, 0, v165
    v_mfma_f32_16x16x32_bf16 v[80:83], v[240:243], a[180:183], v[80:83]
    v_max_f32 v166, 0, v166
    v_max_f32 v167, 0, v167
    v_mfma_f32_16x16x32_bf16 v[76:79], v[240:243], a[176:179], v[76:79]
    v_mul_f32 v164, v164, v196
    v_mul_f32 v165, v165, v197
    v_mfma_f32_16x16x32_bf16 v[76:79], v[236:239], a[160:163], v[76:79]
    v_mfma_f32_16x16x32_bf16 v[76:79], v[232:235], a[144:147], v[76:79]
    s_waitcnt vmcnt(8) lgkmcnt(0)
    s_barrier
    v_readfirstlane_b32 s18, v19
    s_nop 1
    s_cmp_lt_u32 s18, 1
    s_cbranch_scc1 k4_kernel_slow1
k4_kernel_ok1:
    v_mfma_f32_16x16x32_bf16 v[204:207], v[244:247], a[192:195], v[204:207]
    ds_read_b64_tr_b16 v[232:233], v13 offset:0
    v_mfma_f32_16x16x32_bf16 v[204:207], v[248:251], a[208:211], v[204:207]
    s_add_u32 m0, s30, 36864
    s_add_u32 s31, s56, 260224
    v_mfma_f32_16x16x32_bf16 v[204:207], v[252:255], a[224:227], v[204:207]
    buffer_load_dwordx4 v5, s[52:55], s31 offen offset:0 lds
    v_mfma_f32_16x16x32_bf16 v[208:211], v[252:255], a[228:231], v[208:211]
    ds_read_b64_tr_b16 v[234:235], v13 offset:3072
    v_mul_f32 v166, v166, v198
    v_mfma_f32_16x16x32_bf16 v[208:211], v[248:251], a[212:215], v[208:211]
    ds_read_b64_tr_b16 v[236:237], v13 offset:1024
    v_mul_f32 v167, v167, v199
    v_mfma_f32_16x16x32_bf16 v[208:211], v[244:247], a[196:199], v[208:211]
    s_add_u32 s31, s57, 1024
    ds_read_b64_tr_b16 v[238:239], v13 offset:4096
    v_mfma_f32_16x16x32_bf16 v[212:215], v[244:247], a[200:203], v[212:215]
    buffer_load_dwordx4 v5, s[52:55], s31 offen offset:1024 lds
    v_mfma_f32_16x16x32_bf16 v[212:215], v[248:251], a[216:219], v[212:215]
    ds_read_b64_tr_b16 v[240:241], v13 offset:2048
    v_cvt_pk_bf16_f32 v38, v164, v165
    v_mfma_f32_16x16x32_bf16 v[212:215], v[252:255], a[232:235], v[212:215]
    ds_read_b64_tr_b16 v[242:243], v13 offset:5120
    v_cvt_pk_bf16_f32 v39, v166, v167
    v_mfma_f32_16x16x32_bf16 v[216:219], v[252:255], a[236:239], v[216:219]
    s_add_u32 s31, s57, 128
    ds_read_b128 a[32:35], v16 offset:16384
    v_mfma_f32_16x16x32_bf16 v[216:219], v[248:251], a[220:223], v[216:219]
    buffer_load_dwordx4 v5, s[52:55], s31 offen offset:2048 lds
    v_mfma_f32_16x16x32_bf16 v[216:219], v[244:247], a[204:207], v[216:219]
    ds_read_b64_tr_b16 v[244:245], v13 offset:6144
    v_mfma_f32_16x16x32_bf16 v[88:91], v[220:223], a[204:207], v[88:91]
    ds_read_b64_tr_b16 v[246:247], v13 offset:9216
    v_mfma_f32_16x16x32_bf16 v[88:91], v[224:227], a[220:223], v[88:91]
    ds_read_b64_tr_b16 v[248:249], v13 offset:7168
    v_mfma_f32_16x16x32_bf16 v[88:91], v[228:231], a[236:239], v[88:91]
    s_add_u32 m0, s29, 0
    s_add_u32 s44, s6, 0
    v_mfma_f32_16x16x32_bf16 v[84:87], v[228:231], a[232:235], v[84:87]
    buffer_load_dwordx4 v2, s[64:67], s44 offen offset:0 sc1 lds
    v_mfma_f32_16x16x32_bf16 v[84:87], v[224:227], a[216:219], v[84:87]
    ds_read_b64_tr_b16 v[250:251], v13 offset:10240
    v_mfma_f32_16x16x32_bf16 v[84:87], v[220:223], a[200:203], v[84:87]
    ds_read_b64_tr_b16 v[252:253], v13 offset:8192
    v_mfma_f32_16x16x32_bf16 v[80:83], v[220:223], a[196:199], v[80:83]
    ds_read_b64_tr_b16 v[254:255], v13 offset:11264
    v_mfma_f32_16x16x32_bf16 v[80:83], v[224:227], a[212:215], v[80:83]
    buffer_load_dwordx4 v2, s[64:67], s44 offen offset:1024 sc1 lds
    v_mfma_f32_16x16x32_bf16 v[80:83], v[228:231], a[228:231], v[80:83]
    ds_read_b128 a[36:39], v16 offset:17408
    ds_read_b128 a[40:43], v16 offset:18432
    ds_read_b128 a[44:47], v16 offset:19456
    ds_read_b128 a[48:51], v16 offset:24576
    ds_read_b128 a[52:55], v16 offset:25600
    ds_read_b128 a[56:59], v16 offset:26624
    ds_read_b128 a[60:63], v16 offset:27648
    v_mfma_f32_16x16x32_bf16 v[76:79], v[228:231], a[224:227], v[76:79]
    ds_write_b128 v14, v[36:39] offset:51200
    v_mfma_f32_16x16x32_bf16 v[76:79], v[224:227], a[208:211], v[76:79]
    s_add_u32 s45, s3, 49152
    v_mfma_f32_16x16x32_bf16 v[76:79], v[220:223], a[192:195], v[76:79]
    buffer_store_dwordx4 v[36:39], v2, s[64:67], s45 offen offset:2048 sc1
    v_max_f32 v152, 0, v152
    v_max_f32 v153, 0, v153
    v_max_f32 v154, 0, v154
    v_max_f32 v155, 0, v155
    v_mul_f32 v152, v152, v184
    v_mul_f32 v153, v153, v185
    v_mul_f32 v154, v154, v186
    v_mul_f32 v155, v155, v187
    s_waitcnt vmcnt(21) lgkmcnt(0)
    s_barrier
    v_mfma_f32_16x16x32_bf16 v[204:207], v[232:235], a[240:243], v[204:207]
    ds_read_b64_tr_b16 v[220:221], v10 offset:12288
    v_mfma_f32_16x16x32_bf16 v[204:207], v[236:239], v[44:47], v[204:207]
    s_add_u32 m0, s30, 49152
    s_add_u32 s31, s57, 38912
    v_mfma_f32_16x16x32_bf16 v[204:207], v[240:243], v[60:63], v[204:207]
    buffer_load_dwordx4 v5, s[52:55], s31 offen offset:0 lds
    v_mfma_f32_16x16x32_bf16 v[208:211], v[240:243], v[64:67], v[208:211]
    ds_read_b64_tr_b16 v[222:223], v10 offset:18432
    v_cvt_pk_bf16_f32 v40, v152, v153
    v_mfma_f32_16x16x32_bf16 v[208:211], v[236:239], v[48:51], v[208:211]
    ds_read_b64_tr_b16 v[224:225], v11 offset:12288
    v_cvt_pk_bf16_f32 v41, v154, v155
    v_mfma_f32_16x16x32_bf16 v[208:211], v[232:235], a[244:247], v[208:211]
    s_add_u32 s31, s57, 38016
    ds_read_b64_tr_b16 v[226:227], v11 offset:18432
    v_mfma_f32_16x16x32_bf16 v[212:215], v[232:235], a[248:251], v[212:215]
    buffer_load_dwordx4 v5, s[52:55], s31 offen offset:1024 lds
    v_mfma_f32_16x16x32_bf16 v[212:215], v[236:239], v[52:55], v[212:215]
    ds_read_b64_tr_b16 v[228:229], v10 offset:13312
    v_max_f32 v168, 0, v168
    v_mfma_f32_16x16x32_bf16 v[212:215], v[240:243], v[68:71], v[212:215]
    ds_read_b64_tr_b16 v[230:231], v10 offset:19456
    v_max_f32 v169, 0, v169
    v_mfma_f32_16x16x32_bf16 v[216:219], v[240:243], v[72:75], v[216:219]
    s_add_u32 s31, s57, 73728
    ds_read_b128 a[64:67], v17 offset:0
    v_mfma_f32_16x16x32_bf16 v[216:219], v[236:239], v[56:59], v[216:219]
    buffer_load_dwordx4 v5, s[52:55], s31 offen offset:2048 lds
    v_mfma_f32_16x16x32_bf16 v[216:219], v[232:235], a[252:255], v[216:219]
    ds_read_b64_tr_b16 v[232:233], v11 offset:13312
    v_max_f32 v170, 0, v170
    v_mfma_f32_16x16x32_bf16 v[88:91], v[244:247], a[252:255], v[88:91]
    ds_read_b64_tr_b16 v[234:235], v11 offset:19456
    v_max_f32 v171, 0, v171
    v_mfma_f32_16x16x32_bf16 v[88:91], v[248:251], v[56:59], v[88:91]
    ds_read_b64_tr_b16 v[236:237], v10 offset:14336
    v_mul_f32 v168, v168, v200
    v_mfma_f32_16x16x32_bf16 v[88:91], v[252:255], v[72:75], v[88:91]
    s_add_u32 m0, s29, 8192
    s_add_u32 s44, s6, 8192
    v_mfma_f32_16x16x32_bf16 v[84:87], v[252:255], v[68:71], v[84:87]
    buffer_load_dwordx4 v2, s[64:67], s44 offen offset:0 sc1 lds
    v_mfma_f32_16x16x32_bf16 v[84:87], v[248:251], v[52:55], v[84:87]
    ds_read_b64_tr_b16 v[238:239], v10 offset:20480
    v_mul_f32 v169, v169, v201
    v_mfma_f32_16x16x32_bf16 v[84:87], v[244:247], a[248:251], v[84:87]
    ds_read_b64_tr_b16 v[240:241], v11 offset:14336
    v_mul_f32 v170, v170, v202
    v_mfma_f32_16x16x32_bf16 v[80:83], v[244:247], a[244:247], v[80:83]
    ds_read_b64_tr_b16 v[242:243], v11 offset:20480
    v_mul_f32 v171, v171, v203
    v_mfma_f32_16x16x32_bf16 v[80:83], v[248:251], v[48:51], v[80:83]
    buffer_load_dwordx4 v2, s[64:67], s44 offen offset:1024 sc1 lds
    v_mfma_f32_16x16x32_bf16 v[80:83], v[252:255], v[64:67], v[80:83]
    ds_read_b128 a[68:71], v17 offset:1024
    ds_read_b128 a[72:75], v17 offset:2048
    ds_read_b128 a[76:79], v17 offset:3072
    ds_read_b128 a[80:83], v17 offset:8192
    ds_read_b128 a[84:87], v17 offset:9216
    ds_read_b128 a[88:91], v17 offset:10240
    ds_read_b128 a[92:95], v17 offset:11264
    v_mfma_f32_16x16x32_bf16 v[76:79], v[252:255], v[60:63], v[76:79]
    v_cvt_pk_bf16_f32 v42, v168, v169
    v_cvt_pk_bf16_f32 v43, v170, v171
    v_mfma_f32_16x16x32_bf16 v[76:79], v[248:251], v[44:47], v[76:79]
    ds_write_b128 v14, v[40:43] offset:52224
    v_mfma_f32_16x16x32_bf16 v[76:79], v[244:247], a[240:243], v[76:79]
    s_add_u32 s45, s3, 49152
    buffer_store_dwordx4 v[40:43], v2, s[64:67], s45 offen offset:3072 sc1
    s_waitcnt vmcnt(24) lgkmcnt(0)
    s_barrier
    v_mfma_f32_16x16x32_bf16 v[108:111], v[224:227], a[0:3], 0
    ds_read_b64_tr_b16 v[244:245], v10 offset:24576
    v_mfma_f32_16x16x32_bf16 v[92:95], v[220:223], a[0:3], 0
    ds_read_b64_tr_b16 v[246:247], v10 offset:30720
    v_mfma_f32_16x16x32_bf16 v[96:99], v[220:223], a[4:7], 0
    s_add_u32 m0, s30, 61440
    s_add_u32 s31, s57, 75904
    v_mfma_f32_16x16x32_bf16 v[112:115], v[224:227], a[4:7], 0
    buffer_load_dwordx4 v5, s[52:55], s31 offen offset:0 lds
    v_mfma_f32_16x16x32_bf16 v[116:119], v[224:227], a[8:11], 0
    ds_read_b64_tr_b16 v[248:249], v11 offset:24576
    v_max_f32 v204, 0, v204
    v_mfma_f32_16x16x32_bf16 v[100:103], v[220:223], a[8:11], 0
    ds_read_b64_tr_b16 v[250:251], v11 offset:30720
    v_max_f32 v205, 0, v205
    v_mfma_f32_16x16x32_bf16 v[104:107], v[220:223], a[12:15], 0
    ds_read_b64_tr_b16 v[252:253], v10 offset:25600
    v_max_f32 v206, 0, v206
    v_mfma_f32_16x16x32_bf16 v[120:123], v[224:227], a[12:15], 0
    ds_read_b64_tr_b16 v[254:255], v10 offset:31744
    v_max_f32 v207, 0, v207
    v_mfma_f32_16x16x32_bf16 v[152:155], v[232:235], a[12:15], 0
    ds_read_b64_tr_b16 v[220:221], v11 offset:25600
    v_mul_f32 v204, v204, v76
    v_mfma_f32_16x16x32_bf16 v[136:139], v[228:231], a[12:15], 0
    s_add_u32 s31, s57, 111616
    ds_read_b64_tr_b16 v[222:223], v11 offset:31744
    v_mfma_f32_16x16x32_bf16 v[132:135], v[228:231], a[8:11], 0
    buffer_load_dwordx4 v5, s[52:55], s31 offen offset:1024 lds
    v_mfma_f32_16x16x32_bf16 v[148:151], v[232:235], a[8:11], 0
    ds_read_b64_tr_b16 v[224:225], v10 offset:26624
    v_mul_f32 v205, v205, v77
    v_mfma_f32_16x16x32_bf16 v[144:147], v[232:235], a[4:7], 0
    ds_read_b64_tr_b16 v[226:227], v10 offset:32768
    v_mul_f32 v206, v206, v78
    v_mfma_f32_16x16x32_bf16 v[128:131], v[228:231], a[4:7], 0
    v_mul_f32 v207, v207, v79
    v_cvt_pk_bf16_f32 v36, v204, v205
    v_mfma_f32_16x16x32_bf16 v[124:127], v[228:231], a[0:3], 0
    ds_read_b64_tr_b16 v[228:229], v11 offset:26624
    v_cvt_pk_bf16_f32 v37, v206, v207
    v_mfma_f32_16x16x32_bf16 v[140:143], v[232:235], a[0:3], 0
    ds_read_b64_tr_b16 v[230:231], v11 offset:32768
    v_mfma_f32_16x16x32_bf16 v[108:111], v[240:243], a[16:19], v[108:111]
    s_add_u32 s31, s57, 110720
    v_mfma_f32_16x16x32_bf16 v[92:95], v[236:239], a[16:19], v[92:95]
    buffer_load_dwordx4 v5, s[52:55], s31 offen offset:2048 lds
    v_mfma_f32_16x16x32_bf16 v[96:99], v[236:239], a[20:23], v[96:99]
    ds_write_b64 v15, v[36:37] offset:0
    v_mfma_f32_16x16x32_bf16 v[112:115], v[240:243], a[20:23], v[112:115]
    v_max_f32 v208, 0, v208
    v_max_f32 v209, 0, v209
    v_mfma_f32_16x16x32_bf16 v[116:119], v[240:243], a[24:27], v[116:119]
    v_max_f32 v210, 0, v210
    v_max_f32 v211, 0, v211
    v_mfma_f32_16x16x32_bf16 v[100:103], v[236:239], a[24:27], v[100:103]
    v_mul_f32 v208, v208, v80
    v_mul_f32 v209, v209, v81
    v_mfma_f32_16x16x32_bf16 v[104:107], v[236:239], a[28:31], v[104:107]
    v_mul_f32 v210, v210, v82
    v_mul_f32 v211, v211, v83
    v_mfma_f32_16x16x32_bf16 v[120:123], v[240:243], a[28:31], v[120:123]
    v_cvt_pk_bf16_f32 v38, v208, v209
    v_cvt_pk_bf16_f32 v39, v210, v211
    ds_write_b64 v15, v[38:39] offset:1024
    v_max_f32 v212, 0, v212
    v_max_f32 v213, 0, v213
    v_max_f32 v214, 0, v214
    v_max_f32 v215, 0, v215
    v_mul_f32 v212, v212, v84
    v_mul_f32 v213, v213, v85
    v_mul_f32 v214, v214, v86
    v_mul_f32 v215, v215, v87
    v_cvt_pk_bf16_f32 v40, v212, v213
    v_cvt_pk_bf16_f32 v41, v214, v215
    ds_write_b64 v15, v[40:41] offset:2048
    v_max_f32 v216, 0, v216
    v_max_f32 v217, 0, v217
    v_max_f32 v218, 0, v218
    v_max_f32 v219, 0, v219
    v_mul_f32 v216, v216, v88
    v_mul_f32 v217, v217, v89
    v_mul_f32 v218, v218, v90
    v_mul_f32 v219, v219, v91
    v_cvt_pk_bf16_f32 v42, v216, v217
    v_cvt_pk_bf16_f32 v43, v218, v219
    ds_write_b64 v15, v[42:43] offset:3072
    s_waitcnt vmcnt(24) lgkmcnt(0)
    s_barrier
    v_mfma_f32_16x16x32_bf16 v[152:155], v[248:251], a[28:31], v[152:155]
    ds_read_b64_tr_b16 v[232:233], v8 offset:0
    ds_read_b128 a[96:99], v17 offset:16384
    v_mfma_f32_16x16x32_bf16 v[136:139], v[244:247], a[28:31], v[136:139]
    s_add_u32 m0, s30, 73728
    s_add_u32 s31, s57, 149504
    v_mfma_f32_16x16x32_bf16 v[132:135], v[244:247], a[24:27], v[132:135]
    buffer_load_dwordx4 v5, s[52:55], s31 offen offset:0 lds
    v_mfma_f32_16x16x32_bf16 v[148:151], v[248:251], a[24:27], v[148:151]
    ds_read_b64_tr_b16 v[234:235], v8 offset:6144
    ds_read_b128 a[100:103], v17 offset:17408
    v_mfma_f32_16x16x32_bf16 v[144:147], v[248:251], a[20:23], v[144:147]
    s_add_u32 s31, s57, 148608
    ds_read_b64_tr_b16 v[236:237], v9 offset:0
    v_mfma_f32_16x16x32_bf16 v[128:131], v[244:247], a[20:23], v[128:131]
    buffer_load_dwordx4 v5, s[52:55], s31 offen offset:1024 lds
    v_mfma_f32_16x16x32_bf16 v[124:127], v[244:247], a[16:19], v[124:127]
    ds_read_b64_tr_b16 v[238:239], v9 offset:6144
    ds_read_b128 a[104:107], v17 offset:18432
    v_mfma_f32_16x16x32_bf16 v[140:143], v[248:251], a[16:19], v[140:143]
    s_add_u32 s31, s57, 184320
    ds_read_b64_tr_b16 v[240:241], v8 offset:1024
    v_mfma_f32_16x16x32_bf16 v[108:111], v[220:223], a[32:35], v[108:111]
    buffer_load_dwordx4 v5, s[52:55], s31 offen offset:2048 lds
    v_mfma_f32_16x16x32_bf16 v[92:95], v[252:255], a[32:35], v[92:95]
    ds_read_b64_tr_b16 v[242:243], v8 offset:7168
k4_kernel_pg1_5:
    s_cbranch_execz k4_kernel_back1
    ds_read_b128 a[108:111], v17 offset:19456
    v_mfma_f32_16x16x32_bf16 v[96:99], v[252:255], a[36:39], v[96:99]
    s_add_u32 m0, s29, 16384
    s_add_u32 s44, s6, 16384
    v_mfma_f32_16x16x32_bf16 v[112:115], v[220:223], a[36:39], v[112:115]
    buffer_load_dwordx4 v2, s[64:67], s44 offen offset:0 sc1 lds
    v_mfma_f32_16x16x32_bf16 v[116:119], v[220:223], a[40:43], v[116:119]
    ds_read_b64_tr_b16 v[244:245], v9 offset:1024
    ds_read_b128 v[36:39], v18 offset:0
    v_mfma_f32_16x16x32_bf16 v[100:103], v[252:255], a[40:43], v[100:103]
    ds_read_b64_tr_b16 v[246:247], v9 offset:7168
    ds_read_b128 v[40:43], v18 offset:1024
    v_mfma_f32_16x16x32_bf16 v[104:107], v[252:255], a[44:47], v[104:107]
    buffer_load_dwordx4 v2, s[64:67], s44 offen offset:1024 sc1 lds
    v_mfma_f32_16x16x32_bf16 v[120:123], v[220:223], a[44:47], v[120:123]
    ds_read_b64_tr_b16 v[248:249], v8 offset:2048
    v_mfma_f32_16x16x32_bf16 v[152:155], v[228:231], a[44:47], v[152:155]
    s_add_u32 m0, s29, 24576
    s_add_u32 s44, s6, 24576
    v_mfma_f32_16x16x32_bf16 v[136:139], v[224:227], a[44:47], v[136:139]
    buffer_load_dwordx4 v2, s[64:67], s44 offen offset:0 sc1 lds
    v_mfma_f32_16x16x32_bf16 v[132:135], v[224:227], a[40:43], v[132:135]
    ds_read_b64_tr_b16 v[250:251], v8 offset:8192
    v_mfma_f32_16x16x32_bf16 v[148:151], v[228:231], a[40:43], v[148:151]
    ds_read_b64_tr_b16 v[252:253], v9 offset:2048
    ds_read_b64_tr_b16 v[254:255], v9 offset:8192
    v_mfma_f32_16x16x32_bf16 v[144:147], v[228:231], a[36:39], v[144:147]
    buffer_load_dwordx4 v2, s[64:67], s44 offen offset:1024 sc1 lds
    v_mfma_f32_16x16x32_bf16 v[128:131], v[224:227], a[36:39], v[128:131]
    v_mfma_f32_16x16x32_bf16 v[124:127], v[224:227], a[32:35], v[124:127]
    v_mfma_f32_16x16x32_bf16 v[140:143], v[228:231], a[32:35], v[140:143]
    s_waitcnt vmcnt(26) lgkmcnt(0)
    s_barrier
    v_mfma_f32_16x16x32_bf16 v[108:111], v[236:239], a[48:51], v[108:111]
    ds_read_b64_tr_b16 v[220:221], v8 offset:12288
    v_mfma_f32_16x16x32_bf16 v[92:95], v[232:235], a[48:51], v[92:95]
    s_add_u32 m0, s30, 0
    s_add_u32 s31, s57, 186496
    v_mfma_f32_16x16x32_bf16 v[96:99], v[232:235], a[52:55], v[96:99]
    buffer_load_dwordx4 v5, s[52:55], s31 offen offset:0 lds
    v_mfma_f32_16x16x32_bf16 v[112:115], v[236:239], a[52:55], v[112:115]
    ds_read_b64_tr_b16 v[222:223], v8 offset:18432
    s_add_u32 s45, s7, 65536
    v_mfma_f32_16x16x32_bf16 v[116:119], v[236:239], a[56:59], v[116:119]
    ds_read_b64_tr_b16 v[224:225], v9 offset:12288
    v_mfma_f32_16x16x32_bf16 v[100:103], v[232:235], a[56:59], v[100:103]
    s_add_u32 s31, s58, 1024
    ds_read_b64_tr_b16 v[226:227], v9 offset:18432
    v_mfma_f32_16x16x32_bf16 v[104:107], v[232:235], a[60:63], v[104:107]
    buffer_load_dwordx4 v5, s[52:55], s31 offen offset:1024 lds
    v_mfma_f32_16x16x32_bf16 v[120:123], v[236:239], a[60:63], v[120:123]
    ds_read_b64_tr_b16 v[228:229], v8 offset:13312
    v_mfma_f32_16x16x32_bf16 v[152:155], v[244:247], a[60:63], v[152:155]
    ds_read_b64_tr_b16 v[230:231], v8 offset:19456
    v_mfma_f32_16x16x32_bf16 v[136:139], v[240:243], a[60:63], v[136:139]
    s_add_u32 s31, s58, 128
    ds_read_b64_tr_b16 v[232:233], v9 offset:13312
    v_mfma_f32_16x16x32_bf16 v[132:135], v[240:243], a[56:59], v[132:135]
    buffer_load_dwordx4 v5, s[52:55], s31 offen offset:2048 lds
    v_mfma_f32_16x16x32_bf16 v[148:151], v[244:247], a[56:59], v[148:151]
    ds_read_b64_tr_b16 v[234:235], v9 offset:19456
    v_mfma_f32_16x16x32_bf16 v[144:147], v[244:247], a[52:55], v[144:147]
    ds_read_b64_tr_b16 v[236:237], v8 offset:14336
    v_mfma_f32_16x16x32_bf16 v[128:131], v[240:243], a[52:55], v[128:131]
    ds_read_b64_tr_b16 v[238:239], v8 offset:20480
    v_mfma_f32_16x16x32_bf16 v[124:127], v[240:243], a[48:51], v[124:127]
    s_add_u32 m0, s29, 32768
    s_add_u32 s44, s6, 32768
    v_mfma_f32_16x16x32_bf16 v[140:143], v[244:247], a[48:51], v[140:143]
    buffer_load_dwordx4 v2, s[64:67], s44 offen offset:0 sc1 lds
    v_mfma_f32_16x16x32_bf16 v[108:111], v[252:255], a[64:67], v[108:111]
    ds_read_b64_tr_b16 v[240:241], v9 offset:14336
    v_mfma_f32_16x16x32_bf16 v[92:95], v[248:251], a[64:67], v[92:95]
    ds_read_b64_tr_b16 v[242:243], v9 offset:20480
    v_mfma_f32_16x16x32_bf16 v[96:99], v[248:251], a[68:71], v[96:99]
    ds_read_b128 a[112:115], v17 offset:24576
    v_mfma_f32_16x16x32_bf16 v[112:115], v[252:255], a[68:71], v[112:115]
    buffer_load_dwordx4 v2, s[64:67], s44 offen offset:1024 sc1 lds
    v_mfma_f32_16x16x32_bf16 v[116:119], v[252:255], a[72:75], v[116:119]
    ds_read_b128 a[116:119], v17 offset:25600
    ds_read_b128 a[120:123], v17 offset:26624
    ds_read_b128 a[124:127], v17 offset:27648
    v_mfma_f32_16x16x32_bf16 v[100:103], v[248:251], a[72:75], v[100:103]
    buffer_store_dwordx4 v[36:39], v2, s[64:67], s45 offen offset:0 sc1
    v_mfma_f32_16x16x32_bf16 v[104:107], v[248:251], a[76:79], v[104:107]
    buffer_store_dwordx4 v[40:43], v2, s[64:67], s45 offen offset:1024 sc1
    v_mfma_f32_16x16x32_bf16 v[120:123], v[252:255], a[76:79], v[120:123]
    s_waitcnt vmcnt(29) lgkmcnt(0)
    s_barrier
    v_mfma_f32_16x16x32_bf16 v[152:155], v[224:227], a[76:79], v[152:155]
    ds_read_b64_tr_b16 v[244:245], v8 offset:24576
    v_mfma_f32_16x16x32_bf16 v[136:139], v[220:223], a[76:79], v[136:139]
    s_add_u32 m0, s30, 12288
    s_add_u32 s31, s56, 2304
    v_mfma_f32_16x16x32_bf16 v[132:135], v[220:223], a[72:75], v[132:135]
    buffer_load_dwordx4 v5, s[52:55], s31 offen offset:0 lds
    v_mfma_f32_16x16x32_bf16 v[148:151], v[224:227], a[72:75], v[148:151]
    ds_read_b64_tr_b16 v[246:247], v8 offset:30720
    v_mfma_f32_16x16x32_bf16 v[144:147], v[224:227], a[68:71], v[144:147]
    ds_read_b64_tr_b16 v[248:249], v9 offset:24576
    v_mfma_f32_16x16x32_bf16 v[128:131], v[220:223], a[68:71], v[128:131]
    s_add_u32 s31, s56, 38144
    ds_read_b64_tr_b16 v[250:251], v9 offset:30720
    v_mfma_f32_16x16x32_bf16 v[124:127], v[220:223], a[64:67], v[124:127]
    buffer_load_dwordx4 v5, s[52:55], s31 offen offset:1024 lds
    v_mfma_f32_16x16x32_bf16 v[140:143], v[224:227], a[64:67], v[140:143]
    ds_read_b64_tr_b16 v[252:253], v8 offset:25600
    v_mfma_f32_16x16x32_bf16 v[108:111], v[232:235], a[80:83], v[108:111]
    ds_read_b64_tr_b16 v[254:255], v8 offset:31744
    v_mfma_f32_16x16x32_bf16 v[92:95], v[228:231], a[80:83], v[92:95]
    s_add_u32 s31, s56, 73984
    ds_read_b64_tr_b16 v[220:221], v9 offset:25600
    v_mfma_f32_16x16x32_bf16 v[96:99], v[228:231], a[84:87], v[96:99]
    buffer_load_dwordx4 v5, s[52:55], s31 offen offset:2048 lds
    v_mfma_f32_16x16x32_bf16 v[112:115], v[232:235], a[84:87], v[112:115]
    ds_read_b64_tr_b16 v[222:223], v9 offset:31744
    v_mfma_f32_16x16x32_bf16 v[116:119], v[232:235], a[88:91], v[116:119]
    ds_read_b64_tr_b16 v[224:225], v8 offset:26624
    v_mfma_f32_16x16x32_bf16 v[100:103], v[228:231], a[88:91], v[100:103]
    ds_read_b64_tr_b16 v[226:227], v8 offset:32768
    v_mfma_f32_16x16x32_bf16 v[104:107], v[228:231], a[92:95], v[104:107]
    s_add_u32 m0, s29, 40960
    s_add_u32 s44, s6, 40960
    v_mfma_f32_16x16x32_bf16 v[120:123], v[232:235], a[92:95], v[120:123]
    buffer_load_dwordx4 v2, s[64:67], s44 offen offset:0 sc1 lds
    v_mfma_f32_16x16x32_bf16 v[152:155], v[240:243], a[92:95], v[152:155]
    ds_read_b64_tr_b16 v[228:229], v9 offset:26624
    v_mfma_f32_16x16x32_bf16 v[136:139], v[236:239], a[92:95], v[136:139]
    ds_read_b64_tr_b16 v[230:231], v9 offset:32768
    v_mfma_f32_16x16x32_bf16 v[132:135], v[236:239], a[88:91], v[132:135]
    ds_read_b128 a[128:131], v17 offset:32768
    v_mfma_f32_16x16x32_bf16 v[148:151], v[240:243], a[88:91], v[148:151]
    buffer_load_dwordx4 v2, s[64:67], s44 offen offset:1024 sc1 lds
    v_mfma_f32_16x16x32_bf16 v[144:147], v[240:243], a[84:87], v[144:147]
    ds_read_b128 a[132:135], v17 offset:33792
    ds_read_b128 a[136:139], v17 offset:34816
    ds_read_b128 a[140:143], v17 offset:35840
    v_mfma_f32_16x16x32_bf16 v[128:131], v[236:239], a[84:87], v[128:131]
    v_mfma_f32_16x16x32_bf16 v[124:127], v[236:239], a[80:83], v[124:127]
    v_mfma_f32_16x16x32_bf16 v[140:143], v[240:243], a[80:83], v[140:143]
    s_waitcnt vmcnt(5) lgkmcnt(0)
    s_barrier
    v_mfma_f32_16x16x32_bf16 v[108:111], v[248:251], a[96:99], v[108:111]
    ds_read_b64_tr_b16 v[232:233], v8 offset:36864
    v_mfma_f32_16x16x32_bf16 v[92:95], v[244:247], a[96:99], v[92:95]
    ds_read_b64_tr_b16 v[234:235], v8 offset:43008
    v_mfma_f32_16x16x32_bf16 v[96:99], v[244:247], a[100:103], v[96:99]
    s_add_u32 m0, s30, 24576
    s_add_u32 s31, s56, 112896
    v_mfma_f32_16x16x32_bf16 v[112:115], v[248:251], a[100:103], v[112:115]
    buffer_load_dwordx4 v5, s[52:55], s31 offen offset:0 lds
    v_mfma_f32_16x16x32_bf16 v[116:119], v[248:251], a[104:107], v[116:119]
    ds_read_b64_tr_b16 v[236:237], v9 offset:36864
    v_mfma_f32_16x16x32_bf16 v[100:103], v[244:247], a[104:107], v[100:103]
    ds_read_b64_tr_b16 v[238:239], v9 offset:43008
    v_mfma_f32_16x16x32_bf16 v[104:107], v[244:247], a[108:111], v[104:107]
    ds_read_b64_tr_b16 v[240:241], v8 offset:37888
    v_mfma_f32_16x16x32_bf16 v[120:123], v[248:251], a[108:111], v[120:123]
    s_add_u32 s31, s56, 148736
    ds_read_b64_tr_b16 v[242:243], v8 offset:44032
    v_mfma_f32_16x16x32_bf16 v[152:155], v[220:223], a[108:111], v[152:155]
    buffer_load_dwordx4 v5, s[52:55], s31 offen offset:1024 lds
    v_mfma_f32_16x16x32_bf16 v[136:139], v[252:255], a[108:111], v[136:139]
    ds_read_b64_tr_b16 v[244:245], v9 offset:37888
    v_mfma_f32_16x16x32_bf16 v[132:135], v[252:255], a[104:107], v[132:135]
    ds_read_b64_tr_b16 v[246:247], v9 offset:44032
    v_mfma_f32_16x16x32_bf16 v[148:151], v[220:223], a[104:107], v[148:151]
    ds_read_b64_tr_b16 v[248:249], v8 offset:38912
    v_mfma_f32_16x16x32_bf16 v[144:147], v[220:223], a[100:103], v[144:147]
    s_add_u32 s31, s56, 184576
    ds_read_b64_tr_b16 v[250:251], v8 offset:45056
    v_mfma_f32_16x16x32_bf16 v[128:131], v[252:255], a[100:103], v[128:131]
    buffer_load_dwordx4 v5, s[52:55], s31 offen offset:2048 lds
    v_mfma_f32_16x16x32_bf16 v[124:127], v[252:255], a[96:99], v[124:127]
    ds_read_b64_tr_b16 v[252:253], v9 offset:38912
    v_mfma_f32_16x16x32_bf16 v[140:143], v[220:223], a[96:99], v[140:143]
    ds_read_b64_tr_b16 v[254:255], v9 offset:45056
    v_mfma_f32_16x16x32_bf16 v[108:111], v[228:231], a[112:115], v[108:111]
    ds_read_b128 a[144:147], v16 offset:0
    v_mfma_f32_16x16x32_bf16 v[92:95], v[224:227], a[112:115], v[92:95]
    v_mov_b32 v20, 2
    ds_read_b128 a[148:151], v16 offset:1024
    v_mfma_f32_16x16x32_bf16 v[96:99], v[224:227], a[116:119], v[96:99]
    buffer_store_dword v20, v3, s[68:71], s76 offen sc1
    v_mfma_f32_16x16x32_bf16 v[112:115], v[228:231], a[116:119], v[112:115]
    ds_read_b128 a[152:155], v16 offset:2048
    v_mfma_f32_16x16x32_bf16 v[116:119], v[228:231], a[120:123], v[116:119]
    ds_read_b128 a[156:159], v16 offset:3072
    v_mfma_f32_16x16x32_bf16 v[100:103], v[224:227], a[120:123], v[100:103]
    v_mfma_f32_16x16x32_bf16 v[104:107], v[224:227], a[124:127], v[104:107]
    v_mfma_f32_16x16x32_bf16 v[120:123], v[228:231], a[124:127], v[120:123]
    s_waitcnt vmcnt(18) lgkmcnt(0)
    s_barrier
    v_mfma_f32_16x16x32_bf16 v[152:155], v[236:239], a[124:127], v[152:155]
    ds_read_b64_tr_b16 v[220:221], v10 offset:0
    v_mfma_f32_16x16x32_bf16 v[136:139], v[232:235], a[124:127], v[136:139]
    ds_read_b64_tr_b16 v[222:223], v10 offset:6144
    v_mfma_f32_16x16x32_bf16 v[132:135], v[232:235], a[120:123], v[132:135]
    s_add_u32 m0, s30, 36864
    s_add_u32 s31, s57, 223232
    v_mfma_f32_16x16x32_bf16 v[148:151], v[236:239], a[120:123], v[148:151]
    buffer_load_dwordx4 v5, s[52:55], s31 offen offset:0 lds
    v_mfma_f32_16x16x32_bf16 v[144:147], v[236:239], a[116:119], v[144:147]
    ds_read_b64_tr_b16 v[224:225], v11 offset:0
    v_mfma_f32_16x16x32_bf16 v[128:131], v[232:235], a[116:119], v[128:131]
    ds_read_b64_tr_b16 v[226:227], v11 offset:6144
    v_mfma_f32_16x16x32_bf16 v[124:127], v[232:235], a[112:115], v[124:127]
    ds_read_b64_tr_b16 v[228:229], v10 offset:1024
    v_mfma_f32_16x16x32_bf16 v[140:143], v[236:239], a[112:115], v[140:143]
    ds_read_b64_tr_b16 v[230:231], v10 offset:7168
    v_mfma_f32_16x16x32_bf16 v[108:111], v[244:247], a[144:147], v[108:111]
    ds_read_b64_tr_b16 v[232:233], v11 offset:1024
    v_mfma_f32_16x16x32_bf16 v[92:95], v[240:243], a[144:147], v[92:95]
    s_add_u32 s31, s57, 222336
    ds_read_b64_tr_b16 v[234:235], v11 offset:7168
    v_mfma_f32_16x16x32_bf16 v[96:99], v[240:243], a[148:151], v[96:99]
    buffer_load_dwordx4 v5, s[52:55], s31 offen offset:1024 lds
    v_mfma_f32_16x16x32_bf16 v[112:115], v[244:247], a[148:151], v[112:115]
    ds_read_b64_tr_b16 v[236:237], v10 offset:2048
    v_mfma_f32_16x16x32_bf16 v[116:119], v[244:247], a[152:155], v[116:119]
    ds_read_b64_tr_b16 v[238:239], v10 offset:8192
    v_mfma_f32_16x16x32_bf16 v[100:103], v[240:243], a[152:155], v[100:103]
    ds_read_b128 a[160:163], v16 offset:8192
    v_mfma_f32_16x16x32_bf16 v[104:107], v[240:243], a[156:159], v[104:107]
    ds_read_b64_tr_b16 v[240:241], v11 offset:2048
    v_mfma_f32_16x16x32_bf16 v[120:123], v[244:247], a[156:159], v[120:123]
    ds_read_b64_tr_b16 v[242:243], v11 offset:8192
    v_mfma_f32_16x16x32_bf16 v[152:155], v[252:255], a[156:159], v[152:155]
    s_add_u32 s31, s57, 258048
    ds_read_b128 a[164:167], v16 offset:9216
    v_mfma_f32_16x16x32_bf16 v[136:139], v[248:251], a[156:159], v[136:139]
    buffer_load_dwordx4 v5, s[52:55], s31 offen offset:2048 lds
    v_mfma_f32_16x16x32_bf16 v[132:135], v[248:251], a[152:155], v[132:135]
    ds_read_b128 a[168:171], v16 offset:10240
    v_mfma_f32_16x16x32_bf16 v[148:151], v[252:255], a[152:155], v[148:151]
    ds_read_b128 a[172:175], v16 offset:11264
    v_mfma_f32_16x16x32_bf16 v[144:147], v[252:255], a[148:151], v[144:147]
    ds_read_b128 a[176:179], v16 offset:16384
    ds_read_b128 a[180:183], v16 offset:17408
    ds_read_b128 a[184:187], v16 offset:18432
    ds_read_b128 a[188:191], v16 offset:19456
    v_mfma_f32_16x16x32_bf16 v[128:131], v[248:251], a[148:151], v[128:131]
    v_mfma_f32_16x16x32_bf16 v[124:127], v[248:251], a[144:147], v[124:127]
    v_mfma_f32_16x16x32_bf16 v[140:143], v[252:255], a[144:147], v[140:143]
    s_waitcnt vmcnt(19) lgkmcnt(0)
    s_barrier
    v_mfma_f32_16x16x32_bf16 v[108:111], v[224:227], a[160:163], v[108:111]
    ds_read_b64_tr_b16 v[244:245], v10 offset:12288
    v_mfma_f32_16x16x32_bf16 v[92:95], v[220:223], a[160:163], v[92:95]
    ds_read_b64_tr_b16 v[246:247], v10 offset:18432
    v_mfma_f32_16x16x32_bf16 v[96:99], v[220:223], a[164:167], v[96:99]
    s_add_u32 m0, s30, 49152
    s_add_u32 s31, s57, 260224
    v_mfma_f32_16x16x32_bf16 v[112:115], v[224:227], a[164:167], v[112:115]
    buffer_load_dwordx4 v5, s[52:55], s31 offen offset:0 lds
    v_mfma_f32_16x16x32_bf16 v[116:119], v[224:227], a[168:171], v[116:119]
    ds_read_b64_tr_b16 v[248:249], v11 offset:12288
    v_mfma_f32_16x16x32_bf16 v[100:103], v[220:223], a[168:171], v[100:103]
    ds_read_b64_tr_b16 v[250:251], v11 offset:18432
    v_mfma_f32_16x16x32_bf16 v[104:107], v[220:223], a[172:175], v[104:107]
    ds_read_b64_tr_b16 v[252:253], v10 offset:13312
    v_mfma_f32_16x16x32_bf16 v[120:123], v[224:227], a[172:175], v[120:123]
    s_add_u32 s31, s59, 1024
    ds_read_b64_tr_b16 v[254:255], v10 offset:19456
    v_mfma_f32_16x16x32_bf16 v[152:155], v[232:235], a[172:175], v[152:155]
    buffer_load_dwordx4 v5, s[52:55], s31 offen offset:1024 lds
    v_mfma_f32_16x16x32_bf16 v[136:139], v[228:231], a[172:175], v[136:139]
    ds_read_b64_tr_b16 v[220:221], v11 offset:13312
    v_mfma_f32_16x16x32_bf16 v[132:135], v[228:231], a[168:171], v[132:135]
    ds_read_b64_tr_b16 v[222:223], v11 offset:19456
    v_mfma_f32_16x16x32_bf16 v[148:151], v[232:235], a[168:171], v[148:151]
    ds_read_b64_tr_b16 v[224:225], v10 offset:14336
    v_mfma_f32_16x16x32_bf16 v[144:147], v[232:235], a[164:167], v[144:147]
    s_add_u32 s31, s59, 128
    ds_read_b64_tr_b16 v[226:227], v10 offset:20480
    v_mfma_f32_16x16x32_bf16 v[128:131], v[228:231], a[164:167], v[128:131]
    buffer_load_dwordx4 v5, s[52:55], s31 offen offset:2048 lds
    v_mfma_f32_16x16x32_bf16 v[124:127], v[228:231], a[160:163], v[124:127]
    ds_read_b64_tr_b16 v[228:229], v11 offset:14336
    v_mfma_f32_16x16x32_bf16 v[140:143], v[232:235], a[160:163], v[140:143]
    ds_read_b64_tr_b16 v[230:231], v11 offset:20480
    v_mfma_f32_16x16x32_bf16 v[108:111], v[240:243], a[176:179], v[108:111]
    ds_read_b128 a[192:195], v16 offset:24576
    v_mfma_f32_16x16x32_bf16 v[92:95], v[236:239], a[176:179], v[92:95]
    ds_read_b128 a[196:199], v16 offset:25600
    v_mfma_f32_16x16x32_bf16 v[96:99], v[236:239], a[180:183], v[96:99]
    buffer_load_dword v19, v3, s[68:71], s77 offen sc1
    v_mfma_f32_16x16x32_bf16 v[112:115], v[240:243], a[180:183], v[112:115]
    ds_read_b128 a[200:203], v16 offset:26624
    v_mfma_f32_16x16x32_bf16 v[116:119], v[240:243], a[184:187], v[116:119]
    ds_read_b128 a[204:207], v16 offset:27648
    v_mfma_f32_16x16x32_bf16 v[100:103], v[236:239], a[184:187], v[100:103]
    v_mfma_f32_16x16x32_bf16 v[104:107], v[236:239], a[188:191], v[104:107]
    v_mfma_f32_16x16x32_bf16 v[120:123], v[240:243], a[188:191], v[120:123]
    s_waitcnt vmcnt(11) lgkmcnt(0)
    s_barrier
    v_mfma_f32_16x16x32_bf16 v[152:155], v[248:251], a[188:191], v[152:155]
    ds_read_b64_tr_b16 v[232:233], v10 offset:24576
    v_mfma_f32_16x16x32_bf16 v[136:139], v[244:247], a[188:191], v[136:139]
    ds_read_b64_tr_b16 v[234:235], v10 offset:30720
    v_mfma_f32_16x16x32_bf16 v[132:135], v[244:247], a[184:187], v[132:135]
    s_add_u32 m0, s30, 61440
    s_add_u32 s31, s56, 223488
    v_mfma_f32_16x16x32_bf16 v[148:151], v[248:251], a[184:187], v[148:151]
    buffer_load_dwordx4 v5, s[52:55], s31 offen offset:0 lds
    v_mfma_f32_16x16x32_bf16 v[144:147], v[248:251], a[180:183], v[144:147]
    ds_read_b64_tr_b16 v[236:237], v11 offset:24576
    v_mfma_f32_16x16x32_bf16 v[128:131], v[244:247], a[180:183], v[128:131]
    ds_read_b64_tr_b16 v[238:239], v11 offset:30720
    v_mfma_f32_16x16x32_bf16 v[124:127], v[244:247], a[176:179], v[124:127]
    ds_read_b64_tr_b16 v[240:241], v10 offset:25600
    v_mfma_f32_16x16x32_bf16 v[140:143], v[248:251], a[176:179], v[140:143]
    ds_read_b64_tr_b16 v[242:243], v10 offset:31744
    v_mfma_f32_16x16x32_bf16 v[108:111], v[220:223], a[192:195], v[108:111]
    ds_read_b64_tr_b16 v[244:245], v11 offset:25600
    v_mfma_f32_16x16x32_bf16 v[92:95], v[252:255], a[192:195], v[92:95]
    s_add_u32 s31, s56, 259328
    ds_read_b64_tr_b16 v[246:247], v11 offset:31744
    v_mfma_f32_16x16x32_bf16 v[96:99], v[252:255], a[196:199], v[96:99]
    buffer_load_dwordx4 v5, s[52:55], s31 offen offset:1024 lds
    v_mfma_f32_16x16x32_bf16 v[112:115], v[220:223], a[196:199], v[112:115]
    ds_read_b64_tr_b16 v[248:249], v10 offset:26624
    v_mfma_f32_16x16x32_bf16 v[116:119], v[220:223], a[200:203], v[116:119]
    ds_read_b64_tr_b16 v[250:251], v10 offset:32768
    v_mfma_f32_16x16x32_bf16 v[100:103], v[252:255], a[200:203], v[100:103]
    ds_read_b128 a[208:211], v17 offset:0
    v_mfma_f32_16x16x32_bf16 v[104:107], v[252:255], a[204:207], v[104:107]
    ds_read_b64_tr_b16 v[252:253], v11 offset:26624
    v_mfma_f32_16x16x32_bf16 v[120:123], v[220:223], a[204:207], v[120:123]
    ds_read_b64_tr_b16 v[254:255], v11 offset:32768
    v_mfma_f32_16x16x32_bf16 v[152:155], v[228:231], a[204:207], v[152:155]
    s_add_u32 s31, s58, 256
    ds_read_b128 a[212:215], v17 offset:1024
    v_mfma_f32_16x16x32_bf16 v[136:139], v[224:227], a[204:207], v[136:139]
    buffer_load_dwordx4 v5, s[52:55], s31 offen offset:2048 lds
    v_mfma_f32_16x16x32_bf16 v[132:135], v[224:227], a[200:203], v[132:135]
    ds_read_b128 a[216:219], v17 offset:2048
    v_mfma_f32_16x16x32_bf16 v[148:151], v[228:231], a[200:203], v[148:151]
    ds_read_b128 a[220:223], v17 offset:3072
    v_mfma_f32_16x16x32_bf16 v[144:147], v[228:231], a[196:199], v[144:147]
    ds_read_b128 a[224:227], v17 offset:8192
    ds_read_b128 a[228:231], v17 offset:9216
    ds_read_b128 a[232:235], v17 offset:10240
    ds_read_b128 a[236:239], v17 offset:11264
    v_mfma_f32_16x16x32_bf16 v[128:131], v[224:227], a[196:199], v[128:131]
    v_mfma_f32_16x16x32_bf16 v[124:127], v[224:227], a[192:195], v[124:127]
    v_mfma_f32_16x16x32_bf16 v[140:143], v[228:231], a[192:195], v[140:143]
    s_waitcnt vmcnt(3) lgkmcnt(0)
    s_barrier
    v_readfirstlane_b32 s18, v19
    s_nop 1
    s_cmp_lt_u32 s18, 2
    s_cbranch_scc1 k4_kernel_slow2
k4_kernel_ok2:
    v_mfma_f32_16x16x32_bf16 v[108:111], v[236:239], a[208:211], v[108:111]
    ds_read_b64_tr_b16 v[220:221], v8 offset:0
    v_mfma_f32_16x16x32_bf16 v[92:95], v[232:235], a[208:211], v[92:95]
    s_add_u32 m0, s30, 73728
    s_add_u32 s31, s57, 2304
    v_mfma_f32_16x16x32_bf16 v[96:99], v[232:235], a[212:215], v[96:99]
    buffer_load_dwordx4 v5, s[52:55], s31 offen offset:0 lds
    v_mfma_f32_16x16x32_bf16 v[112:115], v[236:239], a[212:215], v[112:115]
    ds_read_b64_tr_b16 v[222:223], v8 offset:6144
    v_mfma_f32_16x16x32_bf16 v[116:119], v[236:239], a[216:219], v[116:119]
    s_add_u32 s31, s57, 38144
    ds_read_b64_tr_b16 v[224:225], v9 offset:0
    v_mfma_f32_16x16x32_bf16 v[100:103], v[232:235], a[216:219], v[100:103]
    buffer_load_dwordx4 v5, s[52:55], s31 offen offset:1024 lds
    v_mfma_f32_16x16x32_bf16 v[104:107], v[232:235], a[220:223], v[104:107]
    ds_read_b64_tr_b16 v[226:227], v9 offset:6144
    v_mfma_f32_16x16x32_bf16 v[120:123], v[236:239], a[220:223], v[120:123]
    s_add_u32 s31, s57, 73984
    ds_read_b64_tr_b16 v[228:229], v8 offset:1024
    v_mfma_f32_16x16x32_bf16 v[152:155], v[244:247], a[220:223], v[152:155]
    buffer_load_dwordx4 v5, s[52:55], s31 offen offset:2048 lds
    v_mfma_f32_16x16x32_bf16 v[136:139], v[240:243], a[220:223], v[136:139]
    ds_read_b64_tr_b16 v[230:231], v8 offset:7168
    v_mfma_f32_16x16x32_bf16 v[132:135], v[240:243], a[216:219], v[132:135]
    s_add_u32 m0, s29, 49152
    s_add_u32 s44, s6, 49152
    v_mfma_f32_16x16x32_bf16 v[148:151], v[244:247], a[216:219], v[148:151]
    buffer_load_dwordx4 v2, s[64:67], s44 offen offset:0 sc1 lds
    v_mfma_f32_16x16x32_bf16 v[144:147], v[244:247], a[212:215], v[144:147]
    ds_read_b64_tr_b16 v[232:233], v9 offset:1024
    v_mfma_f32_16x16x32_bf16 v[128:131], v[240:243], a[212:215], v[128:131]
    ds_read_b64_tr_b16 v[234:235], v9 offset:7168
    v_mfma_f32_16x16x32_bf16 v[124:127], v[240:243], a[208:211], v[124:127]
    buffer_load_dwordx4 v2, s[64:67], s44 offen offset:1024 sc1 lds
    v_mfma_f32_16x16x32_bf16 v[140:143], v[244:247], a[208:211], v[140:143]
    ds_read_b64_tr_b16 v[236:237], v8 offset:2048
    v_mfma_f32_16x16x32_bf16 v[108:111], v[252:255], a[224:227], v[108:111]
    s_add_u32 m0, s29, 57344
    s_add_u32 s44, s6, 57344
    v_mfma_f32_16x16x32_bf16 v[92:95], v[248:251], a[224:227], v[92:95]
    buffer_load_dwordx4 v2, s[64:67], s44 offen offset:0 sc1 lds
    v_mfma_f32_16x16x32_bf16 v[96:99], v[248:251], a[228:231], v[96:99]
    ds_read_b64_tr_b16 v[238:239], v8 offset:8192
    v_mfma_f32_16x16x32_bf16 v[112:115], v[252:255], a[228:231], v[112:115]
    ds_read_b64_tr_b16 v[240:241], v9 offset:2048
    ds_read_b64_tr_b16 v[242:243], v9 offset:8192
    v_mfma_f32_16x16x32_bf16 v[116:119], v[252:255], a[232:235], v[116:119]
    buffer_load_dwordx4 v2, s[64:67], s44 offen offset:1024 sc1 lds
    v_mfma_f32_16x16x32_bf16 v[100:103], v[248:251], a[232:235], v[100:103]
    v_mfma_f32_16x16x32_bf16 v[104:107], v[248:251], a[236:239], v[104:107]
    v_mfma_f32_16x16x32_bf16 v[120:123], v[252:255], a[236:239], v[120:123]
    s_waitcnt vmcnt(23) lgkmcnt(0)
    s_barrier
    v_mfma_f32_16x16x32_bf16 v[152:155], v[224:227], a[236:239], v[152:155]
    ds_read_b64_tr_b16 v[244:245], v8 offset:12288
    v_mfma_f32_16x16x32_bf16 v[136:139], v[220:223], a[236:239], v[136:139]
    s_add_u32 m0, s30, 0
    s_add_u32 s31, s57, 112896
    v_mfma_f32_16x16x32_bf16 v[132:135], v[220:223], a[232:235], v[132:135]
    buffer_load_dwordx4 v5, s[52:55], s31 offen offset:0 lds
    v_mfma_f32_16x16x32_bf16 v[148:151], v[224:227], a[232:235], v[148:151]
    ds_read_b64_tr_b16 v[246:247], v8 offset:18432
    v_mfma_f32_16x16x32_bf16 v[144:147], v[224:227], a[228:231], v[144:147]
    ds_read_b64_tr_b16 v[248:249], v8 offset:13312
    v_mfma_f32_16x16x32_bf16 v[128:131], v[220:223], a[228:231], v[128:131]
    s_add_u32 s31, s57, 148736
    ds_read_b64_tr_b16 v[250:251], v8 offset:19456
    v_mfma_f32_16x16x32_bf16 v[124:127], v[220:223], a[224:227], v[124:127]
    buffer_load_dwordx4 v5, s[52:55], s31 offen offset:1024 lds
    v_mfma_f32_16x16x32_bf16 v[140:143], v[224:227], a[224:227], v[140:143]
    ds_read_b64_tr_b16 v[252:253], v8 offset:14336
    v_mfma_f32_16x16x32_bf16 v[108:111], v[232:235], a[128:131], v[108:111]
    ds_read_b64_tr_b16 v[254:255], v8 offset:20480
    v_mfma_f32_16x16x32_bf16 v[92:95], v[228:231], a[128:131], v[92:95]
    s_add_u32 s31, s57, 184576
    ds_read_b64_tr_b16 v[220:221], v9 offset:12288
    v_mfma_f32_16x16x32_bf16 v[96:99], v[228:231], a[132:135], v[96:99]
    buffer_load_dwordx4 v5, s[52:55], s31 offen offset:2048 lds
    v_mfma_f32_16x16x32_bf16 v[112:115], v[232:235], a[132:135], v[112:115]
    ds_read_b64_tr_b16 v[222:223], v9 offset:18432
    v_mfma_f32_16x16x32_bf16 v[116:119], v[232:235], a[136:139], v[116:119]
    ds_read_b64_tr_b16 v[224:225], v9 offset:13312
    v_mfma_f32_16x16x32_bf16 v[100:103], v[228:231], a[136:139], v[100:103]
    ds_read_b64_tr_b16 v[226:227], v9 offset:19456
    v_mfma_f32_16x16x32_bf16 v[104:107], v[228:231], a[140:143], v[104:107]
    s_add_u32 m0, s29, 65536
    s_add_u32 s44, s6, 65536
    v_mfma_f32_16x16x32_bf16 v[120:123], v[232:235], a[140:143], v[120:123]
    buffer_load_dwordx4 v2, s[64:67], s44 offen offset:0 sc1 lds
    v_mfma_f32_16x16x32_bf16 v[152:155], v[240:243], a[140:143], v[152:155]
    ds_read_b64_tr_b16 v[228:229], v9 offset:14336
    v_mfma_f32_16x16x32_bf16 v[136:139], v[236:239], a[140:143], v[136:139]
    ds_read_b64_tr_b16 v[230:231], v9 offset:20480
    v_mfma_f32_16x16x32_bf16 v[132:135], v[236:239], a[136:139], v[132:135]
    v_mfma_f32_16x16x32_bf16 v[148:151], v[240:243], a[136:139], v[148:151]
    buffer_load_dwordx4 v2, s[64:67], s44 offen offset:1024 sc1 lds
    v_mfma_f32_16x16x32_bf16 v[144:147], v[240:243], a[132:135], v[144:147]
    v_mfma_f32_16x16x32_bf16 v[128:131], v[236:239], a[132:135], v[128:131]
    v_mfma_f32_16x16x32_bf16 v[124:127], v[236:239], a[128:131], v[124:127]
    v_mfma_f32_16x16x32_bf16 v[140:143], v[240:243], a[128:131], v[140:143]
    s_waitcnt vmcnt(23) lgkmcnt(0)
    s_barrier
    v_mfma_f32_16x16x32_bf16 v[156:159], v[244:247], a[0:3], 0
    ds_read_b64_tr_b16 v[232:233], v8 offset:24576
    v_mfma_f32_16x16x32_bf16 v[156:159], v[248:251], a[16:19], v[156:159]
    ds_read_b64_tr_b16 v[234:235], v8 offset:30720
    v_mfma_f32_16x16x32_bf16 v[156:159], v[252:255], a[32:35], v[156:159]
    s_add_u32 m0, s30, 12288
    s_add_u32 s31, s57, 223488
    v_mfma_f32_16x16x32_bf16 v[160:163], v[252:255], a[36:39], 0
    buffer_load_dwordx4 v5, s[52:55], s31 offen offset:0 lds
    v_mfma_f32_16x16x32_bf16 v[160:163], v[248:251], a[20:23], v[160:163]
    ds_read_b64_tr_b16 v[236:237], v8 offset:25600
    v_mfma_f32_16x16x32_bf16 v[160:163], v[244:247], a[4:7], v[160:163]
    ds_read_b64_tr_b16 v[238:239], v8 offset:31744
    v_mfma_f32_16x16x32_bf16 v[164:167], v[244:247], a[8:11], 0
    ds_read_b64_tr_b16 v[240:241], v8 offset:26624
    v_mfma_f32_16x16x32_bf16 v[164:167], v[248:251], a[24:27], v[164:167]
    ds_read_b64_tr_b16 v[242:243], v8 offset:32768
    v_mfma_f32_16x16x32_bf16 v[164:167], v[252:255], a[40:43], v[164:167]
    v_mfma_f32_16x16x32_bf16 v[168:171], v[252:255], a[44:47], 0
    s_add_u32 s31, s57, 259328
    v_mfma_f32_16x16x32_bf16 v[168:171], v[248:251], a[28:31], v[168:171]
    buffer_load_dwordx4 v5, s[52:55], s31 offen offset:1024 lds
    v_mfma_f32_16x16x32_bf16 v[168:171], v[244:247], a[12:15], v[168:171]
    ds_read_b64_tr_b16 v[244:245], v9 offset:24576
    v_mfma_f32_16x16x32_bf16 v[184:187], v[220:223], a[12:15], 0
    ds_read_b64_tr_b16 v[246:247], v9 offset:30720
    v_mfma_f32_16x16x32_bf16 v[184:187], v[224:227], a[28:31], v[184:187]
    ds_read_b64_tr_b16 v[248:249], v9 offset:25600
    v_mfma_f32_16x16x32_bf16 v[184:187], v[228:231], a[44:47], v[184:187]
    ds_read_b64_tr_b16 v[250:251], v9 offset:31744
    v_mfma_f32_16x16x32_bf16 v[180:183], v[228:231], a[40:43], 0
    ds_read_b64_tr_b16 v[252:253], v9 offset:26624
    v_mfma_f32_16x16x32_bf16 v[180:183], v[224:227], a[24:27], v[180:183]
    s_add_u32 s31, s59, 256
    ds_read_b64_tr_b16 v[254:255], v9 offset:32768
    v_mfma_f32_16x16x32_bf16 v[180:183], v[220:223], a[8:11], v[180:183]
    buffer_load_dwordx4 v5, s[52:55], s31 offen offset:2048 lds
    v_mfma_f32_16x16x32_bf16 v[176:179], v[220:223], a[4:7], 0
    v_mfma_f32_16x16x32_bf16 v[176:179], v[224:227], a[20:23], v[176:179]
    v_mfma_f32_16x16x32_bf16 v[176:179], v[228:231], a[36:39], v[176:179]
    v_mfma_f32_16x16x32_bf16 v[172:175], v[228:231], a[32:35], 0
    v_mfma_f32_16x16x32_bf16 v[172:175], v[224:227], a[16:19], v[172:175]
    v_mfma_f32_16x16x32_bf16 v[172:175], v[220:223], a[0:3], v[172:175]
    s_waitcnt vmcnt(8) lgkmcnt(0)
    s_barrier
    v_mfma_f32_16x16x32_bf16 v[156:159], v[232:235], a[48:51], v[156:159]
    ds_read_b64_tr_b16 v[220:221], v8 offset:36864
    v_mfma_f32_16x16x32_bf16 v[156:159], v[236:239], a[64:67], v[156:159]
    ds_read_b64_tr_b16 v[222:223], v8 offset:43008
    v_mfma_f32_16x16x32_bf16 v[156:159], v[240:243], a[80:83], v[156:159]
    s_add_u32 m0, s30, 24576
    s_add_u32 s31, s56, 2432
    v_mfma_f32_16x16x32_bf16 v[160:163], v[240:243], a[84:87], v[160:163]
    buffer_load_dwordx4 v5, s[52:55], s31 offen offset:0 lds
    v_mfma_f32_16x16x32_bf16 v[160:163], v[236:239], a[68:71], v[160:163]
    ds_read_b64_tr_b16 v[224:225], v9 offset:36864
    v_mfma_f32_16x16x32_bf16 v[160:163], v[232:235], a[52:55], v[160:163]
    ds_read_b64_tr_b16 v[226:227], v9 offset:43008
    v_mfma_f32_16x16x32_bf16 v[164:167], v[232:235], a[56:59], v[164:167]
    ds_read_b64_tr_b16 v[228:229], v8 offset:37888
    v_mfma_f32_16x16x32_bf16 v[164:167], v[236:239], a[72:75], v[164:167]
    ds_read_b64_tr_b16 v[230:231], v8 offset:44032
    v_mfma_f32_16x16x32_bf16 v[164:167], v[240:243], a[88:91], v[164:167]
    ds_read_b128 a[240:243], v17 offset:16384
    v_mfma_f32_16x16x32_bf16 v[168:171], v[240:243], a[92:95], v[168:171]
    s_add_u32 s31, s56, 38272
    ds_read_b128 a[244:247], v17 offset:17408
    v_mfma_f32_16x16x32_bf16 v[168:171], v[236:239], a[76:79], v[168:171]
    buffer_load_dwordx4 v5, s[52:55], s31 offen offset:1024 lds
    v_mfma_f32_16x16x32_bf16 v[168:171], v[232:235], a[60:63], v[168:171]
k4_kernel_pg1_6:
    s_cbranch_execz k4_kernel_back1
    ds_read_b64_tr_b16 v[232:233], v9 offset:37888
    v_mfma_f32_16x16x32_bf16 v[184:187], v[244:247], a[60:63], v[184:187]
    ds_read_b64_tr_b16 v[234:235], v9 offset:44032
    v_mfma_f32_16x16x32_bf16 v[184:187], v[248:251], a[76:79], v[184:187]
    ds_read_b64_tr_b16 v[236:237], v8 offset:38912
    v_mfma_f32_16x16x32_bf16 v[184:187], v[252:255], a[92:95], v[184:187]
    ds_read_b64_tr_b16 v[238:239], v8 offset:45056
    v_mfma_f32_16x16x32_bf16 v[180:183], v[252:255], a[88:91], v[180:183]
    ds_read_b64_tr_b16 v[240:241], v9 offset:38912
    v_mfma_f32_16x16x32_bf16 v[180:183], v[248:251], a[72:75], v[180:183]
    s_add_u32 s31, s56, 74112
    ds_read_b64_tr_b16 v[242:243], v9 offset:45056
    v_mfma_f32_16x16x32_bf16 v[180:183], v[244:247], a[56:59], v[180:183]
    buffer_load_dwordx4 v5, s[52:55], s31 offen offset:2048 lds
    v_mfma_f32_16x16x32_bf16 v[176:179], v[244:247], a[52:55], v[176:179]
    ds_read_b128 a[248:251], v17 offset:18432
    v_mfma_f32_16x16x32_bf16 v[176:179], v[248:251], a[68:71], v[176:179]
    ds_read_b128 a[252:255], v17 offset:19456
    v_mfma_f32_16x16x32_bf16 v[176:179], v[252:255], a[84:87], v[176:179]
    ds_read_b128 v[44:47], v17 offset:24576
    ds_read_b128 v[48:51], v17 offset:25600
    ds_read_b128 v[52:55], v17 offset:26624
    ds_read_b128 v[56:59], v17 offset:27648
    v_mfma_f32_16x16x32_bf16 v[172:175], v[252:255], a[80:83], v[172:175]
    v_mfma_f32_16x16x32_bf16 v[172:175], v[248:251], a[64:67], v[172:175]
    v_mfma_f32_16x16x32_bf16 v[172:175], v[244:247], a[48:51], v[172:175]
    s_waitcnt vmcnt(6) lgkmcnt(0)
    s_barrier
    v_mfma_f32_16x16x32_bf16 v[108:111], v[224:227], a[240:243], v[108:111]
    ds_read_b64_tr_b16 v[244:245], v10 offset:0
    v_mfma_f32_16x16x32_bf16 v[92:95], v[220:223], a[240:243], v[92:95]
    ds_read_b64_tr_b16 v[246:247], v10 offset:6144
    v_mfma_f32_16x16x32_bf16 v[96:99], v[220:223], a[244:247], v[96:99]
    ds_read_b64_tr_b16 v[248:249], v11 offset:0
    v_mfma_f32_16x16x32_bf16 v[112:115], v[224:227], a[244:247], v[112:115]
    ds_read_b64_tr_b16 v[250:251], v11 offset:6144
    v_mfma_f32_16x16x32_bf16 v[116:119], v[224:227], a[248:251], v[116:119]
    ds_read_b64_tr_b16 v[252:253], v10 offset:1024
    v_mfma_f32_16x16x32_bf16 v[100:103], v[220:223], a[248:251], v[100:103]
    ds_read_b64_tr_b16 v[254:255], v10 offset:7168
    v_mfma_f32_16x16x32_bf16 v[104:107], v[220:223], a[252:255], v[104:107]
    ds_read_b64_tr_b16 v[220:221], v11 offset:1024
    v_mfma_f32_16x16x32_bf16 v[120:123], v[224:227], a[252:255], v[120:123]
    ds_read_b64_tr_b16 v[222:223], v11 offset:7168
    v_mfma_f32_16x16x32_bf16 v[152:155], v[232:235], a[252:255], v[152:155]
    ds_read_b64_tr_b16 v[224:225], v10 offset:2048
    v_mfma_f32_16x16x32_bf16 v[136:139], v[228:231], a[252:255], v[136:139]
    ds_read_b64_tr_b16 v[226:227], v10 offset:8192
    v_mfma_f32_16x16x32_bf16 v[132:135], v[228:231], a[248:251], v[132:135]
    ds_read_b128 v[60:63], v17 offset:32768
    v_mfma_f32_16x16x32_bf16 v[148:151], v[232:235], a[248:251], v[148:151]
    ds_read_b128 v[64:67], v17 offset:33792
    v_mfma_f32_16x16x32_bf16 v[144:147], v[232:235], a[244:247], v[144:147]
    ds_read_b128 v[68:71], v17 offset:34816
    v_mfma_f32_16x16x32_bf16 v[128:131], v[228:231], a[244:247], v[128:131]
    ds_read_b128 v[72:75], v17 offset:35840
    v_mfma_f32_16x16x32_bf16 v[124:127], v[228:231], a[240:243], v[124:127]
    ds_read_b64_tr_b16 v[228:229], v11 offset:2048
    v_mfma_f32_16x16x32_bf16 v[140:143], v[232:235], a[240:243], v[140:143]
    ds_read_b64_tr_b16 v[230:231], v11 offset:8192
    v_mfma_f32_16x16x32_bf16 v[108:111], v[240:243], v[44:47], v[108:111]
    v_mfma_f32_16x16x32_bf16 v[92:95], v[236:239], v[44:47], v[92:95]
    v_mfma_f32_16x16x32_bf16 v[96:99], v[236:239], v[48:51], v[96:99]
    v_mfma_f32_16x16x32_bf16 v[112:115], v[240:243], v[48:51], v[112:115]
    v_mfma_f32_16x16x32_bf16 v[116:119], v[240:243], v[52:55], v[116:119]
    v_mfma_f32_16x16x32_bf16 v[100:103], v[236:239], v[52:55], v[100:103]
    v_mfma_f32_16x16x32_bf16 v[104:107], v[236:239], v[56:59], v[104:107]
    v_mfma_f32_16x16x32_bf16 v[120:123], v[240:243], v[56:59], v[120:123]
    s_waitcnt lgkmcnt(0)
    v_mfma_f32_16x16x32_bf16 v[152:155], v[248:251], v[56:59], v[152:155]
    ds_read_b64_tr_b16 v[232:233], v10 offset:12288
    v_mfma_f32_16x16x32_bf16 v[136:139], v[244:247], v[56:59], v[136:139]
    ds_read_b64_tr_b16 v[234:235], v10 offset:18432
    v_mfma_f32_16x16x32_bf16 v[132:135], v[244:247], v[52:55], v[132:135]
    s_add_u32 m0, s30, 36864
    s_add_u32 s31, s56, 113024
    v_mfma_f32_16x16x32_bf16 v[148:151], v[248:251], v[52:55], v[148:151]
    buffer_load_dwordx4 v5, s[52:55], s31 offen offset:0 lds
    v_mfma_f32_16x16x32_bf16 v[144:147], v[248:251], v[48:51], v[144:147]
    ds_read_b64_tr_b16 v[236:237], v10 offset:13312
    v_mfma_f32_16x16x32_bf16 v[128:131], v[244:247], v[48:51], v[128:131]
    ds_read_b64_tr_b16 v[238:239], v10 offset:19456
    v_mfma_f32_16x16x32_bf16 v[124:127], v[244:247], v[44:47], v[124:127]
    ds_read_b64_tr_b16 v[240:241], v10 offset:14336
    v_mfma_f32_16x16x32_bf16 v[140:143], v[248:251], v[44:47], v[140:143]
    ds_read_b64_tr_b16 v[242:243], v10 offset:20480
    v_mfma_f32_16x16x32_bf16 v[108:111], v[220:223], v[60:63], v[108:111]
    ds_read_b64_tr_b16 v[244:245], v11 offset:12288
    v_mfma_f32_16x16x32_bf16 v[92:95], v[252:255], v[60:63], v[92:95]
    s_add_u32 s31, s56, 148864
    ds_read_b64_tr_b16 v[246:247], v11 offset:18432
    v_mfma_f32_16x16x32_bf16 v[96:99], v[252:255], v[64:67], v[96:99]
    buffer_load_dwordx4 v5, s[52:55], s31 offen offset:1024 lds
    v_mfma_f32_16x16x32_bf16 v[112:115], v[220:223], v[64:67], v[112:115]
    ds_read_b64_tr_b16 v[248:249], v11 offset:13312
    v_mfma_f32_16x16x32_bf16 v[116:119], v[220:223], v[68:71], v[116:119]
    ds_read_b64_tr_b16 v[250:251], v11 offset:19456
    v_mfma_f32_16x16x32_bf16 v[100:103], v[252:255], v[68:71], v[100:103]
    v_mfma_f32_16x16x32_bf16 v[104:107], v[252:255], v[72:75], v[104:107]
    ds_read_b64_tr_b16 v[252:253], v11 offset:14336
    v_mfma_f32_16x16x32_bf16 v[120:123], v[220:223], v[72:75], v[120:123]
    ds_read_b64_tr_b16 v[254:255], v11 offset:20480
    v_mfma_f32_16x16x32_bf16 v[152:155], v[228:231], v[72:75], v[152:155]
    s_add_u32 s31, s56, 184704
    v_mfma_f32_16x16x32_bf16 v[136:139], v[224:227], v[72:75], v[136:139]
    buffer_load_dwordx4 v5, s[52:55], s31 offen offset:2048 lds
    v_mfma_f32_16x16x32_bf16 v[132:135], v[224:227], v[68:71], v[132:135]
    v_mfma_f32_16x16x32_bf16 v[148:151], v[228:231], v[68:71], v[148:151]
    v_mfma_f32_16x16x32_bf16 v[144:147], v[228:231], v[64:67], v[144:147]
    v_mfma_f32_16x16x32_bf16 v[128:131], v[224:227], v[64:67], v[128:131]
    v_mfma_f32_16x16x32_bf16 v[124:127], v[224:227], v[60:63], v[124:127]
    v_mfma_f32_16x16x32_bf16 v[140:143], v[228:231], v[60:63], v[140:143]
    s_waitcnt vmcnt(11) lgkmcnt(0)
    s_barrier
    v_mfma_f32_16x16x32_bf16 v[156:159], v[232:235], a[96:99], v[156:159]
    ds_read_b64_tr_b16 v[220:221], v10 offset:24576
    v_mfma_f32_16x16x32_bf16 v[156:159], v[236:239], a[112:115], v[156:159]
    ds_read_b64_tr_b16 v[222:223], v10 offset:30720
    v_mfma_f32_16x16x32_bf16 v[156:159], v[240:243], a[128:131], v[156:159]
    s_add_u32 m0, s30, 49152
    s_add_u32 s31, s56, 223616
    v_mfma_f32_16x16x32_bf16 v[160:163], v[240:243], a[132:135], v[160:163]
    buffer_load_dwordx4 v5, s[52:55], s31 offen offset:0 lds
    v_mfma_f32_16x16x32_bf16 v[160:163], v[236:239], a[116:119], v[160:163]
    ds_read_b64_tr_b16 v[224:225], v10 offset:25600
    v_cvt_pk_bf16_f32 v92, v92, v93
    v_mfma_f32_16x16x32_bf16 v[160:163], v[232:235], a[100:103], v[160:163]
    ds_read_b64_tr_b16 v[226:227], v10 offset:31744
    v_cvt_pk_bf16_f32 v93, v94, v95
    v_mfma_f32_16x16x32_bf16 v[164:167], v[232:235], a[104:107], v[164:167]
    ds_read_b64_tr_b16 v[228:229], v10 offset:26624
    v_cvt_pk_bf16_f32 v94, v108, v109
    v_mfma_f32_16x16x32_bf16 v[164:167], v[236:239], a[120:123], v[164:167]
    ds_read_b64_tr_b16 v[230:231], v10 offset:32768
    v_cvt_pk_bf16_f32 v95, v110, v111
    v_mfma_f32_16x16x32_bf16 v[164:167], v[240:243], a[136:139], v[164:167]
    s_add_u32 s45, s78, 0
    v_mfma_f32_16x16x32_bf16 v[168:171], v[240:243], a[140:143], v[168:171]
    s_add_u32 s31, s56, 259456
    v_mfma_f32_16x16x32_bf16 v[168:171], v[236:239], a[124:127], v[168:171]
    buffer_load_dwordx4 v5, s[52:55], s31 offen offset:1024 lds
    v_mfma_f32_16x16x32_bf16 v[168:171], v[232:235], a[108:111], v[168:171]
    ds_read_b64_tr_b16 v[232:233], v11 offset:24576
    v_mfma_f32_16x16x32_bf16 v[184:187], v[244:247], a[108:111], v[184:187]
    ds_read_b64_tr_b16 v[234:235], v11 offset:30720
    v_mfma_f32_16x16x32_bf16 v[184:187], v[248:251], a[124:127], v[184:187]
    ds_read_b64_tr_b16 v[236:237], v11 offset:25600
    v_mfma_f32_16x16x32_bf16 v[184:187], v[252:255], a[140:143], v[184:187]
    ds_read_b64_tr_b16 v[238:239], v11 offset:31744
    v_mfma_f32_16x16x32_bf16 v[180:183], v[252:255], a[136:139], v[180:183]
    ds_read_b64_tr_b16 v[240:241], v11 offset:26624
    v_mfma_f32_16x16x32_bf16 v[180:183], v[248:251], a[120:123], v[180:183]
    s_add_u32 s31, s58, 384
    ds_read_b64_tr_b16 v[242:243], v11 offset:32768
    v_mfma_f32_16x16x32_bf16 v[180:183], v[244:247], a[104:107], v[180:183]
    buffer_load_dwordx4 v5, s[52:55], s31 offen offset:2048 lds
    v_mfma_f32_16x16x32_bf16 v[176:179], v[244:247], a[100:103], v[176:179]
    buffer_store_dwordx4 v[92:95], v2, s[72:75], s45 offen offset:0 sc1
    v_mfma_f32_16x16x32_bf16 v[176:179], v[248:251], a[116:119], v[176:179]
    v_cvt_pk_bf16_f32 v96, v96, v97
    v_cvt_pk_bf16_f32 v97, v98, v99
    v_mfma_f32_16x16x32_bf16 v[176:179], v[252:255], a[132:135], v[176:179]
    v_cvt_pk_bf16_f32 v98, v112, v113
    v_cvt_pk_bf16_f32 v99, v114, v115
    v_mfma_f32_16x16x32_bf16 v[172:175], v[252:255], a[128:131], v[172:175]
    s_add_u32 s45, s78, 0
    v_mfma_f32_16x16x32_bf16 v[172:175], v[248:251], a[112:115], v[172:175]
    buffer_store_dwordx4 v[96:99], v2, s[72:75], s45 offen offset:1024 sc1
    v_mfma_f32_16x16x32_bf16 v[172:175], v[244:247], a[96:99], v[172:175]
    s_waitcnt lgkmcnt(0)
    v_mfma_f32_16x16x32_bf16 v[156:159], v[220:223], a[144:147], v[156:159]
    ds_read_b64_tr_b16 v[244:245], v8 offset:0
    v_mfma_f32_16x16x32_bf16 v[156:159], v[224:227], a[160:163], v[156:159]
    ds_read_b64_tr_b16 v[246:247], v8 offset:6144
    v_mfma_f32_16x16x32_bf16 v[156:159], v[228:231], a[176:179], v[156:159]
    s_add_u32 m0, s30, 61440
    s_add_u32 s31, s57, 2432
    v_mfma_f32_16x16x32_bf16 v[160:163], v[228:231], a[180:183], v[160:163]
    buffer_load_dwordx4 v5, s[52:55], s31 offen offset:0 lds
    v_mfma_f32_16x16x32_bf16 v[160:163], v[224:227], a[164:167], v[160:163]
    ds_read_b64_tr_b16 v[248:249], v8 offset:1024
    v_cvt_pk_bf16_f32 v100, v100, v101
    v_mfma_f32_16x16x32_bf16 v[160:163], v[220:223], a[148:151], v[160:163]
    ds_read_b64_tr_b16 v[250:251], v8 offset:7168
    v_cvt_pk_bf16_f32 v101, v102, v103
    v_mfma_f32_16x16x32_bf16 v[164:167], v[220:223], a[152:155], v[164:167]
    ds_read_b64_tr_b16 v[252:253], v8 offset:2048
    v_cvt_pk_bf16_f32 v102, v116, v117
    v_mfma_f32_16x16x32_bf16 v[164:167], v[224:227], a[168:171], v[164:167]
    ds_read_b64_tr_b16 v[254:255], v8 offset:8192
    v_cvt_pk_bf16_f32 v103, v118, v119
    v_mfma_f32_16x16x32_bf16 v[164:167], v[228:231], a[184:187], v[164:167]
    s_add_u32 s45, s78, 0
    v_mfma_f32_16x16x32_bf16 v[168:171], v[228:231], a[188:191], v[168:171]
    s_add_u32 s31, s57, 38272
    v_mfma_f32_16x16x32_bf16 v[168:171], v[224:227], a[172:175], v[168:171]
    buffer_load_dwordx4 v5, s[52:55], s31 offen offset:1024 lds
    v_mfma_f32_16x16x32_bf16 v[168:171], v[220:223], a[156:159], v[168:171]
    ds_read_b64_tr_b16 v[220:221], v9 offset:0
    v_mfma_f32_16x16x32_bf16 v[184:187], v[232:235], a[156:159], v[184:187]
    ds_read_b64_tr_b16 v[222:223], v9 offset:6144
    v_mfma_f32_16x16x32_bf16 v[184:187], v[236:239], a[172:175], v[184:187]
    ds_read_b64_tr_b16 v[224:225], v9 offset:1024
    v_mfma_f32_16x16x32_bf16 v[184:187], v[240:243], a[188:191], v[184:187]
    ds_read_b64_tr_b16 v[226:227], v9 offset:7168
    v_mfma_f32_16x16x32_bf16 v[180:183], v[240:243], a[184:187], v[180:183]
    ds_read_b64_tr_b16 v[228:229], v9 offset:2048
    v_mfma_f32_16x16x32_bf16 v[180:183], v[236:239], a[168:171], v[180:183]
    s_add_u32 s31, s57, 74112
    ds_read_b64_tr_b16 v[230:231], v9 offset:8192
    v_mfma_f32_16x16x32_bf16 v[180:183], v[232:235], a[152:155], v[180:183]
    buffer_load_dwordx4 v5, s[52:55], s31 offen offset:2048 lds
    v_mfma_f32_16x16x32_bf16 v[176:179], v[232:235], a[148:151], v[176:179]
    buffer_store_dwordx4 v[100:103], v2, s[72:75], s45 offen offset:2048 sc1
    v_mfma_f32_16x16x32_bf16 v[176:179], v[236:239], a[164:167], v[176:179]
    v_mfma_f32_16x16x32_bf16 v[176:179], v[240:243], a[180:183], v[176:179]
    v_mfma_f32_16x16x32_bf16 v[172:175], v[240:243], a[176:179], v[172:175]
    v_mfma_f32_16x16x32_bf16 v[172:175], v[236:239], a[160:163], v[172:175]
    v_mfma_f32_16x16x32_bf16 v[172:175], v[232:235], a[144:147], v[172:175]
    s_waitcnt vmcnt(12) lgkmcnt(0)
    s_barrier
    v_mfma_f32_16x16x32_bf16 v[156:159], v[244:247], a[192:195], v[156:159]
    ds_read_b64_tr_b16 v[232:233], v8 offset:12288
    v_mfma_f32_16x16x32_bf16 v[156:159], v[248:251], a[208:211], v[156:159]
    ds_read_b64_tr_b16 v[234:235], v8 offset:18432
    v_mfma_f32_16x16x32_bf16 v[156:159], v[252:255], a[224:227], v[156:159]
    s_add_u32 m0, s30, 73728
    s_add_u32 s31, s57, 113024
    v_mfma_f32_16x16x32_bf16 v[160:163], v[252:255], a[228:231], v[160:163]
    buffer_load_dwordx4 v5, s[52:55], s31 offen offset:0 lds
    v_mfma_f32_16x16x32_bf16 v[160:163], v[248:251], a[212:215], v[160:163]
    ds_read_b64_tr_b16 v[236:237], v8 offset:13312
    v_cvt_pk_bf16_f32 v104, v104, v105
    v_mfma_f32_16x16x32_bf16 v[160:163], v[244:247], a[196:199], v[160:163]
    ds_read_b64_tr_b16 v[238:239], v8 offset:19456
    v_cvt_pk_bf16_f32 v105, v106, v107
    v_mfma_f32_16x16x32_bf16 v[164:167], v[244:247], a[200:203], v[164:167]
    ds_read_b64_tr_b16 v[240:241], v8 offset:14336
    v_cvt_pk_bf16_f32 v106, v120, v121
    v_mfma_f32_16x16x32_bf16 v[164:167], v[248:251], a[216:219], v[164:167]
    ds_read_b64_tr_b16 v[242:243], v8 offset:20480
    v_cvt_pk_bf16_f32 v107, v122, v123
    v_mfma_f32_16x16x32_bf16 v[164:167], v[252:255], a[232:235], v[164:167]
    s_add_u32 s45, s78, 0
    v_mfma_f32_16x16x32_bf16 v[168:171], v[252:255], a[236:239], v[168:171]
    s_add_u32 s31, s57, 148864
    v_mfma_f32_16x16x32_bf16 v[168:171], v[248:251], a[220:223], v[168:171]
    buffer_load_dwordx4 v5, s[52:55], s31 offen offset:1024 lds
    v_mfma_f32_16x16x32_bf16 v[168:171], v[244:247], a[204:207], v[168:171]
    ds_read_b64_tr_b16 v[244:245], v9 offset:12288
    v_mfma_f32_16x16x32_bf16 v[184:187], v[220:223], a[204:207], v[184:187]
    ds_read_b64_tr_b16 v[246:247], v9 offset:18432
    v_mfma_f32_16x16x32_bf16 v[184:187], v[224:227], a[220:223], v[184:187]
    ds_read_b64_tr_b16 v[248:249], v9 offset:13312
    v_mfma_f32_16x16x32_bf16 v[184:187], v[228:231], a[236:239], v[184:187]
    ds_read_b64_tr_b16 v[250:251], v9 offset:19456
    v_mfma_f32_16x16x32_bf16 v[180:183], v[228:231], a[232:235], v[180:183]
    ds_read_b64_tr_b16 v[252:253], v9 offset:14336
    v_mfma_f32_16x16x32_bf16 v[180:183], v[224:227], a[216:219], v[180:183]
    s_add_u32 s31, s57, 184704
    ds_read_b64_tr_b16 v[254:255], v9 offset:20480
    v_mfma_f32_16x16x32_bf16 v[180:183], v[220:223], a[200:203], v[180:183]
    buffer_load_dwordx4 v5, s[52:55], s31 offen offset:2048 lds
    v_mfma_f32_16x16x32_bf16 v[176:179], v[220:223], a[196:199], v[176:179]
    buffer_store_dwordx4 v[104:107], v2, s[72:75], s45 offen offset:3072 sc1
    v_mfma_f32_16x16x32_bf16 v[176:179], v[224:227], a[212:215], v[176:179]
    v_cvt_pk_bf16_f32 v124, v124, v125
    v_cvt_pk_bf16_f32 v125, v126, v127
    v_mfma_f32_16x16x32_bf16 v[176:179], v[228:231], a[228:231], v[176:179]
    v_cvt_pk_bf16_f32 v126, v140, v141
    v_cvt_pk_bf16_f32 v127, v142, v143
    v_mfma_f32_16x16x32_bf16 v[172:175], v[228:231], a[224:227], v[172:175]
    s_add_u32 s45, s78, 16384
    v_mfma_f32_16x16x32_bf16 v[172:175], v[224:227], a[208:211], v[172:175]
    buffer_store_dwordx4 v[124:127], v2, s[72:75], s45 offen offset:0 sc1
    v_mfma_f32_16x16x32_bf16 v[172:175], v[220:223], a[192:195], v[172:175]
    s_waitcnt lgkmcnt(0)
    v_mfma_f32_16x16x32_bf16 v[156:159], v[232:235], a[240:243], v[156:159]
    ds_read_b64_tr_b16 v[220:221], v8 offset:24576
    v_mfma_f32_16x16x32_bf16 v[156:159], v[236:239], v[44:47], v[156:159]
    ds_read_b64_tr_b16 v[222:223], v8 offset:30720
    v_mfma_f32_16x16x32_bf16 v[156:159], v[240:243], v[60:63], v[156:159]
    s_add_u32 m0, s30, 0
    s_add_u32 s31, s57, 223616
    v_mfma_f32_16x16x32_bf16 v[160:163], v[240:243], v[64:67], v[160:163]
    buffer_load_dwordx4 v5, s[52:55], s31 offen offset:0 lds
    v_mfma_f32_16x16x32_bf16 v[160:163], v[236:239], v[48:51], v[160:163]
    ds_read_b64_tr_b16 v[224:225], v8 offset:25600
    v_cvt_pk_bf16_f32 v128, v128, v129
    v_mfma_f32_16x16x32_bf16 v[160:163], v[232:235], a[244:247], v[160:163]
    ds_read_b64_tr_b16 v[226:227], v8 offset:31744
    v_cvt_pk_bf16_f32 v129, v130, v131
    v_mfma_f32_16x16x32_bf16 v[164:167], v[232:235], a[248:251], v[164:167]
    ds_read_b64_tr_b16 v[228:229], v8 offset:26624
    v_cvt_pk_bf16_f32 v130, v144, v145
    v_mfma_f32_16x16x32_bf16 v[164:167], v[236:239], v[52:55], v[164:167]
    ds_read_b64_tr_b16 v[230:231], v8 offset:32768
    v_cvt_pk_bf16_f32 v131, v146, v147
    v_mfma_f32_16x16x32_bf16 v[164:167], v[240:243], v[68:71], v[164:167]
    s_add_u32 s45, s78, 16384
    v_mfma_f32_16x16x32_bf16 v[168:171], v[240:243], v[72:75], v[168:171]
    s_add_u32 s31, s57, 259456
    v_mfma_f32_16x16x32_bf16 v[168:171], v[236:239], v[56:59], v[168:171]
    buffer_load_dwordx4 v5, s[52:55], s31 offen offset:1024 lds
    v_mfma_f32_16x16x32_bf16 v[168:171], v[232:235], a[252:255], v[168:171]
    ds_read_b64_tr_b16 v[232:233], v9 offset:24576
    v_mfma_f32_16x16x32_bf16 v[184:187], v[244:247], a[252:255], v[184:187]
    ds_read_b64_tr_b16 v[234:235], v9 offset:30720
    v_mfma_f32_16x16x32_bf16 v[184:187], v[248:251], v[56:59], v[184:187]
    ds_read_b64_tr_b16 v[236:237], v9 offset:25600
    v_mfma_f32_16x16x32_bf16 v[184:187], v[252:255], v[72:75], v[184:187]
    ds_read_b64_tr_b16 v[238:239], v9 offset:31744
    v_mfma_f32_16x16x32_bf16 v[180:183], v[252:255], v[68:71], v[180:183]
    ds_read_b64_tr_b16 v[240:241], v9 offset:26624
    v_mfma_f32_16x16x32_bf16 v[180:183], v[248:251], v[52:55], v[180:183]
    s_add_u32 s31, s59, 384
    ds_read_b64_tr_b16 v[242:243], v9 offset:32768
    v_mfma_f32_16x16x32_bf16 v[180:183], v[244:247], a[248:251], v[180:183]
    buffer_load_dwordx4 v5, s[52:55], s31 offen offset:2048 lds
    v_mfma_f32_16x16x32_bf16 v[176:179], v[244:247], a[244:247], v[176:179]
    buffer_store_dwordx4 v[128:131], v2, s[72:75], s45 offen offset:1024 sc1
    v_mfma_f32_16x16x32_bf16 v[176:179], v[248:251], v[48:51], v[176:179]
    v_mfma_f32_16x16x32_bf16 v[176:179], v[252:255], v[64:67], v[176:179]
    v_mfma_f32_16x16x32_bf16 v[172:175], v[252:255], v[60:63], v[172:175]
    v_mfma_f32_16x16x32_bf16 v[172:175], v[248:251], v[44:47], v[172:175]
    v_mfma_f32_16x16x32_bf16 v[172:175], v[244:247], a[240:243], v[172:175]
    s_waitcnt vmcnt(15) lgkmcnt(0)
    s_barrier
    v_mfma_f32_16x16x32_bf16 v[188:191], v[220:223], a[0:3], 0
    ds_read_b64_tr_b16 v[244:245], v8 offset:36864
    v_mfma_f32_16x16x32_bf16 v[188:191], v[224:227], a[16:19], v[188:191]
    ds_read_b64_tr_b16 v[246:247], v8 offset:43008
    v_mfma_f32_16x16x32_bf16 v[188:191], v[228:231], a[32:35], v[188:191]
    s_add_u32 m0, s30, 12288
    s_add_u32 s31, s60, 2048
    v_mfma_f32_16x16x32_bf16 v[192:195], v[228:231], a[36:39], 0
    buffer_load_dwordx4 v7, s[52:55], s31 offen offset:0 lds
    v_mfma_f32_16x16x32_bf16 v[192:195], v[224:227], a[20:23], v[192:195]
    ds_read_b64_tr_b16 v[248:249], v8 offset:37888
    v_cvt_pk_bf16_f32 v132, v132, v133
    v_mfma_f32_16x16x32_bf16 v[192:195], v[220:223], a[4:7], v[192:195]
    ds_read_b64_tr_b16 v[250:251], v8 offset:44032
    v_cvt_pk_bf16_f32 v133, v134, v135
    v_mfma_f32_16x16x32_bf16 v[196:199], v[220:223], a[8:11], 0
    ds_read_b64_tr_b16 v[252:253], v8 offset:38912
    v_cvt_pk_bf16_f32 v134, v148, v149
    v_mfma_f32_16x16x32_bf16 v[196:199], v[224:227], a[24:27], v[196:199]
    ds_read_b64_tr_b16 v[254:255], v8 offset:45056
    v_cvt_pk_bf16_f32 v135, v150, v151
    v_mfma_f32_16x16x32_bf16 v[196:199], v[228:231], a[40:43], v[196:199]
    s_add_u32 s45, s78, 16384
    v_mfma_f32_16x16x32_bf16 v[200:203], v[228:231], a[44:47], 0
    s_add_u32 s31, s60, 74752
    v_mfma_f32_16x16x32_bf16 v[200:203], v[224:227], a[28:31], v[200:203]
    buffer_load_dwordx4 v7, s[52:55], s31 offen offset:1024 lds
    v_mfma_f32_16x16x32_bf16 v[200:203], v[220:223], a[12:15], v[200:203]
    ds_read_b64_tr_b16 v[220:221], v9 offset:36864
    v_mfma_f32_16x16x32_bf16 v[216:219], v[232:235], a[12:15], 0
    ds_read_b64_tr_b16 v[222:223], v9 offset:43008
    v_mfma_f32_16x16x32_bf16 v[216:219], v[236:239], a[28:31], v[216:219]
    ds_read_b64_tr_b16 v[224:225], v9 offset:37888
    v_mfma_f32_16x16x32_bf16 v[216:219], v[240:243], a[44:47], v[216:219]
    ds_read_b64_tr_b16 v[226:227], v9 offset:44032
    v_mfma_f32_16x16x32_bf16 v[212:215], v[240:243], a[40:43], 0
    ds_read_b64_tr_b16 v[228:229], v9 offset:38912
    v_mfma_f32_16x16x32_bf16 v[212:215], v[236:239], a[24:27], v[212:215]
    s_add_u32 s31, s60, 147456
    ds_read_b64_tr_b16 v[230:231], v9 offset:45056
    v_mfma_f32_16x16x32_bf16 v[212:215], v[232:235], a[8:11], v[212:215]
    buffer_load_dwordx4 v7, s[52:55], s31 offen offset:2048 lds
    v_mfma_f32_16x16x32_bf16 v[208:211], v[232:235], a[4:7], 0
    buffer_store_dwordx4 v[132:135], v2, s[72:75], s45 offen offset:2048 sc1
    v_mfma_f32_16x16x32_bf16 v[208:211], v[236:239], a[20:23], v[208:211]
    v_mfma_f32_16x16x32_bf16 v[208:211], v[240:243], a[36:39], v[208:211]
    v_mfma_f32_16x16x32_bf16 v[204:207], v[240:243], a[32:35], 0
    v_mfma_f32_16x16x32_bf16 v[204:207], v[236:239], a[16:19], v[204:207]
    v_mfma_f32_16x16x32_bf16 v[204:207], v[232:235], a[0:3], v[204:207]
    s_waitcnt lgkmcnt(0)
    v_mfma_f32_16x16x32_bf16 v[188:191], v[244:247], a[48:51], v[188:191]
    ds_read_b64_tr_b16 v[232:233], v10 offset:0
    v_mfma_f32_16x16x32_bf16 v[188:191], v[248:251], a[64:67], v[188:191]
    ds_read_b64_tr_b16 v[234:235], v10 offset:6144
    v_mfma_f32_16x16x32_bf16 v[188:191], v[252:255], a[80:83], v[188:191]
    s_add_u32 m0, s30, 24576
    s_add_u32 s31, s60, 223232
    v_mfma_f32_16x16x32_bf16 v[192:195], v[252:255], a[84:87], v[192:195]
    buffer_load_dwordx4 v7, s[52:55], s31 offen offset:0 lds
    v_mfma_f32_16x16x32_bf16 v[192:195], v[248:251], a[68:71], v[192:195]
    ds_read_b64_tr_b16 v[236:237], v10 offset:1024
    v_cvt_pk_bf16_f32 v136, v136, v137
    v_mfma_f32_16x16x32_bf16 v[192:195], v[244:247], a[52:55], v[192:195]
    ds_read_b64_tr_b16 v[238:239], v10 offset:7168
    v_cvt_pk_bf16_f32 v137, v138, v139
    v_mfma_f32_16x16x32_bf16 v[196:199], v[244:247], a[56:59], v[196:199]
    ds_read_b64_tr_b16 v[240:241], v10 offset:2048
    v_cvt_pk_bf16_f32 v138, v152, v153
    v_mfma_f32_16x16x32_bf16 v[196:199], v[248:251], a[72:75], v[196:199]
    ds_read_b64_tr_b16 v[242:243], v10 offset:8192
    v_cvt_pk_bf16_f32 v139, v154, v155
    v_mfma_f32_16x16x32_bf16 v[196:199], v[252:255], a[88:91], v[196:199]
    s_add_u32 s45, s78, 16384
    v_mfma_f32_16x16x32_bf16 v[200:203], v[252:255], a[92:95], v[200:203]
    s_add_u32 s31, s61, 1024
    v_mfma_f32_16x16x32_bf16 v[200:203], v[248:251], a[76:79], v[200:203]
    buffer_load_dwordx4 v7, s[52:55], s31 offen offset:1024 lds
    v_mfma_f32_16x16x32_bf16 v[200:203], v[244:247], a[60:63], v[200:203]
    ds_read_b64_tr_b16 v[244:245], v11 offset:0
    v_mfma_f32_16x16x32_bf16 v[216:219], v[220:223], a[60:63], v[216:219]
    ds_read_b64_tr_b16 v[246:247], v11 offset:6144
    v_mfma_f32_16x16x32_bf16 v[216:219], v[224:227], a[76:79], v[216:219]
    ds_read_b64_tr_b16 v[248:249], v11 offset:1024
    v_mfma_f32_16x16x32_bf16 v[216:219], v[228:231], a[92:95], v[216:219]
    ds_read_b64_tr_b16 v[250:251], v11 offset:7168
    v_mfma_f32_16x16x32_bf16 v[212:215], v[228:231], a[88:91], v[212:215]
    ds_read_b64_tr_b16 v[252:253], v11 offset:2048
    v_mfma_f32_16x16x32_bf16 v[212:215], v[224:227], a[72:75], v[212:215]
    s_add_u32 s31, s61, 73728
    ds_read_b64_tr_b16 v[254:255], v11 offset:8192
    v_mfma_f32_16x16x32_bf16 v[212:215], v[220:223], a[56:59], v[212:215]
    buffer_load_dwordx4 v7, s[52:55], s31 offen offset:2048 lds
    v_mfma_f32_16x16x32_bf16 v[208:211], v[220:223], a[52:55], v[208:211]
    buffer_store_dwordx4 v[136:139], v2, s[72:75], s45 offen offset:3072 sc1
    v_mfma_f32_16x16x32_bf16 v[208:211], v[224:227], a[68:71], v[208:211]
    v_cvt_pk_bf16_f32 v156, v156, v157
    v_cvt_pk_bf16_f32 v157, v158, v159
    v_mfma_f32_16x16x32_bf16 v[208:211], v[228:231], a[84:87], v[208:211]
    v_cvt_pk_bf16_f32 v158, v172, v173
    v_cvt_pk_bf16_f32 v159, v174, v175
    v_mfma_f32_16x16x32_bf16 v[204:207], v[228:231], a[80:83], v[204:207]
    s_add_u32 s45, s78, 32768
    v_mfma_f32_16x16x32_bf16 v[204:207], v[224:227], a[64:67], v[204:207]
    buffer_store_dwordx4 v[156:159], v2, s[72:75], s45 offen offset:0 sc1
    v_mfma_f32_16x16x32_bf16 v[204:207], v[220:223], a[48:51], v[204:207]
    s_waitcnt vmcnt(15) lgkmcnt(0)
    s_barrier
    v_mfma_f32_16x16x32_bf16 v[188:191], v[232:235], a[96:99], v[188:191]
    ds_read_b64_tr_b16 v[220:221], v10 offset:12288
    v_mfma_f32_16x16x32_bf16 v[188:191], v[236:239], a[112:115], v[188:191]
    ds_read_b64_tr_b16 v[222:223], v10 offset:18432
    v_mfma_f32_16x16x32_bf16 v[188:191], v[240:243], a[128:131], v[188:191]
    s_add_u32 m0, s30, 36864
    s_add_u32 s31, s61, 149504
    v_mfma_f32_16x16x32_bf16 v[192:195], v[240:243], a[132:135], v[192:195]
    buffer_load_dwordx4 v7, s[52:55], s31 offen offset:0 lds
    v_mfma_f32_16x16x32_bf16 v[192:195], v[236:239], a[116:119], v[192:195]
    ds_read_b64_tr_b16 v[224:225], v10 offset:13312
    v_cvt_pk_bf16_f32 v160, v160, v161
    v_mfma_f32_16x16x32_bf16 v[192:195], v[232:235], a[100:103], v[192:195]
    ds_read_b64_tr_b16 v[226:227], v10 offset:19456
    v_cvt_pk_bf16_f32 v161, v162, v163
    v_mfma_f32_16x16x32_bf16 v[196:199], v[232:235], a[104:107], v[196:199]
    ds_read_b64_tr_b16 v[228:229], v10 offset:14336
    v_cvt_pk_bf16_f32 v162, v176, v177
    v_mfma_f32_16x16x32_bf16 v[196:199], v[236:239], a[120:123], v[196:199]
    ds_read_b64_tr_b16 v[230:231], v10 offset:20480
    v_cvt_pk_bf16_f32 v163, v178, v179
    v_mfma_f32_16x16x32_bf16 v[196:199], v[240:243], a[136:139], v[196:199]
    s_add_u32 s45, s78, 32768
    v_mfma_f32_16x16x32_bf16 v[200:203], v[240:243], a[140:143], v[200:203]
    s_add_u32 s31, s61, 222208
    v_mfma_f32_16x16x32_bf16 v[200:203], v[236:239], a[124:127], v[200:203]
    buffer_load_dwordx4 v7, s[52:55], s31 offen offset:1024 lds
    v_mfma_f32_16x16x32_bf16 v[200:203], v[232:235], a[108:111], v[200:203]
    ds_read_b64_tr_b16 v[232:233], v11 offset:12288
    v_mfma_f32_16x16x32_bf16 v[216:219], v[244:247], a[108:111], v[216:219]
    ds_read_b64_tr_b16 v[234:235], v11 offset:18432
    v_mfma_f32_16x16x32_bf16 v[216:219], v[248:251], a[124:127], v[216:219]
    ds_read_b64_tr_b16 v[236:237], v11 offset:13312
    v_mfma_f32_16x16x32_bf16 v[216:219], v[252:255], a[140:143], v[216:219]
    ds_read_b64_tr_b16 v[238:239], v11 offset:19456
    v_mfma_f32_16x16x32_bf16 v[212:215], v[252:255], a[136:139], v[212:215]
    ds_read_b64_tr_b16 v[240:241], v11 offset:14336
    v_mfma_f32_16x16x32_bf16 v[212:215], v[248:251], a[120:123], v[212:215]
    s_add_u32 s31, s62, 0
    ds_read_b64_tr_b16 v[242:243], v11 offset:20480
    v_mfma_f32_16x16x32_bf16 v[212:215], v[244:247], a[104:107], v[212:215]
    buffer_load_dwordx4 v7, s[52:55], s31 offen offset:2048 lds
    v_mfma_f32_16x16x32_bf16 v[208:211], v[244:247], a[100:103], v[208:211]
    buffer_store_dwordx4 v[160:163], v2, s[72:75], s45 offen offset:1024 sc1
    v_mfma_f32_16x16x32_bf16 v[208:211], v[248:251], a[116:119], v[208:211]
    v_mfma_f32_16x16x32_bf16 v[208:211], v[252:255], a[132:135], v[208:211]
    v_mfma_f32_16x16x32_bf16 v[204:207], v[252:255], a[128:131], v[204:207]
    v_mfma_f32_16x16x32_bf16 v[204:207], v[248:251], a[112:115], v[204:207]
    v_mfma_f32_16x16x32_bf16 v[204:207], v[244:247], a[96:99], v[204:207]
    s_waitcnt lgkmcnt(0)
    v_mfma_f32_16x16x32_bf16 v[188:191], v[220:223], a[144:147], v[188:191]
    ds_read_b64_tr_b16 v[244:245], v10 offset:24576
    v_mfma_f32_16x16x32_bf16 v[188:191], v[224:227], a[160:163], v[188:191]
    ds_read_b64_tr_b16 v[246:247], v10 offset:30720
    v_mfma_f32_16x16x32_bf16 v[188:191], v[228:231], a[176:179], v[188:191]
    ds_read_b64_tr_b16 v[248:249], v10 offset:25600
    v_lshrrev_b32 v36, 4, v1
    v_mfma_f32_16x16x32_bf16 v[192:195], v[228:231], a[180:183], v[192:195]
    ds_read_b64_tr_b16 v[250:251], v10 offset:31744
    s_mul_i32 s17, s16, 2304
    v_mfma_f32_16x16x32_bf16 v[192:195], v[224:227], a[164:167], v[192:195]
    ds_read_b64_tr_b16 v[252:253], v10 offset:26624
    s_add_u32 s17, s17, 49152
    v_mfma_f32_16x16x32_bf16 v[192:195], v[220:223], a[148:151], v[192:195]
    ds_read_b64_tr_b16 v[254:255], v10 offset:32768
    v_lshl_add_u32 v36, v36, 3, s17
    v_mfma_f32_16x16x32_bf16 v[196:199], v[220:223], a[152:155], v[196:199]
    v_and_b32 v37, 15, v1
    v_lshl_add_u32 v14, v37, 6, v36
    v_mfma_f32_16x16x32_bf16 v[196:199], v[224:227], a[168:171], v[196:199]
    v_and_b32 v37, 1, v1
    v_lshl_add_u32 v36, v37, 6, v36
    v_mfma_f32_16x16x32_bf16 v[196:199], v[228:231], a[184:187], v[196:199]
    v_bfe_u32 v37, v1, 1, 1
    v_lshl_add_u32 v36, v37, 5, v36
    v_mfma_f32_16x16x32_bf16 v[200:203], v[228:231], a[188:191], v[200:203]
    v_bfe_u32 v37, v1, 2, 1
    v_mul_u32_u24 v37, 1152, v37
    v_mfma_f32_16x16x32_bf16 v[200:203], v[224:227], a[172:175], v[200:203]
    v_add_u32 v15, v36, v37
    v_cvt_pk_bf16_f32 v164, v164, v165
    v_mfma_f32_16x16x32_bf16 v[200:203], v[220:223], a[156:159], v[200:203]
    ds_read_b64_tr_b16 v[220:221], v11 offset:24576
    v_cvt_pk_bf16_f32 v165, v166, v167
    v_mfma_f32_16x16x32_bf16 v[216:219], v[232:235], a[156:159], v[216:219]
    ds_read_b64_tr_b16 v[222:223], v11 offset:30720
    v_cvt_pk_bf16_f32 v166, v180, v181
    v_mfma_f32_16x16x32_bf16 v[216:219], v[236:239], a[172:175], v[216:219]
    ds_read_b64_tr_b16 v[224:225], v11 offset:25600
k4_kernel_pg1_7:
    s_cbranch_execz k4_kernel_back1
    v_cvt_pk_bf16_f32 v167, v182, v183
    v_mfma_f32_16x16x32_bf16 v[216:219], v[240:243], a[188:191], v[216:219]
    ds_read_b64_tr_b16 v[226:227], v11 offset:31744
    s_add_u32 s45, s78, 32768
    v_mfma_f32_16x16x32_bf16 v[212:215], v[240:243], a[184:187], v[212:215]
    ds_read_b64_tr_b16 v[228:229], v11 offset:26624
    v_mfma_f32_16x16x32_bf16 v[212:215], v[236:239], a[168:171], v[212:215]
    ds_read_b64_tr_b16 v[230:231], v11 offset:32768
    v_mfma_f32_16x16x32_bf16 v[212:215], v[232:235], a[152:155], v[212:215]
    buffer_store_dwordx4 v[164:167], v2, s[72:75], s45 offen offset:2048 sc1
    v_mfma_f32_16x16x32_bf16 v[208:211], v[232:235], a[148:151], v[208:211]
    v_mfma_f32_16x16x32_bf16 v[208:211], v[236:239], a[164:167], v[208:211]
    v_mfma_f32_16x16x32_bf16 v[208:211], v[240:243], a[180:183], v[208:211]
    v_mfma_f32_16x16x32_bf16 v[204:207], v[240:243], a[176:179], v[204:207]
    v_mfma_f32_16x16x32_bf16 v[204:207], v[236:239], a[160:163], v[204:207]
    v_mfma_f32_16x16x32_bf16 v[204:207], v[232:235], a[144:147], v[204:207]
    s_waitcnt vmcnt(6) lgkmcnt(0)
    s_barrier
    v_mfma_f32_16x16x32_bf16 v[188:191], v[244:247], a[192:195], v[188:191]
    ds_read_b64_tr_b16 v[232:233], v8 offset:0
    v_mfma_f32_16x16x32_bf16 v[188:191], v[248:251], a[208:211], v[188:191]
    ds_read_b64_tr_b16 v[234:235], v8 offset:6144
    v_mfma_f32_16x16x32_bf16 v[188:191], v[252:255], a[224:227], v[188:191]
    v_mov_b32 v20, 1
    ds_read_b64_tr_b16 v[236:237], v8 offset:1024
    v_mfma_f32_16x16x32_bf16 v[192:195], v[252:255], a[228:231], v[192:195]
    buffer_store_dword v20, v3, s[68:71], s82 offen offset:0 sc1
    v_mfma_f32_16x16x32_bf16 v[192:195], v[248:251], a[212:215], v[192:195]
    ds_read_b64_tr_b16 v[238:239], v8 offset:7168
    v_mfma_f32_16x16x32_bf16 v[192:195], v[244:247], a[196:199], v[192:195]
    ds_read_b64_tr_b16 v[240:241], v8 offset:2048
    v_mfma_f32_16x16x32_bf16 v[196:199], v[244:247], a[200:203], v[196:199]
    ds_read_b64_tr_b16 v[242:243], v8 offset:8192
    v_mfma_f32_16x16x32_bf16 v[196:199], v[248:251], a[216:219], v[196:199]
    ds_write_b64 v14, v[24:25] offset:0
    v_mfma_f32_16x16x32_bf16 v[196:199], v[252:255], a[232:235], v[196:199]
    ds_write_b64 v14, v[26:27] offset:32
    v_mfma_f32_16x16x32_bf16 v[200:203], v[252:255], a[236:239], v[200:203]
    v_cvt_pk_bf16_f32 v168, v168, v169
    v_cvt_pk_bf16_f32 v169, v170, v171
    v_mfma_f32_16x16x32_bf16 v[200:203], v[248:251], a[220:223], v[200:203]
    v_cvt_pk_bf16_f32 v170, v184, v185
    v_cvt_pk_bf16_f32 v171, v186, v187
    v_mfma_f32_16x16x32_bf16 v[200:203], v[244:247], a[204:207], v[200:203]
    ds_read_b64_tr_b16 v[244:245], v9 offset:0
    s_add_u32 s45, s78, 32768
    v_mfma_f32_16x16x32_bf16 v[216:219], v[220:223], a[204:207], v[216:219]
    ds_read_b64_tr_b16 v[246:247], v9 offset:6144
    v_mfma_f32_16x16x32_bf16 v[216:219], v[224:227], a[220:223], v[216:219]
    ds_read_b64_tr_b16 v[248:249], v9 offset:1024
    v_mfma_f32_16x16x32_bf16 v[216:219], v[228:231], a[236:239], v[216:219]
    ds_read_b64_tr_b16 v[250:251], v9 offset:7168
    v_mfma_f32_16x16x32_bf16 v[212:215], v[228:231], a[232:235], v[212:215]
    ds_read_b64_tr_b16 v[252:253], v9 offset:2048
    v_mfma_f32_16x16x32_bf16 v[212:215], v[224:227], a[216:219], v[212:215]
    ds_read_b64_tr_b16 v[254:255], v9 offset:8192
    v_mfma_f32_16x16x32_bf16 v[212:215], v[220:223], a[200:203], v[212:215]
    buffer_store_dwordx4 v[168:171], v2, s[72:75], s45 offen offset:3072 sc1
    v_mfma_f32_16x16x32_bf16 v[208:211], v[220:223], a[196:199], v[208:211]
    v_mfma_f32_16x16x32_bf16 v[208:211], v[224:227], a[212:215], v[208:211]
    v_mfma_f32_16x16x32_bf16 v[208:211], v[228:231], a[228:231], v[208:211]
    v_mfma_f32_16x16x32_bf16 v[204:207], v[228:231], a[224:227], v[204:207]
    v_mfma_f32_16x16x32_bf16 v[204:207], v[224:227], a[208:211], v[204:207]
    v_mfma_f32_16x16x32_bf16 v[204:207], v[220:223], a[192:195], v[204:207]
    s_waitcnt lgkmcnt(0)
    v_mfma_f32_16x16x32_bf16 v[188:191], v[232:235], a[240:243], v[188:191]
    ds_read_b64_tr_b16 v[220:221], v12 offset:12288
    v_mfma_f32_16x16x32_bf16 v[188:191], v[236:239], v[44:47], v[188:191]
    ds_read_b64_tr_b16 v[222:223], v12 offset:15360
    v_mfma_f32_16x16x32_bf16 v[188:191], v[240:243], v[60:63], v[188:191]
    ds_read_b64_tr_b16 v[224:225], v12 offset:13312
    v_mfma_f32_16x16x32_bf16 v[192:195], v[240:243], v[64:67], v[192:195]
    ds_read_b64_tr_b16 v[226:227], v12 offset:16384
    v_mfma_f32_16x16x32_bf16 v[192:195], v[236:239], v[48:51], v[192:195]
    ds_read_b64_tr_b16 v[228:229], v12 offset:14336
    v_mfma_f32_16x16x32_bf16 v[192:195], v[232:235], a[244:247], v[192:195]
    ds_read_b64_tr_b16 v[230:231], v12 offset:17408
    v_mfma_f32_16x16x32_bf16 v[196:199], v[232:235], a[248:251], v[196:199]
    ds_write_b64 v14, v[28:29] offset:1152
    v_mfma_f32_16x16x32_bf16 v[196:199], v[236:239], v[52:55], v[196:199]
    ds_write_b64 v14, v[30:31] offset:1184
    v_mfma_f32_16x16x32_bf16 v[196:199], v[240:243], v[68:71], v[196:199]
    s_mov_b32 exec_lo, 0x00ff00ff
    s_mov_b32 exec_hi, 0x00ff00ff
    ds_write_b64 v15, v[32:33] offset:1024
    s_mov_b64 exec, -1
    v_mfma_f32_16x16x32_bf16 v[200:203], v[240:243], v[72:75], v[200:203]
    v_mfma_f32_16x16x32_bf16 v[200:203], v[236:239], v[56:59], v[200:203]
    v_mfma_f32_16x16x32_bf16 v[200:203], v[232:235], a[252:255], v[200:203]
    ds_read_b64_tr_b16 v[232:233], v12 offset:18432
    v_mfma_f32_16x16x32_bf16 v[216:219], v[244:247], a[252:255], v[216:219]
    ds_read_b64_tr_b16 v[234:235], v12 offset:21504
    v_mfma_f32_16x16x32_bf16 v[216:219], v[248:251], v[56:59], v[216:219]
    ds_read_b64_tr_b16 v[236:237], v12 offset:19456
    v_mfma_f32_16x16x32_bf16 v[216:219], v[252:255], v[72:75], v[216:219]
    ds_read_b64_tr_b16 v[238:239], v12 offset:22528
    v_mfma_f32_16x16x32_bf16 v[212:215], v[252:255], v[68:71], v[212:215]
    ds_read_b64_tr_b16 v[240:241], v12 offset:20480
    v_mfma_f32_16x16x32_bf16 v[212:215], v[248:251], v[52:55], v[212:215]
    ds_read_b64_tr_b16 v[242:243], v12 offset:23552
    v_mfma_f32_16x16x32_bf16 v[212:215], v[244:247], a[248:251], v[212:215]
    v_mfma_f32_16x16x32_bf16 v[208:211], v[244:247], a[244:247], v[208:211]
    v_mfma_f32_16x16x32_bf16 v[208:211], v[248:251], v[48:51], v[208:211]
    v_mfma_f32_16x16x32_bf16 v[208:211], v[252:255], v[64:67], v[208:211]
    v_mfma_f32_16x16x32_bf16 v[204:207], v[252:255], v[60:63], v[204:207]
    v_mfma_f32_16x16x32_bf16 v[204:207], v[248:251], v[44:47], v[204:207]
    v_mfma_f32_16x16x32_bf16 v[204:207], v[244:247], a[240:243], v[204:207]
    s_waitcnt vmcnt(4) lgkmcnt(0)
    s_barrier
    v_mfma_f32_16x16x32_bf16 v[76:79], v[220:223], a[0:3], 0
    ds_read_b64_tr_b16 v[244:245], v12 offset:24576
    v_mfma_f32_16x16x32_bf16 v[76:79], v[224:227], a[32:35], v[76:79]
    ds_read_b64_tr_b16 v[246:247], v12 offset:27648
    v_mfma_f32_16x16x32_bf16 v[76:79], v[228:231], a[64:67], v[76:79]
    ds_read_b64_tr_b16 v[248:249], v12 offset:25600
    v_cvt_pk_bf16_f32 v188, v188, v189
    v_mfma_f32_16x16x32_bf16 v[80:83], v[228:231], a[68:71], 0
    ds_read_b64_tr_b16 v[250:251], v12 offset:28672
    v_cvt_pk_bf16_f32 v189, v190, v191
    v_mfma_f32_16x16x32_bf16 v[80:83], v[224:227], a[36:39], v[80:83]
    ds_read_b64_tr_b16 v[252:253], v12 offset:26624
    v_cvt_pk_bf16_f32 v190, v204, v205
    v_mfma_f32_16x16x32_bf16 v[80:83], v[220:223], a[4:7], v[80:83]
    ds_read_b64_tr_b16 v[254:255], v12 offset:29696
    v_cvt_pk_bf16_f32 v191, v206, v207
    v_mfma_f32_16x16x32_bf16 v[84:87], v[220:223], a[8:11], 0
    s_add_u32 s45, s78, 49152
    v_mfma_f32_16x16x32_bf16 v[84:87], v[224:227], a[40:43], v[84:87]
    buffer_store_dwordx4 v[188:191], v2, s[72:75], s45 offen offset:0 sc1
    v_mfma_f32_16x16x32_bf16 v[84:87], v[228:231], a[72:75], v[84:87]
    v_cvt_pk_bf16_f32 v192, v192, v193
    v_cvt_pk_bf16_f32 v193, v194, v195
    v_mfma_f32_16x16x32_bf16 v[88:91], v[228:231], a[76:79], 0
    v_cvt_pk_bf16_f32 v194, v208, v209
    v_cvt_pk_bf16_f32 v195, v210, v211
    v_mfma_f32_16x16x32_bf16 v[88:91], v[224:227], a[44:47], v[88:91]
    s_add_u32 s45, s78, 49152
    v_mfma_f32_16x16x32_bf16 v[88:91], v[220:223], a[12:15], v[88:91]
    ds_read_b64_tr_b16 v[220:221], v12 offset:30720
    v_mfma_f32_16x16x32_bf16 v[88:91], v[232:235], a[28:31], v[88:91]
    ds_read_b64_tr_b16 v[222:223], v12 offset:33792
    v_mfma_f32_16x16x32_bf16 v[88:91], v[236:239], a[60:63], v[88:91]
    ds_read_b64_tr_b16 v[224:225], v12 offset:31744
    v_mfma_f32_16x16x32_bf16 v[88:91], v[240:243], a[92:95], v[88:91]
    ds_read_b64_tr_b16 v[226:227], v12 offset:34816
    v_mfma_f32_16x16x32_bf16 v[84:87], v[240:243], a[88:91], v[84:87]
    ds_read_b64_tr_b16 v[228:229], v12 offset:32768
    v_mfma_f32_16x16x32_bf16 v[84:87], v[236:239], a[56:59], v[84:87]
    ds_read_b64_tr_b16 v[230:231], v12 offset:35840
    v_mfma_f32_16x16x32_bf16 v[84:87], v[232:235], a[24:27], v[84:87]
    buffer_store_dwordx4 v[192:195], v2, s[72:75], s45 offen offset:1024 sc1
    v_mfma_f32_16x16x32_bf16 v[80:83], v[232:235], a[20:23], v[80:83]
    v_mfma_f32_16x16x32_bf16 v[80:83], v[236:239], a[52:55], v[80:83]
    v_mfma_f32_16x16x32_bf16 v[80:83], v[240:243], a[84:87], v[80:83]
    v_mfma_f32_16x16x32_bf16 v[76:79], v[240:243], a[80:83], v[76:79]
    v_mfma_f32_16x16x32_bf16 v[76:79], v[236:239], a[48:51], v[76:79]
    v_mfma_f32_16x16x32_bf16 v[76:79], v[232:235], a[16:19], v[76:79]
    s_waitcnt lgkmcnt(0)
    v_mfma_f32_16x16x32_bf16 v[76:79], v[244:247], a[96:99], v[76:79]
    ds_read_b64_tr_b16 v[232:233], v12 offset:36864
    v_mfma_f32_16x16x32_bf16 v[76:79], v[248:251], a[144:147], v[76:79]
    ds_read_b64_tr_b16 v[234:235], v12 offset:39936
    v_mfma_f32_16x16x32_bf16 v[76:79], v[252:255], a[176:179], v[76:79]
    ds_read_b64_tr_b16 v[236:237], v12 offset:37888
    v_cvt_pk_bf16_f32 v196, v196, v197
    v_mfma_f32_16x16x32_bf16 v[80:83], v[252:255], a[180:183], v[80:83]
    buffer_load_dword v19, v21, s[68:71], s81 offen offset:0 sc1
    v_mfma_f32_16x16x32_bf16 v[80:83], v[248:251], a[148:151], v[80:83]
    ds_read_b64_tr_b16 v[238:239], v12 offset:40960
    v_cvt_pk_bf16_f32 v197, v198, v199
    v_mfma_f32_16x16x32_bf16 v[80:83], v[244:247], a[100:103], v[80:83]
    ds_read_b64_tr_b16 v[240:241], v12 offset:38912
    v_cvt_pk_bf16_f32 v198, v212, v213
    v_mfma_f32_16x16x32_bf16 v[84:87], v[244:247], a[104:107], v[84:87]
    ds_read_b64_tr_b16 v[242:243], v12 offset:41984
    v_cvt_pk_bf16_f32 v199, v214, v215
    v_mfma_f32_16x16x32_bf16 v[84:87], v[248:251], a[152:155], v[84:87]
    s_add_u32 s45, s78, 49152
    v_mfma_f32_16x16x32_bf16 v[84:87], v[252:255], a[184:187], v[84:87]
    buffer_store_dwordx4 v[196:199], v2, s[72:75], s45 offen offset:2048 sc1
    v_mfma_f32_16x16x32_bf16 v[88:91], v[252:255], a[188:191], v[88:91]
    v_cvt_pk_bf16_f32 v200, v200, v201
    v_cvt_pk_bf16_f32 v201, v202, v203
    v_mfma_f32_16x16x32_bf16 v[88:91], v[248:251], a[156:159], v[88:91]
    v_cvt_pk_bf16_f32 v202, v216, v217
    v_cvt_pk_bf16_f32 v203, v218, v219
    v_mfma_f32_16x16x32_bf16 v[88:91], v[244:247], a[108:111], v[88:91]
    ds_read_b64_tr_b16 v[244:245], v12 offset:43008
    s_add_u32 s45, s78, 49152
    v_mfma_f32_16x16x32_bf16 v[88:91], v[220:223], a[124:127], v[88:91]
    ds_read_b64_tr_b16 v[246:247], v12 offset:46080
    v_mfma_f32_16x16x32_bf16 v[88:91], v[224:227], a[172:175], v[88:91]
    ds_read_b64_tr_b16 v[248:249], v12 offset:44032
    v_mfma_f32_16x16x32_bf16 v[88:91], v[228:231], a[204:207], v[88:91]
    ds_read_b64_tr_b16 v[250:251], v12 offset:47104
    v_mfma_f32_16x16x32_bf16 v[84:87], v[228:231], a[200:203], v[84:87]
    ds_read_b64_tr_b16 v[252:253], v12 offset:45056
    v_mfma_f32_16x16x32_bf16 v[84:87], v[224:227], a[168:171], v[84:87]
    ds_read_b64_tr_b16 v[254:255], v12 offset:48128
    v_mfma_f32_16x16x32_bf16 v[84:87], v[220:223], a[120:123], v[84:87]
    buffer_store_dwordx4 v[200:203], v2, s[72:75], s45 offen offset:3072 sc1
    v_mfma_f32_16x16x32_bf16 v[80:83], v[220:223], a[116:119], v[80:83]
    v_mfma_f32_16x16x32_bf16 v[80:83], v[224:227], a[164:167], v[80:83]
    v_mfma_f32_16x16x32_bf16 v[80:83], v[228:231], a[196:199], v[80:83]
    v_mfma_f32_16x16x32_bf16 v[76:79], v[228:231], a[192:195], v[76:79]
    v_mfma_f32_16x16x32_bf16 v[76:79], v[224:227], a[160:163], v[76:79]
    v_mfma_f32_16x16x32_bf16 v[76:79], v[220:223], a[112:115], v[76:79]
    s_waitcnt lgkmcnt(0)
    s_barrier
    v_mfma_f32_16x16x32_bf16 v[76:79], v[232:235], a[208:211], v[76:79]
    v_mfma_f32_16x16x32_bf16 v[76:79], v[236:239], a[240:243], v[76:79]
    v_mfma_f32_16x16x32_bf16 v[76:79], v[240:243], a[128:131], v[76:79]
    v_mfma_f32_16x16x32_bf16 v[80:83], v[240:243], a[132:135], v[80:83]
    v_mfma_f32_16x16x32_bf16 v[80:83], v[236:239], a[244:247], v[80:83]
    v_mfma_f32_16x16x32_bf16 v[80:83], v[232:235], a[212:215], v[80:83]
    v_mfma_f32_16x16x32_bf16 v[84:87], v[232:235], a[216:219], v[84:87]
    v_mfma_f32_16x16x32_bf16 v[84:87], v[236:239], a[248:251], v[84:87]
    v_mfma_f32_16x16x32_bf16 v[84:87], v[240:243], a[136:139], v[84:87]
    v_mfma_f32_16x16x32_bf16 v[88:91], v[240:243], a[140:143], v[88:91]
    v_mfma_f32_16x16x32_bf16 v[88:91], v[236:239], a[252:255], v[88:91]
    v_mfma_f32_16x16x32_bf16 v[88:91], v[232:235], a[220:223], v[88:91]
    v_mfma_f32_16x16x32_bf16 v[88:91], v[244:247], a[236:239], v[88:91]
    v_mfma_f32_16x16x32_bf16 v[88:91], v[248:251], v[56:59], v[88:91]
    v_mfma_f32_16x16x32_bf16 v[88:91], v[252:255], v[72:75], v[88:91]
    v_mfma_f32_16x16x32_bf16 v[84:87], v[252:255], v[68:71], v[84:87]
    v_mfma_f32_16x16x32_bf16 v[84:87], v[248:251], v[52:55], v[84:87]
    v_mfma_f32_16x16x32_bf16 v[84:87], v[244:247], a[232:235], v[84:87]
    v_mfma_f32_16x16x32_bf16 v[80:83], v[244:247], a[228:231], v[80:83]
    v_mfma_f32_16x16x32_bf16 v[80:83], v[248:251], v[48:51], v[80:83]
    v_mfma_f32_16x16x32_bf16 v[80:83], v[252:255], v[64:67], v[80:83]
    v_mfma_f32_16x16x32_bf16 v[76:79], v[252:255], v[60:63], v[76:79]
    v_mfma_f32_16x16x32_bf16 v[76:79], v[248:251], v[44:47], v[76:79]
    v_mfma_f32_16x16x32_bf16 v[76:79], v[244:247], a[224:227], v[76:79]
    s_nop 7
    v_cvt_pk_bf16_f32 v76, v76, v77
    v_cvt_pk_bf16_f32 v77, v78, v79
    v_cvt_pk_bf16_f32 v78, v80, v81
    v_cvt_pk_bf16_f32 v79, v82, v83
    s_nop 0
    v_permlane16_swap_b32 v76, v78
    v_permlane16_swap_b32 v77, v79
    s_add_u32 s45, s79, 65536
    buffer_store_dwordx4 v[76:79], v2, s[72:75], s45 offen offset:0 sc1
    v_cvt_pk_bf16_f32 v84, v84, v85
    v_cvt_pk_bf16_f32 v85, v86, v87
    v_cvt_pk_bf16_f32 v86, v88, v89
    v_cvt_pk_bf16_f32 v87, v90, v91
    s_nop 0
    v_permlane16_swap_b32 v84, v86
    v_permlane16_swap_b32 v85, v87
    s_add_u32 s45, s79, 65536
    buffer_store_dwordx4 v[84:87], v2, s[72:75], s45 offen offset:1024 sc1
    s_waitcnt vmcnt(4)
    v_cmp_gt_u32 vcc, 1, v19
    s_nop 1
    s_cbranch_vccnz k4_kernel_slowg1
k4_kernel_okg1:
    s_add_u32 s44, s32, 0
    buffer_load_dwordx4 v[92:95], v4, s[72:75], s44 offen sc1
    s_add_u32 s44, s32, 4718592
    buffer_load_dwordx4 v[96:99], v4, s[72:75], s44 offen sc1
    s_add_u32 s44, s32, 9437184
    buffer_load_dwordx4 v[100:103], v4, s[72:75], s44 offen sc1
    s_add_u32 s44, s32, 14155776
    buffer_load_dwordx4 v[104:107], v4, s[72:75], s44 offen sc1
    s_add_u32 s44, s32, 16384
    buffer_load_dwordx4 v[124:127], v4, s[72:75], s44 offen sc1
    s_add_u32 s44, s32, 4734976
    buffer_load_dwordx4 v[128:131], v4, s[72:75], s44 offen sc1
    s_add_u32 s44, s32, 9453568
    buffer_load_dwordx4 v[132:135], v4, s[72:75], s44 offen sc1
    s_add_u32 s44, s32, 14172160
    buffer_load_dwordx4 v[136:139], v4, s[72:75], s44 offen sc1
    v_lshrrev_b32 v36, 5, v1
    v_bfe_u32 v37, v1, 3, 2
    v_and_b32 v38, 7, v1
    s_mul_i32 s17, s22, 320
    s_lshl_b32 s18, s23, 5
    s_add_u32 s17, s17, s18
    v_lshlrev_b32 v39, 2, v37
    v_lshl_add_u32 v40, v36, 4, v39
    v_add_u32 v40, s17, v40
    v_mul_u32_u24 v41, 1152, v38
    v_add_u32 v41, 49152, v41
    v_lshl_add_u32 v221, v40, 1, v41
    v_lshlrev_b32 v222, 2, v40
    v_add_u32 v222, 159744, v222
    s_lshl_b32 s17, s22, 5
    s_lshl_b32 s18, s23, 4
    s_add_u32 s17, s17, s18
    s_add_u32 s17, s17, 256
    v_lshrrev_b32 v42, 4, v1
    v_bfe_u32 v43, v1, 3, 1
    v_lshlrev_b32 v40, 1, v42
    v_lshl_add_u32 v40, v43, 3, v40
    v_add_u32 v40, s17, v40
    s_mov_b32 s18, 2359296
    v_mul_lo_u32 v226, v42, s18
    v_lshl_add_u32 v226, v43, 9, v226
    v_lshl_add_u32 v226, v38, 4, v226
    v_lshl_add_u32 v223, v40, 1, v41
    v_lshlrev_b32 v224, 2, v40
    v_add_u32 v224, 159744, v224
    v_lshlrev_b32 v249, 4, v0
    v_add_u32 v250, 49152, v249
    v_add_u32 v251, 8192, v249
    v_mov_b32 v40, 0x40000000
    v_cmp_gt_u32 vcc, 64, v0
    s_nop 1
    v_cndmask_b32 v251, v40, v251, vcc
    s_mov_b32 s30, 0xffff0000
    s_lshl_b32 s17, s21, 4
    s_lshl_b32 s18, s19, 1
    s_add_u32 s17, s17, s18
    s_add_u32 s17, s17, s20
    s_mul_i32 s28, s17, 9216
    s_waitcnt lgkmcnt(0)
    s_mov_b32 s40, s14
    s_mov_b32 s41, s15
    s_mov_b32 s42, 2359296
    s_mov_b32 s43, 0x20000
    s_waitcnt vmcnt(8)
    v_mov_b32 v20, 2
    buffer_store_dword v20, v3, s[68:71], s82 offen offset:0 sc1
    ds_read_b64 v[232:233], v221 offset:0
    ds_read_b128 v[236:239], v222 offset:0
    s_waitcnt vmcnt(8)
    v_lshlrev_b32 v172, 16, v92
    v_and_b32 v173, s30, v92
    v_lshlrev_b32 v174, 16, v93
    v_and_b32 v175, s30, v93
    v_lshlrev_b32 v176, 16, v94
    v_and_b32 v177, s30, v94
    v_lshlrev_b32 v178, 16, v95
    v_and_b32 v179, s30, v95
    s_waitcnt vmcnt(7)
    v_lshlrev_b32 v228, 16, v96
    v_and_b32 v229, s30, v96
    v_pk_add_f32 v[172:173], v[172:173], v[228:229]
    v_lshlrev_b32 v230, 16, v97
    v_and_b32 v231, s30, v97
    v_pk_add_f32 v[174:175], v[174:175], v[230:231]
    v_lshlrev_b32 v228, 16, v98
    v_and_b32 v229, s30, v98
    v_pk_add_f32 v[176:177], v[176:177], v[228:229]
    v_lshlrev_b32 v230, 16, v99
    v_and_b32 v231, s30, v99
    v_pk_add_f32 v[178:179], v[178:179], v[230:231]
    s_waitcnt vmcnt(6)
    v_lshlrev_b32 v228, 16, v100
    v_and_b32 v229, s30, v100
    v_pk_add_f32 v[172:173], v[172:173], v[228:229]
    v_lshlrev_b32 v230, 16, v101
    v_and_b32 v231, s30, v101
    v_pk_add_f32 v[174:175], v[174:175], v[230:231]
    v_lshlrev_b32 v228, 16, v102
    v_and_b32 v229, s30, v102
    v_pk_add_f32 v[176:177], v[176:177], v[228:229]
    v_lshlrev_b32 v230, 16, v103
    v_and_b32 v231, s30, v103
    v_pk_add_f32 v[178:179], v[178:179], v[230:231]
    s_waitcnt vmcnt(5)
    v_lshlrev_b32 v228, 16, v104
    v_and_b32 v229, s30, v104
    v_pk_add_f32 v[172:173], v[172:173], v[228:229]
    v_lshlrev_b32 v230, 16, v105
    v_and_b32 v231, s30, v105
    v_pk_add_f32 v[174:175], v[174:175], v[230:231]
    v_lshlrev_b32 v228, 16, v106
    v_and_b32 v229, s30, v106
    v_pk_add_f32 v[176:177], v[176:177], v[228:229]
    v_lshlrev_b32 v230, 16, v107
    v_and_b32 v231, s30, v107
    v_pk_add_f32 v[178:179], v[178:179], v[230:231]
    v_permlane32_swap_b32 v172, v176
    v_permlane32_swap_b32 v173, v177
    v_permlane32_swap_b32 v174, v178
    v_permlane32_swap_b32 v175, v179
    v_pk_add_f32 v[172:173], v[172:173], v[176:177]
    v_pk_add_f32 v[174:175], v[174:175], v[178:179]
    s_waitcnt lgkmcnt(1)
    v_lshlrev_b32 v228, 16, v232
    v_and_b32 v229, s30, v232
    s_waitcnt lgkmcnt(0)
    v_pk_fma_f32 v[172:173], v[172:173], v[236:237], v[228:229]
    v_cvt_pk_bf16_f32 v232, v172, v173
    v_lshlrev_b32 v228, 16, v233
    v_and_b32 v229, s30, v233
    v_pk_fma_f32 v[174:175], v[174:175], v[238:239], v[228:229]
    v_cvt_pk_bf16_f32 v233, v174, v175
    ds_write_b64 v221, v[232:233] offset:0
    ds_read_b64 v[240:241], v221 offset:128
    ds_read_b128 v[244:247], v222 offset:256
    s_waitcnt vmcnt(4)
    v_lshlrev_b32 v172, 16, v124
    v_and_b32 v173, s30, v124
    v_lshlrev_b32 v174, 16, v125
    v_and_b32 v175, s30, v125
    v_lshlrev_b32 v176, 16, v126
    v_and_b32 v177, s30, v126
    v_lshlrev_b32 v178, 16, v127
    v_and_b32 v179, s30, v127
    s_waitcnt vmcnt(3)
    v_lshlrev_b32 v228, 16, v128
    v_and_b32 v229, s30, v128
    v_pk_add_f32 v[172:173], v[172:173], v[228:229]
    v_lshlrev_b32 v230, 16, v129
    v_and_b32 v231, s30, v129
    v_pk_add_f32 v[174:175], v[174:175], v[230:231]
    v_lshlrev_b32 v228, 16, v130
    v_and_b32 v229, s30, v130
    v_pk_add_f32 v[176:177], v[176:177], v[228:229]
    v_lshlrev_b32 v230, 16, v131
    v_and_b32 v231, s30, v131
    v_pk_add_f32 v[178:179], v[178:179], v[230:231]
    s_waitcnt vmcnt(2)
    v_lshlrev_b32 v228, 16, v132
    v_and_b32 v229, s30, v132
    v_pk_add_f32 v[172:173], v[172:173], v[228:229]
    v_lshlrev_b32 v230, 16, v133
    v_and_b32 v231, s30, v133
    v_pk_add_f32 v[174:175], v[174:175], v[230:231]
    v_lshlrev_b32 v228, 16, v134
    v_and_b32 v229, s30, v134
    v_pk_add_f32 v[176:177], v[176:177], v[228:229]
    v_lshlrev_b32 v230, 16, v135
    v_and_b32 v231, s30, v135
    v_pk_add_f32 v[178:179], v[178:179], v[230:231]
    s_waitcnt vmcnt(1)
    v_lshlrev_b32 v228, 16, v136
    v_and_b32 v229, s30, v136
    v_pk_add_f32 v[172:173], v[172:173], v[228:229]
    v_lshlrev_b32 v230, 16, v137
    v_and_b32 v231, s30, v137
    v_pk_add_f32 v[174:175], v[174:175], v[230:231]
    v_lshlrev_b32 v228, 16, v138
    v_and_b32 v229, s30, v138
    v_pk_add_f32 v[176:177], v[176:177], v[228:229]
    v_lshlrev_b32 v230, 16, v139
    v_and_b32 v231, s30, v139
    v_pk_add_f32 v[178:179], v[178:179], v[230:231]
    v_permlane32_swap_b32 v172, v176
    v_permlane32_swap_b32 v173, v177
    v_permlane32_swap_b32 v174, v178
    v_permlane32_swap_b32 v175, v179
    v_pk_add_f32 v[172:173], v[172:173], v[176:177]
    v_pk_add_f32 v[174:175], v[174:175], v[178:179]
    s_waitcnt lgkmcnt(1)
    v_lshlrev_b32 v228, 16, v240
    v_and_b32 v229, s30, v240
    s_waitcnt lgkmcnt(0)
    v_pk_fma_f32 v[172:173], v[172:173], v[244:245], v[228:229]
    v_cvt_pk_bf16_f32 v240, v172, v173
    v_lshlrev_b32 v228, 16, v241
    v_and_b32 v229, s30, v241
    v_pk_fma_f32 v[174:175], v[174:175], v[246:247], v[228:229]
    v_cvt_pk_bf16_f32 v241, v174, v175
    ds_write_b64 v221, v[240:241] offset:128
    s_mov_b32 s17, 0
k4_kernel_rw:
    buffer_load_dword v19, v21, s[68:71], s81 offen offset:0 sc1
    s_add_u32 s17, s17, 1
    s_cmp_ge_u32 s17, 400000
    s_waitcnt vmcnt(0)
    s_cbranch_scc1 k4_kernel_rwx
    v_cmp_gt_u32 vcc, 2, v19
    s_nop 1
    s_cbranch_vccz k4_kernel_rwx
    s_sleep 1
    s_branch k4_kernel_rw
k4_kernel_rwx:
k4_kernel_rgo:
    s_add_u32 s44, s32, 32768
    buffer_load_dwordx4 v[108:111], v4, s[72:75], s44 offen sc1
    s_add_u32 s44, s32, 4751360
    buffer_load_dwordx4 v[112:115], v4, s[72:75], s44 offen sc1
    s_add_u32 s44, s32, 9469952
    buffer_load_dwordx4 v[116:119], v4, s[72:75], s44 offen sc1
    s_add_u32 s44, s32, 14188544
    buffer_load_dwordx4 v[120:123], v4, s[72:75], s44 offen sc1
    s_add_u32 s44, s32, 49152
    buffer_load_dwordx4 v[140:143], v4, s[72:75], s44 offen sc1
    s_add_u32 s44, s32, 4767744
    buffer_load_dwordx4 v[144:147], v4, s[72:75], s44 offen sc1
    s_add_u32 s44, s32, 9486336
    buffer_load_dwordx4 v[148:151], v4, s[72:75], s44 offen sc1
    s_add_u32 s44, s32, 14204928
    buffer_load_dwordx4 v[152:155], v4, s[72:75], s44 offen sc1
    s_add_u32 s44, s33, 0
    buffer_load_dwordx4 v[156:159], v226, s[72:75], s44 offen sc1
    s_add_u32 s44, s33, 9437184
    buffer_load_dwordx4 v[160:163], v226, s[72:75], s44 offen sc1
    ds_read_b64 v[232:233], v221 offset:256
    ds_read_b128 v[236:239], v222 offset:512
    s_waitcnt vmcnt(9)
    v_lshlrev_b32 v172, 16, v108
    v_and_b32 v173, s30, v108
    v_lshlrev_b32 v174, 16, v109
    v_and_b32 v175, s30, v109
    v_lshlrev_b32 v176, 16, v110
    v_and_b32 v177, s30, v110
    v_lshlrev_b32 v178, 16, v111
    v_and_b32 v179, s30, v111
    s_waitcnt vmcnt(8)
    v_lshlrev_b32 v228, 16, v112
    v_and_b32 v229, s30, v112
    v_pk_add_f32 v[172:173], v[172:173], v[228:229]
    v_lshlrev_b32 v230, 16, v113
    v_and_b32 v231, s30, v113
    v_pk_add_f32 v[174:175], v[174:175], v[230:231]
    v_lshlrev_b32 v228, 16, v114
    v_and_b32 v229, s30, v114
    v_pk_add_f32 v[176:177], v[176:177], v[228:229]
    v_lshlrev_b32 v230, 16, v115
    v_and_b32 v231, s30, v115
    v_pk_add_f32 v[178:179], v[178:179], v[230:231]
    s_waitcnt vmcnt(7)
    v_lshlrev_b32 v228, 16, v116
    v_and_b32 v229, s30, v116
    v_pk_add_f32 v[172:173], v[172:173], v[228:229]
    v_lshlrev_b32 v230, 16, v117
    v_and_b32 v231, s30, v117
    v_pk_add_f32 v[174:175], v[174:175], v[230:231]
    v_lshlrev_b32 v228, 16, v118
    v_and_b32 v229, s30, v118
    v_pk_add_f32 v[176:177], v[176:177], v[228:229]
    v_lshlrev_b32 v230, 16, v119
    v_and_b32 v231, s30, v119
    v_pk_add_f32 v[178:179], v[178:179], v[230:231]
    s_waitcnt vmcnt(6)
    v_lshlrev_b32 v228, 16, v120
    v_and_b32 v229, s30, v120
    v_pk_add_f32 v[172:173], v[172:173], v[228:229]
    v_lshlrev_b32 v230, 16, v121
    v_and_b32 v231, s30, v121
    v_pk_add_f32 v[174:175], v[174:175], v[230:231]
    v_lshlrev_b32 v228, 16, v122
    v_and_b32 v229, s30, v122
    v_pk_add_f32 v[176:177], v[176:177], v[228:229]
    v_lshlrev_b32 v230, 16, v123
    v_and_b32 v231, s30, v123
    v_pk_add_f32 v[178:179], v[178:179], v[230:231]
    v_permlane32_swap_b32 v172, v176
    v_permlane32_swap_b32 v173, v177
    v_permlane32_swap_b32 v174, v178
    v_permlane32_swap_b32 v175, v179
    v_pk_add_f32 v[172:173], v[172:173], v[176:177]
    v_pk_add_f32 v[174:175], v[174:175], v[178:179]
    s_waitcnt lgkmcnt(1)
    v_lshlrev_b32 v228, 16, v232
    v_and_b32 v229, s30, v232
    s_waitcnt lgkmcnt(0)
    v_pk_fma_f32 v[172:173], v[172:173], v[236:237], v[228:229]
    v_cvt_pk_bf16_f32 v232, v172, v173
    v_lshlrev_b32 v228, 16, v233
    v_and_b32 v229, s30, v233
    v_pk_fma_f32 v[174:175], v[174:175], v[238:239], v[228:229]
    v_cvt_pk_bf16_f32 v233, v174, v175
    ds_write_b64 v221, v[232:233] offset:256
    ds_read_b64 v[240:241], v221 offset:384
    ds_read_b128 v[244:247], v222 offset:768
    s_waitcnt vmcnt(5)
    v_lshlrev_b32 v172, 16, v140
    v_and_b32 v173, s30, v140
    v_lshlrev_b32 v174, 16, v141
    v_and_b32 v175, s30, v141
    v_lshlrev_b32 v176, 16, v142
    v_and_b32 v177, s30, v142
    v_lshlrev_b32 v178, 16, v143
    v_and_b32 v179, s30, v143
    s_waitcnt vmcnt(4)
    v_lshlrev_b32 v228, 16, v144
    v_and_b32 v229, s30, v144
    v_pk_add_f32 v[172:173], v[172:173], v[228:229]
    v_lshlrev_b32 v230, 16, v145
    v_and_b32 v231, s30, v145
    v_pk_add_f32 v[174:175], v[174:175], v[230:231]
    v_lshlrev_b32 v228, 16, v146
    v_and_b32 v229, s30, v146
    v_pk_add_f32 v[176:177], v[176:177], v[228:229]
    v_lshlrev_b32 v230, 16, v147
    v_and_b32 v231, s30, v147
    v_pk_add_f32 v[178:179], v[178:179], v[230:231]
    s_waitcnt vmcnt(3)
    v_lshlrev_b32 v228, 16, v148
    v_and_b32 v229, s30, v148
    v_pk_add_f32 v[172:173], v[172:173], v[228:229]
    v_lshlrev_b32 v230, 16, v149
    v_and_b32 v231, s30, v149
    v_pk_add_f32 v[174:175], v[174:175], v[230:231]
    v_lshlrev_b32 v228, 16, v150
    v_and_b32 v229, s30, v150
    v_pk_add_f32 v[176:177], v[176:177], v[228:229]
    v_lshlrev_b32 v230, 16, v151
    v_and_b32 v231, s30, v151
    v_pk_add_f32 v[178:179], v[178:179], v[230:231]
    s_waitcnt vmcnt(2)
    v_lshlrev_b32 v228, 16, v152
    v_and_b32 v229, s30, v152
    v_pk_add_f32 v[172:173], v[172:173], v[228:229]
    v_lshlrev_b32 v230, 16, v153
    v_and_b32 v231, s30, v153
    v_pk_add_f32 v[174:175], v[174:175], v[230:231]
    v_lshlrev_b32 v228, 16, v154
    v_and_b32 v229, s30, v154
    v_pk_add_f32 v[176:177], v[176:177], v[228:229]
    v_lshlrev_b32 v230, 16, v155
    v_and_b32 v231, s30, v155
    v_pk_add_f32 v[178:179], v[178:179], v[230:231]
    v_permlane32_swap_b32 v172, v176
    v_permlane32_swap_b32 v173, v177
    v_permlane32_swap_b32 v174, v178
    v_permlane32_swap_b32 v175, v179
    v_pk_add_f32 v[172:173], v[172:173], v[176:177]
    v_pk_add_f32 v[174:175], v[174:175], v[178:179]
    s_waitcnt lgkmcnt(1)
    v_lshlrev_b32 v228, 16, v240
    v_and_b32 v229, s30, v240
    s_waitcnt lgkmcnt(0)
    v_pk_fma_f32 v[172:173], v[172:173], v[244:245], v[228:229]
    v_cvt_pk_bf16_f32 v240, v172, v173
    v_lshlrev_b32 v228, 16, v241
    v_and_b32 v229, s30, v241
    v_pk_fma_f32 v[174:175], v[174:175], v[246:247], v[228:229]
    v_cvt_pk_bf16_f32 v241, v174, v175
    ds_write_b64 v221, v[240:241] offset:384
    ds_read_b32 v232, v223
    ds_read_b64 v[236:237], v224
    s_waitcnt vmcnt(1)
    v_lshlrev_b32 v172, 16, v156
    v_and_b32 v173, s30, v156
    v_lshlrev_b32 v174, 16, v157
    v_and_b32 v175, s30, v157
    v_lshlrev_b32 v176, 16, v158
    v_and_b32 v177, s30, v158
    v_lshlrev_b32 v178, 16, v159
    v_and_b32 v179, s30, v159
    s_waitcnt vmcnt(0)
    v_lshlrev_b32 v228, 16, v160
    v_and_b32 v229, s30, v160
    v_pk_add_f32 v[172:173], v[172:173], v[228:229]
    v_lshlrev_b32 v230, 16, v161
    v_and_b32 v231, s30, v161
    v_pk_add_f32 v[174:175], v[174:175], v[230:231]
    v_lshlrev_b32 v228, 16, v162
k4_kernel_pg1_8:
    s_cbranch_execz k4_kernel_back1
    v_and_b32 v229, s30, v162
    v_pk_add_f32 v[176:177], v[176:177], v[228:229]
    v_lshlrev_b32 v230, 16, v163
    v_and_b32 v231, s30, v163
    v_pk_add_f32 v[178:179], v[178:179], v[230:231]
    v_permlane32_swap_b32 v172, v176
    v_permlane32_swap_b32 v173, v177
    v_permlane32_swap_b32 v174, v178
    v_permlane32_swap_b32 v175, v179
    v_pk_add_f32 v[172:173], v[172:173], v[176:177]
    v_pk_add_f32 v[174:175], v[174:175], v[178:179]
    s_nop 1
    v_permlane16_swap_b32 v172, v174
    v_permlane16_swap_b32 v173, v175
    v_pk_add_f32 v[172:173], v[172:173], v[174:175]
    s_waitcnt lgkmcnt(1)
    v_lshlrev_b32 v228, 16, v232
    v_and_b32 v229, s30, v232
    s_waitcnt lgkmcnt(0)
    v_pk_fma_f32 v[172:173], v[172:173], v[236:237], v[228:229]
    v_cvt_pk_bf16_f32 v232, v172, v173
    ds_write_b32 v223, v232
    s_waitcnt lgkmcnt(0)
    s_barrier
    ds_read_b128 v[92:95], v250 offset:0
    ds_read_b128 v[96:99], v250 offset:4096
    ds_read_b128 v[100:103], v250 offset:8192
    s_add_u32 s17, s28, 4096
    s_waitcnt lgkmcnt(2)
    buffer_store_dwordx4 v[92:95], v249, s[40:43], s28 offen sc1
    s_waitcnt lgkmcnt(1)
    buffer_store_dwordx4 v[96:99], v249, s[40:43], s17 offen sc1
    s_waitcnt lgkmcnt(0)
    buffer_store_dwordx4 v[100:103], v251, s[40:43], s28 offen sc1
    s_endpgm
k4_kernel_slow1:
    s_mov_b32 s17, 0
k4_kernel_spin1:
    buffer_load_dword v19, v3, s[68:71], s77 offen sc1
    s_waitcnt vmcnt(0)
    v_readfirstlane_b32 s18, v19
    s_nop 1
    s_cmp_ge_u32 s18, 1
    s_cbranch_scc1 k4_kernel_ok1
    s_sleep 2
    s_add_u32 s17, s17, 1
    s_cmp_lt_u32 s17, 400000
    s_cbranch_scc1 k4_kernel_spin1
    s_branch k4_kernel_ok1
k4_kernel_slow2:
    s_mov_b32 s17, 0
k4_kernel_spin2:
    buffer_load_dword v19, v3, s[68:71], s77 offen sc1
    s_waitcnt vmcnt(0)
    v_readfirstlane_b32 s18, v19
    s_nop 1
    s_cmp_ge_u32 s18, 2
    s_cbranch_scc1 k4_kernel_ok2
    s_sleep 2
    s_add_u32 s17, s17, 1
    s_cmp_lt_u32 s17, 400000
    s_cbranch_scc1 k4_kernel_spin2
    s_branch k4_kernel_ok2
k4_kernel_slowg1:
    s_mov_b32 s17, 0
k4_kernel_sg1:
    buffer_load_dword v19, v21, s[68:71], s81 offen offset:0 sc1
    s_add_u32 s17, s17, 1
    s_cmp_ge_u32 s17, 400000
    s_waitcnt vmcnt(0)
    s_cbranch_scc1 k4_kernel_sg1x
    v_cmp_gt_u32 vcc, 1, v19
    s_nop 1
    s_cbranch_vccz k4_kernel_sg1x
    s_sleep 1
    s_branch k4_kernel_sg1
k4_kernel_sg1x:
    s_branch k4_kernel_okg1
k4_kernel_end:
    s_endpgm
.p2align 8
.type tabs,@object
tabs:
.long 0x3f803f80,0x3f803f80,0x3f803f80,0x3f803f80,0x3f713f80,0x3f003f44,0xbe323e32,0xbf44bf00
.long 0x3f443f80,0xbf003e32,0xbf71bf71,0x3e32bf00,0x3f003f80,0xbf80bf00,0x3f00bf00,0x3f003f80
.long 0x3e323f80,0xbf00bf71,0x3f443f44,0xbf71bf00,0xbe323f80,0x3f00bf71,0xbf443f44,0x3f71bf00
.long 0xbf003f80,0x3f80bf00,0xbf00bf00,0xbf003f80,0xbf443f80,0x3f003e32,0x3f71bf71,0xbe32bf00
.long 0xbf713f80,0xbf003f44,0x3e323e32,0x3f44bf00,0xbf803f80,0xbf803f80,0xbf803f80,0xbf803f80
.long 0x0,0x0,0x0,0x0,0x0,0x0,0x0,0x0
.long 0x0,0x0,0x0,0x0,0x0,0x0,0x0,0x0
.long 0x0,0x0,0x0,0x0,0x0,0x0,0x0,0x0
.long 0x3f803f80,0x3f803f80,0x3f803f80,0x3f803f80,0xbf80bf71,0xbf44bf71,0xbe32bf00,0x3f003e32
.long 0x3f803f44,0x3e323f44,0xbf71bf00,0xbf00bf71,0xbf80bf00,0x3f00bf00,0x3f003f80,0xbf80bf00
.long 0x3f803e32,0xbf713e32,0x3f44bf00,0xbf003f44,0xbf803e32,0x3f713e32,0xbf44bf00,0x3f003f44
.long 0x3f80bf00,0xbf00bf00,0xbf003f80,0x3f80bf00,0xbf803f44,0xbe323f44,0x3f71bf00,0x3f00bf71
.long 0x3f80bf71,0x3f44bf71,0x3e32bf00,0xbf003e32,0xbf803f80,0xbf803f80,0xbf803f80,0xbf803f80
.long 0x0,0x0,0x0,0x0,0x0,0x0,0x0,0x0
.long 0x0,0x0,0x0,0x0,0x0,0x0,0x0,0x0
.long 0x0,0x0,0x0,0x0,0x0,0x0,0x0,0x0
.long 0x3f803f80,0x0,0x0,0x0,0x3f713f44,0x0,0x0,0x0
.long 0x3f443e32,0x0,0x0,0x0,0x3f00bf00,0x0,0x0,0x0
.long 0x3e32bf71,0x0,0x0,0x0,0xbe32bf71,0x0,0x0,0x0
.long 0xbf00bf00,0x0,0x0,0x0,0xbf443e32,0x0,0x0,0x0
.long 0xbf713f44,0x0,0x0,0x0,0xbf803f80,0x0,0x0,0x0
.long 0x0,0x0,0x0,0x0,0x0,0x0,0x0,0x0
.long 0x0,0x0,0x0,0x0,0x0,0x0,0x0,0x0
.long 0x0,0x0,0x0,0x0,0x0,0x0,0x0,0x0
.long 0x0,0x0,0x0,0x0,0x0,0x0,0x0,0x0
.long 0x0,0x0,0x0,0x0,0x0,0x0,0x0,0x0
.long 0x0,0x0,0x0,0x0,0x0,0x0,0x0,0x0
.long 0x0,0x0,0x0,0x0,0x0,0x0,0x0,0x0
.long 0x0,0x0,0x0,0x0,0x0,0x0,0x0,0x0
.long 0x0,0x0,0x0,0x0,0x0,0x0,0x0,0x0
.long 0x0,0x0,0x0,0x0,0x0,0x0,0x0,0x0
.long 0x0,0x0,0x0,0x0,0x0,0x0,0x0,0x0
.long 0x80008000,0x80008000,0x80008000,0x80008000,0xbeaf8000,0xbf5ebf25,0xbf7cbf7c,0xbf25bf5e
.long 0xbf258000,0xbf5ebf7c,0x3eafbeaf,0x3f7c3f5e,0xbf5e8000,0x8000bf5e,0x3f5e3f5e,0xbf5e8000
.long 0xbf7c8000,0x3f5ebeaf,0xbf253f25,0x3eafbf5e,0xbf7c8000,0x3f5e3eaf,0xbf25bf25,0x3eaf3f5e
.long 0xbf5e8000,0x80003f5e,0x3f5ebf5e,0xbf5e8000,0xbf258000,0xbf5e3f7c,0x3eaf3eaf,0x3f7cbf5e
.long 0xbeaf8000,0xbf5e3f25,0xbf7c3f7c,0xbf253f5e,0x80008000,0x80008000,0x80008000,0x80008000
.long 0x0,0x0,0x0,0x0,0x0,0x0,0x0,0x0
.long 0x0,0x0,0x0,0x0,0x0,0x0,0x0,0x0
.long 0x0,0x0,0x0,0x0,0x0,0x0,0x0,0x0
.long 0x80008000,0x80008000,0x80008000,0x80008000,0x8000beaf,0x3f253eaf,0x3f7c3f5e,0x3f5e3f7c
.long 0x80003f25,0xbf7cbf25,0xbeafbf5e,0x3f5e3eaf,0x8000bf5e,0x3f5e3f5e,0xbf5e8000,0x8000bf5e
.long 0x80003f7c,0xbeafbf7c,0x3f253f5e,0xbf5ebf25,0x8000bf7c,0xbeaf3f7c,0x3f25bf5e,0xbf5e3f25
.long 0x80003f5e,0x3f5ebf5e,0xbf5e8000,0x80003f5e,0x8000bf25,0xbf7c3f25,0xbeaf3f5e,0x3f5ebeaf
.long 0x80003eaf,0x3f25beaf,0x3f7cbf5e,0x3f5ebf7c,0x80008000,0x80008000,0x80008000,0x80008000
.long 0x0,0x0,0x0,0x0,0x0,0x0,0x0,0x0
.long 0x0,0x0,0x0,0x0,0x0,0x0,0x0,0x0
.long 0x0,0x0,0x0,0x0,0x0,0x0,0x0,0x0
.long 0x80008000,0x0,0x0,0x0,0x3eaf3f25,0x0,0x0,0x0
.long 0x3f253f7c,0x0,0x0,0x0,0x3f5e3f5e,0x0,0x0,0x0
.long 0x3f7c3eaf,0x0,0x0,0x0,0x3f7cbeaf,0x0,0x0,0x0
.long 0x3f5ebf5e,0x0,0x0,0x0,0x3f25bf7c,0x0,0x0,0x0
.long 0x3eafbf25,0x0,0x0,0x0,0x80008000,0x0,0x0,0x0
.long 0x0,0x0,0x0,0x0,0x0,0x0,0x0,0x0
.long 0x0,0x0,0x0,0x0,0x0,0x0,0x0,0x0
.long 0x0,0x0,0x0,0x0,0x0,0x0,0x0,0x0
.long 0x0,0x0,0x0,0x0,0x0,0x0,0x0,0x0
.long 0x0,0x0,0x0,0x0,0x0,0x0,0x0,0x0
.long 0x0,0x0,0x0,0x0,0x0,0x0,0x0,0x0
.long 0x0,0x0,0x0,0x0,0x0,0x0,0x0,0x0
.long 0x0,0x0,0x0,0x0,0x0,0x0,0x0,0x0
.long 0x0,0x0,0x0,0x0,0x0,0x0,0x0,0x0
.long 0x0,0x0,0x0,0x0,0x0,0x0,0x0,0x0
.long 0x0,0x0,0x0,0x0,0x0,0x0,0x0,0x0
.long 0x3f800000,0x3f800000,0x3f800000,0x3f800000,0x3f800000,0x3f7ffc1a,0x3f7ff067,0x3f7fdce9
.long 0x3f800000,0x3f7ff067,0x3f7fc1a0,0x3f7f73af,0x3f800000,0x3f7fdce9,0x3f7f73af,0x3f7ec46d
.long 0x3f800000,0x3f7fc1a0,0x3f7f069e,0x3f7dcf55,0x3f800000,0x3f7f9e8c,0x3f7e7a7a,0x3f7c94a8
.long 0x3f800000,0x3f7f73af,0x3f7dcf55,0x3f7b14be,0x3f800000,0x3f7f4109,0x3f7d0543,0x3f795000
.long 0x3f800000,0x3f7f069e,0x3f7c1c5c,0x3f7746ea,0x3f800000,0x3f7ec46d,0x3f7b14be,0x3f74fa0b
.long 0x3f800000,0x3f7e7a7a,0x3f79ee89,0x3f726a03,0x3f800000,0x3f7e28c6,0x3f78a9e0,0x3f6f9788
.long 0x3f800000,0x3f7dcf55,0x3f7746ea,0x3f6c835e,0x3f800000,0x3f7d6e28,0x3f75c5d4,0x3f692e5f
.long 0x3f800000,0x3f7d0543,0x3f7426cb,0x3f659974,0x3f800000,0x3f7c94a8,0x3f726a03,0x3f61c598
.long 0x3f800000,0x3f800000,0x3f800000,0x3f800000,0x3f7fc1a0,0x3f7f9e8c,0x3f7f73af,0x3f7f4109
.long 0x3f7f069e,0x3f7e7a7a,0x3f7dcf55,0x3f7d0543,0x3f7dcf55,0x3f7c94a8,0x3f7b14be,0x3f795000
.long 0x3f7c1c5c,0x3f79ee89,0x3f7746ea,0x3f7426cb,0x3f79ee89,0x3f768a20,0x3f726a03,0x3f6d9156
.long 0x3f7746ea,0x3f726a03,0x3f6c835e,0x3f659974,0x3f7426cb,0x3f6d9156,0x3f659974,0x3f5c4b07
.long 0x3f708fb2,0x3f6803ca,0x3f5db3d7,0x3f51b3f3,0x3f6c835e,0x3f61c598,0x3f54db31,0x3f45e403
.long 0x3f6803ca,0x3f5adb81,0x3f4b1934,0x3f38ecd8,0x3f631324,0x3f534aca,0x3f407893,0x3f2ae1c9
.long 0x3f5db3d7,0x3f4b1934,0x3f3504f3,0x3f1bd7ca,0x3f57e880,0x3f424cfe,0x3f28cae3,0x3f0be54a
.long 0x3f51b3f3,0x3f38ecd8,0x3f1bd7ca,0x3ef64429,0x3f4b1934,0x3f2effe8,0x3f0e39da,0x3ed34e56
.long 0x3f800000,0x3f800000,0x3f800000,0x3f800000,0x3f7f069e,0x3f7ec46d,0x3f7e7a7a,0x3f7e28c6
.long 0x3f7c1c5c,0x3f7b14be,0x3f79ee89,0x3f78a9e0,0x3f7746ea,0x3f74fa0b,0x3f726a03,0x3f6f9788
.long 0x3f708fb2,0x3f6c835e,0x3f6803ca,0x3f631324,0x3f6803ca,0x3f61c598,0x3f5adb81,0x3f534aca
.long 0x3f5db3d7,0x3f54db31,0x3f4b1934,0x3f407893,0x3f51b3f3,0x3f45e403,0x3f38ecd8,0x3f2ae1c9
.long 0x3f441b7d,0x3f3504f3,0x3f248dbb,0x3f12d5e8,0x3f3504f3,0x3f226799,0x3f0e39da,0x3ef15aea
.long 0x3f248dbb,0x3f0e39da,0x3eec6a50,0x3eb9917b,0x3f12d5e8,0x3ef15aea,0x3eb9917b,0x3e7e39c4
.long 0x3f000000,0x3ec3ef15,0x3e8483ee,0x3e05a8a8,0x3ed8616c,0x3e94a031,0x3e1bc63c,0x3c32b7da
.long 0x3eaf1d44,0x3e47c5c2,0x3d32aa3e,0xbddef599,0x3e8483ee,0x3dc8bd36,0xbd85f213,0xbe6886ae
.long 0x3f800000,0x3f800000,0x3f800000,0x3f800000,0x3f7dcf55,0x3f7d6e28,0x3f7d0543,0x3f7c94a8
.long 0x3f7746ea,0x3f75c5d4,0x3f7426cb,0x3f726a03,0x3f6c835e,0x3f692e5f,0x3f659974,0x3f61c598
.long 0x3f5db3d7,0x3f57e880,0x3f51b3f3,0x3f4b1934,0x3f4b1934,0x3f424cfe,0x3f38ecd8,0x3f2effe8
.long 0x3f3504f3,0x3f28cae3,0x3f1bd7ca,0x3f0e39da,0x3f1bd7ca,0x3f0be54a,0x3ef64429,0x3ed34e56
.long 0x3f000000,0x3ed8616c,0x3eaf1d44,0x3e8483ee,0x3ec3ef15,0x3e94a031,0x3e47c5c2,0x3dc8bd36
.long 0x3e8483ee,0x3e1bc63c,0x3d32aa3e,0xbd85f213,0x3e05a8a8,0x3c32b7da,0xbddef599,0xbe6886ae
.long 0x0,0xbe05a8a8,0xbe8483ee,0xbec3ef15,0xbe05a8a8,0xbe89e6f1,0xbece34d0,0xbf072f74
.long 0xbe8483ee,0xbece34d0,0xbf098c78,0xbf28cae3,0xbec3ef15,0xbf072f74,0xbf28cae3,0xbf45e403
.long 0x0,0x0,0x0,0x0,0x0,0x3c32b7da,0x3cb2b521,0x3d060472
.long 0x0,0x3cb2b521,0x3d32aa3e,0x3d85f213,0x0,0x3d060472,0x3d85f213,0x3dc8bd36
.long 0x0,0x3d32aa3e,0x3db27eb6,0x3e05a8a8,0x0,0x3d5f4a99,0x3ddef599,0x3e26ce12
.long 0x0,0x3d85f213,0x3e05a8a8,0x3e47c5c2,0x0,0x3d9c3ac6,0x3e1bc63c,0x3e6886ae
.long 0x0,0x3db27eb6,0x3e31d0d4,0x3e8483ee,0x0,0x3dc8bd36,0x3e47c5c2,0x3e94a031
.long 0x0,0x3ddef599,0x3e5da259,0x3ea493b7,0x0,0x3df52731,0x3e7363ee,0x3eb45a1e
.long 0x0,0x3e05a8a8,0x3e8483ee,0x3ec3ef15,0x0,0x3e10b9a6,0x3e8f45c0,0x3ed34e56
.long 0x0,0x3e1bc63c,0x3e99f61c,0x3ee273aa,0x0,0x3e26ce12,0x3ea493b7,0x3ef15aea
.long 0x0,0x0,0x0,0x0,0x3d32aa3e,0x3d5f4a99,0x3d85f213,0x3d9c3ac6
.long 0x3db27eb6,0x3ddef599,0x3e05a8a8,0x3e1bc63c,0x3e05a8a8,0x3e26ce12,0x3e47c5c2,0x3e6886ae
.long 0x3e31d0d4,0x3e5da259,0x3e8483ee,0x3e99f61c,0x3e5da259,0x3e89e6f1,0x3ea493b7,0x3ebec330
.long 0x3e8483ee,0x3ea493b7,0x3ec3ef15,0x3ee273aa,0x3e99f61c,0x3ebec330,0x3ee273aa,0x3f026926
.long 0x3eaf1d44,0x3ed8616c,0x3f000000,0x3f12d5e8,0x3ec3ef15,0x3ef15aea,0x3f0e39da,0x3f226799
.long 0x3ed8616c,0x3f04ce53,0x3f1bd7ca,0x3f310700,0x3eec6a50,0x3f108a14,0x3f28cae3,0x3f3e9e4b
.long 0x3f000000,0x3f1bd7ca,0x3f3504f3,0x3f4b1934,0x3f098c78,0x3f26aed9,0x3f407893,0x3f56651d
.long 0x3f12d5e8,0x3f310700,0x3f4b1934,0x3f60712a,0x3f1bd7ca,0x3f3ad85f,0x3f54db31,0x3f692e5f
.long 0x0,0x0,0x0,0x0,0x3db27eb6,0x3dc8bd36,0x3ddef599,0x3df52731
.long 0x3e31d0d4,0x3e47c5c2,0x3e5da259,0x3e7363ee,0x3e8483ee,0x3e94a031,0x3ea493b7,0x3eb45a1e
.long 0x3eaf1d44,0x3ec3ef15,0x3ed8616c,0x3eec6a50,0x3ed8616c,0x3ef15aea,0x3f04ce53,0x3f108a14
.long 0x3f000000,0x3f0e39da,0x3f1bd7ca,0x3f28cae3,0x3f12d5e8,0x3f226799,0x3f310700,0x3f3e9e4b
.long 0x3f248dbb,0x3f3504f3,0x3f441b7d,0x3f51b3f3,0x3f3504f3,0x3f45e403,0x3f54db31,0x3f61c598
.long 0x3f441b7d,0x3f54db31,0x3f631324,0x3f6e9811,0x3f51b3f3,0x3f61c598,0x3f6e9811,0x3f77fc2c
.long 0x3f5db3d7,0x3f6c835e,0x3f7746ea,0x3f7dcf55,0x3f6803ca,0x3f74fa0b,0x3f7d0543,0x3f7ffc1a
.long 0x3f708fb2,0x3f7b14be,0x3f7fc1a0,0x3f7e7a7a,0x3f7746ea,0x3f7ec46d,0x3f7f73af,0x3f795000
.long 0x0,0x0,0x0,0x0,0x3e05a8a8,0x3e10b9a6,0x3e1bc63c,0x3e26ce12
.long 0x3e8483ee,0x3e8f45c0,0x3e99f61c,0x3ea493b7,0x3ec3ef15,0x3ed34e56,0x3ee273aa,0x3ef15aea
.long 0x3f000000,0x3f098c78,0x3f12d5e8,0x3f1bd7ca,0x3f1bd7ca,0x3f26aed9,0x3f310700,0x3f3ad85f
.long 0x3f3504f3,0x3f407893,0x3f4b1934,0x3f54db31,0x3f4b1934,0x3f56651d,0x3f60712a,0x3f692e5f
.long 0x3f5db3d7,0x3f6803ca,0x3f708fb2,0x3f7746ea,0x3f6c835e,0x3f74fa0b,0x3f7b14be,0x3f7ec46d
.long 0x3f7746ea,0x3f7d0543,0x3f7fc1a0,0x3f7f73af,0x3f7dcf55,0x3f7ffc1a,0x3f7e7a7a,0x3f795000
.long 0x3f800000,0x3f7dcf55,0x3f7746ea,0x3f6c835e,0x3f7dcf55,0x3f768a20,0x3f6a51da,0x3f596550
.long 0x3f7746ea,0x3f6a51da,0x3f57e880,0x3f407893,0x3f6c835e,0x3f596550,0x3f407893,0x3f226799
.long 0x3f800000,0x3f800000,0x3f800000,0x3f800000,0x3f7c1c5c,0x3f7b9c62,0x3f7b14be,0x3f7a8575
.long 0x3f708fb2,0x3f6e9811,0x3f6c835e,0x3f6a51da,0x3f5db3d7,0x3f596550,0x3f54db31,0x3f5016b8
.long 0x3f441b7d,0x3f3cbe35,0x3f3504f3,0x3f2cf37b,0x3f248dbb,0x3f199e45,0x3f0e39da,0x3f026926
.long 0x3f000000,0x3ee273aa,0x3ec3ef15,0x3ea493b7,0x3eaf1d44,0x3e89e6f1,0x3e47c5c2,0x3df52731
.long 0x3e31d0d4,0x3db27eb6,0x0,0xbdb27eb6,0x0,0xbdc8bd36,0xbe47c5c2,0xbe94a031
.long 0xbe31d0d4,0xbe8f45c0,0xbec3ef15,0xbef64429,0xbeaf1d44,0xbee77284,0xbf0e39da,0xbf26aed9
.long 0xbf000000,0xbf1bd7ca,0xbf3504f3,0xbf4b1934,0xbf248dbb,0xbf3e9e4b,0xbf54db31,0xbf66d223
.long 0xbf441b7d,0xbf5adb81,0xbf6c835e,0xbf78a9e0,0xbf5db3d7,0xbf6f9788,0xbf7b14be,0xbf7fdce9
.long 0x3f800000,0x3f800000,0x3f800000,0x3f800000,0x3f79ee89,0x3f795000,0x3f78a9e0,0x3f77fc2c
.long 0x3f6803ca,0x3f659974,0x3f631324,0x3f60712a,0x3f4b1934,0x3f45e403,0x3f407893,0x3f3ad85f
.long 0x3f248dbb,0x3f1bd7ca,0x3f12d5e8,0x3f098c78,0x3eec6a50,0x3ed34e56,0x3eb9917b,0x3e9f4757
.long 0x3e8483ee,0x3e47c5c2,0x3e05a8a8,0x3d85f213,0x3d32aa3e,0xbd060472,0xbddef599,0xbe3cce2b
.long 0xbe31d0d4,0xbe8483ee,0xbeaf1d44,0xbed8616c,0xbec3ef15,0xbef15aea,0xbf0e39da,0xbf226799
.long 0xbf12d5e8,0xbf28cae3,0xbf3cbe35,0xbf4e7327,0xbf3cbe35,0xbf5016b8,0xbf60712a,0xbf6d9156
.long 0xbf5db3d7,0xbf6c835e,0xbf7746ea,0xbf7dcf55,0xbf7426cb,0xbf7c94a8,0xbf7ff067,0xbf7e28c6
.long 0xbf7f069e,0xbf7f73af,0xbf79ee89,0xbf6e9811,0xbf7dcf55,0xbf74fa0b,0xbf659974,0xbf5016b8
.long 0x3f800000,0x3f800000,0x3f800000,0x3f800000,0x3f7746ea,0x3f768a20,0x3f75c5d4,0x3f74fa0b
.long 0x3f5db3d7,0x3f5adb81,0x3f57e880,0x3f54db31,0x3f3504f3,0x3f2effe8,0x3f28cae3,0x3f226799
.long 0x3f000000,0x3eec6a50,0x3ed8616c,0x3ec3ef15,0x3e8483ee,0x3e52b743,0x3e1bc63c,0x3dc8bd36
.long 0x0,0xbd85f213,0xbe05a8a8,0xbe47c5c2,0xbe8483ee,0xbea9db13,0xbece34d0,0xbef15aea
.long 0xbf000000,0xbf12d5e8,0xbf248dbb,0xbf3504f3,0xbf3504f3,0xbf45e403,0xbf54db31,0xbf61c598
.long 0xbf5db3d7,0xbf6a51da,0xbf7426cb,0xbf7b14be,0xbf7746ea,0xbf7d6e28,0xbf7ff067,0xbf7ec46d
.long 0xbf800000,0xbf7dcf55,0xbf7746ea,0xbf6c835e,0xbf7746ea,0xbf6b6e32,0xbf5adb81,0xbf45e403
.long 0xbf5db3d7,0xbf47a682,0xbf2cf37b,0xbf0e39da,0xbf3504f3,0xbf151d42,0xbee273aa,0xbe94a031
.long 0x3f800000,0x3f800000,0x3f800000,0x3f800000,0x3f7426cb,0x3f734c1c,0x3f726a03,0x3f718088
.long 0x3f51b3f3,0x3f4e7327,0x3f4b1934,0x3f47a682,0x3f1bd7ca,0x3f151d42,0x3f0e39da,0x3f072f74
.long 0x3eaf1d44,0x3e99f61c,0x3e8483ee,0x3e5da259,0x3d32aa3e,0xbc32b7da,0xbd85f213,0xbdf52731
.long 0xbe8483ee,0xbea493b7,0xbec3ef15,0xbee273aa,0xbf098c78,0xbf199e45,0xbf28cae3,0xbf36fbaf
.long 0xbf441b7d,0xbf51b3f3,0xbf5db3d7,0xbf6803ca,0xbf6c835e,0xbf74fa0b,0xbf7b14be,0xbf7ec46d
.long 0xbf7f069e,0xbf7ff067,0xbf7dcf55,0xbf78a9e0,0xbf79ee89,0xbf718088,0xbf659974,0xbf56651d
.long 0xbf5db3d7,0xbf4b1934,0xbf3504f3,0xbf1bd7ca,0xbf2cf37b,0xbf108a14,0xbee273aa,0xbe9f4757
.long 0xbed8616c,0xbe8f45c0,0xbe05a8a8,0x3cb2b521,0xbe05a8a8,0x3d060472,0x3e47c5c2,0x3eb45a1e
.long 0x0,0x0,0x0,0x0,0x3e31d0d4,0x3e3cce2b,0x3e47c5c2,0x3e52b743
.long 0x3eaf1d44,0x3eb9917b,0x3ec3ef15,0x3ece34d0,0x3f000000,0x3f072f74,0x3f0e39da,0x3f151d42
.long 0x3f248dbb,0x3f2cf37b,0x3f3504f3,0x3f3cbe35,0x3f441b7d,0x3f4cc94c,0x3f54db31,0x3f5c4b07
.long 0x3f5db3d7,0x3f659974,0x3f6c835e,0x3f726a03,0x3f708fb2,0x3f768a20,0x3f7b14be,0x3f7e28c6
.long 0x3f7c1c5c,0x3f7f069e,0x3f800000,0x3f7f069e,0x3f800000,0x3f7ec46d,0x3f7b14be,0x3f74fa0b
.long 0x3f7c1c5c,0x3f75c5d4,0x3f6c835e,0x3f60712a,0x3f708fb2,0x3f6459c6,0x3f54db31,0x3f424cfe
.long 0x3f5db3d7,0x3f4b1934,0x3f3504f3,0x3f1bd7ca,0x3f441b7d,0x3f2ae1c9,0x3f0e39da,0x3edd6dea
.long 0x3f248dbb,0x3f04ce53,0x3ec3ef15,0x3e7363ee,0x3f000000,0x3eb45a1e,0x3e47c5c2,0x3d060472
.long 0x0,0x0,0x0,0x0,0x3e5da259,0x3e6886ae,0x3e7363ee,0x3e7e39c4
.long 0x3ed8616c,0x3ee273aa,0x3eec6a50,0x3ef64429,0x3f1bd7ca,0x3f226799,0x3f28cae3,0x3f2effe8
.long 0x3f441b7d,0x3f4b1934,0x3f51b3f3,0x3f57e880,0x3f631324,0x3f692e5f,0x3f6e9811,0x3f734c1c
.long 0x3f7746ea,0x3f7b14be,0x3f7dcf55,0x3f7f73af,0x3f7fc1a0,0x3f7fdce9,0x3f7e7a7a,0x3f7b9c62
.long 0x3f7c1c5c,0x3f7746ea,0x3f708fb2,0x3f6803ca,0x3f6c835e,0x3f61c598,0x3f54db31,0x3f45e403
.long 0x3f51b3f3,0x3f407893,0x3f2cf37b,0x3f176012,0x3f2cf37b,0x3f151d42,0x3ef64429,0x3ebec330
.long 0x3f000000,0x3ec3ef15,0x3e8483ee,0x3e05a8a8,0x3e99f61c,0x3e26ce12,0x3cb2b521,0xbdf52731
.long 0x3db27eb6,0xbd85f213,0xbe5da259,0xbeb9917b,0xbe05a8a8,0xbe94a031,0xbee273aa,0xbf151d42
.long 0x0,0x0,0x0,0x0,0x3e8483ee,0x3e89e6f1,0x3e8f45c0,0x3e94a031
.long 0x3f000000,0x3f04ce53,0x3f098c78,0x3f0e39da,0x3f3504f3,0x3f3ad85f,0x3f407893,0x3f45e403
.long 0x3f5db3d7,0x3f631324,0x3f6803ca,0x3f6c835e,0x3f7746ea,0x3f7a8575,0x3f7d0543,0x3f7ec46d
.long 0x3f800000,0x3f7f73af,0x3f7dcf55,0x3f7b14be,0x3f7746ea,0x3f718088,0x3f6a51da,0x3f61c598
.long 0x3f5db3d7,0x3f51b3f3,0x3f441b7d,0x3f3504f3,0x3f3504f3,0x3f226799,0x3f0e39da,0x3ef15aea
.long 0x3f000000,0x3ece34d0,0x3e99f61c,0x3e47c5c2,0x3e8483ee,0x3e10b9a6,0x3cb2b521,0xbdc8bd36
.long 0x0,0xbe05a8a8,0xbe8483ee,0xbec3ef15,0xbe8483ee,0xbec91503,0xbf04ce53,0xbf226799
.long 0xbf000000,0xbf203c85,0xbf3cbe35,0xbf54db31,0xbf3504f3,0xbf5016b8,0xbf659974,0xbf74fa0b
.long 0x0,0x0,0x0,0x0,0x3e99f61c,0x3e9f4757,0x3ea493b7,0x3ea9db13
.long 0x3f12d5e8,0x3f176012,0x3f1bd7ca,0x3f203c85,0x3f4b1934,0x3f5016b8,0x3f54db31,0x3f596550
.long 0x3f708fb2,0x3f7426cb,0x3f7746ea,0x3f79ee89,0x3f7fc1a0,0x3f7ffc1a,0x3f7f73af,0x3f7e28c6
.long 0x3f7746ea,0x3f726a03,0x3f6c835e,0x3f659974,0x3f57e880,0x3f4cc94c,0x3f407893,0x3f3308b4
.long 0x3f248dbb,0x3f12d5e8,0x3f000000,0x3ed8616c,0x3ec3ef15,0x3e94a031,0x3e47c5c2,0x3dc8bd36
.long 0x3db27eb6,0xbcb2b521,0xbe05a8a8,0xbe7363ee,0xbe5da259,0xbea9db13,0xbee273aa,0xbf0be54a
.long 0xbf000000,0xbf1bd7ca,0xbf3504f3,0xbf4b1934,0xbf3cbe35,0xbf534aca,0xbf659974,0xbf734c1c
.long 0xbf6803ca,0xbf75c5d4,0xbf7dcf55,0xbf7ff067,0xbf7dcf55,0xbf7fdce9,0xbf7b14be,0xbf6f9788
.long 0x3f803f80,0x3f803f80,0x3f803f80,0x3f803f80,0x80008000,0x80008000,0x80008000,0x80008000
.long 0x3f7b3f80,0x3f553f6d,0xbf7bbf80,0xbf55bf6d,0xbe488000,0xbf0ebec4,0x3e488000,0x3f0e3ec4
.long 0x3f6d3f80,0x3ec43f35,0x3f6d3f80,0x3ec43f35,0xbec48000,0xbf6dbf35,0xbec48000,0xbf6dbf35
.long 0x3f553f80,0xbe483ec4,0xbf55bf80,0x3e48bec4,0xbf0e8000,0xbf7bbf6d,0x3f0e8000,0x3f7b3f6d
.long 0x3f353f80,0xbf350000,0x3f353f80,0xbf350000,0xbf358000,0xbf35bf80,0xbf358000,0xbf35bf80
.long 0x3f0e3f80,0xbf7bbec4,0xbf0ebf80,0x3f7b3ec4,0xbf558000,0xbe48bf6d,0x3f558000,0x3e483f6d
.long 0x3ec43f80,0xbf6dbf35,0x3ec43f80,0xbf6dbf35,0xbf6d8000,0x3ec4bf35,0xbf6d8000,0x3ec4bf35
.long 0x3e483f80,0xbf0ebf6d,0xbe48bf80,0x3f0e3f6d,0xbf7b8000,0x3f55bec4,0x3f7b8000,0xbf553ec4
.long 0x3f803f80,0x3f803f80,0x3f803f80,0x3f803f80,0x80008000,0x80008000,0x80008000,0x80008000
.long 0x3f0e3f35,0x3e483ec4,0xbf0ebf35,0xbe48bec4,0xbf55bf35,0xbf7bbf6d,0x3f553f35,0x3f7b3f6d
.long 0xbec40000,0xbf6dbf35,0xbec40000,0xbf6dbf35,0xbf6dbf80,0xbec4bf35,0xbf6dbf80,0xbec4bf35
.long 0xbf7bbf35,0xbf0ebf6d,0x3f7b3f35,0x3f0e3f6d,0xbe48bf35,0x3f553ec4,0x3e483f35,0xbf55bec4
.long 0xbf35bf80,0x3f350000,0xbf35bf80,0x3f350000,0x3f358000,0x3f353f80,0x3f358000,0x3f353f80
.long 0x3e48bf35,0x3f553f6d,0xbe483f35,0xbf55bf6d,0x3f7b3f35,0xbf0e3ec4,0xbf7bbf35,0x3f0ebec4
.long 0x3f6d0000,0xbec43f35,0x3f6d0000,0xbec43f35,0x3ec43f80,0xbf6dbf35,0x3ec43f80,0xbf6dbf35
.long 0x3f553f35,0xbf7bbec4,0xbf55bf35,0x3f7b3ec4,0xbf0e3f35,0x3e48bf6d,0x3f0ebf35,0xbe483f6d
.long 0x3f803f80,0x3f803f80,0x3f803f80,0x3f803f80,0x80008000,0x80008000,0x80008000,0x80008000
.long 0xbe480000,0xbf0ebec4,0x3e480000,0x3f0e3ec4,0xbf7bbf80,0xbf55bf6d,0x3f7b3f80,0x3f553f6d
.long 0xbf6dbf80,0xbec4bf35,0xbf6dbf80,0xbec4bf35,0x3ec48000,0x3f6d3f35,0x3ec48000,0x3f6d3f35
.long 0x3f0e0000,0x3f7b3f6d,0xbf0e0000,0xbf7bbf6d,0x3f553f80,0xbe483ec4,0xbf55bf80,0x3e48bec4
.long 0x3f353f80,0xbf350000,0x3f353f80,0xbf350000,0xbf358000,0xbf35bf80,0xbf358000,0xbf35bf80
.long 0xbf550000,0xbe48bf6d,0x3f550000,0x3e483f6d,0xbf0ebf80,0x3f7b3ec4,0x3f0e3f80,0xbf7bbec4
.long 0xbec4bf80,0x3f6d3f35,0xbec4bf80,0x3f6d3f35,0x3f6d8000,0xbec43f35,0x3f6d8000,0xbec43f35
.long 0x3f7b0000,0xbf553ec4,0xbf7b0000,0x3f55bec4,0x3e483f80,0xbf0ebf6d,0xbe48bf80,0x3f0e3f6d
.long 0x3f803f80,0x3f803f80,0x3f803f80,0x3f803f80,0x80008000,0x80008000,0x80008000,0x80008000
.long 0xbf55bf35,0xbf7bbf6d,0x3f553f35,0x3f7b3f6d,0xbf0ebf35,0xbe48bec4,0x3f0e3f35,0x3e483ec4
.long 0x3ec40000,0x3f6d3f35,0x3ec40000,0x3f6d3f35,0x3f6d3f80,0x3ec43f35,0x3f6d3f80,0x3ec43f35
.long 0x3e483f35,0xbf55bec4,0xbe48bf35,0x3f553ec4,0xbf7bbf35,0xbf0ebf6d,0x3f7b3f35,0x3f0e3f6d
.long 0xbf35bf80,0x3f350000,0xbf35bf80,0x3f350000,0x3f358000,0x3f353f80,0x3f358000,0x3f353f80
.long 0x3f7b3f35,0xbf0e3ec4,0xbf7bbf35,0x3f0ebec4,0xbe483f35,0xbf55bf6d,0x3e48bf35,0x3f553f6d
.long 0xbf6d0000,0x3ec4bf35,0xbf6d0000,0x3ec4bf35,0xbec4bf80,0x3f6d3f35,0xbec4bf80,0x3f6d3f35
.long 0x3f0ebf35,0xbe483f6d,0xbf0e3f35,0x3e48bf6d,0x3f553f35,0xbf7bbec4,0xbf55bf35,0x3f7b3ec4
.long 0x0,0x0,0x0,0x0,0x3f803f80,0x3f803f80,0x3f803f80,0x3f803f80
.long 0x3e480000,0x3f0e3ec4,0xbe480000,0xbf0ebec4,0x3f7b3f80,0x3f553f6d,0xbf7bbf80,0xbf55bf6d
.long 0x3ec40000,0x3f6d3f35,0x3ec40000,0x3f6d3f35,0x3f6d3f80,0x3ec43f35,0x3f6d3f80,0x3ec43f35
.long 0x3f0e0000,0x3f7b3f6d,0xbf0e0000,0xbf7bbf6d,0x3f553f80,0xbe483ec4,0xbf55bf80,0x3e48bec4
.long 0x3f350000,0x3f353f80,0x3f350000,0x3f353f80,0x3f353f80,0xbf350000,0x3f353f80,0xbf350000
.long 0x3f550000,0x3e483f6d,0xbf550000,0xbe48bf6d,0x3f0e3f80,0xbf7bbec4,0xbf0ebf80,0x3f7b3ec4
.long 0x3f6d0000,0xbec43f35,0x3f6d0000,0xbec43f35,0x3ec43f80,0xbf6dbf35,0x3ec43f80,0xbf6dbf35
.long 0x3f7b0000,0xbf553ec4,0xbf7b0000,0x3f55bec4,0x3e483f80,0xbf0ebf6d,0xbe48bf80,0x3f0e3f6d
.long 0x0,0x0,0x0,0x0,0x3f803f80,0x3f803f80,0x3f803f80,0x3f803f80
.long 0x3f553f35,0x3f7b3f6d,0xbf55bf35,0xbf7bbf6d,0x3f0e3f35,0x3e483ec4,0xbf0ebf35,0xbe48bec4
.long 0x3f6d3f80,0x3ec43f35,0x3f6d3f80,0x3ec43f35,0xbec40000,0xbf6dbf35,0xbec40000,0xbf6dbf35
.long 0x3e483f35,0xbf55bec4,0xbe48bf35,0x3f553ec4,0xbf7bbf35,0xbf0ebf6d,0x3f7b3f35,0x3f0e3f6d
.long 0xbf350000,0xbf35bf80,0xbf350000,0xbf35bf80,0xbf35bf80,0x3f350000,0xbf35bf80,0x3f350000
.long 0xbf7bbf35,0x3f0ebec4,0x3f7b3f35,0xbf0e3ec4,0x3e48bf35,0x3f553f6d,0xbe483f35,0xbf55bf6d
.long 0xbec4bf80,0x3f6d3f35,0xbec4bf80,0x3f6d3f35,0x3f6d0000,0xbec43f35,0x3f6d0000,0xbec43f35
.long 0x3f0ebf35,0xbe483f6d,0xbf0e3f35,0x3e48bf6d,0x3f553f35,0xbf7bbec4,0xbf55bf35,0x3f7b3ec4
.long 0x0,0x0,0x0,0x0,0x3f803f80,0x3f803f80,0x3f803f80,0x3f803f80
.long 0x3f7b3f80,0x3f553f6d,0xbf7bbf80,0xbf55bf6d,0xbe480000,0xbf0ebec4,0x3e480000,0x3f0e3ec4
.long 0xbec40000,0xbf6dbf35,0xbec40000,0xbf6dbf35,0xbf6dbf80,0xbec4bf35,0xbf6dbf80,0xbec4bf35
.long 0xbf55bf80,0x3e48bec4,0x3f553f80,0xbe483ec4,0x3f0e0000,0x3f7b3f6d,0xbf0e0000,0xbf7bbf6d
.long 0x3f350000,0x3f353f80,0x3f350000,0x3f353f80,0x3f353f80,0xbf350000,0x3f353f80,0xbf350000
.long 0x3f0e3f80,0xbf7bbec4,0xbf0ebf80,0x3f7b3ec4,0xbf550000,0xbe48bf6d,0x3f550000,0x3e483f6d
.long 0xbf6d0000,0x3ec4bf35,0xbf6d0000,0x3ec4bf35,0xbec4bf80,0x3f6d3f35,0xbec4bf80,0x3f6d3f35
.long 0xbe48bf80,0x3f0e3f6d,0x3e483f80,0xbf0ebf6d,0x3f7b0000,0xbf553ec4,0xbf7b0000,0x3f55bec4
.long 0x0,0x0,0x0,0x0,0x3f803f80,0x3f803f80,0x3f803f80,0x3f803f80
.long 0x3f0e3f35,0x3e483ec4,0xbf0ebf35,0xbe48bec4,0xbf55bf35,0xbf7bbf6d,0x3f553f35,0x3f7b3f6d
.long 0xbf6dbf80,0xbec4bf35,0xbf6dbf80,0xbec4bf35,0x3ec40000,0x3f6d3f35,0x3ec40000,0x3f6d3f35
.long 0x3f7b3f35,0x3f0e3f6d,0xbf7bbf35,0xbf0ebf6d,0x3e483f35,0xbf55bec4,0xbe48bf35,0x3f553ec4
.long 0xbf350000,0xbf35bf80,0xbf350000,0xbf35bf80,0xbf35bf80,0x3f350000,0xbf35bf80,0x3f350000
.long 0x3e48bf35,0x3f553f6d,0xbe483f35,0xbf55bf6d,0x3f7b3f35,0xbf0e3ec4,0xbf7bbf35,0x3f0ebec4
.long 0x3ec43f80,0xbf6dbf35,0x3ec43f80,0xbf6dbf35,0xbf6d0000,0x3ec4bf35,0xbf6d0000,0x3ec4bf35
.long 0xbf55bf35,0x3f7b3ec4,0x3f553f35,0xbf7bbec4,0x3f0ebf35,0xbe483f6d,0xbf0e3f35,0x3e48bf6d
.long 0x3f80,0xbf80,0x3f80,0xbf80,0xbf808000,0x3f808000,0xbf808000,0x3f808000
.long 0xbe483f80,0x3f0ebf6d,0x3e48bf80,0xbf0e3f6d,0xbf7b8000,0x3f553ec4,0x3f7b8000,0xbf55bec4
.long 0xbec43f80,0x3f6dbf35,0xbec43f80,0x3f6dbf35,0xbf6d8000,0x3ec43f35,0xbf6d8000,0x3ec43f35
.long 0xbf0e3f80,0x3f7bbec4,0x3f0ebf80,0xbf7b3ec4,0xbf558000,0xbe483f6d,0x3f558000,0x3e48bf6d
.long 0xbf353f80,0x3f350000,0xbf353f80,0x3f350000,0xbf358000,0xbf353f80,0xbf358000,0xbf353f80
.long 0xbf553f80,0x3e483ec4,0x3f55bf80,0xbe48bec4,0xbf0e8000,0xbf7b3f6d,0x3f0e8000,0x3f7bbf6d
.long 0xbf6d3f80,0xbec43f35,0xbf6d3f80,0xbec43f35,0xbec48000,0xbf6d3f35,0xbec48000,0xbf6d3f35
.long 0xbf7b3f80,0xbf553f6d,0x3f7bbf80,0x3f55bf6d,0xbe488000,0xbf0e3ec4,0x3e488000,0x3f0ebec4
.long 0x3f80,0xbf80,0x3f80,0xbf80,0xbf808000,0x3f808000,0xbf808000,0x3f808000
.long 0xbf553f35,0x3f7bbec4,0x3f55bf35,0xbf7b3ec4,0xbf0ebf35,0x3e483f6d,0x3f0e3f35,0xbe48bf6d
.long 0xbf6d0000,0x3ec43f35,0xbf6d0000,0x3ec43f35,0x3ec4bf80,0xbf6d3f35,0x3ec4bf80,0xbf6d3f35
.long 0xbe48bf35,0xbf553f6d,0x3e483f35,0x3f55bf6d,0x3f7bbf35,0xbf0ebec4,0xbf7b3f35,0x3f0e3ec4
.long 0x3f35bf80,0xbf350000,0x3f35bf80,0xbf350000,0x3f358000,0x3f35bf80,0x3f358000,0x3f35bf80
.long 0x3f7bbf35,0x3f0ebf6d,0xbf7b3f35,0xbf0e3f6d,0xbe483f35,0x3f55bec4,0x3e48bf35,0xbf553ec4
.long 0x3ec40000,0x3f6dbf35,0x3ec40000,0x3f6dbf35,0xbf6d3f80,0xbec43f35,0xbf6d3f80,0xbec43f35
.long 0xbf0e3f35,0xbe483ec4,0x3f0ebf35,0x3e48bec4,0xbf553f35,0xbf7b3f6d,0x3f55bf35,0x3f7bbf6d
.long 0x3f80,0xbf80,0x3f80,0xbf80,0xbf808000,0x3f808000,0xbf808000,0x3f808000
.long 0xbf7b0000,0x3f553ec4,0x3f7b0000,0xbf55bec4,0x3e48bf80,0xbf0e3f6d,0xbe483f80,0x3f0ebf6d
.long 0x3ec4bf80,0xbf6d3f35,0x3ec4bf80,0xbf6d3f35,0x3f6d8000,0xbec4bf35,0x3f6d8000,0xbec4bf35
.long 0x3f550000,0x3e48bf6d,0xbf550000,0xbe483f6d,0xbf0e3f80,0x3f7bbec4,0x3f0ebf80,0xbf7b3ec4
.long 0xbf353f80,0x3f350000,0xbf353f80,0x3f350000,0xbf358000,0xbf353f80,0xbf358000,0xbf353f80
.long 0xbf0e0000,0xbf7b3f6d,0x3f0e0000,0x3f7bbf6d,0x3f55bf80,0xbe48bec4,0xbf553f80,0x3e483ec4
.long 0x3f6dbf80,0x3ec4bf35,0x3f6dbf80,0x3ec4bf35,0x3ec48000,0x3f6dbf35,0x3ec48000,0x3f6dbf35
.long 0x3e480000,0x3f0ebec4,0xbe480000,0xbf0e3ec4,0xbf7b3f80,0xbf553f6d,0x3f7bbf80,0x3f55bf6d
.long 0x3f80,0xbf80,0x3f80,0xbf80,0xbf808000,0x3f808000,0xbf808000,0x3f808000
.long 0xbf0ebf35,0x3e483f6d,0x3f0e3f35,0xbe48bf6d,0x3f55bf35,0xbf7b3ec4,0xbf553f35,0x3f7bbec4
.long 0x3f6d0000,0xbec4bf35,0x3f6d0000,0xbec4bf35,0xbec43f80,0x3f6dbf35,0xbec43f80,0x3f6dbf35
.long 0xbf7b3f35,0x3f0e3ec4,0x3f7bbf35,0xbf0ebec4,0xbe48bf35,0xbf553f6d,0x3e483f35,0x3f55bf6d
.long 0x3f35bf80,0xbf350000,0x3f35bf80,0xbf350000,0x3f358000,0x3f35bf80,0x3f358000,0x3f35bf80
.long 0xbe483f35,0x3f55bec4,0x3e48bf35,0xbf553ec4,0xbf7b3f35,0xbf0e3f6d,0x3f7bbf35,0x3f0ebf6d
.long 0xbec40000,0xbf6d3f35,0xbec40000,0xbf6d3f35,0x3f6dbf80,0x3ec4bf35,0x3f6dbf80,0x3ec4bf35
.long 0x3f55bf35,0x3f7bbf6d,0xbf553f35,0xbf7b3f6d,0xbf0e3f35,0xbe483ec4,0x3f0ebf35,0x3e48bec4
.long 0x3f800000,0xbf800000,0x3f800000,0xbf800000,0x3f80,0xbf80,0x3f80,0xbf80
.long 0x3f7b0000,0xbf55bec4,0xbf7b0000,0x3f553ec4,0xbe483f80,0x3f0ebf6d,0x3e48bf80,0xbf0e3f6d
.long 0x3f6d0000,0xbec4bf35,0x3f6d0000,0xbec4bf35,0xbec43f80,0x3f6dbf35,0xbec43f80,0x3f6dbf35
.long 0x3f550000,0x3e48bf6d,0xbf550000,0xbe483f6d,0xbf0e3f80,0x3f7bbec4,0x3f0ebf80,0xbf7b3ec4
.long 0x3f350000,0x3f35bf80,0x3f350000,0x3f35bf80,0xbf353f80,0x3f350000,0xbf353f80,0x3f350000
.long 0x3f0e0000,0x3f7bbf6d,0xbf0e0000,0xbf7b3f6d,0xbf553f80,0x3e483ec4,0x3f55bf80,0xbe48bec4
.long 0x3ec40000,0x3f6dbf35,0x3ec40000,0x3f6dbf35,0xbf6d3f80,0xbec43f35,0xbf6d3f80,0xbec43f35
.long 0x3e480000,0x3f0ebec4,0xbe480000,0xbf0e3ec4,0xbf7b3f80,0xbf553f6d,0x3f7bbf80,0x3f55bf6d
.long 0x3f800000,0xbf800000,0x3f800000,0xbf800000,0x3f80,0xbf80,0x3f80,0xbf80
.long 0x3f0e3f35,0xbe48bf6d,0xbf0ebf35,0x3e483f6d,0xbf553f35,0x3f7bbec4,0x3f55bf35,0xbf7b3ec4
.long 0xbec43f80,0x3f6dbf35,0xbec43f80,0x3f6dbf35,0xbf6d0000,0x3ec43f35,0xbf6d0000,0x3ec43f35
.long 0xbf7b3f35,0x3f0e3ec4,0x3f7bbf35,0xbf0ebec4,0xbe48bf35,0xbf553f6d,0x3e483f35,0x3f55bf6d
.long 0xbf350000,0xbf353f80,0xbf350000,0xbf353f80,0x3f35bf80,0xbf350000,0x3f35bf80,0xbf350000
.long 0x3e48bf35,0xbf553ec4,0xbe483f35,0x3f55bec4,0x3f7bbf35,0x3f0ebf6d,0xbf7b3f35,0xbf0e3f6d
.long 0x3f6dbf80,0x3ec4bf35,0x3f6dbf80,0x3ec4bf35,0x3ec40000,0x3f6dbf35,0x3ec40000,0x3f6dbf35
.long 0x3f55bf35,0x3f7bbf6d,0xbf553f35,0xbf7b3f6d,0xbf0e3f35,0xbe483ec4,0x3f0ebf35,0x3e48bec4
.long 0x3f800000,0xbf800000,0x3f800000,0xbf800000,0x3f80,0xbf80,0x3f80,0xbf80
.long 0xbe483f80,0x3f0ebf6d,0x3e48bf80,0xbf0e3f6d,0xbf7b0000,0x3f553ec4,0x3f7b0000,0xbf55bec4
.long 0xbf6d0000,0x3ec43f35,0xbf6d0000,0x3ec43f35,0x3ec4bf80,0xbf6d3f35,0x3ec4bf80,0xbf6d3f35
.long 0x3f0ebf80,0xbf7b3ec4,0xbf0e3f80,0x3f7bbec4,0x3f550000,0x3e48bf6d,0xbf550000,0xbe483f6d
.long 0x3f350000,0x3f35bf80,0x3f350000,0x3f35bf80,0xbf353f80,0x3f350000,0xbf353f80,0x3f350000
.long 0xbf553f80,0x3e483ec4,0x3f55bf80,0xbe48bec4,0xbf0e0000,0xbf7b3f6d,0x3f0e0000,0x3f7bbf6d
.long 0xbec40000,0xbf6d3f35,0xbec40000,0xbf6d3f35,0x3f6dbf80,0x3ec4bf35,0x3f6dbf80,0x3ec4bf35
.long 0x3f7bbf80,0x3f55bf6d,0xbf7b3f80,0xbf553f6d,0x3e480000,0x3f0ebec4,0xbe480000,0xbf0e3ec4
.long 0x3f800000,0xbf800000,0x3f800000,0xbf800000,0x3f80,0xbf80,0x3f80,0xbf80
.long 0xbf553f35,0x3f7bbec4,0x3f55bf35,0xbf7b3ec4,0xbf0ebf35,0x3e483f6d,0x3f0e3f35,0xbe48bf6d
.long 0x3ec4bf80,0xbf6d3f35,0x3ec4bf80,0xbf6d3f35,0x3f6d0000,0xbec4bf35,0x3f6d0000,0xbec4bf35
.long 0x3e483f35,0x3f55bf6d,0xbe48bf35,0xbf553f6d,0xbf7b3f35,0x3f0e3ec4,0x3f7bbf35,0xbf0ebec4
.long 0xbf350000,0xbf353f80,0xbf350000,0xbf353f80,0x3f35bf80,0xbf350000,0x3f35bf80,0xbf350000
.long 0x3f7bbf35,0x3f0ebf6d,0xbf7b3f35,0xbf0e3f6d,0xbe483f35,0x3f55bec4,0x3e48bf35,0xbf553ec4
.long 0xbf6d3f80,0xbec43f35,0xbf6d3f80,0xbec43f35,0xbec40000,0xbf6d3f35,0xbec40000,0xbf6d3f35
.long 0x3f0ebf35,0x3e48bec4,0xbf0e3f35,0xbe483ec4,0x3f55bf35,0x3f7bbf6d,0xbf553f35,0xbf7b3f6d
.long 0xbf803f80,0xbf803f80,0xbf803f80,0xbf803f80,0x0,0x0,0x0,0x0
.long 0xbf7b3f80,0xbf553f6d,0x3f7bbf80,0x3f55bf6d,0xbe480000,0xbf0e3ec4,0x3e480000,0x3f0ebec4
.long 0xbf6d3f80,0xbec43f35,0xbf6d3f80,0xbec43f35,0xbec40000,0xbf6d3f35,0xbec40000,0xbf6d3f35
.long 0xbf553f80,0x3e483ec4,0x3f55bf80,0xbe48bec4,0xbf0e0000,0xbf7b3f6d,0x3f0e0000,0x3f7bbf6d
.long 0xbf353f80,0x3f350000,0xbf353f80,0x3f350000,0xbf350000,0xbf353f80,0xbf350000,0xbf353f80
.long 0xbf0e3f80,0x3f7bbec4,0x3f0ebf80,0xbf7b3ec4,0xbf550000,0xbe483f6d,0x3f550000,0x3e48bf6d
.long 0xbec43f80,0x3f6dbf35,0xbec43f80,0x3f6dbf35,0xbf6d0000,0x3ec43f35,0xbf6d0000,0x3ec43f35
.long 0xbe483f80,0x3f0ebf6d,0x3e48bf80,0xbf0e3f6d,0xbf7b0000,0x3f553ec4,0x3f7b0000,0xbf55bec4
.long 0xbf803f80,0xbf803f80,0xbf803f80,0xbf803f80,0x0,0x0,0x0,0x0
.long 0xbf0e3f35,0xbe483ec4,0x3f0ebf35,0x3e48bec4,0xbf553f35,0xbf7b3f6d,0x3f55bf35,0x3f7bbf6d
.long 0x3ec40000,0x3f6dbf35,0x3ec40000,0x3f6dbf35,0xbf6d3f80,0xbec43f35,0xbf6d3f80,0xbec43f35
.long 0x3f7bbf35,0x3f0ebf6d,0xbf7b3f35,0xbf0e3f6d,0xbe483f35,0x3f55bec4,0x3e48bf35,0xbf553ec4
.long 0x3f35bf80,0xbf350000,0x3f35bf80,0xbf350000,0x3f350000,0x3f35bf80,0x3f350000,0x3f35bf80
.long 0xbe48bf35,0xbf553f6d,0x3e483f35,0x3f55bf6d,0x3f7bbf35,0xbf0ebec4,0xbf7b3f35,0x3f0e3ec4
.long 0xbf6d0000,0x3ec43f35,0xbf6d0000,0x3ec43f35,0x3ec4bf80,0xbf6d3f35,0x3ec4bf80,0xbf6d3f35
.long 0xbf553f35,0x3f7bbec4,0x3f55bf35,0xbf7b3ec4,0xbf0ebf35,0x3e483f6d,0x3f0e3f35,0xbe48bf6d
.long 0xbf803f80,0xbf803f80,0xbf803f80,0xbf803f80,0x0,0x0,0x0,0x0
.long 0x3e480000,0x3f0ebec4,0xbe480000,0xbf0e3ec4,0xbf7b3f80,0xbf553f6d,0x3f7bbf80,0x3f55bf6d
.long 0x3f6dbf80,0x3ec4bf35,0x3f6dbf80,0x3ec4bf35,0x3ec40000,0x3f6dbf35,0x3ec40000,0x3f6dbf35
.long 0xbf0e0000,0xbf7b3f6d,0x3f0e0000,0x3f7bbf6d,0x3f55bf80,0xbe48bec4,0xbf553f80,0x3e483ec4
.long 0xbf353f80,0x3f350000,0xbf353f80,0x3f350000,0xbf350000,0xbf353f80,0xbf350000,0xbf353f80
.long 0x3f550000,0x3e48bf6d,0xbf550000,0xbe483f6d,0xbf0e3f80,0x3f7bbec4,0x3f0ebf80,0xbf7b3ec4
.long 0x3ec4bf80,0xbf6d3f35,0x3ec4bf80,0xbf6d3f35,0x3f6d0000,0xbec4bf35,0x3f6d0000,0xbec4bf35
.long 0xbf7b0000,0x3f553ec4,0x3f7b0000,0xbf55bec4,0x3e48bf80,0xbf0e3f6d,0xbe483f80,0x3f0ebf6d
.long 0xbf803f80,0xbf803f80,0xbf803f80,0xbf803f80,0x0,0x0,0x0,0x0
.long 0x3f55bf35,0x3f7bbf6d,0xbf553f35,0xbf7b3f6d,0xbf0e3f35,0xbe483ec4,0x3f0ebf35,0x3e48bec4
.long 0xbec40000,0xbf6d3f35,0xbec40000,0xbf6d3f35,0x3f6dbf80,0x3ec4bf35,0x3f6dbf80,0x3ec4bf35
.long 0xbe483f35,0x3f55bec4,0x3e48bf35,0xbf553ec4,0xbf7b3f35,0xbf0e3f6d,0x3f7bbf35,0x3f0ebf6d
.long 0x3f35bf80,0xbf350000,0x3f35bf80,0xbf350000,0x3f350000,0x3f35bf80,0x3f350000,0x3f35bf80
.long 0xbf7b3f35,0x3f0e3ec4,0x3f7bbf35,0xbf0ebec4,0xbe48bf35,0xbf553f6d,0x3e483f35,0x3f55bf6d
.long 0x3f6d0000,0xbec4bf35,0x3f6d0000,0xbec4bf35,0xbec43f80,0x3f6dbf35,0xbec43f80,0x3f6dbf35
.long 0xbf0ebf35,0x3e483f6d,0x3f0e3f35,0xbe48bf6d,0x3f55bf35,0xbf7b3ec4,0xbf553f35,0x3f7bbec4
.long 0x0,0x0,0x0,0x0,0x3f80bf80,0x3f80bf80,0x3f80bf80,0x3f80bf80
.long 0xbe480000,0xbf0e3ec4,0x3e480000,0x3f0ebec4,0x3f7bbf80,0x3f55bf6d,0xbf7b3f80,0xbf553f6d
.long 0xbec40000,0xbf6d3f35,0xbec40000,0xbf6d3f35,0x3f6dbf80,0x3ec4bf35,0x3f6dbf80,0x3ec4bf35
.long 0xbf0e0000,0xbf7b3f6d,0x3f0e0000,0x3f7bbf6d,0x3f55bf80,0xbe48bec4,0xbf553f80,0x3e483ec4
.long 0xbf350000,0xbf353f80,0xbf350000,0xbf353f80,0x3f35bf80,0xbf358000,0x3f35bf80,0xbf358000
.long 0xbf550000,0xbe483f6d,0x3f550000,0x3e48bf6d,0x3f0ebf80,0xbf7b3ec4,0xbf0e3f80,0x3f7bbec4
.long 0xbf6d0000,0x3ec43f35,0xbf6d0000,0x3ec43f35,0x3ec4bf80,0xbf6d3f35,0x3ec4bf80,0xbf6d3f35
.long 0xbf7b0000,0x3f553ec4,0x3f7b0000,0xbf55bec4,0x3e48bf80,0xbf0e3f6d,0xbe483f80,0x3f0ebf6d
.long 0x0,0x0,0x0,0x0,0x3f80bf80,0x3f80bf80,0x3f80bf80,0x3f80bf80
.long 0xbf553f35,0xbf7b3f6d,0x3f55bf35,0x3f7bbf6d,0x3f0ebf35,0x3e48bec4,0xbf0e3f35,0xbe483ec4
.long 0xbf6d3f80,0xbec43f35,0xbf6d3f80,0xbec43f35,0xbec48000,0xbf6d3f35,0xbec48000,0xbf6d3f35
.long 0xbe483f35,0x3f55bec4,0x3e48bf35,0xbf553ec4,0xbf7b3f35,0xbf0e3f6d,0x3f7bbf35,0x3f0ebf6d
.long 0x3f350000,0x3f35bf80,0x3f350000,0x3f35bf80,0xbf353f80,0x3f358000,0xbf353f80,0x3f358000
.long 0x3f7bbf35,0xbf0ebec4,0xbf7b3f35,0x3f0e3ec4,0x3e483f35,0x3f55bf6d,0xbe48bf35,0xbf553f6d
.long 0x3ec4bf80,0xbf6d3f35,0x3ec4bf80,0xbf6d3f35,0x3f6d8000,0xbec4bf35,0x3f6d8000,0xbec4bf35
.long 0xbf0ebf35,0x3e483f6d,0x3f0e3f35,0xbe48bf6d,0x3f55bf35,0xbf7b3ec4,0xbf553f35,0x3f7bbec4
.long 0x0,0x0,0x0,0x0,0x3f80bf80,0x3f80bf80,0x3f80bf80,0x3f80bf80
.long 0xbf7b3f80,0xbf553f6d,0x3f7bbf80,0x3f55bf6d,0xbe488000,0xbf0e3ec4,0x3e488000,0x3f0ebec4
.long 0x3ec40000,0x3f6dbf35,0x3ec40000,0x3f6dbf35,0xbf6d3f80,0xbec43f35,0xbf6d3f80,0xbec43f35
.long 0x3f55bf80,0xbe48bec4,0xbf553f80,0x3e483ec4,0x3f0e8000,0x3f7bbf6d,0xbf0e8000,0xbf7b3f6d
.long 0xbf350000,0xbf353f80,0xbf350000,0xbf353f80,0x3f35bf80,0xbf358000,0x3f35bf80,0xbf358000
.long 0xbf0e3f80,0x3f7bbec4,0x3f0ebf80,0xbf7b3ec4,0xbf558000,0xbe483f6d,0x3f558000,0x3e48bf6d
.long 0x3f6d0000,0xbec4bf35,0x3f6d0000,0xbec4bf35,0xbec43f80,0x3f6dbf35,0xbec43f80,0x3f6dbf35
.long 0x3e48bf80,0xbf0e3f6d,0xbe483f80,0x3f0ebf6d,0x3f7b8000,0xbf55bec4,0xbf7b8000,0x3f553ec4
.long 0x0,0x0,0x0,0x0,0x3f80bf80,0x3f80bf80,0x3f80bf80,0x3f80bf80
.long 0xbf0e3f35,0xbe483ec4,0x3f0ebf35,0x3e48bec4,0xbf553f35,0xbf7b3f6d,0x3f55bf35,0x3f7bbf6d
.long 0x3f6dbf80,0x3ec4bf35,0x3f6dbf80,0x3ec4bf35,0x3ec48000,0x3f6dbf35,0x3ec48000,0x3f6dbf35
.long 0xbf7b3f35,0xbf0e3f6d,0x3f7bbf35,0x3f0ebf6d,0x3e48bf35,0xbf553ec4,0xbe483f35,0x3f55bec4
.long 0x3f350000,0x3f35bf80,0x3f350000,0x3f35bf80,0xbf353f80,0x3f358000,0xbf353f80,0x3f358000
.long 0xbe48bf35,0xbf553f6d,0x3e483f35,0x3f55bf6d,0x3f7bbf35,0xbf0ebec4,0xbf7b3f35,0x3f0e3ec4
.long 0xbec43f80,0x3f6dbf35,0xbec43f80,0x3f6dbf35,0xbf6d8000,0x3ec43f35,0xbf6d8000,0x3ec43f35
.long 0x3f55bf35,0xbf7b3ec4,0xbf553f35,0x3f7bbec4,0x3f0e3f35,0xbe48bf6d,0xbf0ebf35,0x3e483f6d
.long 0x3f80,0xbf80,0x3f80,0xbf80,0xbf800000,0x3f800000,0xbf800000,0x3f800000
.long 0x3e483f80,0xbf0ebf6d,0xbe48bf80,0x3f0e3f6d,0xbf7b0000,0x3f55bec4,0x3f7b0000,0xbf553ec4
.long 0x3ec43f80,0xbf6dbf35,0x3ec43f80,0xbf6dbf35,0xbf6d0000,0x3ec4bf35,0xbf6d0000,0x3ec4bf35
.long 0x3f0e3f80,0xbf7bbec4,0xbf0ebf80,0x3f7b3ec4,0xbf550000,0xbe48bf6d,0x3f550000,0x3e483f6d
.long 0x3f353f80,0xbf350000,0x3f353f80,0xbf350000,0xbf350000,0xbf35bf80,0xbf350000,0xbf35bf80
.long 0x3f553f80,0xbe483ec4,0xbf55bf80,0x3e48bec4,0xbf0e0000,0xbf7bbf6d,0x3f0e0000,0x3f7b3f6d
.long 0x3f6d3f80,0x3ec43f35,0x3f6d3f80,0x3ec43f35,0xbec40000,0xbf6dbf35,0xbec40000,0xbf6dbf35
.long 0x3f7b3f80,0x3f553f6d,0xbf7bbf80,0xbf55bf6d,0xbe480000,0xbf0ebec4,0x3e480000,0x3f0e3ec4
.long 0x3f80,0xbf80,0x3f80,0xbf80,0xbf800000,0x3f800000,0xbf800000,0x3f800000
.long 0x3f553f35,0xbf7bbec4,0xbf55bf35,0x3f7b3ec4,0xbf0e3f35,0x3e48bf6d,0x3f0ebf35,0xbe483f6d
.long 0x3f6d0000,0xbec43f35,0x3f6d0000,0xbec43f35,0x3ec43f80,0xbf6dbf35,0x3ec43f80,0xbf6dbf35
.long 0x3e48bf35,0x3f553f6d,0xbe483f35,0xbf55bf6d,0x3f7b3f35,0xbf0e3ec4,0xbf7bbf35,0x3f0ebec4
.long 0xbf35bf80,0x3f350000,0xbf35bf80,0x3f350000,0x3f350000,0x3f353f80,0x3f350000,0x3f353f80
.long 0xbf7bbf35,0xbf0ebf6d,0x3f7b3f35,0x3f0e3f6d,0xbe48bf35,0x3f553ec4,0x3e483f35,0xbf55bec4
.long 0xbec40000,0xbf6dbf35,0xbec40000,0xbf6dbf35,0xbf6dbf80,0xbec4bf35,0xbf6dbf80,0xbec4bf35
.long 0x3f0e3f35,0x3e483ec4,0xbf0ebf35,0xbe48bec4,0xbf55bf35,0xbf7bbf6d,0x3f553f35,0x3f7b3f6d
.long 0x3f80,0xbf80,0x3f80,0xbf80,0xbf800000,0x3f800000,0xbf800000,0x3f800000
.long 0x3f7b0000,0xbf553ec4,0xbf7b0000,0x3f55bec4,0x3e483f80,0xbf0ebf6d,0xbe48bf80,0x3f0e3f6d
.long 0xbec4bf80,0x3f6d3f35,0xbec4bf80,0x3f6d3f35,0x3f6d0000,0xbec43f35,0x3f6d0000,0xbec43f35
.long 0xbf550000,0xbe48bf6d,0x3f550000,0x3e483f6d,0xbf0ebf80,0x3f7b3ec4,0x3f0e3f80,0xbf7bbec4
.long 0x3f353f80,0xbf350000,0x3f353f80,0xbf350000,0xbf350000,0xbf35bf80,0xbf350000,0xbf35bf80
.long 0x3f0e0000,0x3f7b3f6d,0xbf0e0000,0xbf7bbf6d,0x3f553f80,0xbe483ec4,0xbf55bf80,0x3e48bec4
.long 0xbf6dbf80,0xbec4bf35,0xbf6dbf80,0xbec4bf35,0x3ec40000,0x3f6d3f35,0x3ec40000,0x3f6d3f35
.long 0xbe480000,0xbf0ebec4,0x3e480000,0x3f0e3ec4,0xbf7bbf80,0xbf55bf6d,0x3f7b3f80,0x3f553f6d
.long 0x3f80,0xbf80,0x3f80,0xbf80,0xbf800000,0x3f800000,0xbf800000,0x3f800000
.long 0x3f0ebf35,0xbe483f6d,0xbf0e3f35,0x3e48bf6d,0x3f553f35,0xbf7bbec4,0xbf55bf35,0x3f7b3ec4
.long 0xbf6d0000,0x3ec4bf35,0xbf6d0000,0x3ec4bf35,0xbec4bf80,0x3f6d3f35,0xbec4bf80,0x3f6d3f35
.long 0x3f7b3f35,0xbf0e3ec4,0xbf7bbf35,0x3f0ebec4,0xbe483f35,0xbf55bf6d,0x3e48bf35,0x3f553f6d
.long 0xbf35bf80,0x3f350000,0xbf35bf80,0x3f350000,0x3f350000,0x3f353f80,0x3f350000,0x3f353f80
.long 0x3e483f35,0xbf55bec4,0xbe48bf35,0x3f553ec4,0xbf7bbf35,0xbf0ebf6d,0x3f7b3f35,0x3f0e3f6d
.long 0x3ec40000,0x3f6d3f35,0x3ec40000,0x3f6d3f35,0x3f6d3f80,0x3ec43f35,0x3f6d3f80,0x3ec43f35
.long 0xbf55bf35,0xbf7bbf6d,0x3f553f35,0x3f7b3f6d,0xbf0ebf35,0xbe48bec4,0x3f0e3f35,0x3e483ec4
.long 0xbf800000,0x3f800000,0xbf800000,0x3f800000,0x8000bf80,0x80003f80,0x8000bf80,0x80003f80
.long 0xbf7b0000,0x3f55bec4,0x3f7b0000,0xbf553ec4,0xbe48bf80,0x3f0e3f6d,0x3e483f80,0xbf0ebf6d
.long 0xbf6d0000,0x3ec4bf35,0xbf6d0000,0x3ec4bf35,0xbec4bf80,0x3f6d3f35,0xbec4bf80,0x3f6d3f35
.long 0xbf550000,0xbe48bf6d,0x3f550000,0x3e483f6d,0xbf0ebf80,0x3f7b3ec4,0x3f0e3f80,0xbf7bbec4
.long 0xbf350000,0xbf35bf80,0xbf350000,0xbf35bf80,0xbf35bf80,0x3f358000,0xbf35bf80,0x3f358000
.long 0xbf0e0000,0xbf7bbf6d,0x3f0e0000,0x3f7b3f6d,0xbf55bf80,0x3e48bec4,0x3f553f80,0xbe483ec4
.long 0xbec40000,0xbf6dbf35,0xbec40000,0xbf6dbf35,0xbf6dbf80,0xbec4bf35,0xbf6dbf80,0xbec4bf35
.long 0xbe480000,0xbf0ebec4,0x3e480000,0x3f0e3ec4,0xbf7bbf80,0xbf55bf6d,0x3f7b3f80,0x3f553f6d
.long 0xbf800000,0x3f800000,0xbf800000,0x3f800000,0x8000bf80,0x80003f80,0x8000bf80,0x80003f80
.long 0xbf0e3f35,0x3e48bf6d,0x3f0ebf35,0xbe483f6d,0xbf55bf35,0x3f7b3ec4,0x3f553f35,0xbf7bbec4
.long 0x3ec43f80,0xbf6dbf35,0x3ec43f80,0xbf6dbf35,0xbf6d8000,0x3ec4bf35,0xbf6d8000,0x3ec4bf35
.long 0x3f7b3f35,0xbf0e3ec4,0xbf7bbf35,0x3f0ebec4,0xbe483f35,0xbf55bf6d,0x3e48bf35,0x3f553f6d
.long 0x3f350000,0x3f353f80,0x3f350000,0x3f353f80,0x3f353f80,0xbf358000,0x3f353f80,0xbf358000
.long 0xbe48bf35,0x3f553ec4,0x3e483f35,0xbf55bec4,0x3f7b3f35,0x3f0e3f6d,0xbf7bbf35,0xbf0ebf6d
.long 0xbf6dbf80,0xbec4bf35,0xbf6dbf80,0xbec4bf35,0x3ec48000,0x3f6d3f35,0x3ec48000,0x3f6d3f35
.long 0xbf55bf35,0xbf7bbf6d,0x3f553f35,0x3f7b3f6d,0xbf0ebf35,0xbe48bec4,0x3f0e3f35,0x3e483ec4
.long 0xbf800000,0x3f800000,0xbf800000,0x3f800000,0x8000bf80,0x80003f80,0x8000bf80,0x80003f80
.long 0x3e483f80,0xbf0ebf6d,0xbe48bf80,0x3f0e3f6d,0xbf7b8000,0x3f55bec4,0x3f7b8000,0xbf553ec4
.long 0x3f6d0000,0xbec43f35,0x3f6d0000,0xbec43f35,0x3ec43f80,0xbf6dbf35,0x3ec43f80,0xbf6dbf35
.long 0xbf0ebf80,0x3f7b3ec4,0x3f0e3f80,0xbf7bbec4,0x3f558000,0x3e483f6d,0xbf558000,0xbe48bf6d
.long 0xbf350000,0xbf35bf80,0xbf350000,0xbf35bf80,0xbf35bf80,0x3f358000,0xbf35bf80,0x3f358000
.long 0x3f553f80,0xbe483ec4,0xbf55bf80,0x3e48bec4,0xbf0e8000,0xbf7bbf6d,0x3f0e8000,0x3f7b3f6d
.long 0x3ec40000,0x3f6d3f35,0x3ec40000,0x3f6d3f35,0x3f6d3f80,0x3ec43f35,0x3f6d3f80,0x3ec43f35
.long 0xbf7bbf80,0xbf55bf6d,0x3f7b3f80,0x3f553f6d,0x3e488000,0x3f0e3ec4,0xbe488000,0xbf0ebec4
.long 0xbf800000,0x3f800000,0xbf800000,0x3f800000,0x8000bf80,0x80003f80,0x8000bf80,0x80003f80
.long 0x3f553f35,0xbf7bbec4,0xbf55bf35,0x3f7b3ec4,0xbf0e3f35,0x3e48bf6d,0x3f0ebf35,0xbe483f6d
.long 0xbec4bf80,0x3f6d3f35,0xbec4bf80,0x3f6d3f35,0x3f6d8000,0xbec43f35,0x3f6d8000,0xbec43f35
.long 0xbe483f35,0xbf55bf6d,0x3e48bf35,0x3f553f6d,0xbf7bbf35,0x3f0ebec4,0x3f7b3f35,0xbf0e3ec4
.long 0x3f350000,0x3f353f80,0x3f350000,0x3f353f80,0x3f353f80,0xbf358000,0x3f353f80,0xbf358000
.long 0xbf7bbf35,0xbf0ebf6d,0x3f7b3f35,0x3f0e3f6d,0xbe48bf35,0x3f553ec4,0x3e483f35,0xbf55bec4
.long 0x3f6d3f80,0x3ec43f35,0x3f6d3f80,0x3ec43f35,0xbec48000,0xbf6dbf35,0xbec48000,0xbf6dbf35
.long 0xbf0ebf35,0xbe48bec4,0x3f0e3f35,0x3e483ec4,0x3f553f35,0x3f7b3f6d,0xbf55bf35,0xbf7bbf6d
.long 0x3f803f80,0x3f803f80,0x3f803f80,0x3f803f80,0x3f7b3f80,0x3f553f6d,0xbe480000,0xbf0ebec4
.long 0x3f6d3f80,0x3ec43f35,0xbf6dbf80,0xbec4bf35,0x3f553f80,0xbe483ec4,0x3f0e0000,0x3f7b3f6d
.long 0x3f353f80,0xbf350000,0x3f353f80,0xbf350000,0x3f0e3f80,0xbf7bbec4,0xbf550000,0xbe48bf6d
.long 0x3ec43f80,0xbf6dbf35,0xbec4bf80,0x3f6d3f35,0x3e483f80,0xbf0ebf6d,0x3f7b0000,0xbf553ec4
.long 0x3f80,0xbf80,0x3f80,0xbf80,0xbe483f80,0x3f0ebf6d,0xbf7b0000,0x3f553ec4
.long 0xbec43f80,0x3f6dbf35,0x3ec4bf80,0xbf6d3f35,0xbf0e3f80,0x3f7bbec4,0x3f550000,0x3e48bf6d
.long 0xbf353f80,0x3f350000,0xbf353f80,0x3f350000,0xbf553f80,0x3e483ec4,0xbf0e0000,0xbf7b3f6d
.long 0xbf6d3f80,0xbec43f35,0x3f6dbf80,0x3ec4bf35,0xbf7b3f80,0xbf553f6d,0x3e480000,0x3f0ebec4
.long 0xbf803f80,0xbf803f80,0xbf803f80,0xbf803f80,0xbf7b3f80,0xbf553f6d,0x3e480000,0x3f0ebec4
.long 0xbf6d3f80,0xbec43f35,0x3f6dbf80,0x3ec4bf35,0xbf553f80,0x3e483ec4,0xbf0e0000,0xbf7b3f6d
.long 0xbf353f80,0x3f350000,0xbf353f80,0x3f350000,0xbf0e3f80,0x3f7bbec4,0x3f550000,0x3e48bf6d
.long 0xbec43f80,0x3f6dbf35,0x3ec4bf80,0xbf6d3f35,0xbe483f80,0x3f0ebf6d,0xbf7b0000,0x3f553ec4
.long 0x3f80,0xbf80,0x3f80,0xbf80,0x3e483f80,0xbf0ebf6d,0x3f7b0000,0xbf553ec4
.long 0x3ec43f80,0xbf6dbf35,0xbec4bf80,0x3f6d3f35,0x3f0e3f80,0xbf7bbec4,0xbf550000,0xbe48bf6d
.long 0x3f353f80,0xbf350000,0x3f353f80,0xbf350000,0x3f553f80,0xbe483ec4,0x3f0e0000,0x3f7b3f6d
.long 0x3f6d3f80,0x3ec43f35,0xbf6dbf80,0xbec4bf35,0x3f7b3f80,0x3f553f6d,0xbe480000,0xbf0ebec4
.long 0x3f803f80,0x3f803f80,0x3f803f80,0x3f803f80,0x3f0e3f35,0x3e483ec4,0xbf55bf35,0xbf7bbf6d
.long 0xbec40000,0xbf6dbf35,0x3ec40000,0x3f6d3f35,0xbf7bbf35,0xbf0ebf6d,0x3e483f35,0xbf55bec4
.long 0xbf35bf80,0x3f350000,0xbf35bf80,0x3f350000,0x3e48bf35,0x3f553f6d,0x3f7b3f35,0xbf0e3ec4
.long 0x3f6d0000,0xbec43f35,0xbf6d0000,0x3ec4bf35,0x3f553f35,0xbf7bbec4,0x3f0ebf35,0xbe483f6d
.long 0x3f80,0xbf80,0x3f80,0xbf80,0xbf553f35,0x3f7bbec4,0xbf0ebf35,0x3e483f6d
.long 0xbf6d0000,0x3ec43f35,0x3f6d0000,0xbec4bf35,0xbe48bf35,0xbf553f6d,0xbf7b3f35,0x3f0e3ec4
.long 0x3f35bf80,0xbf350000,0x3f35bf80,0xbf350000,0x3f7bbf35,0x3f0ebf6d,0xbe483f35,0x3f55bec4
.long 0x3ec40000,0x3f6dbf35,0xbec40000,0xbf6d3f35,0xbf0e3f35,0xbe483ec4,0x3f55bf35,0x3f7bbf6d
.long 0xbf803f80,0xbf803f80,0xbf803f80,0xbf803f80,0xbf0e3f35,0xbe483ec4,0x3f55bf35,0x3f7bbf6d
.long 0x3ec40000,0x3f6dbf35,0xbec40000,0xbf6d3f35,0x3f7bbf35,0x3f0ebf6d,0xbe483f35,0x3f55bec4
.long 0x3f35bf80,0xbf350000,0x3f35bf80,0xbf350000,0xbe48bf35,0xbf553f6d,0xbf7b3f35,0x3f0e3ec4
.long 0xbf6d0000,0x3ec43f35,0x3f6d0000,0xbec4bf35,0xbf553f35,0x3f7bbec4,0xbf0ebf35,0x3e483f6d
.long 0x3f80,0xbf80,0x3f80,0xbf80,0x3f553f35,0xbf7bbec4,0x3f0ebf35,0xbe483f6d
.long 0x3f6d0000,0xbec43f35,0xbf6d0000,0x3ec4bf35,0x3e48bf35,0x3f553f6d,0x3f7b3f35,0xbf0e3ec4
.long 0xbf35bf80,0x3f350000,0xbf35bf80,0x3f350000,0xbf7bbf35,0xbf0ebf6d,0x3e483f35,0xbf55bec4
.long 0xbec40000,0xbf6dbf35,0x3ec40000,0x3f6d3f35,0x3f0e3f35,0x3e483ec4,0xbf55bf35,0xbf7bbf6d
.long 0x3f803f80,0x3f803f80,0x3f803f80,0x3f803f80,0xbf7bbf80,0xbf55bf6d,0x3e480000,0x3f0e3ec4
.long 0x3f6d3f80,0x3ec43f35,0xbf6dbf80,0xbec4bf35,0xbf55bf80,0x3e48bec4,0xbf0e0000,0xbf7bbf6d
.long 0x3f353f80,0xbf350000,0x3f353f80,0xbf350000,0xbf0ebf80,0x3f7b3ec4,0x3f550000,0x3e483f6d
.long 0x3ec43f80,0xbf6dbf35,0xbec4bf80,0x3f6d3f35,0xbe48bf80,0x3f0e3f6d,0xbf7b0000,0x3f55bec4
.long 0x3f80,0xbf80,0x3f80,0xbf80,0x3e48bf80,0xbf0e3f6d,0x3f7b0000,0xbf55bec4
.long 0xbec43f80,0x3f6dbf35,0x3ec4bf80,0xbf6d3f35,0x3f0ebf80,0xbf7b3ec4,0xbf550000,0xbe483f6d
.long 0xbf353f80,0x3f350000,0xbf353f80,0x3f350000,0x3f55bf80,0xbe48bec4,0x3f0e0000,0x3f7bbf6d
.long 0xbf6d3f80,0xbec43f35,0x3f6dbf80,0x3ec4bf35,0x3f7bbf80,0x3f55bf6d,0xbe480000,0xbf0e3ec4
.long 0xbf803f80,0xbf803f80,0xbf803f80,0xbf803f80,0x3f7bbf80,0x3f55bf6d,0xbe480000,0xbf0e3ec4
.long 0xbf6d3f80,0xbec43f35,0x3f6dbf80,0x3ec4bf35,0x3f55bf80,0xbe48bec4,0x3f0e0000,0x3f7bbf6d
.long 0xbf353f80,0x3f350000,0xbf353f80,0x3f350000,0x3f0ebf80,0xbf7b3ec4,0xbf550000,0xbe483f6d
.long 0xbec43f80,0x3f6dbf35,0x3ec4bf80,0xbf6d3f35,0x3e48bf80,0xbf0e3f6d,0x3f7b0000,0xbf55bec4
.long 0x3f80,0xbf80,0x3f80,0xbf80,0xbe48bf80,0x3f0e3f6d,0xbf7b0000,0x3f55bec4
.long 0x3ec43f80,0xbf6dbf35,0xbec4bf80,0x3f6d3f35,0xbf0ebf80,0x3f7b3ec4,0x3f550000,0x3e483f6d
.long 0x3f353f80,0xbf350000,0x3f353f80,0xbf350000,0xbf55bf80,0x3e48bec4,0xbf0e0000,0xbf7bbf6d
.long 0x3f6d3f80,0x3ec43f35,0xbf6dbf80,0xbec4bf35,0xbf7bbf80,0xbf55bf6d,0x3e480000,0x3f0e3ec4
.long 0x3f803f80,0x3f803f80,0x3f803f80,0x3f803f80,0xbf0ebf35,0xbe48bec4,0x3f553f35,0x3f7b3f6d
.long 0xbec40000,0xbf6dbf35,0x3ec40000,0x3f6d3f35,0x3f7b3f35,0x3f0e3f6d,0xbe48bf35,0x3f553ec4
.long 0xbf35bf80,0x3f350000,0xbf35bf80,0x3f350000,0xbe483f35,0xbf55bf6d,0xbf7bbf35,0x3f0ebec4
.long 0x3f6d0000,0xbec43f35,0xbf6d0000,0x3ec4bf35,0xbf55bf35,0x3f7b3ec4,0xbf0e3f35,0x3e48bf6d
.long 0x3f80,0xbf80,0x3f80,0xbf80,0x3f55bf35,0xbf7b3ec4,0x3f0e3f35,0xbe48bf6d
.long 0xbf6d0000,0x3ec43f35,0x3f6d0000,0xbec4bf35,0x3e483f35,0x3f55bf6d,0x3f7bbf35,0xbf0ebec4
.long 0x3f35bf80,0xbf350000,0x3f35bf80,0xbf350000,0xbf7b3f35,0xbf0e3f6d,0x3e48bf35,0xbf553ec4
.long 0x3ec40000,0x3f6dbf35,0xbec40000,0xbf6d3f35,0x3f0ebf35,0x3e48bec4,0xbf553f35,0xbf7b3f6d
.long 0xbf803f80,0xbf803f80,0xbf803f80,0xbf803f80,0x3f0ebf35,0x3e48bec4,0xbf553f35,0xbf7b3f6d
.long 0x3ec40000,0x3f6dbf35,0xbec40000,0xbf6d3f35,0xbf7b3f35,0xbf0e3f6d,0x3e48bf35,0xbf553ec4
.long 0x3f35bf80,0xbf350000,0x3f35bf80,0xbf350000,0x3e483f35,0x3f55bf6d,0x3f7bbf35,0xbf0ebec4
.long 0xbf6d0000,0x3ec43f35,0x3f6d0000,0xbec4bf35,0x3f55bf35,0xbf7b3ec4,0x3f0e3f35,0xbe48bf6d
.long 0x3f80,0xbf80,0x3f80,0xbf80,0xbf55bf35,0x3f7b3ec4,0xbf0e3f35,0x3e48bf6d
.long 0x3f6d0000,0xbec43f35,0xbf6d0000,0x3ec4bf35,0xbe483f35,0xbf55bf6d,0xbf7bbf35,0x3f0ebec4
.long 0xbf35bf80,0x3f350000,0xbf35bf80,0x3f350000,0x3f7b3f35,0x3f0e3f6d,0xbe48bf35,0x3f553ec4
.long 0xbec40000,0xbf6dbf35,0x3ec40000,0x3f6d3f35,0xbf0ebf35,0xbe48bec4,0x3f553f35,0x3f7b3f6d
.long 0x0,0x0,0x0,0x0,0x3e480000,0x3f0e3ec4,0x3f7b3f80,0x3f553f6d
.long 0x3ec40000,0x3f6d3f35,0xbec40000,0xbf6dbf35,0x3f0e0000,0x3f7b3f6d,0xbf55bf80,0x3e48bec4
.long 0x3f350000,0x3f353f80,0x3f350000,0x3f353f80,0x3f550000,0x3e483f6d,0x3f0e3f80,0xbf7bbec4
.long 0x3f6d0000,0xbec43f35,0xbf6d0000,0x3ec4bf35,0x3f7b0000,0xbf553ec4,0xbe48bf80,0x3f0e3f6d
.long 0x3f800000,0xbf800000,0x3f800000,0xbf800000,0x3f7b0000,0xbf55bec4,0xbe483f80,0x3f0ebf6d
.long 0x3f6d0000,0xbec4bf35,0xbf6d0000,0x3ec43f35,0x3f550000,0x3e48bf6d,0x3f0ebf80,0xbf7b3ec4
.long 0x3f350000,0x3f35bf80,0x3f350000,0x3f35bf80,0x3f0e0000,0x3f7bbf6d,0xbf553f80,0x3e483ec4
.long 0x3ec40000,0x3f6dbf35,0xbec40000,0xbf6d3f35,0x3e480000,0x3f0ebec4,0x3f7bbf80,0x3f55bf6d
.long 0x0,0x0,0x0,0x0,0xbe480000,0xbf0e3ec4,0xbf7b3f80,0xbf553f6d
.long 0xbec40000,0xbf6d3f35,0x3ec40000,0x3f6dbf35,0xbf0e0000,0xbf7b3f6d,0x3f55bf80,0xbe48bec4
.long 0xbf350000,0xbf353f80,0xbf350000,0xbf353f80,0xbf550000,0xbe483f6d,0xbf0e3f80,0x3f7bbec4
.long 0xbf6d0000,0x3ec43f35,0x3f6d0000,0xbec4bf35,0xbf7b0000,0x3f553ec4,0x3e48bf80,0xbf0e3f6d
.long 0xbf800000,0x3f800000,0xbf800000,0x3f800000,0xbf7b0000,0x3f55bec4,0x3e483f80,0xbf0ebf6d
.long 0xbf6d0000,0x3ec4bf35,0x3f6d0000,0xbec43f35,0xbf550000,0xbe48bf6d,0xbf0ebf80,0x3f7b3ec4
.long 0xbf350000,0xbf35bf80,0xbf350000,0xbf35bf80,0xbf0e0000,0xbf7bbf6d,0x3f553f80,0xbe483ec4
.long 0xbec40000,0xbf6dbf35,0x3ec40000,0x3f6d3f35,0xbe480000,0xbf0ebec4,0xbf7bbf80,0xbf55bf6d
.long 0x0,0x0,0x0,0x0,0x3f553f35,0x3f7b3f6d,0x3f0e3f35,0x3e483ec4
.long 0x3f6d3f80,0x3ec43f35,0xbf6dbf80,0xbec4bf35,0x3e483f35,0xbf55bec4,0x3f7b3f35,0x3f0e3f6d
.long 0xbf350000,0xbf35bf80,0xbf350000,0xbf35bf80,0xbf7bbf35,0x3f0ebec4,0x3e48bf35,0x3f553f6d
.long 0xbec4bf80,0x3f6d3f35,0x3ec43f80,0xbf6dbf35,0x3f0ebf35,0xbe483f6d,0xbf55bf35,0x3f7b3ec4
.long 0x3f800000,0xbf800000,0x3f800000,0xbf800000,0x3f0e3f35,0xbe48bf6d,0xbf553f35,0x3f7bbec4
.long 0xbec43f80,0x3f6dbf35,0x3ec4bf80,0xbf6d3f35,0xbf7b3f35,0x3f0e3ec4,0x3e483f35,0x3f55bf6d
.long 0xbf350000,0xbf353f80,0xbf350000,0xbf353f80,0x3e48bf35,0xbf553ec4,0x3f7bbf35,0x3f0ebf6d
.long 0x3f6dbf80,0x3ec4bf35,0xbf6d3f80,0xbec43f35,0x3f55bf35,0x3f7bbf6d,0x3f0ebf35,0x3e48bec4
.long 0x0,0x0,0x0,0x0,0xbf553f35,0xbf7b3f6d,0xbf0e3f35,0xbe483ec4
.long 0xbf6d3f80,0xbec43f35,0x3f6dbf80,0x3ec4bf35,0xbe483f35,0x3f55bec4,0xbf7b3f35,0xbf0e3f6d
.long 0x3f350000,0x3f35bf80,0x3f350000,0x3f35bf80,0x3f7bbf35,0xbf0ebec4,0xbe48bf35,0xbf553f6d
.long 0x3ec4bf80,0xbf6d3f35,0xbec43f80,0x3f6dbf35,0xbf0ebf35,0x3e483f6d,0x3f55bf35,0xbf7b3ec4
.long 0xbf800000,0x3f800000,0xbf800000,0x3f800000,0xbf0e3f35,0x3e48bf6d,0x3f553f35,0xbf7bbec4
.long 0x3ec43f80,0xbf6dbf35,0xbec4bf80,0x3f6d3f35,0x3f7b3f35,0xbf0e3ec4,0xbe483f35,0xbf55bf6d
.long 0x3f350000,0x3f353f80,0x3f350000,0x3f353f80,0xbe48bf35,0x3f553ec4,0xbf7bbf35,0xbf0ebf6d
.long 0xbf6dbf80,0xbec4bf35,0x3f6d3f80,0x3ec43f35,0xbf55bf35,0xbf7bbf6d,0xbf0ebf35,0xbe48bec4
.long 0x0,0x0,0x0,0x0,0xbe480000,0xbf0ebec4,0xbf7bbf80,0xbf55bf6d
.long 0x3ec40000,0x3f6d3f35,0xbec40000,0xbf6dbf35,0xbf0e0000,0xbf7bbf6d,0x3f553f80,0xbe483ec4
.long 0x3f350000,0x3f353f80,0x3f350000,0x3f353f80,0xbf550000,0xbe48bf6d,0xbf0ebf80,0x3f7b3ec4
.long 0x3f6d0000,0xbec43f35,0xbf6d0000,0x3ec4bf35,0xbf7b0000,0x3f55bec4,0x3e483f80,0xbf0ebf6d
.long 0x3f800000,0xbf800000,0x3f800000,0xbf800000,0xbf7b0000,0x3f553ec4,0x3e48bf80,0xbf0e3f6d
.long 0x3f6d0000,0xbec4bf35,0xbf6d0000,0x3ec43f35,0xbf550000,0xbe483f6d,0xbf0e3f80,0x3f7bbec4
.long 0x3f350000,0x3f35bf80,0x3f350000,0x3f35bf80,0xbf0e0000,0xbf7b3f6d,0x3f55bf80,0xbe48bec4
.long 0x3ec40000,0x3f6dbf35,0xbec40000,0xbf6d3f35,0xbe480000,0xbf0e3ec4,0xbf7b3f80,0xbf553f6d
.long 0x0,0x0,0x0,0x0,0x3e480000,0x3f0ebec4,0x3f7bbf80,0x3f55bf6d
.long 0xbec40000,0xbf6d3f35,0x3ec40000,0x3f6dbf35,0x3f0e0000,0x3f7bbf6d,0xbf553f80,0x3e483ec4
.long 0xbf350000,0xbf353f80,0xbf350000,0xbf353f80,0x3f550000,0x3e48bf6d,0x3f0ebf80,0xbf7b3ec4
.long 0xbf6d0000,0x3ec43f35,0x3f6d0000,0xbec4bf35,0x3f7b0000,0xbf55bec4,0xbe483f80,0x3f0ebf6d
.long 0xbf800000,0x3f800000,0xbf800000,0x3f800000,0x3f7b0000,0xbf553ec4,0xbe48bf80,0x3f0e3f6d
.long 0xbf6d0000,0x3ec4bf35,0x3f6d0000,0xbec43f35,0x3f550000,0x3e483f6d,0x3f0e3f80,0xbf7bbec4
.long 0xbf350000,0xbf35bf80,0xbf350000,0xbf35bf80,0x3f0e0000,0x3f7b3f6d,0xbf55bf80,0x3e48bec4
.long 0xbec40000,0xbf6dbf35,0x3ec40000,0x3f6d3f35,0x3e480000,0x3f0e3ec4,0x3f7b3f80,0x3f553f6d
.long 0x0,0x0,0x0,0x0,0xbf55bf35,0xbf7bbf6d,0xbf0ebf35,0xbe48bec4
.long 0x3f6d3f80,0x3ec43f35,0xbf6dbf80,0xbec4bf35,0xbe48bf35,0x3f553ec4,0xbf7bbf35,0xbf0ebf6d
.long 0xbf350000,0xbf35bf80,0xbf350000,0xbf35bf80,0x3f7b3f35,0xbf0e3ec4,0xbe483f35,0xbf55bf6d
.long 0xbec4bf80,0x3f6d3f35,0x3ec43f80,0xbf6dbf35,0xbf0e3f35,0x3e48bf6d,0x3f553f35,0xbf7bbec4
.long 0x3f800000,0xbf800000,0x3f800000,0xbf800000,0xbf0ebf35,0x3e483f6d,0x3f55bf35,0xbf7b3ec4
.long 0xbec43f80,0x3f6dbf35,0x3ec4bf80,0xbf6d3f35,0x3f7bbf35,0xbf0ebec4,0xbe48bf35,0xbf553f6d
.long 0xbf350000,0xbf353f80,0xbf350000,0xbf353f80,0xbe483f35,0x3f55bec4,0xbf7b3f35,0xbf0e3f6d
.long 0x3f6dbf80,0x3ec4bf35,0xbf6d3f80,0xbec43f35,0xbf553f35,0xbf7b3f6d,0xbf0e3f35,0xbe483ec4
.long 0x0,0x0,0x0,0x0,0x3f55bf35,0x3f7bbf6d,0x3f0ebf35,0x3e48bec4
.long 0xbf6d3f80,0xbec43f35,0x3f6dbf80,0x3ec4bf35,0x3e48bf35,0xbf553ec4,0x3f7bbf35,0x3f0ebf6d
.long 0x3f350000,0x3f35bf80,0x3f350000,0x3f35bf80,0xbf7b3f35,0x3f0e3ec4,0x3e483f35,0x3f55bf6d
.long 0x3ec4bf80,0xbf6d3f35,0xbec43f80,0x3f6dbf35,0x3f0e3f35,0xbe48bf6d,0xbf553f35,0x3f7bbec4
.long 0xbf800000,0x3f800000,0xbf800000,0x3f800000,0x3f0ebf35,0xbe483f6d,0xbf55bf35,0x3f7b3ec4
.long 0x3ec43f80,0xbf6dbf35,0xbec4bf80,0x3f6d3f35,0xbf7bbf35,0x3f0ebec4,0x3e48bf35,0x3f553f6d
.long 0x3f350000,0x3f353f80,0x3f350000,0x3f353f80,0x3e483f35,0xbf55bec4,0x3f7b3f35,0x3f0e3f6d
.long 0xbf6dbf80,0xbec4bf35,0x3f6d3f80,0x3ec43f35,0x3f553f35,0x3f7b3f6d,0x3f0e3f35,0x3e483ec4
.long 0x3f7f3f80,0x3f753f7b,0x3f223f35,0x3ef13f0e,0x3f753f80,0x3f223f55,0xbf62bf35,0xbf7fbf7b
.long 0x3f623f80,0x3dc93f0e,0xbe95bf35,0x3f223e48,0x3f463f80,0xbef13e48,0x3f7f3f35,0x3e953f55
.long 0x3f223f80,0xbf62be48,0xbdc93f35,0xbf75bf55,0x3ef13f80,0xbf7fbf0e,0xbf75bf35,0x3f46be48
.long 0x3e953f80,0xbf46bf55,0x3ef1bf35,0x3dc93f7b,0x3dc93f80,0xbe95bf7b,0x3f463f35,0xbf62bf0e
.long 0xbdc93f80,0x3e95bf7b,0xbf463f35,0x3f62bf0e,0xbe953f80,0x3f46bf55,0xbef1bf35,0xbdc93f7b
.long 0xbef13f80,0x3f7fbf0e,0x3f75bf35,0xbf46be48,0xbf223f80,0x3f62be48,0x3dc93f35,0x3f75bf55
.long 0xbf463f80,0x3ef13e48,0xbf7f3f35,0xbe953f55,0xbf623f80,0xbdc93f0e,0x3e95bf35,0xbf223e48
.long 0xbf753f80,0xbf223f55,0x3f62bf35,0x3f7fbf7b,0xbf7f3f80,0xbf753f7b,0xbf223f35,0xbef13f0e
.long 0xbf7f3f80,0xbf753f7b,0xbf223f35,0xbef13f0e,0xbf753f80,0xbf223f55,0x3f62bf35,0x3f7fbf7b
.long 0xbf623f80,0xbdc93f0e,0x3e95bf35,0xbf223e48,0xbf463f80,0x3ef13e48,0xbf7f3f35,0xbe953f55
.long 0xbf223f80,0x3f62be48,0x3dc93f35,0x3f75bf55,0xbef13f80,0x3f7fbf0e,0x3f75bf35,0xbf46be48
.long 0xbe953f80,0x3f46bf55,0xbef1bf35,0xbdc93f7b,0xbdc93f80,0x3e95bf7b,0xbf463f35,0x3f62bf0e
.long 0x3dc93f80,0xbe95bf7b,0x3f463f35,0xbf62bf0e,0x3e953f80,0xbf46bf55,0x3ef1bf35,0x3dc93f7b
.long 0x3ef13f80,0xbf7fbf0e,0xbf75bf35,0x3f46be48,0x3f223f80,0xbf62be48,0xbdc93f35,0xbf75bf55
.long 0x3f463f80,0xbef13e48,0x3f7f3f35,0x3e953f55,0x3f623f80,0x3dc93f0e,0xbe95bf35,0x3f223e48
.long 0x3f753f80,0x3f223f55,0xbf62bf35,0xbf7fbf7b,0x3f7f3f80,0x3f753f7b,0x3f223f35,0x3ef13f0e
.long 0x3f623f6d,0x3f463f55,0x3e953ec4,0x3dc93e48,0x3dc93ec4,0xbef1be48,0xbf46bf6d,0xbe95bf0e
.long 0xbf46bec4,0xbf75bf7b,0x3f7f3f6d,0x3ef13f55,0xbf75bf6d,0x3dc9bf0e,0xbf62bec4,0xbf22bf7b
.long 0xbe95bf6d,0x3f7f3f0e,0x3ef1bec4,0x3f463f7b,0x3f22bec4,0x3e953f7b,0x3dc93f6d,0xbf62bf55
.long 0x3f7f3ec4,0xbf623e48,0xbf22bf6d,0x3f753f0e,0x3ef13f6d,0xbf22bf55,0x3f753ec4,0xbf7fbe48
.long 0xbef13f6d,0x3f22bf55,0xbf753ec4,0x3f7fbe48,0xbf7f3ec4,0x3f623e48,0x3f22bf6d,0xbf753f0e
.long 0xbf22bec4,0xbe953f7b,0xbdc93f6d,0x3f62bf55,0x3e95bf6d,0xbf7f3f0e,0xbef1bec4,0xbf463f7b
.long 0x3f75bf6d,0xbdc9bf0e,0x3f62bec4,0x3f22bf7b,0x3f46bec4,0x3f75bf7b,0xbf7f3f6d,0xbef13f55
.long 0xbdc93ec4,0x3ef1be48,0x3f46bf6d,0x3e95bf0e,0xbf623f6d,0xbf463f55,0xbe953ec4,0xbdc93e48
.long 0xbf623f6d,0xbf463f55,0xbe953ec4,0xbdc93e48,0xbdc93ec4,0x3ef1be48,0x3f46bf6d,0x3e95bf0e
.long 0x3f46bec4,0x3f75bf7b,0xbf7f3f6d,0xbef13f55,0x3f75bf6d,0xbdc9bf0e,0x3f62bec4,0x3f22bf7b
.long 0x3e95bf6d,0xbf7f3f0e,0xbef1bec4,0xbf463f7b,0xbf22bec4,0xbe953f7b,0xbdc93f6d,0x3f62bf55
.long 0xbf7f3ec4,0x3f623e48,0x3f22bf6d,0xbf753f0e,0xbef13f6d,0x3f22bf55,0xbf753ec4,0x3f7fbe48
.long 0x3ef13f6d,0xbf22bf55,0x3f753ec4,0xbf7fbe48,0x3f7f3ec4,0xbf623e48,0xbf22bf6d,0x3f753f0e
.long 0x3f22bec4,0x3e953f7b,0x3dc93f6d,0xbf62bf55,0xbe95bf6d,0x3f7f3f0e,0x3ef1bec4,0x3f463f7b
.long 0xbf75bf6d,0x3dc9bf0e,0xbf62bec4,0xbf22bf7b,0xbf46bec4,0xbf75bf7b,0x3f7f3f6d,0x3ef13f55
.long 0x3dc93ec4,0xbef1be48,0xbf46bf6d,0xbe95bf0e,0x3f623f6d,0x3f463f55,0x3e953ec4,0x3dc93e48
.long 0xbdc90000,0xbe95be48,0xbf46bf35,0xbf62bf55,0x3e950000,0x3f463f0e,0x3ef13f35,0xbdc93e48
.long 0xbef10000,0xbf7fbf55,0x3f753f35,0x3f463f7b,0x3f220000,0x3f623f7b,0xbdc9bf35,0x3f753f0e
.long 0xbf460000,0xbef1bf7b,0xbf7fbf35,0x3e95bf0e,0x3f620000,0xbdc93f55,0xbe953f35,0xbf22bf7b
.long 0xbf750000,0x3f22bf0e,0x3f623f35,0xbf7fbe48,0x3f7f0000,0xbf753e48,0x3f22bf35,0xbef13f55
.long 0xbf7f0000,0x3f753e48,0xbf22bf35,0x3ef13f55,0x3f750000,0xbf22bf0e,0xbf623f35,0x3f7fbe48
.long 0xbf620000,0x3dc93f55,0x3e953f35,0x3f22bf7b,0x3f460000,0x3ef1bf7b,0x3f7fbf35,0xbe95bf0e
.long 0xbf220000,0xbf623f7b,0x3dc9bf35,0xbf753f0e,0x3ef10000,0x3f7fbf55,0xbf753f35,0xbf463f7b
.long 0xbe950000,0xbf463f0e,0xbef13f35,0x3dc93e48,0x3dc90000,0x3e95be48,0x3f46bf35,0x3f62bf55
.long 0x3dc90000,0x3e95be48,0x3f46bf35,0x3f62bf55,0xbe950000,0xbf463f0e,0xbef13f35,0x3dc93e48
.long 0x3ef10000,0x3f7fbf55,0xbf753f35,0xbf463f7b,0xbf220000,0xbf623f7b,0x3dc9bf35,0xbf753f0e
.long 0x3f460000,0x3ef1bf7b,0x3f7fbf35,0xbe95bf0e,0xbf620000,0x3dc93f55,0x3e953f35,0x3f22bf7b
.long 0x3f750000,0xbf22bf0e,0xbf623f35,0x3f7fbe48,0xbf7f0000,0x3f753e48,0xbf22bf35,0x3ef13f55
.long 0x3f7f0000,0xbf753e48,0x3f22bf35,0xbef13f55,0xbf750000,0x3f22bf0e,0x3f623f35,0xbf7fbe48
.long 0x3f620000,0xbdc93f55,0xbe953f35,0xbf22bf7b,0xbf460000,0xbef1bf7b,0xbf7fbf35,0x3e95bf0e
.long 0x3f220000,0x3f623f7b,0xbdc9bf35,0x3f753f0e,0xbef10000,0xbf7fbf55,0x3f753f35,0x3f463f7b
.long 0x3e950000,0x3f463f0e,0x3ef13f35,0xbdc93e48,0xbdc90000,0xbe95be48,0xbf46bf35,0xbf62bf55
.long 0xbef1bec4,0xbf22bf0e,0xbf75bf6d,0xbf7fbf7b,0x3f7f3f6d,0x3f623f7b,0xbf22bec4,0xbf75bf55
.long 0xbf22bf6d,0x3e95be48,0xbdc93ec4,0xbf62bf0e,0xbe953ec4,0xbf7fbf55,0x3ef13f6d,0xbf46be48
.long 0x3f753ec4,0x3dc93f55,0x3f623f6d,0xbf223e48,0xbf46bf6d,0x3f753e48,0x3f7f3ec4,0xbef13f0e
.long 0xbdc93f6d,0xbef1bf7b,0x3f46bec4,0xbe953f55,0x3f62bec4,0xbf463f0e,0x3e95bf6d,0xbdc93f7b
.long 0xbf62bec4,0x3f463f0e,0xbe95bf6d,0x3dc93f7b,0x3dc93f6d,0x3ef1bf7b,0xbf46bec4,0x3e953f55
.long 0x3f46bf6d,0xbf753e48,0xbf7f3ec4,0x3ef13f0e,0xbf753ec4,0xbdc93f55,0xbf623f6d,0x3f223e48
.long 0x3e953ec4,0x3f7fbf55,0xbef13f6d,0x3f46be48,0x3f22bf6d,0xbe95be48,0x3dc93ec4,0x3f62bf0e
.long 0xbf7f3f6d,0xbf623f7b,0x3f22bec4,0x3f75bf55,0x3ef1bec4,0x3f22bf0e,0x3f75bf6d,0x3f7fbf7b
.long 0x3ef1bec4,0x3f22bf0e,0x3f75bf6d,0x3f7fbf7b,0xbf7f3f6d,0xbf623f7b,0x3f22bec4,0x3f75bf55
.long 0x3f22bf6d,0xbe95be48,0x3dc93ec4,0x3f62bf0e,0x3e953ec4,0x3f7fbf55,0xbef13f6d,0x3f46be48
.long 0xbf753ec4,0xbdc93f55,0xbf623f6d,0x3f223e48,0x3f46bf6d,0xbf753e48,0xbf7f3ec4,0x3ef13f0e
.long 0x3dc93f6d,0x3ef1bf7b,0xbf46bec4,0x3e953f55,0xbf62bec4,0x3f463f0e,0xbe95bf6d,0x3dc93f7b
.long 0x3f62bec4,0xbf463f0e,0x3e95bf6d,0xbdc93f7b,0xbdc93f6d,0xbef1bf7b,0x3f46bec4,0xbe953f55
.long 0xbf46bf6d,0x3f753e48,0x3f7f3ec4,0xbef13f0e,0x3f753ec4,0x3dc93f55,0x3f623f6d,0xbf223e48
.long 0xbe953ec4,0xbf7fbf55,0x3ef13f6d,0xbf46be48,0xbf22bf6d,0x3e95be48,0xbdc93ec4,0xbf62bf0e
.long 0x3f7f3f6d,0x3f623f7b,0xbf22bec4,0xbf75bf55,0xbef1bec4,0xbf22bf0e,0xbf75bf6d,0xbf7fbf7b
.long 0x3dc90000,0x3e953e48,0x3f463f35,0x3f623f55,0x3e950000,0x3f463f0e,0x3ef13f35,0xbdc93e48
.long 0x3ef10000,0x3f7f3f55,0xbf75bf35,0xbf46bf7b,0x3f220000,0x3f623f7b,0xbdc9bf35,0x3f753f0e
.long 0x3f460000,0x3ef13f7b,0x3f7f3f35,0xbe953f0e,0x3f620000,0xbdc93f55,0xbe953f35,0xbf22bf7b
.long 0x3f750000,0xbf223f0e,0xbf62bf35,0x3f7f3e48,0x3f7f0000,0xbf753e48,0x3f22bf35,0xbef13f55
.long 0x3f7f0000,0xbf75be48,0x3f223f35,0xbef1bf55,0x3f750000,0xbf22bf0e,0xbf623f35,0x3f7fbe48
.long 0x3f620000,0xbdc9bf55,0xbe95bf35,0xbf223f7b,0x3f460000,0x3ef1bf7b,0x3f7fbf35,0xbe95bf0e
.long 0x3f220000,0x3f62bf7b,0xbdc93f35,0x3f75bf0e,0x3ef10000,0x3f7fbf55,0xbf753f35,0xbf463f7b
.long 0x3e950000,0x3f46bf0e,0x3ef1bf35,0xbdc9be48,0x3dc90000,0x3e95be48,0x3f46bf35,0x3f62bf55
.long 0xbdc90000,0xbe953e48,0xbf463f35,0xbf623f55,0xbe950000,0xbf463f0e,0xbef13f35,0x3dc93e48
.long 0xbef10000,0xbf7f3f55,0x3f75bf35,0x3f46bf7b,0xbf220000,0xbf623f7b,0x3dc9bf35,0xbf753f0e
.long 0xbf460000,0xbef13f7b,0xbf7f3f35,0x3e953f0e,0xbf620000,0x3dc93f55,0x3e953f35,0x3f22bf7b
.long 0xbf750000,0x3f223f0e,0x3f62bf35,0xbf7f3e48,0xbf7f0000,0x3f753e48,0xbf22bf35,0x3ef13f55
.long 0xbf7f0000,0x3f75be48,0xbf223f35,0x3ef1bf55,0xbf750000,0x3f22bf0e,0x3f623f35,0xbf7fbe48
.long 0xbf620000,0x3dc9bf55,0x3e95bf35,0x3f223f7b,0xbf460000,0xbef1bf7b,0xbf7fbf35,0x3e95bf0e
.long 0xbf220000,0xbf62bf7b,0x3dc93f35,0xbf75bf0e,0xbef10000,0xbf7fbf55,0x3f753f35,0x3f463f7b
.long 0xbe950000,0xbf46bf0e,0xbef1bf35,0x3dc9be48,0xbdc90000,0xbe95be48,0xbf46bf35,0xbf62bf55
.long 0x3ef13ec4,0x3f223f0e,0x3f753f6d,0x3f7f3f7b,0x3f7f3f6d,0x3f623f7b,0xbf22bec4,0xbf75bf55
.long 0x3f223f6d,0xbe953e48,0x3dc9bec4,0x3f623f0e,0xbe953ec4,0xbf7fbf55,0x3ef13f6d,0xbf46be48
.long 0xbf75bec4,0xbdc9bf55,0xbf62bf6d,0x3f22be48,0xbf46bf6d,0x3f753e48,0x3f7f3ec4,0xbef13f0e
.long 0x3dc9bf6d,0x3ef13f7b,0xbf463ec4,0x3e95bf55,0x3f62bec4,0xbf463f0e,0x3e95bf6d,0xbdc93f7b
.long 0x3f623ec4,0xbf46bf0e,0x3e953f6d,0xbdc9bf7b,0x3dc93f6d,0x3ef1bf7b,0xbf46bec4,0x3e953f55
.long 0xbf463f6d,0x3f75be48,0x3f7fbec4,0xbef1bf0e,0xbf753ec4,0xbdc93f55,0xbf623f6d,0x3f223e48
.long 0xbe95bec4,0xbf7f3f55,0x3ef1bf6d,0xbf463e48,0x3f22bf6d,0xbe95be48,0x3dc93ec4,0x3f62bf0e
.long 0x3f7fbf6d,0x3f62bf7b,0xbf223ec4,0xbf753f55,0x3ef1bec4,0x3f22bf0e,0x3f75bf6d,0x3f7fbf7b
.long 0xbef13ec4,0xbf223f0e,0xbf753f6d,0xbf7f3f7b,0xbf7f3f6d,0xbf623f7b,0x3f22bec4,0x3f75bf55
.long 0xbf223f6d,0x3e953e48,0xbdc9bec4,0xbf623f0e,0x3e953ec4,0x3f7fbf55,0xbef13f6d,0x3f46be48
.long 0x3f75bec4,0x3dc9bf55,0x3f62bf6d,0xbf22be48,0x3f46bf6d,0xbf753e48,0xbf7f3ec4,0x3ef13f0e
.long 0xbdc9bf6d,0xbef13f7b,0x3f463ec4,0xbe95bf55,0xbf62bec4,0x3f463f0e,0xbe95bf6d,0x3dc93f7b
.long 0xbf623ec4,0x3f46bf0e,0xbe953f6d,0x3dc9bf7b,0xbdc93f6d,0xbef1bf7b,0x3f46bec4,0xbe953f55
.long 0x3f463f6d,0xbf75be48,0xbf7fbec4,0x3ef1bf0e,0x3f753ec4,0x3dc93f55,0x3f623f6d,0xbf223e48
.long 0x3e95bec4,0x3f7f3f55,0xbef1bf6d,0x3f463e48,0xbf22bf6d,0x3e95be48,0xbdc93ec4,0xbf62bf0e
.long 0xbf7fbf6d,0xbf62bf7b,0x3f223ec4,0x3f753f55,0xbef1bec4,0xbf22bf0e,0xbf75bf6d,0xbf7fbf7b
.long 0x3f7f3f80,0x3f753f7b,0x3f223f35,0x3ef13f0e,0xbf75bf80,0xbf22bf55,0x3f623f35,0x3f7f3f7b
.long 0x3f623f80,0x3dc93f0e,0xbe95bf35,0x3f223e48,0xbf46bf80,0x3ef1be48,0xbf7fbf35,0xbe95bf55
.long 0x3f223f80,0xbf62be48,0xbdc93f35,0xbf75bf55,0xbef1bf80,0x3f7f3f0e,0x3f753f35,0xbf463e48
.long 0x3e953f80,0xbf46bf55,0x3ef1bf35,0x3dc93f7b,0xbdc9bf80,0x3e953f7b,0xbf46bf35,0x3f623f0e
.long 0xbdc93f80,0x3e95bf7b,0xbf463f35,0x3f62bf0e,0x3e95bf80,0xbf463f55,0x3ef13f35,0x3dc9bf7b
.long 0xbef13f80,0x3f7fbf0e,0x3f75bf35,0xbf46be48,0x3f22bf80,0xbf623e48,0xbdc9bf35,0xbf753f55
.long 0xbf463f80,0x3ef13e48,0xbf7f3f35,0xbe953f55,0x3f62bf80,0x3dc9bf0e,0xbe953f35,0x3f22be48
.long 0xbf753f80,0xbf223f55,0x3f62bf35,0x3f7fbf7b,0x3f7fbf80,0x3f75bf7b,0x3f22bf35,0x3ef1bf0e
.long 0xbf7f3f80,0xbf753f7b,0xbf223f35,0xbef13f0e,0x3f75bf80,0x3f22bf55,0xbf623f35,0xbf7f3f7b
.long 0xbf623f80,0xbdc93f0e,0x3e95bf35,0xbf223e48,0x3f46bf80,0xbef1be48,0x3f7fbf35,0x3e95bf55
.long 0xbf223f80,0x3f62be48,0x3dc93f35,0x3f75bf55,0x3ef1bf80,0xbf7f3f0e,0xbf753f35,0x3f463e48
.long 0xbe953f80,0x3f46bf55,0xbef1bf35,0xbdc93f7b,0x3dc9bf80,0xbe953f7b,0x3f46bf35,0xbf623f0e
.long 0x3dc93f80,0xbe95bf7b,0x3f463f35,0xbf62bf0e,0xbe95bf80,0x3f463f55,0xbef13f35,0xbdc9bf7b
.long 0x3ef13f80,0xbf7fbf0e,0xbf75bf35,0x3f46be48,0xbf22bf80,0x3f623e48,0x3dc9bf35,0x3f753f55
.long 0x3f463f80,0xbef13e48,0x3f7f3f35,0x3e953f55,0xbf62bf80,0xbdc9bf0e,0x3e953f35,0xbf22be48
.long 0x3f753f80,0x3f223f55,0xbf62bf35,0xbf7fbf7b,0xbf7fbf80,0xbf75bf7b,0xbf22bf35,0xbef1bf0e
.long 0x3f623f6d,0x3f463f55,0x3e953ec4,0x3dc93e48,0xbdc9bec4,0x3ef13e48,0x3f463f6d,0x3e953f0e
.long 0xbf46bec4,0xbf75bf7b,0x3f7f3f6d,0x3ef13f55,0x3f753f6d,0xbdc93f0e,0x3f623ec4,0x3f223f7b
.long 0xbe95bf6d,0x3f7f3f0e,0x3ef1bec4,0x3f463f7b,0xbf223ec4,0xbe95bf7b,0xbdc9bf6d,0x3f623f55
.long 0x3f7f3ec4,0xbf623e48,0xbf22bf6d,0x3f753f0e,0xbef1bf6d,0x3f223f55,0xbf75bec4,0x3f7f3e48
.long 0xbef13f6d,0x3f22bf55,0xbf753ec4,0x3f7fbe48,0x3f7fbec4,0xbf62be48,0xbf223f6d,0x3f75bf0e
.long 0xbf22bec4,0xbe953f7b,0xbdc93f6d,0x3f62bf55,0xbe953f6d,0x3f7fbf0e,0x3ef13ec4,0x3f46bf7b
.long 0x3f75bf6d,0xbdc9bf0e,0x3f62bec4,0x3f22bf7b,0xbf463ec4,0xbf753f7b,0x3f7fbf6d,0x3ef1bf55
.long 0xbdc93ec4,0x3ef1be48,0x3f46bf6d,0x3e95bf0e,0x3f62bf6d,0x3f46bf55,0x3e95bec4,0x3dc9be48
.long 0xbf623f6d,0xbf463f55,0xbe953ec4,0xbdc93e48,0x3dc9bec4,0xbef13e48,0xbf463f6d,0xbe953f0e
.long 0x3f46bec4,0x3f75bf7b,0xbf7f3f6d,0xbef13f55,0xbf753f6d,0x3dc93f0e,0xbf623ec4,0xbf223f7b
.long 0x3e95bf6d,0xbf7f3f0e,0xbef1bec4,0xbf463f7b,0x3f223ec4,0x3e95bf7b,0x3dc9bf6d,0xbf623f55
.long 0xbf7f3ec4,0x3f623e48,0x3f22bf6d,0xbf753f0e,0x3ef1bf6d,0xbf223f55,0x3f75bec4,0xbf7f3e48
.long 0x3ef13f6d,0xbf22bf55,0x3f753ec4,0xbf7fbe48,0xbf7fbec4,0x3f62be48,0x3f223f6d,0xbf75bf0e
.long 0x3f22bec4,0x3e953f7b,0x3dc93f6d,0xbf62bf55,0x3e953f6d,0xbf7fbf0e,0xbef13ec4,0xbf46bf7b
.long 0xbf75bf6d,0x3dc9bf0e,0xbf62bec4,0xbf22bf7b,0x3f463ec4,0x3f753f7b,0xbf7fbf6d,0xbef1bf55
.long 0x3dc93ec4,0xbef1be48,0xbf46bf6d,0xbe95bf0e,0xbf62bf6d,0xbf46bf55,0xbe95bec4,0xbdc9be48
.long 0x3f803f80,0x3f803f80,0x3f803f80,0x3f803f80,0x3f753f7f,0x3f463f62,0xbe95bdc9,0xbf22bef1
.long 0x3f553f7b,0x3e483f0e,0xbf55bf7b,0xbe48bf0e,0x3f223f75,0xbef13dc9,0x3f463e95,0x3f623f7f
.long 0x3ec43f6d,0xbf6dbec4,0x3ec43f6d,0xbf6dbec4,0x3dc93f62,0xbf75bf46,0xbf7fbef1,0x3e95bf22
.long 0xbe483f55,0xbf0ebf7b,0x3e48bf55,0x3f0e3f7b,0xbef13f46,0x3dc9bf75,0x3f623f22,0xbf7fbe95
.long 0xbf353f35,0x3f35bf35,0xbf353f35,0x3f35bf35,0xbf623f22,0x3f7fbe95,0xbef1bf46,0x3dc93f75
.long 0xbf7b3f0e,0x3f553e48,0x3f7bbf0e,0xbf55be48,0xbf7f3ef1,0x3e953f22,0xbdc93f62,0x3f75bf46
.long 0xbf6d3ec4,0xbec43f6d,0xbf6d3ec4,0xbec43f6d,0xbf463e95,0xbf623f7f,0x3f22bf75,0xbef1bdc9
.long 0xbf0e3e48,0xbf7b3f55,0x3f0ebe48,0x3f7bbf55,0xbe953dc9,0xbf223ef1,0xbf753f7f,0xbf463f62
.long 0x0,0x0,0x0,0x0,0x3e95bdc9,0x3f22bef1,0x3f75bf7f,0x3f46bf62
.long 0x3f0ebe48,0x3f7bbf55,0xbf0e3e48,0xbf7b3f55,0x3f46be95,0x3f62bf7f,0xbf223f75,0x3ef13dc9
.long 0x3f6dbec4,0x3ec4bf6d,0x3f6dbec4,0x3ec4bf6d,0x3f7fbef1,0xbe95bf22,0x3dc9bf62,0xbf753f46
.long 0x3f7bbf0e,0xbf55be48,0xbf7b3f0e,0x3f553e48,0x3f62bf22,0xbf7f3e95,0x3ef13f46,0xbdc9bf75
.long 0x3f35bf35,0xbf353f35,0x3f35bf35,0xbf353f35,0x3ef1bf46,0xbdc93f75,0xbf62bf22,0x3f7f3e95
.long 0x3e48bf55,0x3f0e3f7b,0xbe483f55,0xbf0ebf7b,0xbdc9bf62,0x3f753f46,0x3f7f3ef1,0xbe953f22
.long 0xbec4bf6d,0x3f6d3ec4,0xbec4bf6d,0x3f6d3ec4,0xbf22bf75,0x3ef1bdc9,0xbf46be95,0xbf62bf7f
.long 0xbf55bf7b,0xbe48bf0e,0x3f553f7b,0x3e483f0e,0xbf75bf7f,0xbf46bf62,0x3e953dc9,0x3f223ef1
.long 0x3f803f80,0x3f803f80,0x3f803f80,0x3f803f80,0x3ef13f22,0x3dc93e95,0xbf62bf46,0xbf7fbf75
.long 0xbf0ebe48,0xbf7bbf55,0x3f0e3e48,0x3f7b3f55,0xbf7fbf62,0xbe95bf46,0xbdc93ef1,0xbf75bf22
.long 0xbec4bf6d,0x3f6d3ec4,0xbec4bf6d,0x3f6d3ec4,0x3f22be95,0x3ef13f7f,0x3f463f75,0xbf62bdc9
.long 0x3f7b3f0e,0xbf553e48,0xbf7bbf0e,0x3f55be48,0x3e953f7f,0xbf22bf62,0x3f75bdc9,0xbf463ef1
.long 0xbf353f35,0x3f35bf35,0xbf353f35,0x3f35bf35,0xbf75bdc9,0x3f463ef1,0x3e95bf7f,0xbf223f62
.long 0xbe48bf55,0xbf0e3f7b,0x3e483f55,0x3f0ebf7b,0x3f46bf75,0xbf623dc9,0xbf22be95,0xbef13f7f
.long 0x3f6dbec4,0x3ec4bf6d,0x3f6dbec4,0x3ec4bf6d,0x3dc93ef1,0x3f75bf22,0xbf7f3f62,0xbe953f46
.long 0xbf553f7b,0xbe483f0e,0x3f55bf7b,0x3e48bf0e,0xbf623f46,0xbf7f3f75,0xbef13f22,0xbdc93e95
.long 0x0,0x0,0x0,0x0,0x3f62bf46,0x3f7fbf75,0x3ef1bf22,0x3dc9be95
.long 0x3f55bf7b,0x3e48bf0e,0xbf553f7b,0xbe483f0e,0xbdc9bef1,0xbf753f22,0x3f7fbf62,0x3e95bf46
.long 0xbf6d3ec4,0xbec43f6d,0xbf6d3ec4,0xbec43f6d,0xbf463f75,0x3f62bdc9,0x3f223e95,0x3ef1bf7f
.long 0x3e483f55,0x3f0ebf7b,0xbe48bf55,0xbf0e3f7b,0x3f753dc9,0xbf46bef1,0xbe953f7f,0x3f22bf62
.long 0x3f35bf35,0xbf353f35,0x3f35bf35,0xbf353f35,0xbe95bf7f,0x3f223f62,0xbf753dc9,0x3f46bef1
.long 0xbf7bbf0e,0x3f55be48,0x3f7b3f0e,0xbf553e48,0xbf223e95,0xbef1bf7f,0xbf46bf75,0x3f623dc9
.long 0x3ec43f6d,0xbf6dbec4,0x3ec43f6d,0xbf6dbec4,0x3f7f3f62,0x3e953f46,0x3dc9bef1,0x3f753f22
.long 0x3f0e3e48,0x3f7b3f55,0xbf0ebe48,0xbf7bbf55,0xbef1bf22,0xbdc9be95,0x3f623f46,0x3f7f3f75
.long 0x3f803f80,0x3f803f80,0x3f803f80,0x3f803f80,0xbf75bf7f,0xbf46bf62,0x3e953dc9,0x3f223ef1
.long 0x3f553f7b,0x3e483f0e,0xbf55bf7b,0xbe48bf0e,0xbf22bf75,0x3ef1bdc9,0xbf46be95,0xbf62bf7f
.long 0x3ec43f6d,0xbf6dbec4,0x3ec43f6d,0xbf6dbec4,0xbdc9bf62,0x3f753f46,0x3f7f3ef1,0xbe953f22
.long 0xbe483f55,0xbf0ebf7b,0x3e48bf55,0x3f0e3f7b,0x3ef1bf46,0xbdc93f75,0xbf62bf22,0x3f7f3e95
.long 0xbf353f35,0x3f35bf35,0xbf353f35,0x3f35bf35,0x3f62bf22,0xbf7f3e95,0x3ef13f46,0xbdc9bf75
.long 0xbf7b3f0e,0x3f553e48,0x3f7bbf0e,0xbf55be48,0x3f7fbef1,0xbe95bf22,0x3dc9bf62,0xbf753f46
.long 0xbf6d3ec4,0xbec43f6d,0xbf6d3ec4,0xbec43f6d,0x3f46be95,0x3f62bf7f,0xbf223f75,0x3ef13dc9
.long 0xbf0e3e48,0xbf7b3f55,0x3f0ebe48,0x3f7bbf55,0x3e95bdc9,0x3f22bef1,0x3f75bf7f,0x3f46bf62
.long 0x0,0x0,0x0,0x0,0xbe953dc9,0xbf223ef1,0xbf753f7f,0xbf463f62
.long 0x3f0ebe48,0x3f7bbf55,0xbf0e3e48,0xbf7b3f55,0xbf463e95,0xbf623f7f,0x3f22bf75,0xbef1bdc9
.long 0x3f6dbec4,0x3ec4bf6d,0x3f6dbec4,0x3ec4bf6d,0xbf7f3ef1,0x3e953f22,0xbdc93f62,0x3f75bf46
.long 0x3f7bbf0e,0xbf55be48,0xbf7b3f0e,0x3f553e48,0xbf623f22,0x3f7fbe95,0xbef1bf46,0x3dc93f75
.long 0x3f35bf35,0xbf353f35,0x3f35bf35,0xbf353f35,0xbef13f46,0x3dc9bf75,0x3f623f22,0xbf7fbe95
.long 0x3e48bf55,0x3f0e3f7b,0xbe483f55,0xbf0ebf7b,0x3dc93f62,0xbf75bf46,0xbf7fbef1,0x3e95bf22
.long 0xbec4bf6d,0x3f6d3ec4,0xbec4bf6d,0x3f6d3ec4,0x3f223f75,0xbef13dc9,0x3f463e95,0x3f623f7f
.long 0xbf55bf7b,0xbe48bf0e,0x3f553f7b,0x3e483f0e,0x3f753f7f,0x3f463f62,0xbe95bdc9,0xbf22bef1
.long 0x3f803f80,0x3f803f80,0x3f803f80,0x3f803f80,0xbef1bf22,0xbdc9be95,0x3f623f46,0x3f7f3f75
.long 0xbf0ebe48,0xbf7bbf55,0x3f0e3e48,0x3f7b3f55,0x3f7f3f62,0x3e953f46,0x3dc9bef1,0x3f753f22
.long 0xbec4bf6d,0x3f6d3ec4,0xbec4bf6d,0x3f6d3ec4,0xbf223e95,0xbef1bf7f,0xbf46bf75,0x3f623dc9
.long 0x3f7b3f0e,0xbf553e48,0xbf7bbf0e,0x3f55be48,0xbe95bf7f,0x3f223f62,0xbf753dc9,0x3f46bef1
.long 0xbf353f35,0x3f35bf35,0xbf353f35,0x3f35bf35,0x3f753dc9,0xbf46bef1,0xbe953f7f,0x3f22bf62
.long 0xbe48bf55,0xbf0e3f7b,0x3e483f55,0x3f0ebf7b,0xbf463f75,0x3f62bdc9,0x3f223e95,0x3ef1bf7f
.long 0x3f6dbec4,0x3ec4bf6d,0x3f6dbec4,0x3ec4bf6d,0xbdc9bef1,0xbf753f22,0x3f7fbf62,0x3e95bf46
.long 0xbf553f7b,0xbe483f0e,0x3f55bf7b,0x3e48bf0e,0x3f62bf46,0x3f7fbf75,0x3ef1bf22,0x3dc9be95
.long 0x0,0x0,0x0,0x0,0xbf623f46,0xbf7f3f75,0xbef13f22,0xbdc93e95
.long 0x3f55bf7b,0x3e48bf0e,0xbf553f7b,0xbe483f0e,0x3dc93ef1,0x3f75bf22,0xbf7f3f62,0xbe953f46
.long 0xbf6d3ec4,0xbec43f6d,0xbf6d3ec4,0xbec43f6d,0x3f46bf75,0xbf623dc9,0xbf22be95,0xbef13f7f
.long 0x3e483f55,0x3f0ebf7b,0xbe48bf55,0xbf0e3f7b,0xbf75bdc9,0x3f463ef1,0x3e95bf7f,0xbf223f62
.long 0x3f35bf35,0xbf353f35,0x3f35bf35,0xbf353f35,0x3e953f7f,0xbf22bf62,0x3f75bdc9,0xbf463ef1
.long 0xbf7bbf0e,0x3f55be48,0x3f7b3f0e,0xbf553e48,0x3f22be95,0x3ef13f7f,0x3f463f75,0xbf62bdc9
.long 0x3ec43f6d,0xbf6dbec4,0x3ec43f6d,0xbf6dbec4,0xbf7fbf62,0xbe95bf46,0xbdc93ef1,0xbf75bf22
.long 0x3f0e3e48,0x3f7b3f55,0xbf0ebe48,0xbf7bbf55,0x3ef13f22,0x3dc93e95,0xbf62bf46,0xbf7fbf75
.long 0x0,0x0,0x0,0x0,0x3e953dc9,0x3f223ef1,0x3f753f7f,0x3f463f62
.long 0x3f0e3e48,0x3f7b3f55,0xbf0ebe48,0xbf7bbf55,0x3f463e95,0x3f623f7f,0xbf22bf75,0x3ef1bdc9
.long 0x3f6d3ec4,0x3ec43f6d,0x3f6d3ec4,0x3ec43f6d,0x3f7f3ef1,0xbe953f22,0x3dc93f62,0xbf75bf46
.long 0x3f7b3f0e,0xbf553e48,0xbf7bbf0e,0x3f55be48,0x3f623f22,0xbf7fbe95,0x3ef1bf46,0xbdc93f75
.long 0x3f353f35,0xbf35bf35,0x3f353f35,0xbf35bf35,0x3ef13f46,0xbdc9bf75,0xbf623f22,0x3f7fbe95
.long 0x3e483f55,0x3f0ebf7b,0xbe48bf55,0xbf0e3f7b,0xbdc93f62,0x3f75bf46,0x3f7fbef1,0xbe95bf22
.long 0xbec43f6d,0x3f6dbec4,0xbec43f6d,0x3f6dbec4,0xbf223f75,0x3ef13dc9,0xbf463e95,0xbf623f7f
.long 0xbf553f7b,0xbe483f0e,0x3f55bf7b,0x3e48bf0e,0xbf753f7f,0xbf463f62,0x3e95bdc9,0x3f22bef1
.long 0xbf803f80,0xbf803f80,0xbf803f80,0xbf803f80,0xbf753f7f,0xbf463f62,0x3e95bdc9,0x3f22bef1
.long 0xbf553f7b,0xbe483f0e,0x3f55bf7b,0x3e48bf0e,0xbf223f75,0x3ef13dc9,0xbf463e95,0xbf623f7f
.long 0xbec43f6d,0x3f6dbec4,0xbec43f6d,0x3f6dbec4,0xbdc93f62,0x3f75bf46,0x3f7fbef1,0xbe95bf22
.long 0x3e483f55,0x3f0ebf7b,0xbe48bf55,0xbf0e3f7b,0x3ef13f46,0xbdc9bf75,0xbf623f22,0x3f7fbe95
.long 0x3f353f35,0xbf35bf35,0x3f353f35,0xbf35bf35,0x3f623f22,0xbf7fbe95,0x3ef1bf46,0xbdc93f75
.long 0x3f7b3f0e,0xbf553e48,0xbf7bbf0e,0x3f55be48,0x3f7f3ef1,0xbe953f22,0x3dc93f62,0xbf75bf46
.long 0x3f6d3ec4,0x3ec43f6d,0x3f6d3ec4,0x3ec43f6d,0x3f463e95,0x3f623f7f,0xbf22bf75,0x3ef1bdc9
.long 0x3f0e3e48,0x3f7b3f55,0xbf0ebe48,0xbf7bbf55,0x3e953dc9,0x3f223ef1,0x3f753f7f,0x3f463f62
.long 0x0,0x0,0x0,0x0,0x3f623f46,0x3f7f3f75,0x3ef13f22,0x3dc93e95
.long 0x3f553f7b,0x3e483f0e,0xbf55bf7b,0xbe48bf0e,0xbdc93ef1,0xbf75bf22,0x3f7f3f62,0x3e953f46
.long 0xbf6dbec4,0xbec4bf6d,0xbf6dbec4,0xbec4bf6d,0xbf46bf75,0x3f623dc9,0x3f22be95,0x3ef13f7f
.long 0x3e48bf55,0x3f0e3f7b,0xbe483f55,0xbf0ebf7b,0x3f75bdc9,0xbf463ef1,0xbe95bf7f,0x3f223f62
.long 0x3f353f35,0xbf35bf35,0x3f353f35,0xbf35bf35,0xbe953f7f,0x3f22bf62,0xbf75bdc9,0x3f463ef1
.long 0xbf7b3f0e,0x3f553e48,0x3f7bbf0e,0xbf55be48,0xbf22be95,0xbef13f7f,0xbf463f75,0x3f62bdc9
.long 0x3ec4bf6d,0xbf6d3ec4,0x3ec4bf6d,0xbf6d3ec4,0x3f7fbf62,0x3e95bf46,0x3dc93ef1,0x3f75bf22
.long 0x3f0ebe48,0x3f7bbf55,0xbf0e3e48,0xbf7b3f55,0xbef13f22,0xbdc93e95,0x3f62bf46,0x3f7fbf75
.long 0xbf803f80,0xbf803f80,0xbf803f80,0xbf803f80,0xbef13f22,0xbdc93e95,0x3f62bf46,0x3f7fbf75
.long 0x3f0ebe48,0x3f7bbf55,0xbf0e3e48,0xbf7b3f55,0x3f7fbf62,0x3e95bf46,0x3dc93ef1,0x3f75bf22
.long 0x3ec4bf6d,0xbf6d3ec4,0x3ec4bf6d,0xbf6d3ec4,0xbf22be95,0xbef13f7f,0xbf463f75,0x3f62bdc9
.long 0xbf7b3f0e,0x3f553e48,0x3f7bbf0e,0xbf55be48,0xbe953f7f,0x3f22bf62,0xbf75bdc9,0x3f463ef1
.long 0x3f353f35,0xbf35bf35,0x3f353f35,0xbf35bf35,0x3f75bdc9,0xbf463ef1,0xbe95bf7f,0x3f223f62
.long 0x3e48bf55,0x3f0e3f7b,0xbe483f55,0xbf0ebf7b,0xbf46bf75,0x3f623dc9,0x3f22be95,0x3ef13f7f
.long 0xbf6dbec4,0xbec4bf6d,0xbf6dbec4,0xbec4bf6d,0xbdc93ef1,0xbf75bf22,0x3f7f3f62,0x3e953f46
.long 0x3f553f7b,0x3e483f0e,0xbf55bf7b,0xbe48bf0e,0x3f623f46,0x3f7f3f75,0x3ef13f22,0x3dc93e95
.long 0x0,0x0,0x0,0x0,0xbe95bdc9,0xbf22bef1,0xbf75bf7f,0xbf46bf62
.long 0x3f0e3e48,0x3f7b3f55,0xbf0ebe48,0xbf7bbf55,0xbf46be95,0xbf62bf7f,0x3f223f75,0xbef13dc9
.long 0x3f6d3ec4,0x3ec43f6d,0x3f6d3ec4,0x3ec43f6d,0xbf7fbef1,0x3e95bf22,0xbdc9bf62,0x3f753f46
.long 0x3f7b3f0e,0xbf553e48,0xbf7bbf0e,0x3f55be48,0xbf62bf22,0x3f7f3e95,0xbef13f46,0x3dc9bf75
.long 0x3f353f35,0xbf35bf35,0x3f353f35,0xbf35bf35,0xbef1bf46,0x3dc93f75,0x3f62bf22,0xbf7f3e95
.long 0x3e483f55,0x3f0ebf7b,0xbe48bf55,0xbf0e3f7b,0x3dc9bf62,0xbf753f46,0xbf7f3ef1,0x3e953f22
.long 0xbec43f6d,0x3f6dbec4,0xbec43f6d,0x3f6dbec4,0x3f22bf75,0xbef1bdc9,0x3f46be95,0x3f62bf7f
.long 0xbf553f7b,0xbe483f0e,0x3f55bf7b,0x3e48bf0e,0x3f75bf7f,0x3f46bf62,0xbe953dc9,0xbf223ef1
.long 0xbf803f80,0xbf803f80,0xbf803f80,0xbf803f80,0x3f75bf7f,0x3f46bf62,0xbe953dc9,0xbf223ef1
.long 0xbf553f7b,0xbe483f0e,0x3f55bf7b,0x3e48bf0e,0x3f22bf75,0xbef1bdc9,0x3f46be95,0x3f62bf7f
.long 0xbec43f6d,0x3f6dbec4,0xbec43f6d,0x3f6dbec4,0x3dc9bf62,0xbf753f46,0xbf7f3ef1,0x3e953f22
.long 0x3e483f55,0x3f0ebf7b,0xbe48bf55,0xbf0e3f7b,0xbef1bf46,0x3dc93f75,0x3f62bf22,0xbf7f3e95
.long 0x3f353f35,0xbf35bf35,0x3f353f35,0xbf35bf35,0xbf62bf22,0x3f7f3e95,0xbef13f46,0x3dc9bf75
.long 0x3f7b3f0e,0xbf553e48,0xbf7bbf0e,0x3f55be48,0xbf7fbef1,0x3e95bf22,0xbdc9bf62,0x3f753f46
.long 0x3f6d3ec4,0x3ec43f6d,0x3f6d3ec4,0x3ec43f6d,0xbf46be95,0xbf62bf7f,0x3f223f75,0xbef13dc9
.long 0x3f0e3e48,0x3f7b3f55,0xbf0ebe48,0xbf7bbf55,0xbe95bdc9,0xbf22bef1,0xbf75bf7f,0xbf46bf62
.long 0x0,0x0,0x0,0x0,0xbf62bf46,0xbf7fbf75,0xbef1bf22,0xbdc9be95
.long 0x3f553f7b,0x3e483f0e,0xbf55bf7b,0xbe48bf0e,0x3dc9bef1,0x3f753f22,0xbf7fbf62,0xbe95bf46
.long 0xbf6dbec4,0xbec4bf6d,0xbf6dbec4,0xbec4bf6d,0x3f463f75,0xbf62bdc9,0xbf223e95,0xbef1bf7f
.long 0x3e48bf55,0x3f0e3f7b,0xbe483f55,0xbf0ebf7b,0xbf753dc9,0x3f46bef1,0x3e953f7f,0xbf22bf62
.long 0x3f353f35,0xbf35bf35,0x3f353f35,0xbf35bf35,0x3e95bf7f,0xbf223f62,0x3f753dc9,0xbf46bef1
.long 0xbf7b3f0e,0x3f553e48,0x3f7bbf0e,0xbf55be48,0x3f223e95,0x3ef1bf7f,0x3f46bf75,0xbf623dc9
.long 0x3ec4bf6d,0xbf6d3ec4,0x3ec4bf6d,0xbf6d3ec4,0xbf7f3f62,0xbe953f46,0xbdc9bef1,0xbf753f22
.long 0x3f0ebe48,0x3f7bbf55,0xbf0e3e48,0xbf7b3f55,0x3ef1bf22,0x3dc9be95,0xbf623f46,0xbf7f3f75
.long 0xbf803f80,0xbf803f80,0xbf803f80,0xbf803f80,0x3ef1bf22,0x3dc9be95,0xbf623f46,0xbf7f3f75
.long 0x3f0ebe48,0x3f7bbf55,0xbf0e3e48,0xbf7b3f55,0xbf7f3f62,0xbe953f46,0xbdc9bef1,0xbf753f22
.long 0x3ec4bf6d,0xbf6d3ec4,0x3ec4bf6d,0xbf6d3ec4,0x3f223e95,0x3ef1bf7f,0x3f46bf75,0xbf623dc9
.long 0xbf7b3f0e,0x3f553e48,0x3f7bbf0e,0xbf55be48,0x3e95bf7f,0xbf223f62,0x3f753dc9,0xbf46bef1
.long 0x3f353f35,0xbf35bf35,0x3f353f35,0xbf35bf35,0xbf753dc9,0x3f46bef1,0x3e953f7f,0xbf22bf62
.long 0x3e48bf55,0x3f0e3f7b,0xbe483f55,0xbf0ebf7b,0x3f463f75,0xbf62bdc9,0xbf223e95,0xbef1bf7f
.long 0xbf6dbec4,0xbec4bf6d,0xbf6dbec4,0xbec4bf6d,0x3dc9bef1,0x3f753f22,0xbf7fbf62,0xbe95bf46
.long 0x3f553f7b,0x3e483f0e,0xbf55bf7b,0xbe48bf0e,0xbf62bf46,0xbf7fbf75,0xbef1bf22,0xbdc9be95
.long 0x3f803f80,0x3f803f80,0x3f803f80,0x3f803f80,0x3f7b3f80,0x3f553f6d,0xbf7bbf80,0xbf55bf6d
.long 0x3f6d3f80,0x3ec43f35,0x3f6d3f80,0x3ec43f35,0x3f553f80,0xbe483ec4,0xbf55bf80,0x3e48bec4
.long 0x3f353f80,0xbf350000,0x3f353f80,0xbf350000,0x3f0e3f80,0xbf7bbec4,0xbf0ebf80,0x3f7b3ec4
.long 0x3ec43f80,0xbf6dbf35,0x3ec43f80,0xbf6dbf35,0x3e483f80,0xbf0ebf6d,0xbe48bf80,0x3f0e3f6d
.long 0x3f80,0xbf80,0x3f80,0xbf80,0xbe483f80,0x3f0ebf6d,0x3e48bf80,0xbf0e3f6d
.long 0xbec43f80,0x3f6dbf35,0xbec43f80,0x3f6dbf35,0xbf0e3f80,0x3f7bbec4,0x3f0ebf80,0xbf7b3ec4
.long 0xbf353f80,0x3f350000,0xbf353f80,0x3f350000,0xbf553f80,0x3e483ec4,0x3f55bf80,0xbe48bec4
.long 0xbf6d3f80,0xbec43f35,0xbf6d3f80,0xbec43f35,0xbf7b3f80,0xbf553f6d,0x3f7bbf80,0x3f55bf6d
.long 0x3f803f80,0x3f803f80,0x3f803f80,0x3f803f80,0x3f0e3f35,0x3e483ec4,0xbf0ebf35,0xbe48bec4
.long 0xbec40000,0xbf6dbf35,0xbec40000,0xbf6dbf35,0xbf7bbf35,0xbf0ebf6d,0x3f7b3f35,0x3f0e3f6d
.long 0xbf35bf80,0x3f350000,0xbf35bf80,0x3f350000,0x3e48bf35,0x3f553f6d,0xbe483f35,0xbf55bf6d
.long 0x3f6d0000,0xbec43f35,0x3f6d0000,0xbec43f35,0x3f553f35,0xbf7bbec4,0xbf55bf35,0x3f7b3ec4
.long 0x3f80,0xbf80,0x3f80,0xbf80,0xbf553f35,0x3f7bbec4,0x3f55bf35,0xbf7b3ec4
.long 0xbf6d0000,0x3ec43f35,0xbf6d0000,0x3ec43f35,0xbe48bf35,0xbf553f6d,0x3e483f35,0x3f55bf6d
.long 0x3f35bf80,0xbf350000,0x3f35bf80,0xbf350000,0x3f7bbf35,0x3f0ebf6d,0xbf7b3f35,0xbf0e3f6d
.long 0x3ec40000,0x3f6dbf35,0x3ec40000,0x3f6dbf35,0xbf0e3f35,0xbe483ec4,0x3f0ebf35,0x3e48bec4
.long 0x3f803f80,0x3f803f80,0x3f803f80,0x3f803f80,0xbe480000,0xbf0ebec4,0x3e480000,0x3f0e3ec4
.long 0xbf6dbf80,0xbec4bf35,0xbf6dbf80,0xbec4bf35,0x3f0e0000,0x3f7b3f6d,0xbf0e0000,0xbf7bbf6d
.long 0x3f353f80,0xbf350000,0x3f353f80,0xbf350000,0xbf550000,0xbe48bf6d,0x3f550000,0x3e483f6d
.long 0xbec4bf80,0x3f6d3f35,0xbec4bf80,0x3f6d3f35,0x3f7b0000,0xbf553ec4,0xbf7b0000,0x3f55bec4
.long 0x3f80,0xbf80,0x3f80,0xbf80,0xbf7b0000,0x3f553ec4,0x3f7b0000,0xbf55bec4
.long 0x3ec4bf80,0xbf6d3f35,0x3ec4bf80,0xbf6d3f35,0x3f550000,0x3e48bf6d,0xbf550000,0xbe483f6d
.long 0xbf353f80,0x3f350000,0xbf353f80,0x3f350000,0xbf0e0000,0xbf7b3f6d,0x3f0e0000,0x3f7bbf6d
.long 0x3f6dbf80,0x3ec4bf35,0x3f6dbf80,0x3ec4bf35,0x3e480000,0x3f0ebec4,0xbe480000,0xbf0e3ec4
.long 0x3f803f80,0x3f803f80,0x3f803f80,0x3f803f80,0xbf55bf35,0xbf7bbf6d,0x3f553f35,0x3f7b3f6d
.long 0x3ec40000,0x3f6d3f35,0x3ec40000,0x3f6d3f35,0x3e483f35,0xbf55bec4,0xbe48bf35,0x3f553ec4
.long 0xbf35bf80,0x3f350000,0xbf35bf80,0x3f350000,0x3f7b3f35,0xbf0e3ec4,0xbf7bbf35,0x3f0ebec4
.long 0xbf6d0000,0x3ec4bf35,0xbf6d0000,0x3ec4bf35,0x3f0ebf35,0xbe483f6d,0xbf0e3f35,0x3e48bf6d
.long 0x3f80,0xbf80,0x3f80,0xbf80,0xbf0ebf35,0x3e483f6d,0x3f0e3f35,0xbe48bf6d
.long 0x3f6d0000,0xbec4bf35,0x3f6d0000,0xbec4bf35,0xbf7b3f35,0x3f0e3ec4,0x3f7bbf35,0xbf0ebec4
.long 0x3f35bf80,0xbf350000,0x3f35bf80,0xbf350000,0xbe483f35,0x3f55bec4,0x3e48bf35,0xbf553ec4
.long 0xbec40000,0xbf6d3f35,0xbec40000,0xbf6d3f35,0x3f55bf35,0x3f7bbf6d,0xbf553f35,0xbf7b3f6d
.long 0xbf803f80,0xbf803f80,0xbf803f80,0xbf803f80,0xbf7b3f80,0xbf553f6d,0x3f7bbf80,0x3f55bf6d
.long 0xbf6d3f80,0xbec43f35,0xbf6d3f80,0xbec43f35,0xbf553f80,0x3e483ec4,0x3f55bf80,0xbe48bec4
.long 0xbf353f80,0x3f350000,0xbf353f80,0x3f350000,0xbf0e3f80,0x3f7bbec4,0x3f0ebf80,0xbf7b3ec4
.long 0xbec43f80,0x3f6dbf35,0xbec43f80,0x3f6dbf35,0xbe483f80,0x3f0ebf6d,0x3e48bf80,0xbf0e3f6d
.long 0x3f80,0xbf80,0x3f80,0xbf80,0x3e483f80,0xbf0ebf6d,0xbe48bf80,0x3f0e3f6d
.long 0x3ec43f80,0xbf6dbf35,0x3ec43f80,0xbf6dbf35,0x3f0e3f80,0xbf7bbec4,0xbf0ebf80,0x3f7b3ec4
.long 0x3f353f80,0xbf350000,0x3f353f80,0xbf350000,0x3f553f80,0xbe483ec4,0xbf55bf80,0x3e48bec4
.long 0x3f6d3f80,0x3ec43f35,0x3f6d3f80,0x3ec43f35,0x3f7b3f80,0x3f553f6d,0xbf7bbf80,0xbf55bf6d
.long 0xbf803f80,0xbf803f80,0xbf803f80,0xbf803f80,0xbf0e3f35,0xbe483ec4,0x3f0ebf35,0x3e48bec4
.long 0x3ec40000,0x3f6dbf35,0x3ec40000,0x3f6dbf35,0x3f7bbf35,0x3f0ebf6d,0xbf7b3f35,0xbf0e3f6d
.long 0x3f35bf80,0xbf350000,0x3f35bf80,0xbf350000,0xbe48bf35,0xbf553f6d,0x3e483f35,0x3f55bf6d
.long 0xbf6d0000,0x3ec43f35,0xbf6d0000,0x3ec43f35,0xbf553f35,0x3f7bbec4,0x3f55bf35,0xbf7b3ec4
.long 0x3f80,0xbf80,0x3f80,0xbf80,0x3f553f35,0xbf7bbec4,0xbf55bf35,0x3f7b3ec4
.long 0x3f6d0000,0xbec43f35,0x3f6d0000,0xbec43f35,0x3e48bf35,0x3f553f6d,0xbe483f35,0xbf55bf6d
.long 0xbf35bf80,0x3f350000,0xbf35bf80,0x3f350000,0xbf7bbf35,0xbf0ebf6d,0x3f7b3f35,0x3f0e3f6d
.long 0xbec40000,0xbf6dbf35,0xbec40000,0xbf6dbf35,0x3f0e3f35,0x3e483ec4,0xbf0ebf35,0xbe48bec4
.long 0xbf803f80,0xbf803f80,0xbf803f80,0xbf803f80,0x3e480000,0x3f0ebec4,0xbe480000,0xbf0e3ec4
.long 0x3f6dbf80,0x3ec4bf35,0x3f6dbf80,0x3ec4bf35,0xbf0e0000,0xbf7b3f6d,0x3f0e0000,0x3f7bbf6d
.long 0xbf353f80,0x3f350000,0xbf353f80,0x3f350000,0x3f550000,0x3e48bf6d,0xbf550000,0xbe483f6d
.long 0x3ec4bf80,0xbf6d3f35,0x3ec4bf80,0xbf6d3f35,0xbf7b0000,0x3f553ec4,0x3f7b0000,0xbf55bec4
.long 0x3f80,0xbf80,0x3f80,0xbf80,0x3f7b0000,0xbf553ec4,0xbf7b0000,0x3f55bec4
.long 0xbec4bf80,0x3f6d3f35,0xbec4bf80,0x3f6d3f35,0xbf550000,0xbe48bf6d,0x3f550000,0x3e483f6d
.long 0x3f353f80,0xbf350000,0x3f353f80,0xbf350000,0x3f0e0000,0x3f7b3f6d,0xbf0e0000,0xbf7bbf6d
.long 0xbf6dbf80,0xbec4bf35,0xbf6dbf80,0xbec4bf35,0xbe480000,0xbf0ebec4,0x3e480000,0x3f0e3ec4
.long 0xbf803f80,0xbf803f80,0xbf803f80,0xbf803f80,0x3f55bf35,0x3f7bbf6d,0xbf553f35,0xbf7b3f6d
.long 0xbec40000,0xbf6d3f35,0xbec40000,0xbf6d3f35,0xbe483f35,0x3f55bec4,0x3e48bf35,0xbf553ec4
.long 0x3f35bf80,0xbf350000,0x3f35bf80,0xbf350000,0xbf7b3f35,0x3f0e3ec4,0x3f7bbf35,0xbf0ebec4
.long 0x3f6d0000,0xbec4bf35,0x3f6d0000,0xbec4bf35,0xbf0ebf35,0x3e483f6d,0x3f0e3f35,0xbe48bf6d
.long 0x3f80,0xbf80,0x3f80,0xbf80,0x3f0ebf35,0xbe483f6d,0xbf0e3f35,0x3e48bf6d
.long 0xbf6d0000,0x3ec4bf35,0xbf6d0000,0x3ec4bf35,0x3f7b3f35,0xbf0e3ec4,0xbf7bbf35,0x3f0ebec4
.long 0xbf35bf80,0x3f350000,0xbf35bf80,0x3f350000,0x3e483f35,0xbf55bec4,0xbe48bf35,0x3f553ec4
.long 0x3ec40000,0x3f6d3f35,0x3ec40000,0x3f6d3f35,0xbf55bf35,0xbf7bbf6d,0x3f553f35,0x3f7b3f6d
.long 0x0,0x0,0x0,0x0,0x3e480000,0x3f0e3ec4,0xbe480000,0xbf0ebec4
.long 0x3ec40000,0x3f6d3f35,0x3ec40000,0x3f6d3f35,0x3f0e0000,0x3f7b3f6d,0xbf0e0000,0xbf7bbf6d
.long 0x3f350000,0x3f353f80,0x3f350000,0x3f353f80,0x3f550000,0x3e483f6d,0xbf550000,0xbe48bf6d
.long 0x3f6d0000,0xbec43f35,0x3f6d0000,0xbec43f35,0x3f7b0000,0xbf553ec4,0xbf7b0000,0x3f55bec4
.long 0x3f800000,0xbf800000,0x3f800000,0xbf800000,0x3f7b0000,0xbf55bec4,0xbf7b0000,0x3f553ec4
.long 0x3f6d0000,0xbec4bf35,0x3f6d0000,0xbec4bf35,0x3f550000,0x3e48bf6d,0xbf550000,0xbe483f6d
.long 0x3f350000,0x3f35bf80,0x3f350000,0x3f35bf80,0x3f0e0000,0x3f7bbf6d,0xbf0e0000,0xbf7b3f6d
.long 0x3ec40000,0x3f6dbf35,0x3ec40000,0x3f6dbf35,0x3e480000,0x3f0ebec4,0xbe480000,0xbf0e3ec4
.long 0x0,0x0,0x0,0x0,0x3f553f35,0x3f7b3f6d,0xbf55bf35,0xbf7bbf6d
.long 0x3f6d3f80,0x3ec43f35,0x3f6d3f80,0x3ec43f35,0x3e483f35,0xbf55bec4,0xbe48bf35,0x3f553ec4
.long 0xbf350000,0xbf35bf80,0xbf350000,0xbf35bf80,0xbf7bbf35,0x3f0ebec4,0x3f7b3f35,0xbf0e3ec4
.long 0xbec4bf80,0x3f6d3f35,0xbec4bf80,0x3f6d3f35,0x3f0ebf35,0xbe483f6d,0xbf0e3f35,0x3e48bf6d
.long 0x3f800000,0xbf800000,0x3f800000,0xbf800000,0x3f0e3f35,0xbe48bf6d,0xbf0ebf35,0x3e483f6d
.long 0xbec43f80,0x3f6dbf35,0xbec43f80,0x3f6dbf35,0xbf7b3f35,0x3f0e3ec4,0x3f7bbf35,0xbf0ebec4
.long 0xbf350000,0xbf353f80,0xbf350000,0xbf353f80,0x3e48bf35,0xbf553ec4,0xbe483f35,0x3f55bec4
.long 0x3f6dbf80,0x3ec4bf35,0x3f6dbf80,0x3ec4bf35,0x3f55bf35,0x3f7bbf6d,0xbf553f35,0xbf7b3f6d
.long 0x0,0x0,0x0,0x0,0x3f7b3f80,0x3f553f6d,0xbf7bbf80,0xbf55bf6d
.long 0xbec40000,0xbf6dbf35,0xbec40000,0xbf6dbf35,0xbf55bf80,0x3e48bec4,0x3f553f80,0xbe483ec4
.long 0x3f350000,0x3f353f80,0x3f350000,0x3f353f80,0x3f0e3f80,0xbf7bbec4,0xbf0ebf80,0x3f7b3ec4
.long 0xbf6d0000,0x3ec4bf35,0xbf6d0000,0x3ec4bf35,0xbe48bf80,0x3f0e3f6d,0x3e483f80,0xbf0ebf6d
.long 0x3f800000,0xbf800000,0x3f800000,0xbf800000,0xbe483f80,0x3f0ebf6d,0x3e48bf80,0xbf0e3f6d
.long 0xbf6d0000,0x3ec43f35,0xbf6d0000,0x3ec43f35,0x3f0ebf80,0xbf7b3ec4,0xbf0e3f80,0x3f7bbec4
.long 0x3f350000,0x3f35bf80,0x3f350000,0x3f35bf80,0xbf553f80,0x3e483ec4,0x3f55bf80,0xbe48bec4
.long 0xbec40000,0xbf6d3f35,0xbec40000,0xbf6d3f35,0x3f7bbf80,0x3f55bf6d,0xbf7b3f80,0xbf553f6d
.long 0x0,0x0,0x0,0x0,0x3f0e3f35,0x3e483ec4,0xbf0ebf35,0xbe48bec4
.long 0xbf6dbf80,0xbec4bf35,0xbf6dbf80,0xbec4bf35,0x3f7b3f35,0x3f0e3f6d,0xbf7bbf35,0xbf0ebf6d
.long 0xbf350000,0xbf35bf80,0xbf350000,0xbf35bf80,0x3e48bf35,0x3f553f6d,0xbe483f35,0xbf55bf6d
.long 0x3ec43f80,0xbf6dbf35,0x3ec43f80,0xbf6dbf35,0xbf55bf35,0x3f7b3ec4,0x3f553f35,0xbf7bbec4
.long 0x3f800000,0xbf800000,0x3f800000,0xbf800000,0xbf553f35,0x3f7bbec4,0x3f55bf35,0xbf7b3ec4
.long 0x3ec4bf80,0xbf6d3f35,0x3ec4bf80,0xbf6d3f35,0x3e483f35,0x3f55bf6d,0xbe48bf35,0xbf553f6d
.long 0xbf350000,0xbf353f80,0xbf350000,0xbf353f80,0x3f7bbf35,0x3f0ebf6d,0xbf7b3f35,0xbf0e3f6d
.long 0xbf6d3f80,0xbec43f35,0xbf6d3f80,0xbec43f35,0x3f0ebf35,0x3e48bec4,0xbf0e3f35,0xbe483ec4
.long 0x0,0x0,0x0,0x0,0xbe480000,0xbf0e3ec4,0x3e480000,0x3f0ebec4
.long 0xbec40000,0xbf6d3f35,0xbec40000,0xbf6d3f35,0xbf0e0000,0xbf7b3f6d,0x3f0e0000,0x3f7bbf6d
.long 0xbf350000,0xbf353f80,0xbf350000,0xbf353f80,0xbf550000,0xbe483f6d,0x3f550000,0x3e48bf6d
.long 0xbf6d0000,0x3ec43f35,0xbf6d0000,0x3ec43f35,0xbf7b0000,0x3f553ec4,0x3f7b0000,0xbf55bec4
.long 0xbf800000,0x3f800000,0xbf800000,0x3f800000,0xbf7b0000,0x3f55bec4,0x3f7b0000,0xbf553ec4
.long 0xbf6d0000,0x3ec4bf35,0xbf6d0000,0x3ec4bf35,0xbf550000,0xbe48bf6d,0x3f550000,0x3e483f6d
.long 0xbf350000,0xbf35bf80,0xbf350000,0xbf35bf80,0xbf0e0000,0xbf7bbf6d,0x3f0e0000,0x3f7b3f6d
.long 0xbec40000,0xbf6dbf35,0xbec40000,0xbf6dbf35,0xbe480000,0xbf0ebec4,0x3e480000,0x3f0e3ec4
.long 0x0,0x0,0x0,0x0,0xbf553f35,0xbf7b3f6d,0x3f55bf35,0x3f7bbf6d
.long 0xbf6d3f80,0xbec43f35,0xbf6d3f80,0xbec43f35,0xbe483f35,0x3f55bec4,0x3e48bf35,0xbf553ec4
.long 0x3f350000,0x3f35bf80,0x3f350000,0x3f35bf80,0x3f7bbf35,0xbf0ebec4,0xbf7b3f35,0x3f0e3ec4
.long 0x3ec4bf80,0xbf6d3f35,0x3ec4bf80,0xbf6d3f35,0xbf0ebf35,0x3e483f6d,0x3f0e3f35,0xbe48bf6d
.long 0xbf800000,0x3f800000,0xbf800000,0x3f800000,0xbf0e3f35,0x3e48bf6d,0x3f0ebf35,0xbe483f6d
.long 0x3ec43f80,0xbf6dbf35,0x3ec43f80,0xbf6dbf35,0x3f7b3f35,0xbf0e3ec4,0xbf7bbf35,0x3f0ebec4
.long 0x3f350000,0x3f353f80,0x3f350000,0x3f353f80,0xbe48bf35,0x3f553ec4,0x3e483f35,0xbf55bec4
.long 0xbf6dbf80,0xbec4bf35,0xbf6dbf80,0xbec4bf35,0xbf55bf35,0xbf7bbf6d,0x3f553f35,0x3f7b3f6d
.long 0x0,0x0,0x0,0x0,0xbf7b3f80,0xbf553f6d,0x3f7bbf80,0x3f55bf6d
.long 0x3ec40000,0x3f6dbf35,0x3ec40000,0x3f6dbf35,0x3f55bf80,0xbe48bec4,0xbf553f80,0x3e483ec4
.long 0xbf350000,0xbf353f80,0xbf350000,0xbf353f80,0xbf0e3f80,0x3f7bbec4,0x3f0ebf80,0xbf7b3ec4
.long 0x3f6d0000,0xbec4bf35,0x3f6d0000,0xbec4bf35,0x3e48bf80,0xbf0e3f6d,0xbe483f80,0x3f0ebf6d
.long 0xbf800000,0x3f800000,0xbf800000,0x3f800000,0x3e483f80,0xbf0ebf6d,0xbe48bf80,0x3f0e3f6d
.long 0x3f6d0000,0xbec43f35,0x3f6d0000,0xbec43f35,0xbf0ebf80,0x3f7b3ec4,0x3f0e3f80,0xbf7bbec4
.long 0xbf350000,0xbf35bf80,0xbf350000,0xbf35bf80,0x3f553f80,0xbe483ec4,0xbf55bf80,0x3e48bec4
.long 0x3ec40000,0x3f6d3f35,0x3ec40000,0x3f6d3f35,0xbf7bbf80,0xbf55bf6d,0x3f7b3f80,0x3f553f6d
.long 0x0,0x0,0x0,0x0,0xbf0e3f35,0xbe483ec4,0x3f0ebf35,0x3e48bec4
.long 0x3f6dbf80,0x3ec4bf35,0x3f6dbf80,0x3ec4bf35,0xbf7b3f35,0xbf0e3f6d,0x3f7bbf35,0x3f0ebf6d
.long 0x3f350000,0x3f35bf80,0x3f350000,0x3f35bf80,0xbe48bf35,0xbf553f6d,0x3e483f35,0x3f55bf6d
.long 0xbec43f80,0x3f6dbf35,0xbec43f80,0x3f6dbf35,0x3f55bf35,0xbf7b3ec4,0xbf553f35,0x3f7bbec4
.long 0xbf800000,0x3f800000,0xbf800000,0x3f800000,0x3f553f35,0xbf7bbec4,0xbf55bf35,0x3f7b3ec4
.long 0xbec4bf80,0x3f6d3f35,0xbec4bf80,0x3f6d3f35,0xbe483f35,0xbf55bf6d,0x3e48bf35,0x3f553f6d
.long 0x3f350000,0x3f353f80,0x3f350000,0x3f353f80,0xbf7bbf35,0xbf0ebf6d,0x3f7b3f35,0x3f0e3f6d
.long 0x3f6d3f80,0x3ec43f35,0x3f6d3f80,0x3ec43f35,0xbf0ebf35,0xbe48bec4,0x3f0e3f35,0x3e483ec4
.long 0x3f800000,0x0,0x3f800000,0x0,0x3f800000,0x0,0x3f800000,0x0
.long 0x3f800000,0x0,0x3f800000,0x0,0x3f800000,0x0,0x3f800000,0x0
.long 0x3f800000,0x0,0x3f800000,0x0,0x3f800000,0x0,0x3f800000,0x0
.long 0x3f800000,0x0,0x3f800000,0x0,0x3f800000,0x0,0x3f800000,0x0
.long 0x3f800000,0x0,0x3f800000,0x0,0x3f800000,0x0,0x3f800000,0x0
.long 0x3f800000,0x0,0x3f800000,0x0,0x3f800000,0x0,0x3f800000,0x0
.long 0x3f800000,0x0,0x3f800000,0x0,0x3f800000,0x0,0x3f800000,0x0
.long 0x3f800000,0x0,0x3f800000,0x0,0x3f800000,0x0,0x3f800000,0x0
.long 0x3f800000,0x0,0x3f7c1c5c,0x3e31d0d4,0x3f7ffc1a,0x3c32b7da,0x3f7b9c62,0x3e3cce2b
.long 0x3f7ff067,0x3cb2b521,0x3f7b14be,0x3e47c5c2,0x3f7fdce9,0x3d060472,0x3f7a8575,0x3e52b743
.long 0x3f7fc1a0,0x3d32aa3e,0x3f79ee89,0x3e5da259,0x3f7f9e8c,0x3d5f4a99,0x3f795000,0x3e6886ae
.long 0x3f7f73af,0x3d85f213,0x3f78a9e0,0x3e7363ee,0x3f7f4109,0x3d9c3ac6,0x3f77fc2c,0x3e7e39c4
.long 0x3f7f069e,0x3db27eb6,0x3f7746ea,0x3e8483ee,0x3f7ec46d,0x3dc8bd36,0x3f768a20,0x3e89e6f1
.long 0x3f7e7a7a,0x3ddef599,0x3f75c5d4,0x3e8f45c0,0x3f7e28c6,0x3df52731,0x3f74fa0b,0x3e94a031
.long 0x3f7dcf55,0x3e05a8a8,0x3f7426cb,0x3e99f61c,0x3f7d6e28,0x3e10b9a6,0x3f734c1c,0x3e9f4757
.long 0x3f7d0543,0x3e1bc63c,0x3f726a03,0x3ea493b7,0x3f7c94a8,0x3e26ce12,0x3f718088,0x3ea9db13
.long 0x3f800000,0x0,0x3f708fb2,0x3eaf1d44,0x3f7ff067,0x3cb2b521,0x3f6e9811,0x3eb9917b
.long 0x3f7fc1a0,0x3d32aa3e,0x3f6c835e,0x3ec3ef15,0x3f7f73af,0x3d85f213,0x3f6a51da,0x3ece34d0
.long 0x3f7f069e,0x3db27eb6,0x3f6803ca,0x3ed8616c,0x3f7e7a7a,0x3ddef599,0x3f659974,0x3ee273aa
.long 0x3f7dcf55,0x3e05a8a8,0x3f631324,0x3eec6a50,0x3f7d0543,0x3e1bc63c,0x3f60712a,0x3ef64429
.long 0x3f7c1c5c,0x3e31d0d4,0x3f5db3d7,0x3f000000,0x3f7b14be,0x3e47c5c2,0x3f5adb81,0x3f04ce53
.long 0x3f79ee89,0x3e5da259,0x3f57e880,0x3f098c78,0x3f78a9e0,0x3e7363ee,0x3f54db31,0x3f0e39da
.long 0x3f7746ea,0x3e8483ee,0x3f51b3f3,0x3f12d5e8,0x3f75c5d4,0x3e8f45c0,0x3f4e7327,0x3f176012
.long 0x3f7426cb,0x3e99f61c,0x3f4b1934,0x3f1bd7ca,0x3f726a03,0x3ea493b7,0x3f47a682,0x3f203c85
.long 0x3f800000,0x0,0x3f5db3d7,0x3f000000,0x3f7fdce9,0x3d060472,0x3f596550,0x3f072f74
.long 0x3f7f73af,0x3d85f213,0x3f54db31,0x3f0e39da,0x3f7ec46d,0x3dc8bd36,0x3f5016b8,0x3f151d42
.long 0x3f7dcf55,0x3e05a8a8,0x3f4b1934,0x3f1bd7ca,0x3f7c94a8,0x3e26ce12,0x3f45e403,0x3f226799
.long 0x3f7b14be,0x3e47c5c2,0x3f407893,0x3f28cae3,0x3f795000,0x3e6886ae,0x3f3ad85f,0x3f2effe8
.long 0x3f7746ea,0x3e8483ee,0x3f3504f3,0x3f3504f3,0x3f74fa0b,0x3e94a031,0x3f2effe8,0x3f3ad85f
.long 0x3f726a03,0x3ea493b7,0x3f28cae3,0x3f407893,0x3f6f9788,0x3eb45a1e,0x3f226799,0x3f45e403
.long 0x3f6c835e,0x3ec3ef15,0x3f1bd7ca,0x3f4b1934,0x3f692e5f,0x3ed34e56,0x3f151d42,0x3f5016b8
.long 0x3f659974,0x3ee273aa,0x3f0e39da,0x3f54db31,0x3f61c598,0x3ef15aea,0x3f072f74,0x3f596550
.long 0x3f800000,0x0,0x3f441b7d,0x3f248dbb,0x3f7fc1a0,0x3d32aa3e,0x3f3cbe35,0x3f2cf37b
.long 0x3f7f069e,0x3db27eb6,0x3f3504f3,0x3f3504f3,0x3f7dcf55,0x3e05a8a8,0x3f2cf37b,0x3f3cbe35
.long 0x3f7c1c5c,0x3e31d0d4,0x3f248dbb,0x3f441b7d,0x3f79ee89,0x3e5da259,0x3f1bd7ca,0x3f4b1934
.long 0x3f7746ea,0x3e8483ee,0x3f12d5e8,0x3f51b3f3,0x3f7426cb,0x3e99f61c,0x3f098c78,0x3f57e880
.long 0x3f708fb2,0x3eaf1d44,0x3f000000,0x3f5db3d7,0x3f6c835e,0x3ec3ef15,0x3eec6a50,0x3f631324
.long 0x3f6803ca,0x3ed8616c,0x3ed8616c,0x3f6803ca,0x3f631324,0x3eec6a50,0x3ec3ef15,0x3f6c835e
.long 0x3f5db3d7,0x3f000000,0x3eaf1d44,0x3f708fb2,0x3f57e880,0x3f098c78,0x3e99f61c,0x3f7426cb
.long 0x3f51b3f3,0x3f12d5e8,0x3e8483ee,0x3f7746ea,0x3f4b1934,0x3f1bd7ca,0x3e5da259,0x3f79ee89
.long 0x3f800000,0x0,0x3f248dbb,0x3f441b7d,0x3f7f9e8c,0x3d5f4a99,0x3f199e45,0x3f4cc94c
.long 0x3f7e7a7a,0x3ddef599,0x3f0e39da,0x3f54db31,0x3f7c94a8,0x3e26ce12,0x3f026926,0x3f5c4b07
.long 0x3f79ee89,0x3e5da259,0x3eec6a50,0x3f631324,0x3f768a20,0x3e89e6f1,0x3ed34e56,0x3f692e5f
.long 0x3f726a03,0x3ea493b7,0x3eb9917b,0x3f6e9811,0x3f6d9156,0x3ebec330,0x3e9f4757,0x3f734c1c
.long 0x3f6803ca,0x3ed8616c,0x3e8483ee,0x3f7746ea,0x3f61c598,0x3ef15aea,0x3e52b743,0x3f7a8575
.long 0x3f5adb81,0x3f04ce53,0x3e1bc63c,0x3f7d0543,0x3f534aca,0x3f108a14,0x3dc8bd36,0x3f7ec46d
.long 0x3f4b1934,0x3f1bd7ca,0x3d32aa3e,0x3f7fc1a0,0x3f424cfe,0x3f26aed9,0xbc32b7da,0x3f7ffc1a
.long 0x3f38ecd8,0x3f310700,0xbd85f213,0x3f7f73af,0x3f2effe8,0x3f3ad85f,0xbdf52731,0x3f7e28c6
.long 0x3f800000,0x0,0x3f000000,0x3f5db3d7,0x3f7f73af,0x3d85f213,0x3ee273aa,0x3f659974
.long 0x3f7dcf55,0x3e05a8a8,0x3ec3ef15,0x3f6c835e,0x3f7b14be,0x3e47c5c2,0x3ea493b7,0x3f726a03
.long 0x3f7746ea,0x3e8483ee,0x3e8483ee,0x3f7746ea,0x3f726a03,0x3ea493b7,0x3e47c5c2,0x3f7b14be
.long 0x3f6c835e,0x3ec3ef15,0x3e05a8a8,0x3f7dcf55,0x3f659974,0x3ee273aa,0x3d85f213,0x3f7f73af
.long 0x3f5db3d7,0x3f000000,0x0,0x3f800000,0x3f54db31,0x3f0e39da,0xbd85f213,0x3f7f73af
.long 0x3f4b1934,0x3f1bd7ca,0xbe05a8a8,0x3f7dcf55,0x3f407893,0x3f28cae3,0xbe47c5c2,0x3f7b14be
.long 0x3f3504f3,0x3f3504f3,0xbe8483ee,0x3f7746ea,0x3f28cae3,0x3f407893,0xbea493b7,0x3f726a03
.long 0x3f1bd7ca,0x3f4b1934,0xbec3ef15,0x3f6c835e,0x3f0e39da,0x3f54db31,0xbee273aa,0x3f659974
.long 0x3f800000,0x0,0x3eaf1d44,0x3f708fb2,0x3f7f4109,0x3d9c3ac6,0x3e89e6f1,0x3f768a20
.long 0x3f7d0543,0x3e1bc63c,0x3e47c5c2,0x3f7b14be,0x3f795000,0x3e6886ae,0x3df52731,0x3f7e28c6
.long 0x3f7426cb,0x3e99f61c,0x3d32aa3e,0x3f7fc1a0,0x3f6d9156,0x3ebec330,0xbd060472,0x3f7fdce9
.long 0x3f659974,0x3ee273aa,0xbddef599,0x3f7e7a7a,0x3f5c4b07,0x3f026926,0xbe3cce2b,0x3f7b9c62
.long 0x3f51b3f3,0x3f12d5e8,0xbe8483ee,0x3f7746ea,0x3f45e403,0x3f226799,0xbea9db13,0x3f718088
.long 0x3f38ecd8,0x3f310700,0xbece34d0,0x3f6a51da,0x3f2ae1c9,0x3f3e9e4b,0xbef15aea,0x3f61c598
.long 0x3f1bd7ca,0x3f4b1934,0xbf098c78,0x3f57e880,0x3f0be54a,0x3f56651d,0xbf199e45,0x3f4cc94c
.long 0x3ef64429,0x3f60712a,0xbf28cae3,0x3f407893,0x3ed34e56,0x3f692e5f,0xbf36fbaf,0x3f3308b4
.long 0x3f800000,0x0,0x3e31d0d4,0x3f7c1c5c,0x3f7f069e,0x3db27eb6,0x3db27eb6,0x3f7f069e
.long 0x3f7c1c5c,0x3e31d0d4,0x0,0x3f800000,0x3f7746ea,0x3e8483ee,0xbdb27eb6,0x3f7f069e
.long 0x3f708fb2,0x3eaf1d44,0xbe31d0d4,0x3f7c1c5c,0x3f6803ca,0x3ed8616c,0xbe8483ee,0x3f7746ea
.long 0x3f5db3d7,0x3f000000,0xbeaf1d44,0x3f708fb2,0x3f51b3f3,0x3f12d5e8,0xbed8616c,0x3f6803ca
.long 0x3f441b7d,0x3f248dbb,0xbf000000,0x3f5db3d7,0x3f3504f3,0x3f3504f3,0xbf12d5e8,0x3f51b3f3
.long 0x3f248dbb,0x3f441b7d,0xbf248dbb,0x3f441b7d,0x3f12d5e8,0x3f51b3f3,0xbf3504f3,0x3f3504f3
.long 0x3f000000,0x3f5db3d7,0xbf441b7d,0x3f248dbb,0x3ed8616c,0x3f6803ca,0xbf51b3f3,0x3f12d5e8
.long 0x3eaf1d44,0x3f708fb2,0xbf5db3d7,0x3f000000,0x3e8483ee,0x3f7746ea,0xbf6803ca,0x3ed8616c
.long 0x3f800000,0x0,0x0,0x3f800000,0x3f7ec46d,0x3dc8bd36,0xbdc8bd36,0x3f7ec46d
.long 0x3f7b14be,0x3e47c5c2,0xbe47c5c2,0x3f7b14be,0x3f74fa0b,0x3e94a031,0xbe94a031,0x3f74fa0b
.long 0x3f6c835e,0x3ec3ef15,0xbec3ef15,0x3f6c835e,0x3f61c598,0x3ef15aea,0xbef15aea,0x3f61c598
.long 0x3f54db31,0x3f0e39da,0xbf0e39da,0x3f54db31,0x3f45e403,0x3f226799,0xbf226799,0x3f45e403
.long 0x3f3504f3,0x3f3504f3,0xbf3504f3,0x3f3504f3,0x3f226799,0x3f45e403,0xbf45e403,0x3f226799
.long 0x3f0e39da,0x3f54db31,0xbf54db31,0x3f0e39da,0x3ef15aea,0x3f61c598,0xbf61c598,0x3ef15aea
.long 0x3ec3ef15,0x3f6c835e,0xbf6c835e,0x3ec3ef15,0x3e94a031,0x3f74fa0b,0xbf74fa0b,0x3e94a031
.long 0x3e47c5c2,0x3f7b14be,0xbf7b14be,0x3e47c5c2,0x3dc8bd36,0x3f7ec46d,0xbf7ec46d,0x3dc8bd36
.long 0x3f800000,0x0,0xbe31d0d4,0x3f7c1c5c,0x3f7e7a7a,0x3ddef599,0xbe8f45c0,0x3f75c5d4
.long 0x3f79ee89,0x3e5da259,0xbec3ef15,0x3f6c835e,0x3f726a03,0x3ea493b7,0xbef64429,0x3f60712a
.long 0x3f6803ca,0x3ed8616c,0xbf12d5e8,0x3f51b3f3,0x3f5adb81,0x3f04ce53,0xbf28cae3,0x3f407893
.long 0x3f4b1934,0x3f1bd7ca,0xbf3cbe35,0x3f2cf37b,0x3f38ecd8,0x3f310700,0xbf4e7327,0x3f176012
.long 0x3f248dbb,0x3f441b7d,0xbf5db3d7,0x3f000000,0x3f0e39da,0x3f54db31,0xbf6a51da,0x3ece34d0
.long 0x3eec6a50,0x3f631324,0xbf7426cb,0x3e99f61c,0x3eb9917b,0x3f6e9811,0xbf7b14be,0x3e47c5c2
.long 0x3e8483ee,0x3f7746ea,0xbf7f069e,0x3db27eb6,0x3e1bc63c,0x3f7d0543,0xbf7ff067,0xbcb2b521
.long 0x3d32aa3e,0x3f7fc1a0,0xbf7dcf55,0xbe05a8a8,0xbd85f213,0x3f7f73af,0xbf78a9e0,0xbe7363ee
.long 0x3f800000,0x0,0xbeaf1d44,0x3f708fb2,0x3f7e28c6,0x3df52731,0xbee77284,0x3f6459c6
.long 0x3f78a9e0,0x3e7363ee,0xbf0e39da,0x3f54db31,0x3f6f9788,0x3eb45a1e,0xbf26aed9,0x3f424cfe
.long 0x3f631324,0x3eec6a50,0xbf3cbe35,0x3f2cf37b,0x3f534aca,0x3f108a14,0xbf5016b8,0x3f151d42
.long 0x3f407893,0x3f28cae3,0xbf60712a,0x3ef64429,0x3f2ae1c9,0x3f3e9e4b,0xbf6d9156,0x3ebec330
.long 0x3f12d5e8,0x3f51b3f3,0xbf7746ea,0x3e8483ee,0x3ef15aea,0x3f61c598,0xbf7d6e28,0x3e10b9a6
.long 0x3eb9917b,0x3f6e9811,0xbf7ff067,0x3cb2b521,0x3e7e39c4,0x3f77fc2c,0xbf7ec46d,0xbdc8bd36
.long 0x3e05a8a8,0x3f7dcf55,0xbf79ee89,0xbe5da259,0x3c32b7da,0x3f7ffc1a,0xbf718088,0xbea9db13
.long 0xbddef599,0x3f7e7a7a,0xbf659974,0xbee273aa,0xbe6886ae,0x3f795000,0xbf56651d,0xbf0be54a
.long 0x80003f80,0x80003f80,0x80003f80,0x0,0x80003f80,0xbf7c3e32,0xbeafbf71,0x0
.long 0x80003f80,0xbeafbf71,0x3f253f44,0x0,0x80003f80,0x3f5ebf00,0xbf5ebf00,0x0
.long 0x80003f80,0x3f253f44,0x3f7c3e32,0x0,0x80003f80,0xbf253f44,0xbf7c3e32,0x0
.long 0x80003f80,0xbf5ebf00,0x3f5ebf00,0x0,0x80003f80,0x3eafbf71,0xbf253f44,0x0
.long 0x80003f80,0x3f7c3e32,0x3eafbf71,0x0,0x80003f80,0x80003f80,0x80003f80,0x0
.long 0x80003f80,0xbf7c3e32,0xbeafbf71,0x0,0x80003f80,0xbeafbf71,0x3f253f44,0x0
.long 0x80003f80,0x3f5ebf00,0xbf5ebf00,0x0,0x80003f80,0x3f253f44,0x3f7c3e32,0x0
.long 0x80003f80,0xbf253f44,0xbf7c3e32,0x0,0x80003f80,0xbf5ebf00,0x3f5ebf00,0x0
.long 0x80003f80,0x80003f80,0x80003f80,0x0,0xbeaf3f71,0xbf7cbe32,0x8000bf80,0x0
.long 0xbf253f44,0x3eafbf71,0x80003f80,0x0,0xbf5e3f00,0x3f5e3f00,0x8000bf80,0x0
.long 0xbf7c3e32,0xbf253f44,0x80003f80,0x0,0xbf7cbe32,0xbf25bf44,0x8000bf80,0x0
.long 0xbf5ebf00,0x3f5ebf00,0x80003f80,0x0,0xbf25bf44,0x3eaf3f71,0x8000bf80,0x0
.long 0xbeafbf71,0xbf7c3e32,0x80003f80,0x0,0x8000bf80,0x8000bf80,0x8000bf80,0x0
.long 0x3eafbf71,0x3f7c3e32,0x80003f80,0x0,0x3f25bf44,0xbeaf3f71,0x8000bf80,0x0
.long 0x3f5ebf00,0xbf5ebf00,0x80003f80,0x0,0x3f7cbe32,0x3f25bf44,0x8000bf80,0x0
.long 0x3f7c3e32,0x3f253f44,0x80003f80,0x0,0x3f5e3f00,0xbf5e3f00,0x8000bf80,0x0
.long 0x80003f80,0x80003f80,0x0,0x0,0xbf253f44,0xbf5ebf00,0x0,0x0
.long 0xbf7c3e32,0x3f5ebf00,0x0,0x0,0xbf5ebf00,0x80003f80,0x0,0x0
.long 0xbeafbf71,0xbf5ebf00,0x0,0x0,0x3eafbf71,0x3f5ebf00,0x0,0x0
.long 0x3f5ebf00,0x80003f80,0x0,0x0,0x3f7c3e32,0xbf5ebf00,0x0,0x0
.long 0x3f253f44,0x3f5ebf00,0x0,0x0,0x80003f80,0x80003f80,0x0,0x0
.long 0xbf253f44,0xbf5ebf00,0x0,0x0,0xbf7c3e32,0x3f5ebf00,0x0,0x0
.long 0xbf5ebf00,0x80003f80,0x0,0x0,0xbeafbf71,0xbf5ebf00,0x0,0x0
.long 0x3eafbf71,0x3f5ebf00,0x0,0x0,0x3f5ebf00,0x80003f80,0x0,0x0
.long 0x80003f80,0x80003f80,0x0,0x0,0xbf5e3f00,0xbf25bf44,0x0,0x0
.long 0xbf5ebf00,0x3f7c3e32,0x0,0x0,0x8000bf80,0xbf5e3f00,0x0,0x0
.long 0x3f5ebf00,0x3eafbf71,0x0,0x0,0x3f5e3f00,0x3eaf3f71,0x0,0x0
.long 0x80003f80,0xbf5ebf00,0x0,0x0,0xbf5e3f00,0x3f7cbe32,0x0,0x0
.long 0xbf5ebf00,0xbf253f44,0x0,0x0,0x8000bf80,0x8000bf80,0x0,0x0
.long 0x3f5ebf00,0x3f253f44,0x0,0x0,0x3f5e3f00,0xbf7cbe32,0x0,0x0
.long 0x80003f80,0x3f5ebf00,0x0,0x0,0xbf5e3f00,0xbeaf3f71,0x0,0x0
.long 0xbf5ebf00,0xbeafbf71,0x0,0x0,0x8000bf80,0x3f5e3f00,0x0,0x0
.long 0x80003f80,0x3eafbf71,0xbf253f44,0x0,0x80003f80,0x3f7c3e32,0x3eafbf71,0x0
.long 0x0,0x0,0x0,0x0,0x0,0x0,0x0,0x0
.long 0x0,0x0,0x0,0x0,0x0,0x0,0x0,0x0
.long 0x0,0x0,0x0,0x0,0x0,0x0,0x0,0x0
.long 0x0,0x0,0x0,0x0,0x0,0x0,0x0,0x0
.long 0x0,0x0,0x0,0x0,0x0,0x0,0x0,0x0
.long 0x0,0x0,0x0,0x0,0x0,0x0,0x0,0x0
.long 0x0,0x0,0x0,0x0,0x0,0x0,0x0,0x0
.long 0x3f253f44,0xbeafbf71,0x80003f80,0x0,0x3eaf3f71,0x3f7cbe32,0x8000bf80,0x0
.long 0x0,0x0,0x0,0x0,0x0,0x0,0x0,0x0
.long 0x0,0x0,0x0,0x0,0x0,0x0,0x0,0x0
.long 0x0,0x0,0x0,0x0,0x0,0x0,0x0,0x0
.long 0x0,0x0,0x0,0x0,0x0,0x0,0x0,0x0
.long 0x0,0x0,0x0,0x0,0x0,0x0,0x0,0x0
.long 0x0,0x0,0x0,0x0,0x0,0x0,0x0,0x0
.long 0x0,0x0,0x0,0x0,0x0,0x0,0x0,0x0
.long 0x3f7c3e32,0xbf5ebf00,0x0,0x0,0x3f253f44,0x3f5ebf00,0x0,0x0
.long 0x0,0x0,0x0,0x0,0x0,0x0,0x0,0x0
.long 0x0,0x0,0x0,0x0,0x0,0x0,0x0,0x0
.long 0x0,0x0,0x0,0x0,0x0,0x0,0x0,0x0
.long 0x0,0x0,0x0,0x0,0x0,0x0,0x0,0x0
.long 0x0,0x0,0x0,0x0,0x0,0x0,0x0,0x0
.long 0x0,0x0,0x0,0x0,0x0,0x0,0x0,0x0
.long 0x0,0x0,0x0,0x0,0x0,0x0,0x0,0x0
.long 0x3f5ebf00,0xbf7c3e32,0x0,0x0,0x3f5e3f00,0x3f25bf44,0x0,0x0
.long 0x0,0x0,0x0,0x0,0x0,0x0,0x0,0x0
.long 0x0,0x0,0x0,0x0,0x0,0x0,0x0,0x0
.long 0x0,0x0,0x0,0x0,0x0,0x0,0x0,0x0
.long 0x0,0x0,0x0,0x0,0x0,0x0,0x0,0x0
.long 0x0,0x0,0x0,0x0,0x0,0x0,0x0,0x0
.long 0x0,0x0,0x0,0x0,0x0,0x0,0x0,0x0
.long 0x0,0x0,0x0,0x0,0x0,0x0,0x0,0x0
.long 0x0,0x0,0x0,0x0,0x0,0x0,0x0,0x0
.long 0x80003f80,0x3eafbf71,0xbf253f44,0x0,0x80003f80,0x3f7c3e32,0x3eafbf71,0x0
.long 0x0,0x0,0x0,0x0,0x0,0x0,0x0,0x0
.long 0x0,0x0,0x0,0x0,0x0,0x0,0x0,0x0
.long 0x0,0x0,0x0,0x0,0x0,0x0,0x0,0x0
.long 0x0,0x0,0x0,0x0,0x0,0x0,0x0,0x0
.long 0x0,0x0,0x0,0x0,0x0,0x0,0x0,0x0
.long 0x0,0x0,0x0,0x0,0x0,0x0,0x0,0x0
.long 0x0,0x0,0x0,0x0,0x0,0x0,0x0,0x0
.long 0x3f253f44,0xbeafbf71,0x80003f80,0x0,0x3eaf3f71,0x3f7cbe32,0x8000bf80,0x0
.long 0x0,0x0,0x0,0x0,0x0,0x0,0x0,0x0
.long 0x0,0x0,0x0,0x0,0x0,0x0,0x0,0x0
.long 0x0,0x0,0x0,0x0,0x0,0x0,0x0,0x0
.long 0x0,0x0,0x0,0x0,0x0,0x0,0x0,0x0
.long 0x0,0x0,0x0,0x0,0x0,0x0,0x0,0x0
.long 0x0,0x0,0x0,0x0,0x0,0x0,0x0,0x0
.long 0x0,0x0,0x0,0x0,0x0,0x0,0x0,0x0
.long 0x3f7c3e32,0xbf5ebf00,0x0,0x0,0x3f253f44,0x3f5ebf00,0x0,0x0
.long 0x0,0x0,0x0,0x0,0x0,0x0,0x0,0x0
.long 0x0,0x0,0x0,0x0,0x0,0x0,0x0,0x0
.long 0x0,0x0,0x0,0x0,0x0,0x0,0x0,0x0
.long 0x0,0x0,0x0,0x0,0x0,0x0,0x0,0x0
.long 0x0,0x0,0x0,0x0,0x0,0x0,0x0,0x0
.long 0x0,0x0,0x0,0x0,0x0,0x0,0x0,0x0
.long 0x0,0x0,0x0,0x0,0x0,0x0,0x0,0x0
.long 0x3f5ebf00,0xbf7c3e32,0x0,0x0,0x3f5e3f00,0x3f25bf44,0x0,0x0
.long 0x0,0x0,0x0,0x0,0x0,0x0,0x0,0x0
.long 0x0,0x0,0x0,0x0,0x0,0x0,0x0,0x0
.long 0x0,0x0,0x0,0x0,0x0,0x0,0x0,0x0
.long 0x0,0x0,0x0,0x0,0x0,0x0,0x0,0x0
.long 0x0,0x0,0x0,0x0,0x0,0x0,0x0,0x0
.long 0x0,0x0,0x0,0x0,0x0,0x0,0x0,0x0
.long 0x0,0x0,0x0,0x0,0x0,0x0,0x0,0x0
.long 0x0,0x0,0x0,0x0,0x0,0x0,0x0,0x0
.long 0x80003f80,0x3eafbf71,0xbf253f44,0x0,0x80003f80,0x3f7c3e32,0x3eafbf71,0x0
.long 0x0,0x0,0x0,0x0,0x0,0x0,0x0,0x0
.long 0x0,0x0,0x0,0x0,0x0,0x0,0x0,0x0
.long 0x0,0x0,0x0,0x0,0x0,0x0,0x0,0x0
.long 0x0,0x0,0x0,0x0,0x0,0x0,0x0,0x0
.long 0x0,0x0,0x0,0x0,0x0,0x0,0x0,0x0
.long 0x0,0x0,0x0,0x0,0x0,0x0,0x0,0x0
.long 0x0,0x0,0x0,0x0,0x0,0x0,0x0,0x0
.long 0x3f253f44,0xbeafbf71,0x80003f80,0x0,0x3eaf3f71,0x3f7cbe32,0x8000bf80,0x0
.long 0x0,0x0,0x0,0x0,0x0,0x0,0x0,0x0
.long 0x0,0x0,0x0,0x0,0x0,0x0,0x0,0x0
.long 0x0,0x0,0x0,0x0,0x0,0x0,0x0,0x0
.long 0x0,0x0,0x0,0x0,0x0,0x0,0x0,0x0
.long 0x0,0x0,0x0,0x0,0x0,0x0,0x0,0x0
.long 0x0,0x0,0x0,0x0,0x0,0x0,0x0,0x0
.long 0x0,0x0,0x0,0x0,0x0,0x0,0x0,0x0
.long 0x3f7c3e32,0xbf5ebf00,0x0,0x0,0x3f253f44,0x3f5ebf00,0x0,0x0
.long 0x0,0x0,0x0,0x0,0x0,0x0,0x0,0x0
.long 0x0,0x0,0x0,0x0,0x0,0x0,0x0,0x0
.long 0x0,0x0,0x0,0x0,0x0,0x0,0x0,0x0
.long 0x0,0x0,0x0,0x0,0x0,0x0,0x0,0x0
.long 0x0,0x0,0x0,0x0,0x0,0x0,0x0,0x0
.long 0x0,0x0,0x0,0x0,0x0,0x0,0x0,0x0
.long 0x0,0x0,0x0,0x0,0x0,0x0,0x0,0x0
.long 0x3f5ebf00,0xbf7c3e32,0x0,0x0,0x3f5e3f00,0x3f25bf44,0x0,0x0
.long 0x0,0x0,0x0,0x0,0x0,0x0,0x0,0x0
.long 0x0,0x0,0x0,0x0,0x0,0x0,0x0,0x0
.long 0x0,0x0,0x0,0x0,0x0,0x0,0x0,0x0
.long 0x0,0x0,0x0,0x0,0x0,0x0,0x0,0x0
.long 0x0,0x0,0x0,0x0,0x0,0x0,0x0,0x0
.long 0x0,0x0,0x0,0x0,0x0,0x0,0x0,0x0
.long 0x0,0x0,0x0,0x0,0x0,0x0,0x0,0x0
.long 0x0,0x0,0x0,0x0,0x0,0x0,0x0,0x0
.long 0x80003f80,0x3eafbf71,0xbf253f44,0x0,0x80003f80,0x3f7c3e32,0x3eafbf71,0x0
.long 0x0,0x0,0x0,0x0,0x0,0x0,0x0,0x0
.long 0x0,0x0,0x0,0x0,0x0,0x0,0x0,0x0
.long 0x0,0x0,0x0,0x0,0x0,0x0,0x0,0x0
.long 0x0,0x0,0x0,0x0,0x0,0x0,0x0,0x0
.long 0x0,0x0,0x0,0x0,0x0,0x0,0x0,0x0
.long 0x0,0x0,0x0,0x0,0x0,0x0,0x0,0x0
.long 0x0,0x0,0x0,0x0,0x0,0x0,0x0,0x0
.long 0x3f253f44,0xbeafbf71,0x80003f80,0x0,0x3eaf3f71,0x3f7cbe32,0x8000bf80,0x0
.long 0x0,0x0,0x0,0x0,0x0,0x0,0x0,0x0
.long 0x0,0x0,0x0,0x0,0x0,0x0,0x0,0x0
.long 0x0,0x0,0x0,0x0,0x0,0x0,0x0,0x0
.long 0x0,0x0,0x0,0x0,0x0,0x0,0x0,0x0
.long 0x0,0x0,0x0,0x0,0x0,0x0,0x0,0x0
.long 0x0,0x0,0x0,0x0,0x0,0x0,0x0,0x0
.long 0x0,0x0,0x0,0x0,0x0,0x0,0x0,0x0
.long 0x3f7c3e32,0xbf5ebf00,0x0,0x0,0x3f253f44,0x3f5ebf00,0x0,0x0
.long 0x0,0x0,0x0,0x0,0x0,0x0,0x0,0x0
.long 0x0,0x0,0x0,0x0,0x0,0x0,0x0,0x0
.long 0x0,0x0,0x0,0x0,0x0,0x0,0x0,0x0
.long 0x0,0x0,0x0,0x0,0x0,0x0,0x0,0x0
.long 0x0,0x0,0x0,0x0,0x0,0x0,0x0,0x0
.long 0x0,0x0,0x0,0x0,0x0,0x0,0x0,0x0
.long 0x0,0x0,0x0,0x0,0x0,0x0,0x0,0x0
.long 0x3f5ebf00,0xbf7c3e32,0x0,0x0,0x3f5e3f00,0x3f25bf44,0x0,0x0
.long 0x0,0x0,0x0,0x0,0x0,0x0,0x0,0x0
.long 0x0,0x0,0x0,0x0,0x0,0x0,0x0,0x0
.long 0x0,0x0,0x0,0x0,0x0,0x0,0x0,0x0
.long 0x0,0x0,0x0,0x0,0x0,0x0,0x0,0x0
.size tabs, 38912
tabs_end:
.section .rodata,"a"
.p2align 6
.amdhsa_kernel k0_kernel
  .amdhsa_next_free_vgpr 244
  .amdhsa_next_free_sgpr 62
  .amdhsa_accum_offset 244
  .amdhsa_group_segment_fixed_size 0
  .amdhsa_kernarg_size 96
  .amdhsa_user_sgpr_count 2
  .amdhsa_user_sgpr_kernarg_segment_ptr 1
  .amdhsa_system_sgpr_workgroup_id_x 1
  .amdhsa_float_denorm_mode_32 3
.end_amdhsa_kernel
.p2align 6
.amdhsa_kernel k2_kernel
  .amdhsa_next_free_vgpr 252
  .amdhsa_next_free_sgpr 56
  .amdhsa_accum_offset 228
  .amdhsa_group_segment_fixed_size 0
  .amdhsa_kernarg_size 96
  .amdhsa_user_sgpr_count 2
  .amdhsa_user_sgpr_kernarg_segment_ptr 1
  .amdhsa_system_sgpr_workgroup_id_x 1
  .amdhsa_float_denorm_mode_32 3
.end_amdhsa_kernel
.p2align 6
.amdhsa_kernel k4_kernel
  .amdhsa_next_free_vgpr 512
  .amdhsa_next_free_sgpr 91
  .amdhsa_accum_offset 256
  .amdhsa_group_segment_fixed_size 0
  .amdhsa_kernarg_size 96
  .amdhsa_user_sgpr_count 2
  .amdhsa_user_sgpr_kernarg_segment_ptr 1
  .amdhsa_system_sgpr_workgroup_id_x 1
  .amdhsa_float_denorm_mode_32 3
.end_amdhsa_kernel
```
